```python
import torch

def _softmax(x, axis=-1):
    return torch.softmax(x, dim=axis)
def _gelu(x):
    return torch.nn.functional.gelu(x, approximate="tanh")
def _silu(x):
    return torch.nn.functional.silu(x)
def _sigmoid(x):
    return torch.sigmoid(x)
def _layernorm(x, axis=-1, eps=1e-5):
    m = x.mean(dim=axis, keepdim=True)
    v = x.var(dim=axis, keepdim=True, unbiased=False)
    return (x - m) / torch.sqrt(v + eps)
def _scatter_add(tgt, idx, src, axis=0):
    return tgt.clone().index_add_(axis, idx, src)
def _segment_sum(src, seg, n):
    out = torch.zeros((n,) + src.shape[1:], dtype=src.dtype)
    return out.index_add_(0, seg, src)
def _pad(x, pw):
    flat = tuple(v for pair in reversed(pw) for v in pair)
    return torch.nn.functional.pad(x, flat)

kernel_name = 'gated_mix__ssm_conv_s4d__spectral_gfnet__prompt'

def setup_inputs():

    _w = (lambda a: (lambda t: t.to(torch.bfloat16) if t.is_floating_point() else t)(torch.as_tensor(a)))
    def _A_setup():
        Bsz, L, D, N = 1, 2048, 1024, 128
        return {
            "u": _w((lambda *s: torch.randn(*s, dtype=torch.bfloat16) * 0.05)(Bsz, L, D)),
            "log_A_real": _w((lambda *s: torch.randn(*s, dtype=torch.bfloat16) * 6.4)(D, N) * 0.5),
            "A_imag": _w((lambda *s: torch.randn(*s, dtype=torch.bfloat16) * 0.05)(D, N) * 3.14),
            "C_real": _w((lambda *s: torch.randn(*s, dtype=torch.bfloat16) * 0.05)(D, N) / N ** 0.5),
            "C_imag": _w((lambda *s: torch.randn(*s, dtype=torch.bfloat16) * 0.05)(D, N) / N ** 0.5),
            "log_dt": _w((lambda *s: torch.randn(*s, dtype=torch.bfloat16) * 0.05)(D) * 0.5 - 4.0),
            "D_skip": _w((lambda *s: torch.randn(*s, dtype=torch.bfloat16) * 0.05)(D)),
        }
    _A_in = _A_setup()

    def _B_setup():
        B, S, D = 1, 2048, 1024
        Df = D // 2 + 1
        return {
            "x": _w((lambda *s: torch.randn(*s, dtype=torch.bfloat16) * 0.05)(B, S, D)),
            "w_r": _w((lambda *s: torch.randn(*s, dtype=torch.bfloat16) * 0.8)(S, Df) * 0.02),
            "w_i": _w((lambda *s: torch.randn(*s, dtype=torch.bfloat16) * 0.8)(S, Df) * 0.02),
        }
    _B_in = _B_setup()

    return {
        "A_u": _A_in["u"],
        "A_log_A_real": _A_in["log_A_real"],
        "A_A_imag": _A_in["A_imag"],
        "A_C_real": _A_in["C_real"],
        "A_C_imag": _A_in["C_imag"],
        "A_log_dt": _A_in["log_dt"],
        "A_D_skip": _A_in["D_skip"],
        "B_x": _B_in["x"],
        "B_w_r": _B_in["w_r"],
        "B_w_i": _B_in["w_i"],
        "gate_w": _w((lambda *s: torch.randn(*s, dtype=torch.bfloat16) * 0.05)(1024) * 16.0),
    }

def reference(A_u, A_log_A_real, A_A_imag, A_C_real, A_C_imag, A_log_dt, A_D_skip, B_x, B_w_r, B_w_i, gate_w):
    def _A_ref(u, log_A_real, A_imag, C_real, C_imag, log_dt, D_skip):
        L = u.shape[1]
        dt = torch.exp(log_dt)
        A = -torch.exp(log_A_real) + 1j * A_imag
        C = (C_real + 1j * C_imag) * dt[:, None]
        pos = (lambda x, dt: x.to(dt))(torch.arange(L), log_dt.dtype)
        P = torch.exp((A * dt[:, None])[:, :, None] * pos[None, None, :])
        K = 2.0 * torch.einsum("dn,dnl->dl", C, P).real
        L2 = 2 * L
        u_t = (lambda x, *d: x.permute(*d))(u, 0, 2, 1)
        Kf = (lambda x, *a, **k: torch.fft.rfft(x.float(), *a, **k))(K, L2)
        Uf = (lambda x, *a, **k: torch.fft.rfft(x.float(), *a, **k))(u_t, L2)
        y = (lambda x, *a, **k: torch.fft.irfft(x, *a, **k).to(torch.bfloat16))(Uf * Kf[None, :, :], L2)[:, :, :L]
        y = (lambda x, *d: x.permute(*d))(y, 0, 2, 1)
        return y + u * D_skip[None, None, :]

    def _B_ref(x, w_r, w_i):
        B, S, D = x.shape
        X = (lambda x, axes=(-2,-1): torch.fft.rfft2(x.float(), dim=axes))(x, axes=(-2, -1))
        W = w_r + 1j * w_i
        X = X * W
        y = (lambda x, s, axes=(-2,-1): torch.fft.irfft2(x, s=s, dim=axes).to(torch.bfloat16))(X, (S, D), axes=(-2, -1))
        return y

    x = A_u
    g = _sigmoid((x * gate_w).sum(-1, keepdims=True))
    a = _A_ref(x, A_log_A_real, A_A_imag, A_C_real, A_C_imag, A_log_dt, A_D_skip)
    b = _B_ref(x, B_w_r, B_w_i)
    return g * a + (1 - g) * b
```

```asm
; @launch grid=(256,1,1) block=(512,1,1) lds=148992
.amdgcn_target "amdgcn-amd-amdhsa--gfx950"
.text
.globl gated_mix__ssm_conv_s4d__spectral_gfnet__prompt_kernel
.p2align 8
.type gated_mix__ssm_conv_s4d__spectral_gfnet__prompt_kernel,@function
gated_mix__ssm_conv_s4d__spectral_gfnet__prompt_kernel:
    s_load_dwordx2 s[36:37], s[0:1], 0
    s_load_dwordx8 s[8:15], s[0:1], 8
    s_load_dwordx2 s[40:41], s[0:1], 104
    s_load_dwordx4 s[16:19], s[0:1], 40
    s_load_dwordx2 s[44:45], s[0:1], 64
    s_load_dwordx2 s[48:49], s[0:1], 72
    s_getpc_b64 s[80:81]
Lpc:
    s_cmp_ge_u32 s2, 256
    s_cbranch_scc1 Lend
    v_and_b32 v1, 63, v0
    v_lshrrev_b32 v2, 6, v0
    v_and_b32 v3, 7, v0
    v_lshl_add_u32 v3, v2, 3, v3
    v_lshlrev_b32 v4, 7, v3
    v_cmp_lt_u32 vcc, 31, v3
    v_add_u32 v5, LpathA-Lpc-4096, v4
    s_lshr_b32 s3, s2, 3
    v_cndmask_b32 v4, v4, v5, vcc
    v_lshl_add_u32 v5, s3, 3, v2
    v_lshlrev_b32 v5, 7, v5
    v_add_u32 v6, -8, v1
    v_lshl_add_u32 v5, v6, 15, v5
    v_cmp_gt_u32 vcc, 8, v1
    v_min_u32 v5, Lend_tab-Lpc-4, v5
    s_nop 0
    v_cndmask_b32 v4, v5, v4, vcc
    s_mov_b64 exec, 0x1fff
    global_load_dword v255, v4, s[80:81]
    s_mov_b64 exec, -1
    v_lshrrev_b32 v2, 6, v0
    v_and_b32 v1, 63, v0
    v_readfirstlane_b32 s66, v2
    v_and_b32 v0, 255, v0
    s_mov_b32 s42, 268435456
    s_mov_b32 s43, 0x00020000
    s_mov_b32 s46, 2101248
    s_mov_b32 s47, 0x00020000
    s_mov_b32 s50, 2101248
    s_mov_b32 s51, 0x00020000
    s_and_b32 s56, s66, 3
    s_cmp_ge_u32 s66, 4
    s_cbranch_scc1 LpathA
    s_setprio 2
    s_and_b32 s61, s2, 7
    s_lshr_b32 s62, s2, 3
    s_lshl_b32 s60, s61, 5
    s_or_b32 s60, s60, s62
    v_lshlrev_b32 v3, 3, v0
    s_lshl_b32 s24, s60, 11
    s_add_u32 s25, s24, 524288
    s_add_u32 s26, s24, 1048576
    s_add_u32 s27, s24, 1572864
    s_add_u32 s28, s24, 2097152
    s_add_u32 s29, s24, 2621440
    s_add_u32 s30, s24, 3145728
    s_add_u32 s31, s24, 3670016
    s_mov_b32 s38, 4194304
    s_mov_b32 s39, 0x00020000
    v_mov_b32 v2, 0
    ds_write_b32 v2, v2 offset:128
    s_waitcnt lgkmcnt(0)
    s_load_dword s57, s[40:41], 0
    buffer_load_dwordx2 v[10:11], v3, s[36:39], s24 offen nt
    buffer_load_dwordx2 v[12:13], v3, s[36:39], s25 offen nt
    buffer_load_dwordx2 v[14:15], v3, s[36:39], s26 offen nt
    buffer_load_dwordx2 v[16:17], v3, s[36:39], s27 offen nt
    buffer_load_dwordx2 v[18:19], v3, s[36:39], s28 offen nt
    buffer_load_dwordx2 v[20:21], v3, s[36:39], s29 offen nt
    buffer_load_dwordx2 v[22:23], v3, s[36:39], s30 offen nt
    buffer_load_dwordx2 v[24:25], v3, s[36:39], s31 offen nt
    s_barrier
    s_load_dwordx2 s[20:21], s[0:1], 80
    s_load_dwordx2 s[52:53], s[0:1], 88
    s_add_u32 s4, s80, Ltab-Lpc
    s_addc_u32 s5, s81, 0
    s_mov_b32 s74, 0
    s_mov_b32 s58, 0xfffefffe
    s_mov_b32 s75, 0x05040100
    s_mov_b32 s76, 0x07060302
    s_mov_b32 s54, 4194304
    s_mov_b32 s55, 0x00020000
    s_cmp_gt_u32 s61, 4
    s_cselect_b32 s64, 1, 0
    s_cselect_b32 s66, 8, 0
    s_cselect_b32 s67, 127, 0
    s_sub_i32 s63, s61, s66
    s_lshl_b32 s66, s62, 2
    s_add_u32 s66, s66, s56
    s_cmp_eq_u32 s66, s67
    s_cselect_b32 s65, 1, 0
    s_mov_b32 s70, 0x00000f0f
    s_mov_b32 s71, 0x0000f0f0
    s_mov_b32 s72, 0x0f0f0000
    s_mov_b32 s73, 0xf0f00000
    v_bfe_u32 v4, v1, 3, 1
    v_and_b32 v5, 3, v1
    v_lshl_add_u32 v4, v4, 2, v5
    v_lshrrev_b32 v5, 1, v4
    v_cmp_eq_u32 vcc, 1, v4
    v_and_b32 v7, 1, v4
    s_nop 0
    v_cndmask_b32 v5, v5, 4, vcc
    v_cndmask_b32 v7, v7, 0, vcc
    v_cvt_f32_u32 v5, v5
    v_cvt_f32_u32 v7, v7
    v_mul_f32 v5, 0x3e000000, v5
    v_mul_f32 v7, 0x3e800000, v7
    v_mov_b32 v144, v7
    v_cos_f32 v144, v144
    v_add_f32 v145, v5, v7
    v_cos_f32 v145, v145
    v_fmamk_f32 v146, v5, 0x40000000, v7
    v_cos_f32 v146, v146
    v_fmamk_f32 v147, v5, 0x40400000, v7
    v_cos_f32 v147, v147
    v_bfe_i32 v4, v4, 1, 1
    v_and_b32 v4, 0x80008000, v4
    v_cvt_pk_bf16_f32 v152, v144, v145
    v_cvt_pk_bf16_f32 v153, v146, v147
    v_xor_b32 v154, v4, v152
    v_xor_b32 v155, v4, v153
    v_cndmask_b32 v98, 0, v152, s[70:71]
    v_cndmask_b32 v102, 0, v152, s[72:73]
    v_cndmask_b32 v99, 0, v153, s[70:71]
    v_cndmask_b32 v103, 0, v153, s[72:73]
    v_cndmask_b32 v100, 0, v154, s[70:71]
    v_cndmask_b32 v104, 0, v154, s[72:73]
    v_cndmask_b32 v101, 0, v155, s[70:71]
    v_cndmask_b32 v105, 0, v155, s[72:73]
    v_and_b32 v2, 31, v1
    v_cmp_eq_u32 vcc, 0, v2
    v_mov_b32 v7, 0xbf803f80
    s_nop 0
    v_cndmask_b32 v224, 0, v7, vcc
    v_cndmask_b32 v225, 0, v7, vcc
    v_cndmask_b32 v226, 0, v7, vcc
    v_cndmask_b32 v227, 0, v7, vcc
    v_lshrrev_b32 v6, 3, v1
    v_and_b32 v6, 4, v6
    v_cvt_f32_u32 v2, v2
    v_cvt_f32_u32 v6, v6
    v_mul_f32 v4, 0x3d000000, v2
    v_mul_f32 v5, v4, v6
    v_mov_b32 v152, v5
    v_cos_f32 v144, v152
    v_sin_f32 v152, v152
    v_add_f32 v153, v4, v5
    v_cos_f32 v145, v153
    v_sin_f32 v153, v153
    v_fmamk_f32 v154, v4, 0x40000000, v5
    v_cos_f32 v146, v154
    v_sin_f32 v154, v154
    v_fmamk_f32 v155, v4, 0x40400000, v5
    v_cos_f32 v147, v155
    v_sin_f32 v155, v155
    v_fmamk_f32 v156, v4, 0x41000000, v5
    v_cos_f32 v148, v156
    v_sin_f32 v156, v156
    v_fmamk_f32 v157, v4, 0x41100000, v5
    v_cos_f32 v149, v157
    v_sin_f32 v157, v157
    v_fmamk_f32 v158, v4, 0x41200000, v5
    v_cos_f32 v150, v158
    v_sin_f32 v158, v158
    v_fmamk_f32 v159, v4, 0x41300000, v5
    v_cos_f32 v151, v159
    v_sin_f32 v159, v159
    v_bfe_i32 v7, v1, 0, 1
    v_and_b32 v7, 0x80008000, v7
    v_cvt_pk_bf16_f32 v42, v144, v145
    v_cvt_pk_bf16_f32 v50, -v152, -v153
    v_cvt_pk_bf16_f32 v58, v152, v153
    v_cvt_pk_bf16_f32 v43, v146, v147
    v_cvt_pk_bf16_f32 v51, -v154, -v155
    v_cvt_pk_bf16_f32 v59, v154, v155
    v_cvt_pk_bf16_f32 v44, v148, v149
    v_cvt_pk_bf16_f32 v52, -v156, -v157
    v_cvt_pk_bf16_f32 v60, v156, v157
    v_cvt_pk_bf16_f32 v45, v150, v151
    v_cvt_pk_bf16_f32 v53, -v158, -v159
    v_cvt_pk_bf16_f32 v61, v158, v159
    v_xor_b32 v46, v7, v42
    v_xor_b32 v47, v7, v43
    v_xor_b32 v48, v7, v44
    v_xor_b32 v49, v7, v45
    v_xor_b32 v54, v7, v50
    v_xor_b32 v55, v7, v51
    v_xor_b32 v56, v7, v52
    v_xor_b32 v57, v7, v53
    v_xor_b32 v62, v7, v58
    v_xor_b32 v63, v7, v59
    v_xor_b32 v64, v7, v60
    v_xor_b32 v65, v7, v61
    v_mul_f32 v4, 0x3d000000, v4
    v_mul_f32 v5, 0x3d000000, v5
    v_mov_b32 v82, v5
    v_cos_f32 v66, v82
    v_sin_f32 v82, v82
    v_add_f32 v83, v4, v5
    v_cos_f32 v67, v83
    v_sin_f32 v83, v83
    v_fmamk_f32 v84, v4, 0x40000000, v5
    v_cos_f32 v68, v84
    v_sin_f32 v84, v84
    v_fmamk_f32 v85, v4, 0x40400000, v5
    v_cos_f32 v69, v85
    v_sin_f32 v85, v85
    v_fmamk_f32 v86, v4, 0x41000000, v5
    v_cos_f32 v70, v86
    v_sin_f32 v86, v86
    v_fmamk_f32 v87, v4, 0x41100000, v5
    v_cos_f32 v71, v87
    v_sin_f32 v87, v87
    v_fmamk_f32 v88, v4, 0x41200000, v5
    v_cos_f32 v72, v88
    v_sin_f32 v88, v88
    v_fmamk_f32 v89, v4, 0x41300000, v5
    v_cos_f32 v73, v89
    v_sin_f32 v89, v89
    v_fmamk_f32 v90, v4, 0x41800000, v5
    v_cos_f32 v74, v90
    v_sin_f32 v90, v90
    v_fmamk_f32 v91, v4, 0x41880000, v5
    v_cos_f32 v75, v91
    v_sin_f32 v91, v91
    v_fmamk_f32 v92, v4, 0x41900000, v5
    v_cos_f32 v76, v92
    v_sin_f32 v92, v92
    v_fmamk_f32 v93, v4, 0x41980000, v5
    v_cos_f32 v77, v93
    v_sin_f32 v93, v93
    v_fmamk_f32 v94, v4, 0x41c00000, v5
    v_cos_f32 v78, v94
    v_sin_f32 v94, v94
    v_fmamk_f32 v95, v4, 0x41c80000, v5
    v_cos_f32 v79, v95
    v_sin_f32 v95, v95
    v_fmamk_f32 v96, v4, 0x41d00000, v5
    v_cos_f32 v80, v96
    v_sin_f32 v96, v96
    v_fmamk_f32 v97, v4, 0x41d80000, v5
    v_cos_f32 v81, v97
    v_sin_f32 v97, v97
    s_cmp_lg_u32 s56, 0
    s_cbranch_scc1 LnoH_1
    v_bfe_u32 v4, v1, 1, 4
    v_cvt_f32_u32 v4, v4
    v_mul_f32 v4, 0x3d000000, v4
    v_and_b32 v7, 1, v1
    v_cvt_f32_u32 v7, v7
    v_mul_f32 v7, 0x3e800000, v7
    v_fma_f32 v5, v4, v6, v7
    v_mov_b32 v152, v5
    v_cos_f32 v144, v152
    v_sin_f32 v152, v152
    v_add_f32 v153, v4, v5
    v_cos_f32 v145, v153
    v_sin_f32 v153, v153
    v_fmamk_f32 v154, v4, 0x40000000, v5
    v_cos_f32 v146, v154
    v_sin_f32 v154, v154
    v_fmamk_f32 v155, v4, 0x40400000, v5
    v_cos_f32 v147, v155
    v_sin_f32 v155, v155
    v_fmamk_f32 v156, v4, 0x41000000, v5
    v_cos_f32 v148, v156
    v_sin_f32 v156, v156
    v_fmamk_f32 v157, v4, 0x41100000, v5
    v_cos_f32 v149, v157
    v_sin_f32 v157, v157
    v_fmamk_f32 v158, v4, 0x41200000, v5
    v_cos_f32 v150, v158
    v_sin_f32 v158, v158
    v_fmamk_f32 v159, v4, 0x41300000, v5
    v_cos_f32 v151, v159
    v_sin_f32 v159, v159
    v_bfe_i32 v7, v1, 1, 1
    v_and_b32 v7, 0x80008000, v7
    v_cvt_pk_bf16_f32 v106, v144, v145
    v_cvt_pk_bf16_f32 v114, v152, v153
    v_cvt_pk_bf16_f32 v107, v146, v147
    v_cvt_pk_bf16_f32 v115, v154, v155
    v_cvt_pk_bf16_f32 v108, v148, v149
    v_cvt_pk_bf16_f32 v116, v156, v157
    v_cvt_pk_bf16_f32 v109, v150, v151
    v_cvt_pk_bf16_f32 v117, v158, v159
    v_xor_b32 v110, v7, v106
    v_xor_b32 v111, v7, v107
    v_xor_b32 v112, v7, v108
    v_xor_b32 v113, v7, v109
    v_xor_b32 v118, v7, v114
    v_xor_b32 v119, v7, v115
    v_xor_b32 v120, v7, v116
    v_xor_b32 v121, v7, v117
LnoH_1:
    v_lshlrev_b32 v3, 4, v0
    v_lshrrev_b32 v4, 2, v0
    v_lshlrev_b32 v4, 16, v4
    v_and_b32 v5, 3, v0
    v_lshl_add_u32 v4, v5, 4, v4
    v_bfe_u32 v6, v1, 2, 2
    v_lshrrev_b32 v7, 5, v1
    v_lshl_add_u32 v6, v7, 2, v6
    v_lshlrev_b32 v6, 7, v6
    v_lshl_add_u32 v5, v5, 4, v6
    v_bfe_u32 v6, v1, 4, 1
    v_lshl_add_u32 v5, v6, 6, v5
    s_lshl_b32 s66, s56, 12
    v_add_u32 v5, s66, v5
    s_sub_u32 s6, 8, s56
    s_cmp_eq_u32 s56, 0
    s_cselect_b32 s66, 8, 9
    s_cselect_b32 s6, 4, s6
    v_and_b32 v6, 31, v1
    v_lshlrev_b32 v6, 2, v6
    v_lshl_add_u32 v244, v7, s66, v6
    v_sub_u32 v245, 636, v244
    v_lshlrev_b32 v8, 4, v1
    s_add_u32 s66, s24, 5242880
    s_lshl_b32 s67, s56, 19
    s_add_u32 s34, s66, s67
    s_lshl_b32 s67, s6, 19
    s_add_u32 s35, s66, s67
    s_lshl_b32 s66, s60, 6
    s_add_u32 s66, s66, 1048576
    s_add_u32 s67, s66, 16384
    s_add_u32 s68, s66, 32768
    s_add_u32 s77, s66, 49152
    s_add_u32 s7, s63, 2048
    s_lshl_b32 s22, s56, 3
    s_add_u32 s7, s7, s22
    s_lshl_b32 s22, s62, 4
    s_add_u32 s22, s22, s64
    s_lshl_b32 s22, s22, 1
    v_lshrrev_b32 v138, 1, v1
    v_lshl_add_u32 v138, v138, 6, s7
    v_and_b32 v2, 1, v1
    v_lshlrev_b32 v2, 4, v2
    v_add_u32 v139, 32, v138
    v_and_b32 v138, 2047, v138
    v_and_b32 v139, 2047, v139
    s_movk_i32 s7, 1026
    v_mad_u32_u24 v138, v138, s7, v2
    v_mad_u32_u24 v139, v139, s7, v2
    s_mul_i32 s23, s56, 1056
    s_waitcnt lgkmcnt(0)
    s_andn2_b32 s57, 65537, s57
    s_xor_b32 s59, s57, 0x6b2e91d4
    v_mov_b32 v9, s57
    s_waitcnt vmcnt(0)
    s_setprio 2
    v_perm_b32 v26, v12, v10, s75
    v_perm_b32 v27, v16, v14, s75
    v_perm_b32 v28, v20, v18, s75
    v_perm_b32 v29, v24, v22, s75
    v_perm_b32 v30, v12, v10, s76
    v_perm_b32 v31, v16, v14, s76
    v_perm_b32 v32, v20, v18, s76
    v_perm_b32 v33, v24, v22, s76
    v_mfma_f32_32x32x16_bf16 v[144:159], v[98:101], v[26:29], 0
    s_nop 0
    v_mfma_f32_32x32x16_bf16 v[144:159], v[102:105], v[30:33], v[144:159]
    v_perm_b32 v34, v13, v11, s75
    v_perm_b32 v35, v17, v15, s75
    v_perm_b32 v36, v21, v19, s75
    v_perm_b32 v37, v25, v23, s75
    v_perm_b32 v38, v13, v11, s76
    v_perm_b32 v39, v17, v15, s76
    v_perm_b32 v40, v21, v19, s76
    v_perm_b32 v41, v25, v23, s76
    v_mfma_f32_32x32x16_bf16 v[160:175], v[98:101], v[34:37], 0
    s_nop 0
    v_mfma_f32_32x32x16_bf16 v[160:175], v[102:105], v[38:41], v[160:175]
    v_and_or_b32 v176, v26, s58, v9
    v_and_or_b32 v177, v27, s58, v9
    v_and_or_b32 v178, v28, s58, v9
    v_and_or_b32 v179, v29, s58, v9
    buffer_store_dwordx4 v[176:179], v4, s[40:43], s66 offen sc1
    v_and_or_b32 v180, v30, s58, v9
    v_and_or_b32 v181, v31, s58, v9
    v_and_or_b32 v182, v32, s58, v9
    v_and_or_b32 v183, v33, s58, v9
    buffer_store_dwordx4 v[180:183], v4, s[40:43], s67 offen sc1
    v_and_or_b32 v184, v34, s58, v9
    v_and_or_b32 v185, v35, s58, v9
    v_and_or_b32 v186, v36, s58, v9
    v_and_or_b32 v187, v37, s58, v9
    buffer_store_dwordx4 v[184:187], v4, s[40:43], s68 offen sc1
    v_and_or_b32 v188, v38, s58, v9
    v_and_or_b32 v189, v39, s58, v9
    v_and_or_b32 v190, v40, s58, v9
    v_and_or_b32 v191, v41, s58, v9
    buffer_store_dwordx4 v[188:191], v4, s[40:43], s77 offen sc1
    v_cvt_pk_bf16_f32 v192, v144, v152
    v_cvt_pk_bf16_f32 v193, v160, v168
    v_cvt_pk_bf16_f32 v194, v145, v153
    v_cvt_pk_bf16_f32 v195, v161, v169
    ds_write_b128 v3, v[192:195] offset:16640
    v_cvt_pk_bf16_f32 v196, v146, v154
    v_cvt_pk_bf16_f32 v197, v162, v170
    v_cvt_pk_bf16_f32 v198, v147, v155
    v_cvt_pk_bf16_f32 v199, v163, v171
    ds_write_b128 v3, v[196:199] offset:20736
    v_cvt_pk_bf16_f32 v200, v148, v156
    v_cvt_pk_bf16_f32 v201, v164, v172
    v_cvt_pk_bf16_f32 v202, v149, v157
    v_cvt_pk_bf16_f32 v203, v165, v173
    ds_write_b128 v3, v[200:203] offset:24832
    v_cvt_pk_bf16_f32 v204, v150, v158
    v_cvt_pk_bf16_f32 v205, v166, v174
    v_cvt_pk_bf16_f32 v206, v151, v159
    v_cvt_pk_bf16_f32 v207, v167, v175
    ds_write_b128 v3, v[204:207] offset:28928
    v_mov_b32 v2, 0
    v_mov_b32 v4, 1
    s_waitcnt lgkmcnt(0)
    s_mov_b64 exec, 1
    ds_add_u32 v2, v4 offset:128
    s_mov_b64 exec, -1
Lrowbar_2:
    ds_read_b32 v4, v2 offset:128
    s_waitcnt lgkmcnt(0)
    v_readfirstlane_b32 s7, v4
    s_nop 0
    s_cmp_lt_u32 s7, 4
    s_cbranch_scc1 Lrowbar_2
    ds_read_b64_tr_b16 v[208:209], v5 offset:16640
    ds_read_b64_tr_b16 v[210:211], v5 offset:17664
    ds_read_b64_tr_b16 v[212:213], v5 offset:18688
    ds_read_b64_tr_b16 v[214:215], v5 offset:19712
    ds_read_b64_tr_b16 v[216:217], v5 offset:16648
    ds_read_b64_tr_b16 v[218:219], v5 offset:17672
    ds_read_b64_tr_b16 v[220:221], v5 offset:18696
    ds_read_b64_tr_b16 v[222:223], v5 offset:19720
    s_cmp_eq_u32 s56, 0
    s_cbranch_scc1 Lb1real_3
    s_waitcnt lgkmcnt(4)
    v_mfma_f32_32x32x16_bf16 v[144:159], v[208:211], v[42:45], 0
    v_mfma_f32_32x32x16_bf16 v[160:175], v[208:211], v[50:53], 0
    v_mfma_f32_32x32x16_bf16 v[144:159], v[212:215], v[46:49], v[144:159]
    v_mfma_f32_32x32x16_bf16 v[160:175], v[212:215], v[54:57], v[160:175]
    s_waitcnt lgkmcnt(0)
    v_mfma_f32_32x32x16_bf16 v[160:175], v[216:219], v[42:45], v[160:175]
    v_mfma_f32_32x32x16_bf16 v[144:159], v[216:219], v[58:61], v[144:159]
    v_mfma_f32_32x32x16_bf16 v[160:175], v[220:223], v[46:49], v[160:175]
    v_mfma_f32_32x32x16_bf16 v[144:159], v[220:223], v[62:65], v[144:159]
    s_nop 11
    v_mul_f32 v98, v144, v66
    v_mul_f32 v100, v160, v66
    v_mul_f32 v99, v145, v67
    v_mul_f32 v101, v161, v67
    v_fmac_f32 v98, v160, v82
    v_fma_f32 v100, v144, -v82, v100
    v_fmac_f32 v99, v161, v83
    v_fma_f32 v101, v145, -v83, v101
    v_cvt_pk_bf16_f32 v208, v98, v99
    v_cvt_pk_bf16_f32 v216, v100, v101
    v_mul_f32 v102, v146, v68
    v_mul_f32 v104, v162, v68
    v_mul_f32 v103, v147, v69
    v_mul_f32 v105, v163, v69
    v_fmac_f32 v102, v162, v84
    v_fma_f32 v104, v146, -v84, v104
    v_fmac_f32 v103, v163, v85
    v_fma_f32 v105, v147, -v85, v105
    v_cvt_pk_bf16_f32 v209, v102, v103
    v_cvt_pk_bf16_f32 v217, v104, v105
    v_mul_f32 v98, v148, v70
    v_mul_f32 v100, v164, v70
    v_mul_f32 v99, v149, v71
    v_mul_f32 v101, v165, v71
    v_fmac_f32 v98, v164, v86
    v_fma_f32 v100, v148, -v86, v100
    v_fmac_f32 v99, v165, v87
    v_fma_f32 v101, v149, -v87, v101
    v_cvt_pk_bf16_f32 v210, v98, v99
    v_cvt_pk_bf16_f32 v218, v100, v101
    v_mul_f32 v102, v150, v72
    v_mul_f32 v104, v166, v72
    v_mul_f32 v103, v151, v73
    v_mul_f32 v105, v167, v73
    v_fmac_f32 v102, v166, v88
    v_fma_f32 v104, v150, -v88, v104
    v_fmac_f32 v103, v167, v89
    v_fma_f32 v105, v151, -v89, v105
    v_cvt_pk_bf16_f32 v211, v102, v103
    v_cvt_pk_bf16_f32 v219, v104, v105
    s_nop 0
    v_mfma_f32_32x32x16_bf16 v[176:191], v[42:45], v[208:211], 0
    v_mul_f32 v98, v152, v74
    v_mul_f32 v100, v168, v74
    v_mul_f32 v99, v153, v75
    v_mul_f32 v101, v169, v75
    v_fmac_f32 v98, v168, v90
    v_fma_f32 v100, v152, -v90, v100
    v_fmac_f32 v99, v169, v91
    v_mfma_f32_32x32x16_bf16 v[192:207], v[50:53], v[208:211], 0
    v_fma_f32 v101, v153, -v91, v101
    v_cvt_pk_bf16_f32 v212, v98, v99
    v_cvt_pk_bf16_f32 v220, v100, v101
    v_mul_f32 v102, v154, v76
    v_mul_f32 v104, v170, v76
    v_mul_f32 v103, v155, v77
    v_mul_f32 v105, v171, v77
    v_mfma_f32_32x32x16_bf16 v[176:191], v[58:61], v[216:219], v[176:191]
    v_fmac_f32 v102, v170, v92
    v_fma_f32 v104, v154, -v92, v104
    v_fmac_f32 v103, v171, v93
    v_fma_f32 v105, v155, -v93, v105
    v_cvt_pk_bf16_f32 v213, v102, v103
    v_cvt_pk_bf16_f32 v221, v104, v105
    v_mul_f32 v98, v156, v78
    v_mfma_f32_32x32x16_bf16 v[192:207], v[42:45], v[216:219], v[192:207]
    v_mul_f32 v100, v172, v78
    v_mul_f32 v99, v157, v79
    v_mul_f32 v101, v173, v79
    v_fmac_f32 v98, v172, v94
    v_fma_f32 v100, v156, -v94, v100
    v_fmac_f32 v99, v173, v95
    v_fma_f32 v101, v157, -v95, v101
    v_cvt_pk_bf16_f32 v214, v98, v99
    v_cvt_pk_bf16_f32 v222, v100, v101
    v_mul_f32 v102, v158, v80
    v_mul_f32 v104, v174, v80
    v_mul_f32 v103, v159, v81
    v_mul_f32 v105, v175, v81
    v_fmac_f32 v102, v174, v96
    v_fma_f32 v104, v158, -v96, v104
    v_fmac_f32 v103, v175, v97
    v_fma_f32 v105, v159, -v97, v105
    v_cvt_pk_bf16_f32 v215, v102, v103
    v_cvt_pk_bf16_f32 v223, v104, v105
    s_nop 0
    v_mfma_f32_32x32x16_bf16 v[176:191], v[46:49], v[212:215], v[176:191]
    v_mfma_f32_32x32x16_bf16 v[192:207], v[54:57], v[212:215], v[192:207]
    v_mfma_f32_32x32x16_bf16 v[176:191], v[62:65], v[220:223], v[176:191]
    v_mfma_f32_32x32x16_bf16 v[192:207], v[46:49], v[220:223], v[192:207]
    s_nop 11
    v_cvt_pk_bf16_f32 v228, v176, v192
    v_and_or_b32 v228, v228, s58, v9
    buffer_store_dword v228, v244, s[40:43], s34 offen offset:0 sc1
    v_cvt_pk_bf16_f32 v229, v177, v193
    v_and_or_b32 v229, v229, s58, v9
    buffer_store_dword v229, v244, s[40:43], s34 offen offset:128 sc1
    v_cvt_pk_bf16_f32 v230, v178, v194
    v_and_or_b32 v230, v230, s58, v9
    buffer_store_dword v230, v244, s[40:43], s34 offen offset:256 sc1
    v_cvt_pk_bf16_f32 v231, v179, v195
    v_and_or_b32 v231, v231, s58, v9
    buffer_store_dword v231, v244, s[40:43], s34 offen offset:384 sc1
    v_cvt_pk_bf16_f32 v232, v180, v196
    v_and_or_b32 v232, v232, s58, v9
    buffer_store_dword v232, v244, s[40:43], s34 offen offset:1024 sc1
    v_cvt_pk_bf16_f32 v233, v181, v197
    v_and_or_b32 v233, v233, s58, v9
    buffer_store_dword v233, v244, s[40:43], s34 offen offset:1152 sc1
    v_cvt_pk_bf16_f32 v234, v182, v198
    v_and_or_b32 v234, v234, s58, v9
    buffer_store_dword v234, v244, s[40:43], s34 offen offset:1280 sc1
    v_cvt_pk_bf16_f32 v235, v183, v199
    v_and_or_b32 v235, v235, s58, v9
    buffer_store_dword v235, v244, s[40:43], s34 offen offset:1408 sc1
    v_cvt_pk_bf16_f32 v236, v184, -v200
    v_and_or_b32 v236, v236, s58, v9
    buffer_store_dword v236, v245, s[40:43], s35 offen offset:1408 sc1
    v_cvt_pk_bf16_f32 v237, v185, -v201
    v_and_or_b32 v237, v237, s58, v9
    buffer_store_dword v237, v245, s[40:43], s35 offen offset:1280 sc1
    v_cvt_pk_bf16_f32 v238, v186, -v202
    v_and_or_b32 v238, v238, s58, v9
    buffer_store_dword v238, v245, s[40:43], s35 offen offset:1152 sc1
    v_cvt_pk_bf16_f32 v239, v187, -v203
    v_and_or_b32 v239, v239, s58, v9
    buffer_store_dword v239, v245, s[40:43], s35 offen offset:1024 sc1
    v_cvt_pk_bf16_f32 v240, v188, -v204
    v_and_or_b32 v240, v240, s58, v9
    buffer_store_dword v240, v245, s[40:43], s35 offen offset:384 sc1
    v_cvt_pk_bf16_f32 v241, v189, -v205
    v_and_or_b32 v241, v241, s58, v9
    buffer_store_dword v241, v245, s[40:43], s35 offen offset:256 sc1
    v_cvt_pk_bf16_f32 v242, v190, -v206
    v_and_or_b32 v242, v242, s58, v9
    buffer_store_dword v242, v245, s[40:43], s35 offen offset:128 sc1
    v_cvt_pk_bf16_f32 v243, v191, -v207
    v_and_or_b32 v243, v243, s58, v9
    buffer_store_dword v243, v245, s[40:43], s35 offen offset:0 sc1
    s_branch Lb1done_4
Lb1real_3:
    s_waitcnt lgkmcnt(4)
    v_mfma_f32_32x32x16_bf16 v[144:159], v[208:211], v[42:45], 0
    v_mfma_f32_32x32x16_bf16 v[160:175], v[208:211], v[50:53], 0
    v_mfma_f32_32x32x16_bf16 v[144:159], v[212:215], v[46:49], v[144:159]
    v_mfma_f32_32x32x16_bf16 v[160:175], v[212:215], v[54:57], v[160:175]
    s_waitcnt lgkmcnt(0)
    v_mfma_f32_32x32x16_bf16 v[176:191], v[216:219], v[42:45], 0
    v_mfma_f32_32x32x16_bf16 v[192:207], v[216:219], v[50:53], 0
    v_mfma_f32_32x32x16_bf16 v[176:191], v[220:223], v[46:49], v[176:191]
    s_nop 6
    v_mul_f32 v98, v144, v66
    v_mul_f32 v100, v160, v66
    v_mul_f32 v99, v145, v67
    v_mul_f32 v101, v161, v67
    v_fmac_f32 v98, v160, v82
    v_fma_f32 v100, v144, -v82, v100
    v_fmac_f32 v99, v161, v83
    v_mfma_f32_32x32x16_bf16 v[192:207], v[220:223], v[54:57], v[192:207]
    v_fma_f32 v101, v145, -v83, v101
    v_cvt_pk_bf16_f32 v228, v98, v99
    v_cvt_pk_bf16_f32 v236, v100, v101
    v_mul_f32 v102, v146, v68
    v_mul_f32 v104, v162, v68
    v_mul_f32 v103, v147, v69
    v_mul_f32 v105, v163, v69
    v_fmac_f32 v102, v162, v84
    v_fma_f32 v104, v146, -v84, v104
    v_fmac_f32 v103, v163, v85
    v_fma_f32 v105, v147, -v85, v105
    v_cvt_pk_bf16_f32 v229, v102, v103
    v_cvt_pk_bf16_f32 v237, v104, v105
    v_mul_f32 v98, v148, v70
    v_mul_f32 v100, v164, v70
    v_mul_f32 v99, v149, v71
    v_mul_f32 v101, v165, v71
    v_fmac_f32 v98, v164, v86
    v_fma_f32 v100, v148, -v86, v100
    v_fmac_f32 v99, v165, v87
    v_fma_f32 v101, v149, -v87, v101
    v_cvt_pk_bf16_f32 v230, v98, v99
    v_cvt_pk_bf16_f32 v238, v100, v101
    v_mul_f32 v102, v150, v72
    v_mul_f32 v104, v166, v72
    v_mul_f32 v103, v151, v73
    v_mul_f32 v105, v167, v73
    v_fmac_f32 v102, v166, v88
    v_fma_f32 v104, v150, -v88, v104
    v_fmac_f32 v103, v167, v89
    v_fma_f32 v105, v151, -v89, v105
    v_cvt_pk_bf16_f32 v231, v102, v103
    v_cvt_pk_bf16_f32 v239, v104, v105
    v_mul_f32 v98, v152, v74
    v_mul_f32 v100, v168, v74
    v_mul_f32 v99, v153, v75
    v_mul_f32 v101, v169, v75
    v_fmac_f32 v98, v168, v90
    v_fma_f32 v100, v152, -v90, v100
    v_fmac_f32 v99, v169, v91
    v_fma_f32 v101, v153, -v91, v101
    v_cvt_pk_bf16_f32 v232, v98, v99
    v_cvt_pk_bf16_f32 v240, v100, v101
    v_mul_f32 v102, v154, v76
    v_mul_f32 v104, v170, v76
    v_mul_f32 v103, v155, v77
    v_mul_f32 v105, v171, v77
    v_fmac_f32 v102, v170, v92
    v_fma_f32 v104, v154, -v92, v104
    v_fmac_f32 v103, v171, v93
    v_fma_f32 v105, v155, -v93, v105
    v_cvt_pk_bf16_f32 v233, v102, v103
    v_cvt_pk_bf16_f32 v241, v104, v105
    v_mul_f32 v98, v156, v78
    v_mul_f32 v100, v172, v78
    v_mul_f32 v99, v157, v79
    v_mul_f32 v101, v173, v79
    v_fmac_f32 v98, v172, v94
    v_fma_f32 v100, v156, -v94, v100
    v_fmac_f32 v99, v173, v95
    v_fma_f32 v101, v157, -v95, v101
    v_cvt_pk_bf16_f32 v234, v98, v99
    v_cvt_pk_bf16_f32 v242, v100, v101
    v_mul_f32 v102, v158, v80
    v_mul_f32 v104, v174, v80
    v_mul_f32 v103, v159, v81
    v_mul_f32 v105, v175, v81
    v_fmac_f32 v102, v174, v96
    v_fma_f32 v104, v158, -v96, v104
    v_fmac_f32 v103, v175, v97
    v_fma_f32 v105, v159, -v97, v105
    v_cvt_pk_bf16_f32 v235, v102, v103
    v_cvt_pk_bf16_f32 v243, v104, v105
    v_mfma_f32_32x32x16_bf16 v[160:175], v[224:227], v[228:231], 0
    v_mul_f32 v98, v176, v66
    v_mul_f32 v100, v192, v66
    v_mul_f32 v99, v177, v67
    v_mul_f32 v101, v193, v67
    v_fmac_f32 v98, v192, v82
    v_fma_f32 v100, v176, -v82, v100
    v_fmac_f32 v99, v193, v83
    v_mfma_f32_32x32x16_bf16 v[160:175], v[224:227], v[232:235], v[160:175]
    v_fma_f32 v101, v177, -v83, v101
    v_cvt_pk_bf16_f32 v208, v98, v99
    v_cvt_pk_bf16_f32 v216, v100, v101
    v_mul_f32 v102, v178, v68
    v_mul_f32 v104, v194, v68
    v_mul_f32 v103, v179, v69
    v_mul_f32 v105, v195, v69
    v_mfma_f32_32x32x16_bf16 v[144:159], v[106:109], v[228:231], 0
    v_fmac_f32 v102, v194, v84
    v_fma_f32 v104, v178, -v84, v104
    v_fmac_f32 v103, v195, v85
    v_fma_f32 v105, v179, -v85, v105
    v_cvt_pk_bf16_f32 v209, v102, v103
    v_cvt_pk_bf16_f32 v217, v104, v105
    v_mul_f32 v98, v180, v70
    v_mfma_f32_32x32x16_bf16 v[144:159], v[114:117], v[236:239], v[144:159]
    v_mul_f32 v100, v196, v70
    v_mul_f32 v99, v181, v71
    v_mul_f32 v101, v197, v71
    v_fmac_f32 v98, v196, v86
    v_fma_f32 v100, v180, -v86, v100
    v_fmac_f32 v99, v197, v87
    v_fma_f32 v101, v181, -v87, v101
    v_mfma_f32_32x32x16_bf16 v[144:159], v[110:113], v[232:235], v[144:159]
    v_cvt_pk_bf16_f32 v210, v98, v99
    v_cvt_pk_bf16_f32 v218, v100, v101
    v_mul_f32 v102, v182, v72
    v_mul_f32 v104, v198, v72
    v_mul_f32 v103, v183, v73
    v_mul_f32 v105, v199, v73
    v_fmac_f32 v102, v198, v88
    v_mfma_f32_32x32x16_bf16 v[144:159], v[118:121], v[240:243], v[144:159]
    v_fma_f32 v104, v182, -v88, v104
    v_fmac_f32 v103, v199, v89
    v_fma_f32 v105, v183, -v89, v105
    v_cvt_pk_bf16_f32 v211, v102, v103
    v_cvt_pk_bf16_f32 v219, v104, v105
    v_mul_f32 v98, v184, v74
    v_mul_f32 v100, v200, v74
    v_mul_f32 v99, v185, v75
    v_mul_f32 v101, v201, v75
    v_fmac_f32 v98, v200, v90
    v_fma_f32 v100, v184, -v90, v100
    v_fmac_f32 v99, v201, v91
    v_fma_f32 v101, v185, -v91, v101
    v_cvt_pk_bf16_f32 v212, v98, v99
    v_cvt_pk_bf16_f32 v220, v100, v101
    v_mul_f32 v102, v186, v76
    v_mul_f32 v104, v202, v76
    v_mul_f32 v103, v187, v77
    v_mul_f32 v105, v203, v77
    v_fmac_f32 v102, v202, v92
    v_fma_f32 v104, v186, -v92, v104
    v_fmac_f32 v103, v203, v93
    v_fma_f32 v105, v187, -v93, v105
    v_cvt_pk_bf16_f32 v213, v102, v103
    v_cvt_pk_bf16_f32 v221, v104, v105
    v_mul_f32 v98, v188, v78
    v_mul_f32 v100, v204, v78
    v_mul_f32 v99, v189, v79
    v_mul_f32 v101, v205, v79
    v_fmac_f32 v98, v204, v94
    v_fma_f32 v100, v188, -v94, v100
    v_fmac_f32 v99, v205, v95
    v_fma_f32 v101, v189, -v95, v101
    v_cvt_pk_bf16_f32 v214, v98, v99
    v_cvt_pk_bf16_f32 v222, v100, v101
    v_mul_f32 v102, v190, v80
    v_mul_f32 v104, v206, v80
    v_mul_f32 v103, v191, v81
    v_mul_f32 v105, v207, v81
    v_fmac_f32 v102, v206, v96
    v_fma_f32 v104, v190, -v96, v104
    v_fmac_f32 v103, v207, v97
    v_fma_f32 v105, v191, -v97, v105
    v_cvt_pk_bf16_f32 v215, v102, v103
    v_cvt_pk_bf16_f32 v223, v104, v105
    s_mov_b64 s[66:67], 1
    v_mfma_f32_32x32x16_bf16 v[192:207], v[224:227], v[208:211], 0
    v_cndmask_b32 v145, v145, v160, s[66:67]
    v_cvt_pk_bf16_f32 v228, v144, v145
    v_and_or_b32 v228, v228, s58, v9
    buffer_store_dword v228, v244, s[40:43], s34 offen offset:0 sc1
    v_mfma_f32_32x32x16_bf16 v[192:207], v[224:227], v[212:215], v[192:207]
    v_cvt_pk_bf16_f32 v229, v146, v147
    v_and_or_b32 v229, v229, s58, v9
    buffer_store_dword v229, v244, s[40:43], s34 offen offset:128 sc1
    v_cvt_pk_bf16_f32 v230, v148, v149
    v_mfma_f32_32x32x16_bf16 v[176:191], v[106:109], v[208:211], 0
    v_and_or_b32 v230, v230, s58, v9
    buffer_store_dword v230, v244, s[40:43], s34 offen offset:512 sc1
    v_cvt_pk_bf16_f32 v231, v150, v151
    v_and_or_b32 v231, v231, s58, v9
    v_mfma_f32_32x32x16_bf16 v[176:191], v[114:117], v[216:219], v[176:191]
    buffer_store_dword v231, v244, s[40:43], s34 offen offset:640 sc1
    v_cvt_pk_bf16_f32 v232, v152, v153
    v_and_or_b32 v232, v232, s58, v9
    buffer_store_dword v232, v244, s[40:43], s34 offen offset:1024 sc1
    v_cvt_pk_bf16_f32 v233, v154, v155
    v_mfma_f32_32x32x16_bf16 v[176:191], v[110:113], v[212:215], v[176:191]
    v_and_or_b32 v233, v233, s58, v9
    buffer_store_dword v233, v244, s[40:43], s34 offen offset:1152 sc1
    v_cvt_pk_bf16_f32 v234, v156, v157
    v_and_or_b32 v234, v234, s58, v9
    v_mfma_f32_32x32x16_bf16 v[176:191], v[118:121], v[220:223], v[176:191]
    buffer_store_dword v234, v244, s[40:43], s34 offen offset:1536 sc1
    v_cvt_pk_bf16_f32 v235, v158, v159
    v_and_or_b32 v235, v235, s58, v9
    buffer_store_dword v235, v244, s[40:43], s34 offen offset:1664 sc1
    s_nop 7
    v_cndmask_b32 v177, v177, v192, s[66:67]
    v_cvt_pk_bf16_f32 v236, v176, v177
    v_and_or_b32 v236, v236, s58, v9
    buffer_store_dword v236, v244, s[40:43], s35 offen offset:0 sc1
    v_cvt_pk_bf16_f32 v237, v178, v179
    v_and_or_b32 v237, v237, s58, v9
    buffer_store_dword v237, v244, s[40:43], s35 offen offset:128 sc1
    v_cvt_pk_bf16_f32 v238, v180, v181
    v_and_or_b32 v238, v238, s58, v9
    buffer_store_dword v238, v244, s[40:43], s35 offen offset:512 sc1
    v_cvt_pk_bf16_f32 v239, v182, v183
    v_and_or_b32 v239, v239, s58, v9
    buffer_store_dword v239, v244, s[40:43], s35 offen offset:640 sc1
    v_cvt_pk_bf16_f32 v240, v184, v185
    v_and_or_b32 v240, v240, s58, v9
    buffer_store_dword v240, v244, s[40:43], s35 offen offset:1024 sc1
    v_cvt_pk_bf16_f32 v241, v186, v187
    v_and_or_b32 v241, v241, s58, v9
    buffer_store_dword v241, v244, s[40:43], s35 offen offset:1152 sc1
    v_cvt_pk_bf16_f32 v242, v188, v189
    v_and_or_b32 v242, v242, s58, v9
    buffer_store_dword v242, v244, s[40:43], s35 offen offset:1536 sc1
    v_cvt_pk_bf16_f32 v243, v190, v191
    v_and_or_b32 v243, v243, s58, v9
    buffer_store_dword v243, v244, s[40:43], s35 offen offset:1664 sc1
Lb1done_4:
    s_setprio 0
    v_lshlrev_b32 v2, 3, v0
    global_load_dwordx2 v[140:141], v2, s[20:21]
    global_load_dwordx2 v[142:143], v2, s[18:19]
    s_mul_i32 s7, s56, 2048
    s_add_u32 m0, s7, 256
    s_add_u32 s7, s7, 34816
    v_lshl_add_u32 v2, v1, 4, s7
    global_load_lds_dwordx4 v2, s[4:5] offset:0
    global_load_lds_dwordx4 v2, s[4:5] offset:1024
    s_lshl_b32 s79, s61, 13
    s_mul_i32 s7, s56, 2048
    s_add_u32 m0, s7, 8448
    s_add_u32 s7, s7, s79
    s_add_u32 s7, s7, 43008
    v_lshl_add_u32 v2, v1, 4, s7
    global_load_lds_dwordx4 v2, s[4:5] offset:0
    global_load_lds_dwordx4 v2, s[4:5] offset:1024
    s_lshl_b32 s7, s2, 2
    s_add_u32 s7, s7, s56
    s_mul_i32 s7, s7, 2052
    v_mul_u32_u24 v2, 1026, v1
    s_mov_b64 exec, 3
    buffer_load_ushort v172, v2, s[44:47], s7 offen offset:0 nt
    buffer_load_ushort v173, v2, s[44:47], s7 offen offset:1024 nt
    buffer_load_ushort v174, v2, s[48:51], s7 offen offset:0 nt
    buffer_load_ushort v175, v2, s[48:51], s7 offen offset:1024 nt
    s_mov_b64 exec, -1
    v_lshrrev_b32 v7, 2, v0
    v_and_b32 v5, 3, v0
    v_lshlrev_b32 v160, 8, v7
    v_lshl_add_u32 v160, v5, 4, v160
    s_lshl_b32 s77, s2, 14
    s_add_u32 s77, s77, 1048576
    v_mul_u32_u24 v161, 16928, v5
    v_lshl_add_u32 v161, v7, 3, v161
    v_add_u32 v161, 68352, v161
    s_mul_i32 s7, s56, 16928
    s_add_u32 s7, s7, 68352
    v_lshl_add_u32 v162, v1, 3, s7
    v_mov_b32 v164, 0
    v_mov_b32 v165, 0
    v_lshrrev_b32 v7, 2, v0
    v_and_b32 v5, 3, v0
    v_lshlrev_b32 v5, 4, v5
    v_lshl_add_u32 v4, v7, 11, v5
    v_lshl_add_u32 v106, v7, 14, v5
    v_bfe_u32 v5, v0, 4, 2
    v_lshlrev_b32 v5, 4, v5
    v_xor_b32 v5, v3, v5
    v_bfe_u32 v7, v0, 3, 2
    v_lshlrev_b32 v7, 4, v7
    v_xor_b32 v107, v3, v7
    v_and_b32 v7, 15, v1
    v_lshrrev_b32 v6, 4, v1
    v_lshl_add_u32 v6, v6, 6, v7
    s_lshl_b32 s66, s56, 3
    s_add_u32 s66, s66, 51456
    v_lshrrev_b32 v2, 3, v6
    v_lshl_add_u32 v108, v2, 5, s66
    v_and_b32 v2, 7, v1
    v_mul_u32_u24 v2, 1056, v2
    v_add_u32 v108, v2, v108
    v_lshlrev_b32 v109, 3, v6
    v_lshlrev_b32 v6, 6, v6
    v_bfe_u32 v8, v1, 1, 2
    v_xor_b32 v8, s56, v8
    v_lshl_add_u32 v8, v8, 4, v6
    v_bfe_u32 v7, v1, 2, 2
    v_xor_b32 v7, s56, v7
    v_lshl_add_u32 v6, v7, 4, v6
    s_lshl_b32 s66, s61, 19
    s_lshl_b32 s67, s62, 6
    s_add_u32 s66, s66, s67
    s_add_u32 s66, s66, 5242880
    s_lshl_b32 s78, s61, 11
    s_add_u32 s78, s78, s67
    s_add_u32 s78, s78, 9437184
    s_add_u32 s67, s66, 131072
    s_add_u32 s68, s66, 262144
    s_add_u32 s69, s66, 393216
    s_waitcnt vmcnt(8)
    v_dot2_f32_bf16 v176, v10, v140, 0
    v_dot2_f32_bf16 v177, v12, v140, 0
    v_dot2_f32_bf16 v178, v14, v140, 0
    v_dot2_f32_bf16 v179, v16, v140, 0
    v_dot2_f32_bf16 v180, v18, v140, 0
    v_dot2_f32_bf16 v181, v20, v140, 0
    v_dot2_f32_bf16 v182, v22, v140, 0
    v_dot2_f32_bf16 v183, v24, v140, 0
    v_dot2_f32_bf16 v176, v11, v141, v176
    v_dot2_f32_bf16 v177, v13, v141, v177
    v_dot2_f32_bf16 v178, v15, v141, v178
    v_dot2_f32_bf16 v179, v17, v141, v179
    v_dot2_f32_bf16 v180, v19, v141, v180
    v_dot2_f32_bf16 v181, v21, v141, v181
    v_dot2_f32_bf16 v182, v23, v141, v182
    v_dot2_f32_bf16 v183, v25, v141, v183
    v_permlane32_swap_b32 v176, v180
    v_permlane32_swap_b32 v177, v181
    v_permlane32_swap_b32 v178, v182
    v_permlane32_swap_b32 v179, v183
    v_add_f32 v176, v176, v180
    v_add_f32 v177, v177, v181
    v_add_f32 v178, v178, v182
    v_add_f32 v179, v179, v183
    s_nop 0
    v_permlane16_swap_b32 v176, v178
    v_permlane16_swap_b32 v177, v179
    v_add_f32 v176, v176, v178
    v_add_f32 v177, v177, v179
    s_nop 0
    v_add_f32_dpp v176, v176, v176 row_ror:8 row_mask:0xf bank_mask:0xf
    v_add_f32_dpp v177, v177, v177 row_ror:8 row_mask:0xf bank_mask:0xf
    s_nop 0
    v_add_f32_dpp v176, v176, v176 row_ror:4 row_mask:0xf bank_mask:0xf
    v_add_f32_dpp v177, v177, v177 row_ror:4 row_mask:0xf bank_mask:0xf
    s_nop 0
    v_add_f32_dpp v176, v176, v176 row_ror:2 row_mask:0xf bank_mask:0xf
    v_add_f32_dpp v177, v177, v177 row_ror:2 row_mask:0xf bank_mask:0xf
    s_nop 0
    v_add_f32_dpp v176, v176, v176 row_ror:1 row_mask:0xf bank_mask:0xf
    v_add_f32_dpp v177, v177, v177 row_ror:1 row_mask:0xf bank_mask:0xf
    v_lshrrev_b32 v2, 4, v1
    v_lshlrev_b32 v2, 5, v2
    s_lshl_b32 s7, s56, 2
    v_add_u32 v2, s7, v2
    ds_write_b32 v2, v176 offset:0
    ds_write_b32 v2, v177 offset:16
    s_waitcnt vmcnt(0)
    buffer_load_dwordx4 v[144:147], v160, s[40:43], s77 offen offset:0 sc1
    buffer_load_dwordx4 v[148:151], v160, s[40:43], s77 offen offset:64 sc1
    buffer_load_dwordx4 v[152:155], v160, s[40:43], s77 offen offset:128 sc1
    buffer_load_dwordx4 v[156:159], v160, s[40:43], s77 offen offset:192 sc1
Lpoll_5:
    s_waitcnt vmcnt(0)
Lchk_7:
    v_xor_b32 v2, s57, v144
    v_bitop3_b32 v2, v2, v145, s57 bitop3:0xf6
    v_bitop3_b32 v2, v2, v146, s57 bitop3:0xf6
    v_bitop3_b32 v2, v2, v147, s57 bitop3:0xf6
    v_bitop3_b32 v2, v2, v148, s57 bitop3:0xf6
    v_bitop3_b32 v2, v2, v149, s57 bitop3:0xf6
    v_bitop3_b32 v2, v2, v150, s57 bitop3:0xf6
    v_bitop3_b32 v2, v2, v151, s57 bitop3:0xf6
    v_bitop3_b32 v2, v2, v152, s57 bitop3:0xf6
    v_bitop3_b32 v2, v2, v153, s57 bitop3:0xf6
    v_bitop3_b32 v2, v2, v154, s57 bitop3:0xf6
    v_bitop3_b32 v2, v2, v155, s57 bitop3:0xf6
    v_bitop3_b32 v2, v2, v156, s57 bitop3:0xf6
    v_bitop3_b32 v2, v2, v157, s57 bitop3:0xf6
    v_bitop3_b32 v2, v2, v158, s57 bitop3:0xf6
    v_bitop3_b32 v2, v2, v159, s57 bitop3:0xf6
    v_and_b32 v2, 65537, v2
    v_cmp_ne_u32 vcc, 0, v2
    s_cbranch_vccz Lok_6
    s_sleep 2
    v_xor_b32 v2, s57, v144
    v_bitop3_b32 v2, v2, v145, s57 bitop3:0xf6
    v_bitop3_b32 v2, v2, v146, s57 bitop3:0xf6
    v_bitop3_b32 v2, v2, v147, s57 bitop3:0xf6
    v_and_b32 v2, 65537, v2
    v_cmp_ne_u32 vcc, 0, v2
    s_cbranch_vccz Lskip_8
    buffer_load_dwordx4 v[144:147], v160, s[40:43], s77 offen offset:0 sc1
Lskip_8:
    v_xor_b32 v2, s57, v148
    v_bitop3_b32 v2, v2, v149, s57 bitop3:0xf6
    v_bitop3_b32 v2, v2, v150, s57 bitop3:0xf6
    v_bitop3_b32 v2, v2, v151, s57 bitop3:0xf6
    v_and_b32 v2, 65537, v2
    v_cmp_ne_u32 vcc, 0, v2
    s_cbranch_vccz Lskip_9
    buffer_load_dwordx4 v[148:151], v160, s[40:43], s77 offen offset:64 sc1
Lskip_9:
    v_xor_b32 v2, s57, v152
    v_bitop3_b32 v2, v2, v153, s57 bitop3:0xf6
    v_bitop3_b32 v2, v2, v154, s57 bitop3:0xf6
    v_bitop3_b32 v2, v2, v155, s57 bitop3:0xf6
    v_and_b32 v2, 65537, v2
    v_cmp_ne_u32 vcc, 0, v2
    s_cbranch_vccz Lskip_10
    buffer_load_dwordx4 v[152:155], v160, s[40:43], s77 offen offset:128 sc1
Lskip_10:
    v_xor_b32 v2, s57, v156
    v_bitop3_b32 v2, v2, v157, s57 bitop3:0xf6
    v_bitop3_b32 v2, v2, v158, s57 bitop3:0xf6
    v_bitop3_b32 v2, v2, v159, s57 bitop3:0xf6
    v_and_b32 v2, 65537, v2
    v_cmp_ne_u32 vcc, 0, v2
    s_cbranch_vccz Lskip_11
    buffer_load_dwordx4 v[156:159], v160, s[40:43], s77 offen offset:192 sc1
Lskip_11:
    s_add_u32 s74, s74, 1
    s_cmp_lt_u32 s74, 32768
    s_cbranch_scc1 Lpoll_5
    s_waitcnt vmcnt(0)
Lok_6:
    v_perm_b32 v172, v174, v172, s75
    v_perm_b32 v173, v175, v173, s75
    v_mov_b32 v174, s59
    v_mov_b32 v175, s59
    s_lshl_b32 s7, s56, 13
    s_lshl_b32 s79, s2, 4
    s_add_u32 s7, s7, s79
    s_add_u32 s7, s7, 17825792
    v_lshlrev_b32 v2, 12, v1
    s_mov_b64 exec, 3
    buffer_store_dwordx4 v[172:175], v2, s[40:43], s7 offen sc1
    s_mov_b64 exec, -1
    s_add_u32 m0, s23, 51456
    s_nop 0
    buffer_load_dwordx4 v138, s[44:47], s22 offen nt lds
    s_waitcnt lgkmcnt(0)
    s_barrier
    s_setprio 2
    s_mov_b32 exec_hi, 0x0fffffff
    ds_write_b64 v162, v[164:165]
    s_mov_b32 exec_hi, -1
    v_perm_b32 v176, v148, v144, s75
    v_perm_b32 v177, v156, v152, s75
    ds_write_b64 v161, v[176:177] offset:480
    v_perm_b32 v178, v148, v144, s76
    v_perm_b32 v179, v156, v152, s76
    ds_write_b64 v161, v[178:179] offset:992
    v_perm_b32 v180, v149, v145, s75
    v_perm_b32 v181, v157, v153, s75
    ds_write_b64 v161, v[180:181] offset:1504
    v_perm_b32 v182, v149, v145, s76
    v_perm_b32 v183, v157, v153, s76
    ds_write_b64 v161, v[182:183] offset:2016
    v_perm_b32 v176, v150, v146, s75
    v_perm_b32 v177, v158, v154, s75
    ds_write_b64 v161, v[176:177] offset:2528
    v_perm_b32 v178, v150, v146, s76
    v_perm_b32 v179, v158, v154, s76
    ds_write_b64 v161, v[178:179] offset:3040
    v_perm_b32 v180, v151, v147, s75
    v_perm_b32 v181, v159, v155, s75
    ds_write_b64 v161, v[180:181] offset:3552
    v_perm_b32 v182, v151, v147, s76
    v_perm_b32 v183, v159, v155, s76
    ds_write_b64 v161, v[182:183] offset:4064
    s_waitcnt lgkmcnt(0)
    s_barrier
    s_setprio 0
    s_add_u32 m0, s23, 55680
    s_nop 0
    buffer_load_dwordx4 v139, s[44:47], s22 offen nt lds
    v_bfe_u32 v7, v1, 3, 1
    v_and_b32 v2, 3, v1
    v_lshl_add_u32 v7, v7, 2, v2
    v_lshlrev_b32 v2, 4, v7
    ds_read_b128 v[192:195], v2 offset:0
    v_cvt_f32_u32 v204, v7
    v_mul_f32 v205, 0.5, v204
    v_cos_f32 v197, v205
    v_mul_f32 v205, 0x3e000000, v204
    v_cos_f32 v198, v205
    v_sin_f32 v199, v205
    v_mul_f32 v205, 0x3e800000, v204
    v_cos_f32 v200, v205
    v_sin_f32 v201, v205
    v_mul_f32 v205, 0x3ec00000, v204
    v_cos_f32 v202, v205
    v_sin_f32 v203, v205
    s_waitcnt lgkmcnt(0)
    v_add_f32 v192, v192, v193
    v_add_f32 v194, v194, v195
    v_add_f32 v192, v192, v194
    v_cvt_pk_bf16_f32 v192, v192, v192
    v_lshlrev_b32 v192, 16, v192
    v_mul_f32 v192, 0xbfb8aa3b, v192
    v_exp_f32 v192, v192
    s_nop 0
    v_add_f32 v192, 1.0, v192
    v_rcp_f32 v192, v192
    s_nop 0
    v_cvt_pk_bf16_f32 v193, v192, v192
    v_lshlrev_b32 v192, 16, v193
    v_sub_f32 v196, 1.0, v192
    v_cvt_pk_bf16_f32 v196, v196, v196
    v_lshlrev_b32 v196, 16, v196
    v_mul_f32 v196, 0x35800000, v196
    v_bfe_i32 v2, v7, 0, 1
    v_xor_b32 v2, 0xffff, v2
    v_and_b32 v193, v2, v193
    v_lshrrev_b32 v7, 1, v7
    v_cndmask_b32 v194, 0, v193, s[70:71]
    v_cndmask_b32 v195, 0, v193, s[72:73]
    v_cmp_eq_u32 vcc, 0, v7
    v_mul_f32 v197, v197, v196
    s_nop 0
    v_cndmask_b32 v248, 0, v194, vcc
    v_cndmask_b32 v252, 0, v195, vcc
    v_cmp_eq_u32 vcc, 1, v7
    v_mul_f32 v199, v199, v196
    v_mul_f32 v198, v198, v196
    v_cndmask_b32 v249, 0, v194, vcc
    v_cndmask_b32 v253, 0, v195, vcc
    v_cmp_eq_u32 vcc, 2, v7
    v_mul_f32 v201, v201, v196
    v_mul_f32 v200, v200, v196
    v_cndmask_b32 v250, 0, v194, vcc
    v_cndmask_b32 v254, 0, v195, vcc
    v_cmp_eq_u32 vcc, 3, v7
    v_mul_f32 v203, v203, v196
    v_mul_f32 v202, v202, v196
    v_cndmask_b32 v251, 0, v194, vcc
    v_cndmask_b32 v255, 0, v195, vcc
    v_cvt_pk_bf16_f32 v204, v196, v197
    v_cvt_pk_bf16_f32 v205, v198, -v199
    v_cvt_pk_bf16_f32 v206, v200, -v201
    v_cvt_pk_bf16_f32 v207, v202, -v203
    v_cndmask_b32 v98, 0, v204, s[70:71]
    v_cndmask_b32 v102, 0, v204, s[72:73]
    v_cndmask_b32 v99, 0, v205, s[70:71]
    v_cndmask_b32 v103, 0, v205, s[72:73]
    v_cndmask_b32 v100, 0, v206, s[70:71]
    v_cndmask_b32 v104, 0, v206, s[72:73]
    v_cndmask_b32 v101, 0, v207, s[70:71]
    v_cndmask_b32 v105, 0, v207, s[72:73]
    s_cmp_eq_u32 s65, 0
    s_cbranch_scc1 Lnospec_12
    s_lshl_b32 s7, s64, 4
    v_lshlrev_b32 v2, 1, v109
    v_subrev_u32 v7, s7, v2
    s_sub_u32 s7, s61, 1
    s_cmp_lt_u32 s7, 4
    s_cselect_b32 s7, -16, 0
    v_sub_u32 v2, s7, v2
    s_lshl_b32 s32, s61, 12
    s_sub_u32 s33, 32768, s32
    s_and_b32 s33, s33, 32767
    s_add_u32 s32, s32, 17825792
    s_add_u32 s33, s33, 17825792
    v_add_u32 v110, 0, v7
    v_subrev_u32 v111, 0, v2
    v_and_b32 v110, 4095, v110
    v_and_b32 v111, 4095, v111
    v_add_u32 v112, 256, v7
    v_subrev_u32 v113, 256, v2
    v_and_b32 v112, 4095, v112
    v_and_b32 v113, 4095, v113
    v_add_u32 v114, 512, v7
    v_subrev_u32 v115, 512, v2
    v_and_b32 v114, 4095, v114
    v_and_b32 v115, 4095, v115
    v_add_u32 v116, 768, v7
    v_subrev_u32 v117, 768, v2
    v_and_b32 v116, 4095, v116
    v_and_b32 v117, 4095, v117
    buffer_load_dwordx4 v[66:69], v110, s[40:43], s32 offen sc1
    buffer_load_dwordx4 v[70:73], v111, s[40:43], s33 offen sc1
    buffer_load_dwordx4 v[74:77], v112, s[40:43], s32 offen sc1
    buffer_load_dwordx4 v[78:81], v113, s[40:43], s33 offen sc1
    buffer_load_dwordx4 v[82:85], v114, s[40:43], s32 offen sc1
    buffer_load_dwordx4 v[86:89], v115, s[40:43], s33 offen sc1
    buffer_load_dwordx4 v[90:93], v116, s[40:43], s32 offen sc1
    buffer_load_dwordx4 v[94:97], v117, s[40:43], s33 offen sc1
Lnospec_12:
    buffer_load_dwordx4 v[10:13], v4, s[40:43], s66 offen sc1
    buffer_load_dwordx4 v[14:17], v4, s[40:43], s67 offen sc1
    buffer_load_dwordx4 v[18:21], v4, s[40:43], s68 offen sc1
    buffer_load_dwordx4 v[22:25], v4, s[40:43], s69 offen sc1
    s_add_u32 m0, s23, 59904
    s_nop 0
    buffer_load_dwordx4 v138, s[48:51], s22 offen nt lds
    v_lshlrev_b32 v2, 4, v1
    ds_read_b128 v[240:243], v2 offset:6400
    ds_read_b128 v[244:247], v2 offset:7424
    ds_read_b128 v[208:211], v2 offset:8448
    ds_read_b128 v[212:215], v2 offset:9472
    ds_read_b128 v[216:219], v2 offset:10496
    ds_read_b128 v[220:223], v2 offset:11520
    ds_read_b128 v[224:227], v2 offset:12544
    ds_read_b128 v[228:231], v2 offset:13568
    ds_read_b128 v[232:235], v2 offset:14592
    ds_read_b128 v[236:239], v2 offset:15616
    s_waitcnt vmcnt(1)
    s_branch Lchk_15
Lpoll_13:
    s_waitcnt vmcnt(0)
Lchk_15:
    v_xor_b32 v2, s57, v10
    v_bitop3_b32 v2, v2, v11, s57 bitop3:0xf6
    v_bitop3_b32 v2, v2, v12, s57 bitop3:0xf6
    v_bitop3_b32 v2, v2, v13, s57 bitop3:0xf6
    v_bitop3_b32 v2, v2, v14, s57 bitop3:0xf6
    v_bitop3_b32 v2, v2, v15, s57 bitop3:0xf6
    v_bitop3_b32 v2, v2, v16, s57 bitop3:0xf6
    v_bitop3_b32 v2, v2, v17, s57 bitop3:0xf6
    v_bitop3_b32 v2, v2, v18, s57 bitop3:0xf6
    v_bitop3_b32 v2, v2, v19, s57 bitop3:0xf6
    v_bitop3_b32 v2, v2, v20, s57 bitop3:0xf6
    v_bitop3_b32 v2, v2, v21, s57 bitop3:0xf6
    v_bitop3_b32 v2, v2, v22, s57 bitop3:0xf6
    v_bitop3_b32 v2, v2, v23, s57 bitop3:0xf6
    v_bitop3_b32 v2, v2, v24, s57 bitop3:0xf6
    v_bitop3_b32 v2, v2, v25, s57 bitop3:0xf6
    v_and_b32 v2, 65537, v2
    v_cmp_ne_u32 vcc, 0, v2
    s_cbranch_vccz Lok_14
    s_sleep 2
    v_xor_b32 v2, s57, v10
    v_bitop3_b32 v2, v2, v11, s57 bitop3:0xf6
    v_bitop3_b32 v2, v2, v12, s57 bitop3:0xf6
    v_bitop3_b32 v2, v2, v13, s57 bitop3:0xf6
    v_and_b32 v2, 65537, v2
    v_cmp_ne_u32 vcc, 0, v2
    s_cbranch_vccz Lskip_16
    buffer_load_dwordx4 v[10:13], v4, s[40:43], s66 offen sc1
Lskip_16:
    v_xor_b32 v2, s57, v14
    v_bitop3_b32 v2, v2, v15, s57 bitop3:0xf6
    v_bitop3_b32 v2, v2, v16, s57 bitop3:0xf6
    v_bitop3_b32 v2, v2, v17, s57 bitop3:0xf6
    v_and_b32 v2, 65537, v2
    v_cmp_ne_u32 vcc, 0, v2
    s_cbranch_vccz Lskip_17
    buffer_load_dwordx4 v[14:17], v4, s[40:43], s67 offen sc1
Lskip_17:
    v_xor_b32 v2, s57, v18
    v_bitop3_b32 v2, v2, v19, s57 bitop3:0xf6
    v_bitop3_b32 v2, v2, v20, s57 bitop3:0xf6
    v_bitop3_b32 v2, v2, v21, s57 bitop3:0xf6
    v_and_b32 v2, 65537, v2
    v_cmp_ne_u32 vcc, 0, v2
    s_cbranch_vccz Lskip_18
    buffer_load_dwordx4 v[18:21], v4, s[40:43], s68 offen sc1
Lskip_18:
    v_xor_b32 v2, s57, v22
    v_bitop3_b32 v2, v2, v23, s57 bitop3:0xf6
    v_bitop3_b32 v2, v2, v24, s57 bitop3:0xf6
    v_bitop3_b32 v2, v2, v25, s57 bitop3:0xf6
    v_and_b32 v2, 65537, v2
    v_cmp_ne_u32 vcc, 0, v2
    s_cbranch_vccz Lskip_19
    buffer_load_dwordx4 v[22:25], v4, s[40:43], s69 offen sc1
Lskip_19:
    s_add_u32 s74, s74, 1
    s_cmp_lt_u32 s74, 32768
    s_cbranch_scc1 Lpoll_13
    s_waitcnt vmcnt(0)
Lok_14:
    s_setprio 2
    ds_write_b128 v5, v[10:13] offset:33024
    ds_write_b128 v5, v[14:17] offset:37120
    ds_write_b128 v5, v[18:21] offset:41216
    ds_write_b128 v5, v[22:25] offset:45312
    s_add_u32 m0, s23, 64128
    s_nop 0
    buffer_load_dwordx4 v139, s[48:51], s22 offen nt lds
    v_mov_b32 v2, 0
    v_mov_b32 v7, 1
    s_waitcnt lgkmcnt(0)
    s_mov_b64 exec, 1
    ds_add_u32 v2, v7 offset:128
    s_mov_b64 exec, -1
Lrowbar_20:
    ds_read_b32 v7, v2 offset:128
    s_waitcnt lgkmcnt(0)
    v_readfirstlane_b32 s7, v7
    s_nop 0
    s_cmp_lt_u32 s7, 8
    s_cbranch_scc1 Lrowbar_20
    ds_read_b128 v[10:13], v6 offset:33024
    ds_read_b128 v[14:17], v6 offset:34048
    ds_read_b128 v[18:21], v6 offset:35072
    ds_read_b128 v[22:25], v6 offset:36096
    s_add_u32 s67, s78, 1048576
    s_add_u32 s68, s78, 2097152
    s_add_u32 s69, s78, 3145728
    s_waitcnt lgkmcnt(0)
    v_swap_b32 v11, v14
    v_swap_b32 v12, v18
    v_swap_b32 v13, v22
    v_swap_b32 v16, v19
    v_swap_b32 v17, v23
    v_swap_b32 v21, v24
    v_mfma_f32_16x16x32_bf16 v[144:147], v[10:13], v[208:211], 0
    v_mfma_f32_16x16x32_bf16 v[148:151], v[10:13], v[212:215], 0
    v_mfma_f32_16x16x32_bf16 v[152:155], v[14:17], v[208:211], 0
    v_mfma_f32_16x16x32_bf16 v[156:159], v[14:17], v[212:215], 0
    v_mfma_f32_16x16x32_bf16 v[160:163], v[18:21], v[208:211], 0
    v_mfma_f32_16x16x32_bf16 v[164:167], v[18:21], v[212:215], 0
    v_mfma_f32_16x16x32_bf16 v[168:171], v[22:25], v[208:211], 0
    v_mfma_f32_16x16x32_bf16 v[172:175], v[22:25], v[212:215], 0
    s_nop 0
    v_mul_f32 v192, v144, v224
    v_mul_f32 v193, v148, v224
    v_mul_f32 v194, v145, v225
    v_mul_f32 v195, v149, v225
    v_mul_f32 v196, v146, v226
    v_mul_f32 v197, v150, v226
    v_mul_f32 v198, v147, v227
    v_mul_f32 v199, v151, v227
    v_fmac_f32 v192, v148, v228
    v_fma_f32 v193, v144, -v228, v193
    v_fmac_f32 v194, v149, v229
    v_fma_f32 v195, v145, -v229, v195
    v_fmac_f32 v196, v150, v230
    v_fma_f32 v197, v146, -v230, v197
    v_fmac_f32 v198, v151, v231
    v_fma_f32 v199, v147, -v231, v199
    v_cvt_pk_bf16_f32 v176, v192, v193
    v_cvt_pk_bf16_f32 v177, v194, v195
    v_cvt_pk_bf16_f32 v178, v196, v197
    v_cvt_pk_bf16_f32 v179, v198, v199
    s_nop 1
    v_mfma_f32_16x16x32_bf16 v[144:147], v[240:243], v[176:179], 0
    v_mfma_f32_16x16x32_bf16 v[148:151], v[244:247], v[176:179], 0
    v_mul_f32 v192, v152, v224
    v_mul_f32 v193, v156, v224
    v_mul_f32 v194, v153, v225
    v_mul_f32 v195, v157, v225
    v_mul_f32 v196, v154, v226
    v_mul_f32 v197, v158, v226
    v_mul_f32 v198, v155, v227
    v_mul_f32 v199, v159, v227
    v_fmac_f32 v192, v156, v228
    v_fma_f32 v193, v152, -v228, v193
    v_fmac_f32 v194, v157, v229
    v_fma_f32 v195, v153, -v229, v195
    v_fmac_f32 v196, v158, v230
    v_fma_f32 v197, v154, -v230, v197
    v_fmac_f32 v198, v159, v231
    v_fma_f32 v199, v155, -v231, v199
    v_cvt_pk_bf16_f32 v180, v192, v193
    v_cvt_pk_bf16_f32 v181, v194, v195
    v_cvt_pk_bf16_f32 v182, v196, v197
    v_cvt_pk_bf16_f32 v183, v198, v199
    s_nop 1
    v_mfma_f32_16x16x32_bf16 v[152:155], v[240:243], v[180:183], 0
    v_mfma_f32_16x16x32_bf16 v[156:159], v[244:247], v[180:183], 0
    v_mul_f32 v192, v160, v224
    v_mul_f32 v193, v164, v224
    v_mul_f32 v194, v161, v225
    v_mul_f32 v195, v165, v225
    v_mul_f32 v196, v162, v226
    v_mul_f32 v197, v166, v226
    v_mul_f32 v198, v163, v227
    v_mul_f32 v199, v167, v227
    v_fmac_f32 v192, v164, v228
    v_fma_f32 v193, v160, -v228, v193
    v_fmac_f32 v194, v165, v229
    v_fma_f32 v195, v161, -v229, v195
    v_fmac_f32 v196, v166, v230
    v_fma_f32 v197, v162, -v230, v197
    v_fmac_f32 v198, v167, v231
    v_fma_f32 v199, v163, -v231, v199
    v_cvt_pk_bf16_f32 v184, v192, v193
    v_cvt_pk_bf16_f32 v185, v194, v195
    v_cvt_pk_bf16_f32 v186, v196, v197
    v_cvt_pk_bf16_f32 v187, v198, v199
    s_nop 1
    v_mfma_f32_16x16x32_bf16 v[160:163], v[240:243], v[184:187], 0
    v_mfma_f32_16x16x32_bf16 v[164:167], v[244:247], v[184:187], 0
    v_mul_f32 v192, v168, v224
    v_mul_f32 v193, v172, v224
    v_mul_f32 v194, v169, v225
    v_mul_f32 v195, v173, v225
    v_mul_f32 v196, v170, v226
    v_mul_f32 v197, v174, v226
    v_mul_f32 v198, v171, v227
    v_mul_f32 v199, v175, v227
    v_fmac_f32 v192, v172, v228
    v_fma_f32 v193, v168, -v228, v193
    v_fmac_f32 v194, v173, v229
    v_fma_f32 v195, v169, -v229, v195
    v_fmac_f32 v196, v174, v230
    v_fma_f32 v197, v170, -v230, v197
    v_fmac_f32 v198, v175, v231
    v_fma_f32 v199, v171, -v231, v199
    v_cvt_pk_bf16_f32 v188, v192, v193
    v_cvt_pk_bf16_f32 v189, v194, v195
    v_cvt_pk_bf16_f32 v190, v196, v197
    v_cvt_pk_bf16_f32 v191, v198, v199
    s_nop 1
    v_mfma_f32_16x16x32_bf16 v[168:171], v[240:243], v[188:191], 0
    v_mfma_f32_16x16x32_bf16 v[172:175], v[244:247], v[188:191], 0
    s_setprio 0
    s_cmp_eq_u32 s65, 0
    s_cbranch_scc1 Lnospec_21
Lpoll_22:
    s_waitcnt vmcnt(0)
Lchk_24:
    v_xor_b32 v2, s59, v68
    v_bitop3_b32 v2, v2, v72, s59 bitop3:0xf6
    v_bitop3_b32 v2, v2, v76, s59 bitop3:0xf6
    v_bitop3_b32 v2, v2, v80, s59 bitop3:0xf6
    v_bitop3_b32 v2, v2, v84, s59 bitop3:0xf6
    v_bitop3_b32 v2, v2, v88, s59 bitop3:0xf6
    v_bitop3_b32 v2, v2, v92, s59 bitop3:0xf6
    v_bitop3_b32 v2, v2, v96, s59 bitop3:0xf6
    v_cmp_ne_u32 vcc, 0, v2
    s_cbranch_vccz Lok_23
    s_sleep 2
    v_xor_b32 v2, s59, v68
    v_cmp_ne_u32 vcc, 0, v2
    s_cbranch_vccz Lskip_25
    buffer_load_dwordx4 v[66:69], v110, s[40:43], s32 offen sc1
Lskip_25:
    v_xor_b32 v2, s59, v72
    v_cmp_ne_u32 vcc, 0, v2
    s_cbranch_vccz Lskip_26
    buffer_load_dwordx4 v[70:73], v111, s[40:43], s33 offen sc1
Lskip_26:
    v_xor_b32 v2, s59, v76
    v_cmp_ne_u32 vcc, 0, v2
    s_cbranch_vccz Lskip_27
    buffer_load_dwordx4 v[74:77], v112, s[40:43], s32 offen sc1
Lskip_27:
    v_xor_b32 v2, s59, v80
    v_cmp_ne_u32 vcc, 0, v2
    s_cbranch_vccz Lskip_28
    buffer_load_dwordx4 v[78:81], v113, s[40:43], s33 offen sc1
Lskip_28:
    v_xor_b32 v2, s59, v84
    v_cmp_ne_u32 vcc, 0, v2
    s_cbranch_vccz Lskip_29
    buffer_load_dwordx4 v[82:85], v114, s[40:43], s32 offen sc1
Lskip_29:
    v_xor_b32 v2, s59, v88
    v_cmp_ne_u32 vcc, 0, v2
    s_cbranch_vccz Lskip_30
    buffer_load_dwordx4 v[86:89], v115, s[40:43], s33 offen sc1
Lskip_30:
    v_xor_b32 v2, s59, v92
    v_cmp_ne_u32 vcc, 0, v2
    s_cbranch_vccz Lskip_31
    buffer_load_dwordx4 v[90:93], v116, s[40:43], s32 offen sc1
Lskip_31:
    v_xor_b32 v2, s59, v96
    v_cmp_ne_u32 vcc, 0, v2
    s_cbranch_vccz Lskip_32
    buffer_load_dwordx4 v[94:97], v117, s[40:43], s33 offen sc1
Lskip_32:
    s_add_u32 s74, s74, 1
    s_cmp_lt_u32 s74, 32768
    s_cbranch_scc1 Lpoll_22
    s_waitcnt vmcnt(0)
Lok_23:
    s_and_b32 s7, s61, 3
    s_cmp_eq_u32 s7, 0
    s_cselect_b32 s7, 0x3e800000, 0
    s_cselect_b32 s33, 0x3e800000, 0.5
    s_cselect_b32 s65, 2, 1
    s_cmp_eq_u32 s64, 1
    s_cselect_b32 s32, s7, s33
    s_cselect_b32 s33, s33, s7
    v_lshlrev_b32 v118, 16, v66
    v_lshlrev_b32 v119, 16, v70
    v_lshlrev_b32 v120, 16, v67
    v_lshlrev_b32 v121, 16, v71
    v_add_f32 v118, v118, v119
    v_add_f32 v120, v120, v121
    v_sub_f32 v119, v118, v120
    v_mul_f32 v122, s32, v118
    v_mul_f32 v130, s7, v119
    v_fmac_f32 v122, s33, v120
    v_and_b32 v118, 0xffff0000, v66
    v_and_b32 v119, 0xffff0000, v70
    v_and_b32 v120, 0xffff0000, v67
    v_and_b32 v121, 0xffff0000, v71
    v_sub_f32 v118, v118, v119
    v_sub_f32 v120, v120, v121
    v_sub_f32 v119, v118, v120
    v_mul_f32 v126, s32, v118
    v_mul_f32 v134, s7, v119
    v_fmac_f32 v126, s33, v120
    v_lshlrev_b32 v118, 16, v74
    v_lshlrev_b32 v119, 16, v78
    v_lshlrev_b32 v120, 16, v75
    v_lshlrev_b32 v121, 16, v79
    v_add_f32 v118, v118, v119
    v_add_f32 v120, v120, v121
    v_sub_f32 v119, v118, v120
    v_mul_f32 v123, s32, v118
    v_mul_f32 v131, s7, v119
    v_fmac_f32 v123, s33, v120
    v_and_b32 v118, 0xffff0000, v74
    v_and_b32 v119, 0xffff0000, v78
    v_and_b32 v120, 0xffff0000, v75
    v_and_b32 v121, 0xffff0000, v79
    v_sub_f32 v118, v118, v119
    v_sub_f32 v120, v120, v121
    v_sub_f32 v119, v118, v120
    v_mul_f32 v127, s32, v118
    v_mul_f32 v135, s7, v119
    v_fmac_f32 v127, s33, v120
    v_lshlrev_b32 v118, 16, v82
    v_lshlrev_b32 v119, 16, v86
    v_lshlrev_b32 v120, 16, v83
    v_lshlrev_b32 v121, 16, v87
    v_add_f32 v118, v118, v119
    v_add_f32 v120, v120, v121
    v_sub_f32 v119, v118, v120
    v_mul_f32 v124, s32, v118
    v_mul_f32 v132, s7, v119
    v_fmac_f32 v124, s33, v120
    v_and_b32 v118, 0xffff0000, v82
    v_and_b32 v119, 0xffff0000, v86
    v_and_b32 v120, 0xffff0000, v83
    v_and_b32 v121, 0xffff0000, v87
    v_sub_f32 v118, v118, v119
    v_sub_f32 v120, v120, v121
    v_sub_f32 v119, v118, v120
    v_mul_f32 v128, s32, v118
    v_mul_f32 v136, s7, v119
    v_fmac_f32 v128, s33, v120
    v_lshlrev_b32 v118, 16, v90
    v_lshlrev_b32 v119, 16, v94
    v_lshlrev_b32 v120, 16, v91
    v_lshlrev_b32 v121, 16, v95
    v_add_f32 v118, v118, v119
    v_add_f32 v120, v120, v121
    v_sub_f32 v119, v118, v120
    v_mul_f32 v125, s32, v118
    v_mul_f32 v133, s7, v119
    v_fmac_f32 v125, s33, v120
    v_and_b32 v118, 0xffff0000, v90
    v_and_b32 v119, 0xffff0000, v94
    v_and_b32 v120, 0xffff0000, v91
    v_and_b32 v121, 0xffff0000, v95
    v_sub_f32 v118, v118, v119
    v_sub_f32 v120, v120, v121
    v_sub_f32 v119, v118, v120
    v_mul_f32 v129, s32, v118
    v_mul_f32 v137, s7, v119
    v_fmac_f32 v129, s33, v120
Lnospec_21:
    s_waitcnt vmcnt(0)
    s_barrier
    s_setprio 2
    ds_read_b64 v[68:69], v108 offset:0
    ds_read_b64 v[84:85], v108 offset:8448
    ds_read_b64 v[72:73], v108 offset:64
    ds_read_b64 v[88:89], v108 offset:8512
    ds_read_b64 v[76:77], v108 offset:128
    ds_read_b64 v[92:93], v108 offset:8576
    ds_read_b64 v[80:81], v108 offset:192
    ds_read_b64 v[96:97], v108 offset:8640
    s_waitcnt lgkmcnt(4)
    v_lshlrev_b32 v66, 16, v68
    v_and_b32 v67, 0xffff0000, v68
    v_lshlrev_b32 v68, 16, v69
    v_and_b32 v69, 0xffff0000, v69
    v_lshlrev_b32 v82, 16, v84
    v_and_b32 v83, 0xffff0000, v84
    v_lshlrev_b32 v84, 16, v85
    v_and_b32 v85, 0xffff0000, v85
    v_lshlrev_b32 v70, 16, v72
    v_and_b32 v71, 0xffff0000, v72
    v_lshlrev_b32 v72, 16, v73
    v_and_b32 v73, 0xffff0000, v73
    v_lshlrev_b32 v86, 16, v88
    v_and_b32 v87, 0xffff0000, v88
    v_lshlrev_b32 v88, 16, v89
    v_and_b32 v89, 0xffff0000, v89
    s_waitcnt lgkmcnt(0)
    v_lshlrev_b32 v74, 16, v76
    v_and_b32 v75, 0xffff0000, v76
    v_lshlrev_b32 v76, 16, v77
    v_and_b32 v77, 0xffff0000, v77
    v_lshlrev_b32 v90, 16, v92
    v_and_b32 v91, 0xffff0000, v92
    v_lshlrev_b32 v92, 16, v93
    v_and_b32 v93, 0xffff0000, v93
    v_lshlrev_b32 v78, 16, v80
    v_and_b32 v79, 0xffff0000, v80
    v_lshlrev_b32 v80, 16, v81
    v_and_b32 v81, 0xffff0000, v81
    v_lshlrev_b32 v94, 16, v96
    v_and_b32 v95, 0xffff0000, v96
    v_lshlrev_b32 v96, 16, v97
    v_and_b32 v97, 0xffff0000, v97
    s_cmp_eq_u32 s65, 0
    s_cbranch_scc1 Lnosp2_33
    s_cmp_eq_u32 s65, 1
    s_cbranch_scc1 Lsp1_34
    v_mov_b32 v192, v144
    v_mov_b32 v193, v148
    ds_write_b64 v109, v[192:193] offset:49408
    v_mov_b32 v192, v145
    v_mov_b32 v193, v149
    ds_write_b64 v109, v[192:193] offset:49536
    v_mov_b32 v192, v146
    v_mov_b32 v193, v150
    ds_write_b64 v109, v[192:193] offset:49664
    v_mov_b32 v192, v147
    v_mov_b32 v193, v151
    ds_write_b64 v109, v[192:193] offset:49792
    s_lshl_b32 s7, s61, 1
    s_sub_u32 s7, 2048, s7
    v_sub_u32 v2, s7, v109
    v_subrev_u32 v2, 0, v2
    v_and_b32 v2, 2047, v2
    ds_read_b64 v[192:193], v2 offset:49408
    v_sub_u32 v2, s7, v109
    v_subrev_u32 v2, 128, v2
    v_and_b32 v2, 2047, v2
    ds_read_b64 v[194:195], v2 offset:49408
    v_sub_u32 v2, s7, v109
    v_subrev_u32 v2, 256, v2
    v_and_b32 v2, 2047, v2
    ds_read_b64 v[196:197], v2 offset:49408
    v_sub_u32 v2, s7, v109
    v_subrev_u32 v2, 384, v2
    v_and_b32 v2, 2047, v2
    ds_read_b64 v[198:199], v2 offset:49408
    s_waitcnt lgkmcnt(0)
    v_mul_f32 v2, v144, v122
    v_mul_f32 v7, v144, v126
    v_fma_f32 v2, -v148, v126, v2
    v_fmac_f32 v7, v148, v122
    v_fmac_f32 v2, v192, v130
    v_fmac_f32 v7, v192, v134
    v_fma_f32 v144, v193, v134, v2
    v_fma_f32 v148, -v193, v130, v7
    v_mov_b32 v66, 1.0
    v_mov_b32 v82, 0
    v_mul_f32 v2, v145, v123
    v_mul_f32 v7, v145, v127
    v_fma_f32 v2, -v149, v127, v2
    v_fmac_f32 v7, v149, v123
    v_fmac_f32 v2, v194, v131
    v_fmac_f32 v7, v194, v135
    v_fma_f32 v145, v195, v135, v2
    v_fma_f32 v149, -v195, v131, v7
    v_mov_b32 v70, 1.0
    v_mov_b32 v86, 0
    v_mul_f32 v2, v146, v124
    v_mul_f32 v7, v146, v128
    v_fma_f32 v2, -v150, v128, v2
    v_fmac_f32 v7, v150, v124
    v_fmac_f32 v2, v196, v132
    v_fmac_f32 v7, v196, v136
    v_fma_f32 v146, v197, v136, v2
    v_fma_f32 v150, -v197, v132, v7
    v_mov_b32 v74, 1.0
    v_mov_b32 v90, 0
    v_mul_f32 v2, v147, v125
    v_mul_f32 v7, v147, v129
    v_fma_f32 v2, -v151, v129, v2
    v_fmac_f32 v7, v151, v125
    v_fmac_f32 v2, v198, v133
    v_fmac_f32 v7, v198, v137
    v_fma_f32 v147, v199, v137, v2
    v_fma_f32 v151, -v199, v133, v7
    v_mov_b32 v78, 1.0
    v_mov_b32 v94, 0
    s_branch Lnosp2_33
Lsp1_34:
    s_cmp_eq_u32 s64, 1
    s_cbranch_scc1 Lsp3_35
    v_mov_b32 v66, v122
    v_mov_b32 v70, v123
    v_mov_b32 v74, v124
    v_mov_b32 v78, v125
    v_mov_b32 v82, v126
    v_mov_b32 v86, v127
    v_mov_b32 v90, v128
    v_mov_b32 v94, v129
    s_branch Lnosp2_33
Lsp3_35:
    v_mov_b32 v69, v122
    v_mov_b32 v73, v123
    v_mov_b32 v77, v124
    v_mov_b32 v81, v125
    v_mov_b32 v85, v126
    v_mov_b32 v89, v127
    v_mov_b32 v93, v128
    v_mov_b32 v97, v129
Lnosp2_33:
    v_mul_f32 v192, v144, v66
    v_mul_f32 v193, v148, v66
    v_mul_f32 v194, v145, v70
    v_mul_f32 v195, v149, v70
    v_mul_f32 v196, v146, v74
    v_mul_f32 v197, v150, v74
    v_mul_f32 v198, v147, v78
    v_mul_f32 v199, v151, v78
    v_fma_f32 v192, v148, -v82, v192
    v_fmac_f32 v193, v144, v82
    v_fma_f32 v194, v149, -v86, v194
    v_fmac_f32 v195, v145, v86
    v_fma_f32 v196, v150, -v90, v196
    v_fmac_f32 v197, v146, v90
    v_fma_f32 v198, v151, -v94, v198
    v_fmac_f32 v199, v147, v94
    v_cvt_pk_bf16_f32 v176, v193, v192
    v_cvt_pk_bf16_f32 v177, v195, v194
    v_cvt_pk_bf16_f32 v178, v197, v196
    v_cvt_pk_bf16_f32 v179, v199, v198
    s_nop 1
    v_mfma_f32_16x16x32_bf16 v[148:151], v[176:179], v[240:243], 0
    v_mfma_f32_16x16x32_bf16 v[144:147], v[176:179], v[244:247], 0
    v_mul_f32 v192, v152, v67
    v_mul_f32 v193, v156, v67
    v_mul_f32 v194, v153, v71
    v_mul_f32 v195, v157, v71
    v_mul_f32 v196, v154, v75
    v_mul_f32 v197, v158, v75
    v_mul_f32 v198, v155, v79
    v_mul_f32 v199, v159, v79
    v_fma_f32 v192, v156, -v83, v192
    v_fmac_f32 v193, v152, v83
    v_fma_f32 v194, v157, -v87, v194
    v_fmac_f32 v195, v153, v87
    v_fma_f32 v196, v158, -v91, v196
    v_fmac_f32 v197, v154, v91
    v_fma_f32 v198, v159, -v95, v198
    v_fmac_f32 v199, v155, v95
    v_cvt_pk_bf16_f32 v180, v193, v192
    v_cvt_pk_bf16_f32 v181, v195, v194
    v_cvt_pk_bf16_f32 v182, v197, v196
    v_cvt_pk_bf16_f32 v183, v199, v198
    s_nop 1
    v_mfma_f32_16x16x32_bf16 v[156:159], v[180:183], v[240:243], 0
    v_mfma_f32_16x16x32_bf16 v[152:155], v[180:183], v[244:247], 0
    v_mul_f32 v192, v160, v68
    v_mul_f32 v193, v164, v68
    v_mul_f32 v194, v161, v72
    v_mul_f32 v195, v165, v72
    v_mul_f32 v196, v162, v76
    v_mul_f32 v197, v166, v76
    v_mul_f32 v198, v163, v80
    v_mul_f32 v199, v167, v80
    v_fma_f32 v192, v164, -v84, v192
    v_fmac_f32 v193, v160, v84
    v_fma_f32 v194, v165, -v88, v194
    v_fmac_f32 v195, v161, v88
    v_fma_f32 v196, v166, -v92, v196
    v_fmac_f32 v197, v162, v92
    v_fma_f32 v198, v167, -v96, v198
    v_fmac_f32 v199, v163, v96
    v_cvt_pk_bf16_f32 v184, v193, v192
    v_cvt_pk_bf16_f32 v185, v195, v194
    v_cvt_pk_bf16_f32 v186, v197, v196
    v_cvt_pk_bf16_f32 v187, v199, v198
    s_nop 1
    v_mfma_f32_16x16x32_bf16 v[164:167], v[184:187], v[240:243], 0
    v_mfma_f32_16x16x32_bf16 v[160:163], v[184:187], v[244:247], 0
    v_mul_f32 v192, v168, v69
    v_mul_f32 v193, v172, v69
    v_mul_f32 v194, v169, v73
    v_mul_f32 v195, v173, v73
    v_mul_f32 v196, v170, v77
    v_mul_f32 v197, v174, v77
    v_mul_f32 v198, v171, v81
    v_mul_f32 v199, v175, v81
    v_fma_f32 v192, v172, -v85, v192
    v_fmac_f32 v193, v168, v85
    v_fma_f32 v194, v173, -v89, v194
    v_fmac_f32 v195, v169, v89
    v_fma_f32 v196, v174, -v93, v196
    v_fmac_f32 v197, v170, v93
    v_fma_f32 v198, v175, -v97, v198
    v_fmac_f32 v199, v171, v97
    v_cvt_pk_bf16_f32 v188, v193, v192
    v_cvt_pk_bf16_f32 v189, v195, v194
    v_cvt_pk_bf16_f32 v190, v197, v196
    v_cvt_pk_bf16_f32 v191, v199, v198
    s_nop 1
    v_mfma_f32_16x16x32_bf16 v[172:175], v[188:191], v[240:243], 0
    v_mfma_f32_16x16x32_bf16 v[168:171], v[188:191], v[244:247], 0
    v_mul_f32 v192, v144, v232
    v_mul_f32 v193, v148, v232
    v_mul_f32 v194, v145, v233
    v_mul_f32 v195, v149, v233
    v_mul_f32 v196, v146, v234
    v_mul_f32 v197, v150, v234
    v_mul_f32 v198, v147, v235
    v_mul_f32 v199, v151, v235
    v_fma_f32 v192, v148, -v236, v192
    v_fmac_f32 v193, v144, v236
    v_fma_f32 v194, v149, -v237, v194
    v_fmac_f32 v195, v145, v237
    v_fma_f32 v196, v150, -v238, v196
    v_fmac_f32 v197, v146, v238
    v_fma_f32 v198, v151, -v239, v198
    v_fmac_f32 v199, v147, v239
    v_cvt_pk_bf16_f32 v176, v192, v193
    v_cvt_pk_bf16_f32 v177, v194, v195
    v_cvt_pk_bf16_f32 v178, v196, v197
    v_cvt_pk_bf16_f32 v179, v198, v199
    s_nop 1
    v_mfma_f32_16x16x32_bf16 v[144:147], v[216:219], v[176:179], 0
    v_mfma_f32_16x16x32_bf16 v[148:151], v[220:223], v[176:179], 0
    v_mul_f32 v192, v152, v232
    v_mul_f32 v193, v156, v232
    v_mul_f32 v194, v153, v233
    v_mul_f32 v195, v157, v233
    v_mul_f32 v196, v154, v234
    v_mul_f32 v197, v158, v234
    v_mul_f32 v198, v155, v235
    v_mul_f32 v199, v159, v235
    v_fma_f32 v192, v156, -v236, v192
    v_fmac_f32 v193, v152, v236
    v_fma_f32 v194, v157, -v237, v194
    v_fmac_f32 v195, v153, v237
    v_fma_f32 v196, v158, -v238, v196
    v_fmac_f32 v197, v154, v238
    v_fma_f32 v198, v159, -v239, v198
    v_fmac_f32 v199, v155, v239
    v_cvt_pk_bf16_f32 v180, v192, v193
    v_cvt_pk_bf16_f32 v181, v194, v195
    v_cvt_pk_bf16_f32 v182, v196, v197
    v_cvt_pk_bf16_f32 v183, v198, v199
    s_nop 1
    v_mfma_f32_16x16x32_bf16 v[152:155], v[216:219], v[180:183], 0
    v_mfma_f32_16x16x32_bf16 v[156:159], v[220:223], v[180:183], 0
    v_mul_f32 v192, v160, v232
    v_mul_f32 v193, v164, v232
    v_mul_f32 v194, v161, v233
    v_mul_f32 v195, v165, v233
    v_mul_f32 v196, v162, v234
    v_mul_f32 v197, v166, v234
    v_mul_f32 v198, v163, v235
    v_mul_f32 v199, v167, v235
    v_fma_f32 v192, v164, -v236, v192
    v_fmac_f32 v193, v160, v236
    v_fma_f32 v194, v165, -v237, v194
    v_fmac_f32 v195, v161, v237
    v_fma_f32 v196, v166, -v238, v196
    v_fmac_f32 v197, v162, v238
    v_fma_f32 v198, v167, -v239, v198
    v_fmac_f32 v199, v163, v239
    v_cvt_pk_bf16_f32 v184, v192, v193
    v_cvt_pk_bf16_f32 v185, v194, v195
    v_cvt_pk_bf16_f32 v186, v196, v197
    v_cvt_pk_bf16_f32 v187, v198, v199
    s_nop 1
    v_mfma_f32_16x16x32_bf16 v[160:163], v[216:219], v[184:187], 0
    v_mfma_f32_16x16x32_bf16 v[164:167], v[220:223], v[184:187], 0
    v_mul_f32 v192, v168, v232
    v_mul_f32 v193, v172, v232
    v_mul_f32 v194, v169, v233
    v_mul_f32 v195, v173, v233
    v_mul_f32 v196, v170, v234
    v_mul_f32 v197, v174, v234
    v_mul_f32 v198, v171, v235
    v_mul_f32 v199, v175, v235
    v_fma_f32 v192, v172, -v236, v192
    v_fmac_f32 v193, v168, v236
    v_fma_f32 v194, v173, -v237, v194
    v_fmac_f32 v195, v169, v237
    v_fma_f32 v196, v174, -v238, v196
    v_fmac_f32 v197, v170, v238
    v_fma_f32 v198, v175, -v239, v198
    v_fmac_f32 v199, v171, v239
    v_cvt_pk_bf16_f32 v188, v192, v193
    v_cvt_pk_bf16_f32 v189, v194, v195
    v_cvt_pk_bf16_f32 v190, v196, v197
    v_cvt_pk_bf16_f32 v191, v198, v199
    s_nop 1
    v_mfma_f32_16x16x32_bf16 v[168:171], v[216:219], v[188:191], 0
    v_mfma_f32_16x16x32_bf16 v[172:175], v[220:223], v[188:191], 0
    v_cvt_pk_bf16_f32 v10, v144, v148
    v_and_or_b32 v10, v10, s58, v9
    v_cvt_pk_bf16_f32 v11, v152, v156
    v_and_or_b32 v11, v11, s58, v9
    v_cvt_pk_bf16_f32 v12, v160, v164
    v_and_or_b32 v12, v12, s58, v9
    s_nop 1
    v_cvt_pk_bf16_f32 v13, v168, v172
    v_and_or_b32 v13, v13, s58, v9
    ds_write_b128 v8, v[10:13] offset:16640
    v_cvt_pk_bf16_f32 v14, v145, v149
    v_and_or_b32 v14, v14, s58, v9
    v_cvt_pk_bf16_f32 v15, v153, v157
    v_and_or_b32 v15, v15, s58, v9
    v_cvt_pk_bf16_f32 v16, v161, v165
    v_and_or_b32 v16, v16, s58, v9
    v_cvt_pk_bf16_f32 v17, v169, v173
    v_and_or_b32 v17, v17, s58, v9
    ds_write_b128 v8, v[14:17] offset:17664
    v_cvt_pk_bf16_f32 v18, v146, v150
    v_and_or_b32 v18, v18, s58, v9
    v_cvt_pk_bf16_f32 v19, v154, v158
    v_and_or_b32 v19, v19, s58, v9
    v_cvt_pk_bf16_f32 v20, v162, v166
    v_and_or_b32 v20, v20, s58, v9
    v_cvt_pk_bf16_f32 v21, v170, v174
    v_and_or_b32 v21, v21, s58, v9
    ds_write_b128 v8, v[18:21] offset:18688
    v_cvt_pk_bf16_f32 v22, v147, v151
    v_and_or_b32 v22, v22, s58, v9
    v_cvt_pk_bf16_f32 v23, v155, v159
    v_and_or_b32 v23, v23, s58, v9
    v_cvt_pk_bf16_f32 v24, v163, v167
    v_and_or_b32 v24, v24, s58, v9
    v_cvt_pk_bf16_f32 v25, v171, v175
    v_and_or_b32 v25, v25, s58, v9
    ds_write_b128 v8, v[22:25] offset:19712
    s_waitcnt vmcnt(0)
    s_waitcnt lgkmcnt(0)
    s_barrier
    ds_read_b128 v[10:13], v107 offset:16640
    ds_read_b128 v[14:17], v107 offset:20736
    ds_read_b128 v[18:21], v107 offset:24832
    ds_read_b128 v[22:25], v107 offset:28928
    s_waitcnt lgkmcnt(3)
    buffer_store_dwordx4 v[10:13], v106, s[40:43], s78 offen sc1
    s_waitcnt lgkmcnt(2)
    buffer_store_dwordx4 v[14:17], v106, s[40:43], s67 offen sc1
    s_waitcnt lgkmcnt(1)
    buffer_store_dwordx4 v[18:21], v106, s[40:43], s68 offen sc1
    s_waitcnt lgkmcnt(0)
    buffer_store_dwordx4 v[22:25], v106, s[40:43], s69 offen sc1
    s_setprio 0
    v_mfma_f32_32x32x16_bf16 v[208:223], v[248:251], v[26:29], 0
    v_mfma_f32_32x32x16_bf16 v[224:239], v[248:251], v[34:37], 0
    v_mfma_f32_32x32x16_bf16 v[208:223], v[252:255], v[30:33], v[208:223]
    v_mfma_f32_32x32x16_bf16 v[224:239], v[252:255], v[38:41], v[224:239]
    v_and_b32 v7, 31, v1
    v_lshrrev_b32 v6, 5, v1
    v_lshlrev_b32 v4, 9, v6
    v_lshl_add_u32 v4, v7, 2, v4
    v_sub_u32 v5, 636, v4
    v_mul_u32_u24 v6, 576, v6
    v_lshl_add_u32 v6, v7, 4, v6
    s_mul_i32 s66, s56, 4864
    v_add_u32 v6, s66, v6
    v_bfe_u32 v8, v1, 2, 2
    v_mul_u32_u24 v8, 2432, v8
    v_and_b32 v7, 1, v1
    v_mul_u32_u24 v7, 576, v7
    v_add_u32 v8, v8, v7
    v_bfe_u32 v7, v1, 1, 1
    v_lshl_add_u32 v8, v7, 4, v8
    v_lshrrev_b32 v7, 4, v0
    v_lshl_add_u32 v8, v7, 5, v8
    s_lshl_b32 s77, s60, 14
    s_add_u32 s68, s77, 9437184
    s_lshl_b32 s66, s56, 11
    s_add_u32 s66, s66, s68
    s_lshl_b32 s67, s6, 11
    s_add_u32 s67, s67, s68
    s_add_u32 s77, s77, 13631488
    s_add_u32 s78, s77, 4096
    s_add_u32 s68, s77, 8192
    s_add_u32 s69, s77, 12288
    v_cmp_gt_u32 vcc, 32, v1
    s_nop 1
    v_cndmask_b32 v240, 0, 0.5, vcc
    v_bfe_u32 v7, v1, 3, 1
    v_lshlrev_b32 v7, 31, v7
    v_xor_b32 v241, v7, v240
    s_waitcnt vmcnt(0)
    v_bfe_u32 v246, v1, 3, 2
    v_and_b32 v247, 3, v1
    v_lshl_add_u32 v246, v247, 2, v246
    v_bfe_u32 v247, v1, 2, 1
    v_lshl_add_u32 v246, v247, 4, v246
    v_cvt_f32_u32 v246, v246
    v_lshrrev_b32 v247, 3, v1
    v_and_b32 v247, 4, v247
    v_cvt_f32_u32 v247, v247
    v_mul_f32 v246, 0x3d000000, v246
    v_mul_f32 v247, v246, v247
    v_bfe_i32 v2, v1, 3, 1
    v_and_b32 v2, 0x80008000, v2
    v_xor_b32 v2, 0x80000000, v2
    v_mov_b32 v180, v247
    v_cos_f32 v176, v180
    v_sin_f32 v180, v180
    v_add_f32 v181, v246, v247
    v_cos_f32 v177, v181
    v_sin_f32 v181, v181
    v_fmamk_f32 v182, v246, 0x40000000, v247
    v_cos_f32 v178, v182
    v_sin_f32 v182, v182
    v_fmamk_f32 v183, v246, 0x40400000, v247
    v_cos_f32 v179, v183
    v_sin_f32 v183, v183
    v_cvt_pk_bf16_f32 v106, v176, -v180
    v_cvt_pk_bf16_f32 v110, v180, v176
    v_cvt_pk_bf16_f32 v107, v177, -v181
    v_cvt_pk_bf16_f32 v111, v181, v177
    v_cvt_pk_bf16_f32 v108, v178, -v182
    v_cvt_pk_bf16_f32 v112, v182, v178
    v_cvt_pk_bf16_f32 v109, v179, -v183
    v_cvt_pk_bf16_f32 v113, v183, v179
    v_fmamk_f32 v180, v246, 0x41000000, v247
    v_cos_f32 v176, v180
    v_sin_f32 v180, v180
    v_fmamk_f32 v181, v246, 0x41100000, v247
    v_cos_f32 v177, v181
    v_sin_f32 v181, v181
    v_fmamk_f32 v182, v246, 0x41200000, v247
    v_cos_f32 v178, v182
    v_sin_f32 v182, v182
    v_fmamk_f32 v183, v246, 0x41300000, v247
    v_cos_f32 v179, v183
    v_sin_f32 v183, v183
    v_cvt_pk_bf16_f32 v114, v176, -v180
    v_cvt_pk_bf16_f32 v118, v180, v176
    v_cvt_pk_bf16_f32 v115, v177, -v181
    v_cvt_pk_bf16_f32 v119, v181, v177
    v_cvt_pk_bf16_f32 v116, v178, -v182
    v_cvt_pk_bf16_f32 v120, v182, v178
    v_cvt_pk_bf16_f32 v117, v179, -v183
    v_cvt_pk_bf16_f32 v121, v183, v179
    v_xor_b32 v122, v2, v106
    v_xor_b32 v123, v2, v107
    v_xor_b32 v124, v2, v108
    v_xor_b32 v125, v2, v109
    v_xor_b32 v126, v2, v110
    v_xor_b32 v127, v2, v111
    v_xor_b32 v128, v2, v112
    v_xor_b32 v129, v2, v113
    v_xor_b32 v130, v2, v114
    v_xor_b32 v131, v2, v115
    v_xor_b32 v132, v2, v116
    v_xor_b32 v133, v2, v117
    v_xor_b32 v134, v2, v118
    v_xor_b32 v135, v2, v119
    v_xor_b32 v136, v2, v120
    v_xor_b32 v137, v2, v121
    v_mul_f32 v246, 0x3d000000, v246
    v_mul_f32 v247, 0x3d000000, v247
    v_mov_b32 v82, v247
    v_cos_f32 v66, v82
    v_sin_f32 v82, v82
    v_add_f32 v83, v246, v247
    v_cos_f32 v67, v83
    v_sin_f32 v83, v83
    v_fmamk_f32 v84, v246, 0x40000000, v247
    v_cos_f32 v68, v84
    v_sin_f32 v84, v84
    v_fmamk_f32 v85, v246, 0x40400000, v247
    v_cos_f32 v69, v85
    v_sin_f32 v85, v85
    v_fmamk_f32 v86, v246, 0x41000000, v247
    v_cos_f32 v70, v86
    v_sin_f32 v86, v86
    v_fmamk_f32 v87, v246, 0x41100000, v247
    v_cos_f32 v71, v87
    v_sin_f32 v87, v87
    v_fmamk_f32 v88, v246, 0x41200000, v247
    v_cos_f32 v72, v88
    v_sin_f32 v88, v88
    v_fmamk_f32 v89, v246, 0x41300000, v247
    v_cos_f32 v73, v89
    v_sin_f32 v89, v89
    v_fmamk_f32 v90, v246, 0x41800000, v247
    v_cos_f32 v74, v90
    v_sin_f32 v90, v90
    v_fmamk_f32 v91, v246, 0x41880000, v247
    v_cos_f32 v75, v91
    v_sin_f32 v91, v91
    v_fmamk_f32 v92, v246, 0x41900000, v247
    v_cos_f32 v76, v92
    v_sin_f32 v92, v92
    v_fmamk_f32 v93, v246, 0x41980000, v247
    v_cos_f32 v77, v93
    v_sin_f32 v93, v93
    v_fmamk_f32 v94, v246, 0x41c00000, v247
    v_cos_f32 v78, v94
    v_sin_f32 v94, v94
    v_fmamk_f32 v95, v246, 0x41c80000, v247
    v_cos_f32 v79, v95
    v_sin_f32 v95, v95
    v_fmamk_f32 v96, v246, 0x41d00000, v247
    v_cos_f32 v80, v96
    v_sin_f32 v96, v96
    v_fmamk_f32 v97, v246, 0x41d80000, v247
    v_cos_f32 v81, v97
    v_sin_f32 v97, v97
    s_waitcnt lgkmcnt(0)
    s_cmp_eq_u32 s56, 0
    s_cbranch_scc1 Lb3real_36
    buffer_load_dword v10, v4, s[40:43], s66 offen offset:0 sc1
    buffer_load_dword v11, v4, s[40:43], s66 offen offset:128 sc1
    buffer_load_dword v12, v4, s[40:43], s66 offen offset:256 sc1
    buffer_load_dword v13, v4, s[40:43], s66 offen offset:384 sc1
    buffer_load_dword v14, v4, s[40:43], s66 offen offset:1024 sc1
    buffer_load_dword v15, v4, s[40:43], s66 offen offset:1152 sc1
    buffer_load_dword v16, v4, s[40:43], s66 offen offset:1280 sc1
    buffer_load_dword v17, v4, s[40:43], s66 offen offset:1408 sc1
    buffer_load_dword v18, v5, s[40:43], s67 offen offset:1408 sc1
    buffer_load_dword v19, v5, s[40:43], s67 offen offset:1280 sc1
    buffer_load_dword v20, v5, s[40:43], s67 offen offset:1152 sc1
    buffer_load_dword v21, v5, s[40:43], s67 offen offset:1024 sc1
    buffer_load_dword v22, v5, s[40:43], s67 offen offset:384 sc1
    buffer_load_dword v23, v5, s[40:43], s67 offen offset:256 sc1
    buffer_load_dword v24, v5, s[40:43], s67 offen offset:128 sc1
    buffer_load_dword v25, v5, s[40:43], s67 offen offset:0 sc1
Lpoll_38:
    s_waitcnt vmcnt(0)
Lchk_40:
    v_xor_b32 v2, s57, v10
    v_bitop3_b32 v2, v2, v11, s57 bitop3:0xf6
    v_bitop3_b32 v2, v2, v12, s57 bitop3:0xf6
    v_bitop3_b32 v2, v2, v13, s57 bitop3:0xf6
    v_bitop3_b32 v2, v2, v14, s57 bitop3:0xf6
    v_bitop3_b32 v2, v2, v15, s57 bitop3:0xf6
    v_bitop3_b32 v2, v2, v16, s57 bitop3:0xf6
    v_bitop3_b32 v2, v2, v17, s57 bitop3:0xf6
    v_bitop3_b32 v2, v2, v18, s57 bitop3:0xf6
    v_bitop3_b32 v2, v2, v19, s57 bitop3:0xf6
    v_bitop3_b32 v2, v2, v20, s57 bitop3:0xf6
    v_bitop3_b32 v2, v2, v21, s57 bitop3:0xf6
    v_bitop3_b32 v2, v2, v22, s57 bitop3:0xf6
    v_bitop3_b32 v2, v2, v23, s57 bitop3:0xf6
    v_bitop3_b32 v2, v2, v24, s57 bitop3:0xf6
    v_bitop3_b32 v2, v2, v25, s57 bitop3:0xf6
    v_and_b32 v2, 65537, v2
    v_cmp_ne_u32 vcc, 0, v2
    s_cbranch_vccz Lok_39
    s_sleep 2
    v_xor_b32 v2, s57, v10
    v_and_b32 v2, 65537, v2
    v_cmp_ne_u32 vcc, 0, v2
    s_cbranch_vccz Lskip_41
    buffer_load_dword v10, v4, s[40:43], s66 offen offset:0 sc1
Lskip_41:
    v_xor_b32 v2, s57, v11
    v_and_b32 v2, 65537, v2
    v_cmp_ne_u32 vcc, 0, v2
    s_cbranch_vccz Lskip_42
    buffer_load_dword v11, v4, s[40:43], s66 offen offset:128 sc1
Lskip_42:
    v_xor_b32 v2, s57, v12
    v_and_b32 v2, 65537, v2
    v_cmp_ne_u32 vcc, 0, v2
    s_cbranch_vccz Lskip_43
    buffer_load_dword v12, v4, s[40:43], s66 offen offset:256 sc1
Lskip_43:
    v_xor_b32 v2, s57, v13
    v_and_b32 v2, 65537, v2
    v_cmp_ne_u32 vcc, 0, v2
    s_cbranch_vccz Lskip_44
    buffer_load_dword v13, v4, s[40:43], s66 offen offset:384 sc1
Lskip_44:
    v_xor_b32 v2, s57, v14
    v_and_b32 v2, 65537, v2
    v_cmp_ne_u32 vcc, 0, v2
    s_cbranch_vccz Lskip_45
    buffer_load_dword v14, v4, s[40:43], s66 offen offset:1024 sc1
Lskip_45:
    v_xor_b32 v2, s57, v15
    v_and_b32 v2, 65537, v2
    v_cmp_ne_u32 vcc, 0, v2
    s_cbranch_vccz Lskip_46
    buffer_load_dword v15, v4, s[40:43], s66 offen offset:1152 sc1
Lskip_46:
    v_xor_b32 v2, s57, v16
    v_and_b32 v2, 65537, v2
    v_cmp_ne_u32 vcc, 0, v2
    s_cbranch_vccz Lskip_47
    buffer_load_dword v16, v4, s[40:43], s66 offen offset:1280 sc1
Lskip_47:
    v_xor_b32 v2, s57, v17
    v_and_b32 v2, 65537, v2
    v_cmp_ne_u32 vcc, 0, v2
    s_cbranch_vccz Lskip_48
    buffer_load_dword v17, v4, s[40:43], s66 offen offset:1408 sc1
Lskip_48:
    v_xor_b32 v2, s57, v18
    v_and_b32 v2, 65537, v2
    v_cmp_ne_u32 vcc, 0, v2
    s_cbranch_vccz Lskip_49
    buffer_load_dword v18, v5, s[40:43], s67 offen offset:1408 sc1
Lskip_49:
    v_xor_b32 v2, s57, v19
    v_and_b32 v2, 65537, v2
    v_cmp_ne_u32 vcc, 0, v2
    s_cbranch_vccz Lskip_50
    buffer_load_dword v19, v5, s[40:43], s67 offen offset:1280 sc1
Lskip_50:
    v_xor_b32 v2, s57, v20
    v_and_b32 v2, 65537, v2
    v_cmp_ne_u32 vcc, 0, v2
    s_cbranch_vccz Lskip_51
    buffer_load_dword v20, v5, s[40:43], s67 offen offset:1152 sc1
Lskip_51:
    v_xor_b32 v2, s57, v21
    v_and_b32 v2, 65537, v2
    v_cmp_ne_u32 vcc, 0, v2
    s_cbranch_vccz Lskip_52
    buffer_load_dword v21, v5, s[40:43], s67 offen offset:1024 sc1
Lskip_52:
    v_xor_b32 v2, s57, v22
    v_and_b32 v2, 65537, v2
    v_cmp_ne_u32 vcc, 0, v2
    s_cbranch_vccz Lskip_53
    buffer_load_dword v22, v5, s[40:43], s67 offen offset:384 sc1
Lskip_53:
    v_xor_b32 v2, s57, v23
    v_and_b32 v2, 65537, v2
    v_cmp_ne_u32 vcc, 0, v2
    s_cbranch_vccz Lskip_54
    buffer_load_dword v23, v5, s[40:43], s67 offen offset:256 sc1
Lskip_54:
    v_xor_b32 v2, s57, v24
    v_and_b32 v2, 65537, v2
    v_cmp_ne_u32 vcc, 0, v2
    s_cbranch_vccz Lskip_55
    buffer_load_dword v24, v5, s[40:43], s67 offen offset:128 sc1
Lskip_55:
    v_xor_b32 v2, s57, v25
    v_and_b32 v2, 65537, v2
    v_cmp_ne_u32 vcc, 0, v2
    s_cbranch_vccz Lskip_56
    buffer_load_dword v25, v5, s[40:43], s67 offen offset:0 sc1
Lskip_56:
    s_add_u32 s74, s74, 1
    s_cmp_lt_u32 s74, 32768
    s_cbranch_scc1 Lpoll_38
    s_waitcnt vmcnt(0)
Lok_39:
    v_mfma_f32_32x32x16_bf16 v[144:159], v[10:13], v[106:109], 0
    v_lshlrev_b32 v2, 16, v142
    v_mul_f32 v208, v2, v208
    v_mul_f32 v209, v2, v209
    v_mul_f32 v210, v2, v210
    v_mfma_f32_32x32x16_bf16 v[160:175], v[10:13], v[110:113], 0
    v_mul_f32 v211, v2, v211
    v_mul_f32 v212, v2, v212
    v_mul_f32 v213, v2, v213
    v_mul_f32 v214, v2, v214
    v_mul_f32 v215, v2, v215
    v_mfma_f32_32x32x16_bf16 v[144:159], v[14:17], v[114:117], v[144:159]
    v_and_b32 v2, 0xffff0000, v142
    v_mul_f32 v216, v2, v216
    v_mul_f32 v217, v2, v217
    v_mul_f32 v218, v2, v218
    v_mul_f32 v219, v2, v219
    v_mfma_f32_32x32x16_bf16 v[160:175], v[14:17], v[118:121], v[160:175]
    v_mul_f32 v220, v2, v220
    v_mul_f32 v221, v2, v221
    v_mul_f32 v222, v2, v222
    v_mul_f32 v223, v2, v223
    v_mfma_f32_32x32x16_bf16 v[144:159], v[18:21], v[122:125], v[144:159]
    v_lshlrev_b32 v2, 16, v143
    v_mul_f32 v224, v2, v224
    v_mul_f32 v225, v2, v225
    v_mul_f32 v226, v2, v226
    v_mfma_f32_32x32x16_bf16 v[160:175], v[18:21], v[126:129], v[160:175]
    v_mul_f32 v227, v2, v227
    v_mul_f32 v228, v2, v228
    v_mul_f32 v229, v2, v229
    v_mul_f32 v230, v2, v230
    v_mul_f32 v231, v2, v231
    v_mfma_f32_32x32x16_bf16 v[144:159], v[22:25], v[130:133], v[144:159]
    v_and_b32 v2, 0xffff0000, v143
    v_mul_f32 v232, v2, v232
    v_mul_f32 v233, v2, v233
    v_mul_f32 v234, v2, v234
    v_mul_f32 v235, v2, v235
    v_mfma_f32_32x32x16_bf16 v[160:175], v[22:25], v[134:137], v[160:175]
    v_mul_f32 v236, v2, v236
    v_mul_f32 v237, v2, v237
    v_mul_f32 v238, v2, v238
    v_mul_f32 v239, v2, v239
    s_nop 1
    v_mul_f32 v106, v144, v66
    s_nop 4
    v_mul_f32 v108, v160, v66
    v_mul_f32 v107, v145, v67
    v_mul_f32 v109, v161, v67
    v_fma_f32 v106, v160, -v82, v106
    v_fmac_f32 v108, v144, v82
    v_fma_f32 v107, v161, -v83, v107
    v_fmac_f32 v109, v145, v83
    v_cvt_pk_bf16_f32 v10, v106, v107
    v_cvt_pk_bf16_f32 v18, v108, v109
    v_mul_f32 v110, v146, v68
    v_mul_f32 v112, v162, v68
    v_mul_f32 v111, v147, v69
    v_mul_f32 v113, v163, v69
    v_fma_f32 v110, v162, -v84, v110
    v_fmac_f32 v112, v146, v84
    v_fma_f32 v111, v163, -v85, v111
    v_fmac_f32 v113, v147, v85
    v_cvt_pk_bf16_f32 v11, v110, v111
    v_cvt_pk_bf16_f32 v19, v112, v113
    v_mul_f32 v106, v148, v70
    v_mul_f32 v108, v164, v70
    v_mul_f32 v107, v149, v71
    v_mul_f32 v109, v165, v71
    v_fma_f32 v106, v164, -v86, v106
    v_fmac_f32 v108, v148, v86
    v_fma_f32 v107, v165, -v87, v107
    v_fmac_f32 v109, v149, v87
    v_cvt_pk_bf16_f32 v12, v106, v107
    v_cvt_pk_bf16_f32 v20, v108, v109
    v_mul_f32 v110, v150, v72
    v_mul_f32 v112, v166, v72
    v_mul_f32 v111, v151, v73
    v_mul_f32 v113, v167, v73
    v_fma_f32 v110, v166, -v88, v110
    v_fmac_f32 v112, v150, v88
    v_fma_f32 v111, v167, -v89, v111
    v_fmac_f32 v113, v151, v89
    v_cvt_pk_bf16_f32 v13, v110, v111
    v_cvt_pk_bf16_f32 v21, v112, v113
    buffer_load_dwordx4 v[26:29], v3, s[40:43], s77 offen sc1
    buffer_load_dwordx4 v[30:33], v3, s[40:43], s78 offen sc1
    buffer_load_dwordx4 v[34:37], v3, s[40:43], s68 offen sc1
    buffer_load_dwordx4 v[38:41], v3, s[40:43], s69 offen sc1
    v_mfma_f32_32x32x16_bf16 v[176:191], v[10:13], v[42:45], 0
    v_mul_f32 v106, v152, v74
    v_mul_f32 v108, v168, v74
    v_mul_f32 v107, v153, v75
    v_mul_f32 v109, v169, v75
    v_fma_f32 v106, v168, -v90, v106
    v_fmac_f32 v108, v152, v90
    v_fma_f32 v107, v169, -v91, v107
    v_mfma_f32_32x32x16_bf16 v[192:207], v[10:13], v[58:61], 0
    v_fmac_f32 v109, v153, v91
    v_cvt_pk_bf16_f32 v14, v106, v107
    v_cvt_pk_bf16_f32 v22, v108, v109
    v_mul_f32 v110, v154, v76
    v_mul_f32 v112, v170, v76
    v_mul_f32 v111, v155, v77
    v_mul_f32 v113, v171, v77
    v_mfma_f32_32x32x16_bf16 v[176:191], v[18:21], v[50:53], v[176:191]
    v_fma_f32 v110, v170, -v92, v110
    v_fmac_f32 v112, v154, v92
    v_fma_f32 v111, v171, -v93, v111
    v_fmac_f32 v113, v155, v93
    v_cvt_pk_bf16_f32 v15, v110, v111
    v_cvt_pk_bf16_f32 v23, v112, v113
    v_mul_f32 v106, v156, v78
    v_mfma_f32_32x32x16_bf16 v[192:207], v[18:21], v[42:45], v[192:207]
    v_mul_f32 v108, v172, v78
    v_mul_f32 v107, v157, v79
    v_mul_f32 v109, v173, v79
    v_fma_f32 v106, v172, -v94, v106
    v_fmac_f32 v108, v156, v94
    v_fma_f32 v107, v173, -v95, v107
    v_fmac_f32 v109, v157, v95
    v_cvt_pk_bf16_f32 v16, v106, v107
    v_cvt_pk_bf16_f32 v24, v108, v109
    v_mul_f32 v110, v158, v80
    v_mul_f32 v112, v174, v80
    v_mul_f32 v111, v159, v81
    v_mul_f32 v113, v175, v81
    v_fma_f32 v110, v174, -v96, v110
    v_fmac_f32 v112, v158, v96
    v_fma_f32 v111, v175, -v97, v111
    v_fmac_f32 v113, v159, v97
    v_cvt_pk_bf16_f32 v17, v110, v111
    v_cvt_pk_bf16_f32 v25, v112, v113
    s_nop 0
    v_mfma_f32_32x32x16_bf16 v[176:191], v[14:17], v[46:49], v[176:191]
    v_mfma_f32_32x32x16_bf16 v[176:191], v[22:25], v[54:57], v[176:191]
    v_mfma_f32_32x32x16_bf16 v[192:207], v[14:17], v[62:65], v[192:207]
    v_mfma_f32_32x32x16_bf16 v[192:207], v[22:25], v[46:49], v[192:207]
    s_nop 9
    v_cvt_pk_bf16_f32 v10, v176, v177
    v_cvt_pk_bf16_f32 v11, v178, v179
    v_cvt_pk_bf16_f32 v12, v180, v181
    v_cvt_pk_bf16_f32 v13, v182, v183
    ds_write_b128 v6, v[10:13] offset:33024
    v_cvt_pk_bf16_f32 v14, v184, v185
    v_cvt_pk_bf16_f32 v15, v186, v187
    v_cvt_pk_bf16_f32 v16, v188, v189
    v_cvt_pk_bf16_f32 v17, v190, v191
    ds_write_b128 v6, v[14:17] offset:34176
    v_cvt_pk_bf16_f32 v18, v192, v193
    v_cvt_pk_bf16_f32 v19, v194, v195
    v_cvt_pk_bf16_f32 v20, v196, v197
    v_cvt_pk_bf16_f32 v21, v198, v199
    ds_write_b128 v6, v[18:21] offset:35456
    v_cvt_pk_bf16_f32 v22, v200, v201
    v_cvt_pk_bf16_f32 v23, v202, v203
    v_cvt_pk_bf16_f32 v24, v204, v205
    v_cvt_pk_bf16_f32 v25, v206, v207
    ds_write_b128 v6, v[22:25] offset:36608
    s_branch Lb3done_37
Lb3real_36:
    buffer_load_dword v10, v4, s[40:43], s66 offen offset:0 sc1
    buffer_load_dword v11, v4, s[40:43], s66 offen offset:128 sc1
    buffer_load_dword v12, v4, s[40:43], s66 offen offset:256 sc1
    buffer_load_dword v13, v4, s[40:43], s66 offen offset:384 sc1
    buffer_load_dword v14, v4, s[40:43], s66 offen offset:1024 sc1
    buffer_load_dword v15, v4, s[40:43], s66 offen offset:1152 sc1
    buffer_load_dword v16, v4, s[40:43], s66 offen offset:1280 sc1
    buffer_load_dword v17, v4, s[40:43], s66 offen offset:1408 sc1
    buffer_load_dword v18, v4, s[40:43], s67 offen offset:0 sc1
    buffer_load_dword v19, v4, s[40:43], s67 offen offset:128 sc1
    buffer_load_dword v20, v4, s[40:43], s67 offen offset:256 sc1
    buffer_load_dword v21, v4, s[40:43], s67 offen offset:384 sc1
    buffer_load_dword v22, v4, s[40:43], s67 offen offset:1024 sc1
    buffer_load_dword v23, v4, s[40:43], s67 offen offset:1152 sc1
    buffer_load_dword v24, v4, s[40:43], s67 offen offset:1280 sc1
    buffer_load_dword v25, v4, s[40:43], s67 offen offset:1408 sc1
Lpoll_57:
    s_waitcnt vmcnt(0)
Lchk_59:
    v_xor_b32 v2, s57, v10
    v_bitop3_b32 v2, v2, v11, s57 bitop3:0xf6
    v_bitop3_b32 v2, v2, v12, s57 bitop3:0xf6
    v_bitop3_b32 v2, v2, v13, s57 bitop3:0xf6
    v_bitop3_b32 v2, v2, v14, s57 bitop3:0xf6
    v_bitop3_b32 v2, v2, v15, s57 bitop3:0xf6
    v_bitop3_b32 v2, v2, v16, s57 bitop3:0xf6
    v_bitop3_b32 v2, v2, v17, s57 bitop3:0xf6
    v_bitop3_b32 v2, v2, v18, s57 bitop3:0xf6
    v_bitop3_b32 v2, v2, v19, s57 bitop3:0xf6
    v_bitop3_b32 v2, v2, v20, s57 bitop3:0xf6
    v_bitop3_b32 v2, v2, v21, s57 bitop3:0xf6
    v_bitop3_b32 v2, v2, v22, s57 bitop3:0xf6
    v_bitop3_b32 v2, v2, v23, s57 bitop3:0xf6
    v_bitop3_b32 v2, v2, v24, s57 bitop3:0xf6
    v_bitop3_b32 v2, v2, v25, s57 bitop3:0xf6
    v_and_b32 v2, 65537, v2
    v_cmp_ne_u32 vcc, 0, v2
    s_cbranch_vccz Lok_58
    s_sleep 2
    v_xor_b32 v2, s57, v10
    v_and_b32 v2, 65537, v2
    v_cmp_ne_u32 vcc, 0, v2
    s_cbranch_vccz Lskip_60
    buffer_load_dword v10, v4, s[40:43], s66 offen offset:0 sc1
Lskip_60:
    v_xor_b32 v2, s57, v11
    v_and_b32 v2, 65537, v2
    v_cmp_ne_u32 vcc, 0, v2
    s_cbranch_vccz Lskip_61
    buffer_load_dword v11, v4, s[40:43], s66 offen offset:128 sc1
Lskip_61:
    v_xor_b32 v2, s57, v12
    v_and_b32 v2, 65537, v2
    v_cmp_ne_u32 vcc, 0, v2
    s_cbranch_vccz Lskip_62
    buffer_load_dword v12, v4, s[40:43], s66 offen offset:256 sc1
Lskip_62:
    v_xor_b32 v2, s57, v13
    v_and_b32 v2, 65537, v2
    v_cmp_ne_u32 vcc, 0, v2
    s_cbranch_vccz Lskip_63
    buffer_load_dword v13, v4, s[40:43], s66 offen offset:384 sc1
Lskip_63:
    v_xor_b32 v2, s57, v14
    v_and_b32 v2, 65537, v2
    v_cmp_ne_u32 vcc, 0, v2
    s_cbranch_vccz Lskip_64
    buffer_load_dword v14, v4, s[40:43], s66 offen offset:1024 sc1
Lskip_64:
    v_xor_b32 v2, s57, v15
    v_and_b32 v2, 65537, v2
    v_cmp_ne_u32 vcc, 0, v2
    s_cbranch_vccz Lskip_65
    buffer_load_dword v15, v4, s[40:43], s66 offen offset:1152 sc1
Lskip_65:
    v_xor_b32 v2, s57, v16
    v_and_b32 v2, 65537, v2
    v_cmp_ne_u32 vcc, 0, v2
    s_cbranch_vccz Lskip_66
    buffer_load_dword v16, v4, s[40:43], s66 offen offset:1280 sc1
Lskip_66:
    v_xor_b32 v2, s57, v17
    v_and_b32 v2, 65537, v2
    v_cmp_ne_u32 vcc, 0, v2
    s_cbranch_vccz Lskip_67
    buffer_load_dword v17, v4, s[40:43], s66 offen offset:1408 sc1
Lskip_67:
    v_xor_b32 v2, s57, v18
    v_and_b32 v2, 65537, v2
    v_cmp_ne_u32 vcc, 0, v2
    s_cbranch_vccz Lskip_68
    buffer_load_dword v18, v4, s[40:43], s67 offen offset:0 sc1
Lskip_68:
    v_xor_b32 v2, s57, v19
    v_and_b32 v2, 65537, v2
    v_cmp_ne_u32 vcc, 0, v2
    s_cbranch_vccz Lskip_69
    buffer_load_dword v19, v4, s[40:43], s67 offen offset:128 sc1
Lskip_69:
    v_xor_b32 v2, s57, v20
    v_and_b32 v2, 65537, v2
    v_cmp_ne_u32 vcc, 0, v2
    s_cbranch_vccz Lskip_70
    buffer_load_dword v20, v4, s[40:43], s67 offen offset:256 sc1
Lskip_70:
    v_xor_b32 v2, s57, v21
    v_and_b32 v2, 65537, v2
    v_cmp_ne_u32 vcc, 0, v2
    s_cbranch_vccz Lskip_71
    buffer_load_dword v21, v4, s[40:43], s67 offen offset:384 sc1
Lskip_71:
    v_xor_b32 v2, s57, v22
    v_and_b32 v2, 65537, v2
    v_cmp_ne_u32 vcc, 0, v2
    s_cbranch_vccz Lskip_72
    buffer_load_dword v22, v4, s[40:43], s67 offen offset:1024 sc1
Lskip_72:
    v_xor_b32 v2, s57, v23
    v_and_b32 v2, 65537, v2
    v_cmp_ne_u32 vcc, 0, v2
    s_cbranch_vccz Lskip_73
    buffer_load_dword v23, v4, s[40:43], s67 offen offset:1152 sc1
Lskip_73:
    v_xor_b32 v2, s57, v24
    v_and_b32 v2, 65537, v2
    v_cmp_ne_u32 vcc, 0, v2
    s_cbranch_vccz Lskip_74
    buffer_load_dword v24, v4, s[40:43], s67 offen offset:1280 sc1
Lskip_74:
    v_xor_b32 v2, s57, v25
    v_and_b32 v2, 65537, v2
    v_cmp_ne_u32 vcc, 0, v2
    s_cbranch_vccz Lskip_75
    buffer_load_dword v25, v4, s[40:43], s67 offen offset:1408 sc1
Lskip_75:
    s_add_u32 s74, s74, 1
    s_cmp_lt_u32 s74, 32768
    s_cbranch_scc1 Lpoll_57
    s_waitcnt vmcnt(0)
Lok_58:
    v_readlane_b32 s7, v10, 0
    v_readlane_b32 s79, v18, 0
    v_mfma_f32_32x32x16_bf16 v[144:159], v[10:13], v[106:109], 0
    s_lshl_b32 s32, s7, 16
    s_and_b32 s7, s7, 0xffff0000
    v_mul_f32 v242, s32, v240
    v_fma_f32 v242, s7, v241, -v242
    s_lshl_b32 s32, s79, 16
    s_and_b32 s79, s79, 0xffff0000
    v_mul_f32 v243, s32, v240
    v_mfma_f32_32x32x16_bf16 v[160:175], v[10:13], v[110:113], 0
    v_fma_f32 v243, s79, v241, -v243
    v_lshlrev_b32 v2, 16, v142
    v_mul_f32 v208, v2, v208
    v_mul_f32 v209, v2, v209
    v_mul_f32 v210, v2, v210
    v_mul_f32 v211, v2, v211
    v_mul_f32 v212, v2, v212
    v_mfma_f32_32x32x16_bf16 v[144:159], v[14:17], v[114:117], v[144:159]
    v_mul_f32 v213, v2, v213
    v_mul_f32 v214, v2, v214
    v_mul_f32 v215, v2, v215
    v_and_b32 v2, 0xffff0000, v142
    v_mul_f32 v216, v2, v216
    v_mul_f32 v217, v2, v217
    v_mul_f32 v218, v2, v218
    v_mfma_f32_32x32x16_bf16 v[160:175], v[14:17], v[118:121], v[160:175]
    v_mul_f32 v219, v2, v219
    v_mul_f32 v220, v2, v220
    v_mul_f32 v221, v2, v221
    v_mul_f32 v222, v2, v222
    v_mul_f32 v223, v2, v223
    v_lshlrev_b32 v2, 16, v143
    v_mul_f32 v224, v2, v224
    v_mfma_f32_32x32x16_bf16 v[176:191], v[18:21], v[106:109], 0
    v_mul_f32 v225, v2, v225
    v_mul_f32 v226, v2, v226
    v_mul_f32 v227, v2, v227
    v_mul_f32 v228, v2, v228
    v_mul_f32 v229, v2, v229
    v_mul_f32 v230, v2, v230
    v_mul_f32 v231, v2, v231
    v_mfma_f32_32x32x16_bf16 v[192:207], v[18:21], v[110:113], 0
    v_and_b32 v2, 0xffff0000, v143
    v_mul_f32 v232, v2, v232
    v_mul_f32 v233, v2, v233
    v_mul_f32 v234, v2, v234
    v_mul_f32 v235, v2, v235
    v_mul_f32 v236, v2, v236
    v_mul_f32 v237, v2, v237
    v_mul_f32 v238, v2, v238
    v_mul_f32 v239, v2, v239
    v_mfma_f32_32x32x16_bf16 v[176:191], v[22:25], v[114:117], v[176:191]
    v_add_f32 v144, v144, v242
    v_mul_f32 v244, v144, v66
    v_mul_f32 v246, v160, v66
    v_mul_f32 v245, v145, v67
    v_mul_f32 v247, v161, v67
    v_fma_f32 v244, v160, -v82, v244
    v_fmac_f32 v246, v144, v82
    v_mfma_f32_32x32x16_bf16 v[192:207], v[22:25], v[118:121], v[192:207]
    v_fma_f32 v245, v161, -v83, v245
    v_fmac_f32 v247, v145, v83
    v_cvt_pk_bf16_f32 v122, v244, v245
    v_cvt_pk_bf16_f32 v130, v246, v247
    v_mul_f32 v138, v146, v68
    v_mul_f32 v140, v162, v68
    v_mul_f32 v139, v147, v69
    v_mul_f32 v141, v163, v69
    v_fma_f32 v138, v162, -v84, v138
    v_fmac_f32 v140, v146, v84
    v_fma_f32 v139, v163, -v85, v139
    v_fmac_f32 v141, v147, v85
    v_cvt_pk_bf16_f32 v123, v138, v139
    v_cvt_pk_bf16_f32 v131, v140, v141
    v_mul_f32 v244, v148, v70
    v_mul_f32 v246, v164, v70
    v_mul_f32 v245, v149, v71
    v_mul_f32 v247, v165, v71
    v_fma_f32 v244, v164, -v86, v244
    v_fmac_f32 v246, v148, v86
    v_fma_f32 v245, v165, -v87, v245
    v_fmac_f32 v247, v149, v87
    v_cvt_pk_bf16_f32 v124, v244, v245
    v_cvt_pk_bf16_f32 v132, v246, v247
    v_mul_f32 v138, v150, v72
    v_mul_f32 v140, v166, v72
    v_mul_f32 v139, v151, v73
    v_mul_f32 v141, v167, v73
    v_fma_f32 v138, v166, -v88, v138
    v_fmac_f32 v140, v150, v88
    v_fma_f32 v139, v167, -v89, v139
    v_fmac_f32 v141, v151, v89
    v_cvt_pk_bf16_f32 v125, v138, v139
    v_cvt_pk_bf16_f32 v133, v140, v141
    v_mul_f32 v244, v152, v74
    v_mul_f32 v246, v168, v74
    v_mul_f32 v245, v153, v75
    v_mul_f32 v247, v169, v75
    v_fma_f32 v244, v168, -v90, v244
    v_fmac_f32 v246, v152, v90
    v_fma_f32 v245, v169, -v91, v245
    v_fmac_f32 v247, v153, v91
    v_cvt_pk_bf16_f32 v126, v244, v245
    v_cvt_pk_bf16_f32 v134, v246, v247
    v_mul_f32 v138, v154, v76
    v_mul_f32 v140, v170, v76
    v_mul_f32 v139, v155, v77
    v_mul_f32 v141, v171, v77
    v_fma_f32 v138, v170, -v92, v138
    v_fmac_f32 v140, v154, v92
    v_fma_f32 v139, v171, -v93, v139
    v_fmac_f32 v141, v155, v93
    v_cvt_pk_bf16_f32 v127, v138, v139
    v_cvt_pk_bf16_f32 v135, v140, v141
    v_mul_f32 v244, v156, v78
    v_mul_f32 v246, v172, v78
    v_mul_f32 v245, v157, v79
    v_mul_f32 v247, v173, v79
    v_fma_f32 v244, v172, -v94, v244
    v_fmac_f32 v246, v156, v94
    v_fma_f32 v245, v173, -v95, v245
    v_fmac_f32 v247, v157, v95
    v_cvt_pk_bf16_f32 v128, v244, v245
    v_cvt_pk_bf16_f32 v136, v246, v247
    v_mul_f32 v138, v158, v80
    v_mul_f32 v140, v174, v80
    v_mul_f32 v139, v159, v81
    v_mul_f32 v141, v175, v81
    v_fma_f32 v138, v174, -v96, v138
    v_fmac_f32 v140, v158, v96
    v_fma_f32 v139, v175, -v97, v139
    v_fmac_f32 v141, v159, v97
    v_cvt_pk_bf16_f32 v129, v138, v139
    v_cvt_pk_bf16_f32 v137, v140, v141
    buffer_load_dwordx4 v[26:29], v3, s[40:43], s77 offen sc1
    buffer_load_dwordx4 v[30:33], v3, s[40:43], s78 offen sc1
    buffer_load_dwordx4 v[34:37], v3, s[40:43], s68 offen sc1
    buffer_load_dwordx4 v[38:41], v3, s[40:43], s69 offen sc1
    v_mfma_f32_32x32x16_bf16 v[144:159], v[122:125], v[42:45], 0
    v_add_f32 v176, v176, v243
    v_mul_f32 v244, v176, v66
    v_mul_f32 v246, v192, v66
    v_mul_f32 v245, v177, v67
    v_mul_f32 v247, v193, v67
    v_fma_f32 v244, v192, -v82, v244
    v_fmac_f32 v246, v176, v82
    v_mfma_f32_32x32x16_bf16 v[144:159], v[130:133], v[50:53], v[144:159]
    v_fma_f32 v245, v193, -v83, v245
    v_fmac_f32 v247, v177, v83
    v_cvt_pk_bf16_f32 v106, v244, v245
    v_cvt_pk_bf16_f32 v114, v246, v247
    v_mul_f32 v138, v178, v68
    v_mul_f32 v140, v194, v68
    v_mul_f32 v139, v179, v69
    v_mfma_f32_32x32x16_bf16 v[144:159], v[126:129], v[46:49], v[144:159]
    v_mul_f32 v141, v195, v69
    v_fma_f32 v138, v194, -v84, v138
    v_fmac_f32 v140, v178, v84
    v_fma_f32 v139, v195, -v85, v139
    v_fmac_f32 v141, v179, v85
    v_cvt_pk_bf16_f32 v107, v138, v139
    v_cvt_pk_bf16_f32 v115, v140, v141
    v_mfma_f32_32x32x16_bf16 v[144:159], v[134:137], v[54:57], v[144:159]
    v_mul_f32 v244, v180, v70
    v_mul_f32 v246, v196, v70
    v_mul_f32 v245, v181, v71
    v_mul_f32 v247, v197, v71
    v_fma_f32 v244, v196, -v86, v244
    v_fmac_f32 v246, v180, v86
    v_fma_f32 v245, v197, -v87, v245
    v_fmac_f32 v247, v181, v87
    v_cvt_pk_bf16_f32 v108, v244, v245
    v_cvt_pk_bf16_f32 v116, v246, v247
    v_mul_f32 v138, v182, v72
    v_mul_f32 v140, v198, v72
    v_mul_f32 v139, v183, v73
    v_mul_f32 v141, v199, v73
    v_fma_f32 v138, v198, -v88, v138
    v_fmac_f32 v140, v182, v88
    v_fma_f32 v139, v199, -v89, v139
    v_fmac_f32 v141, v183, v89
    v_cvt_pk_bf16_f32 v109, v138, v139
    v_cvt_pk_bf16_f32 v117, v140, v141
    v_mul_f32 v244, v184, v74
    v_mul_f32 v246, v200, v74
    v_mul_f32 v245, v185, v75
    v_mul_f32 v247, v201, v75
    v_fma_f32 v244, v200, -v90, v244
    v_fmac_f32 v246, v184, v90
    v_fma_f32 v245, v201, -v91, v245
    v_fmac_f32 v247, v185, v91
    v_cvt_pk_bf16_f32 v110, v244, v245
    v_cvt_pk_bf16_f32 v118, v246, v247
    v_mul_f32 v138, v186, v76
    v_mul_f32 v140, v202, v76
    v_mul_f32 v139, v187, v77
    v_mul_f32 v141, v203, v77
    v_fma_f32 v138, v202, -v92, v138
    v_fmac_f32 v140, v186, v92
    v_fma_f32 v139, v203, -v93, v139
    v_fmac_f32 v141, v187, v93
    v_cvt_pk_bf16_f32 v111, v138, v139
    v_cvt_pk_bf16_f32 v119, v140, v141
    v_mul_f32 v244, v188, v78
    v_mul_f32 v246, v204, v78
    v_mul_f32 v245, v189, v79
    v_mul_f32 v247, v205, v79
    v_fma_f32 v244, v204, -v94, v244
    v_fmac_f32 v246, v188, v94
    v_fma_f32 v245, v205, -v95, v245
    v_fmac_f32 v247, v189, v95
    v_cvt_pk_bf16_f32 v112, v244, v245
    v_cvt_pk_bf16_f32 v120, v246, v247
    v_mul_f32 v138, v190, v80
    v_mul_f32 v140, v206, v80
    v_mul_f32 v139, v191, v81
    v_mul_f32 v141, v207, v81
    v_fma_f32 v138, v206, -v96, v138
    v_fmac_f32 v140, v190, v96
    v_fma_f32 v139, v207, -v97, v139
    v_fmac_f32 v141, v191, v97
    v_cvt_pk_bf16_f32 v113, v138, v139
    v_cvt_pk_bf16_f32 v121, v140, v141
    v_mfma_f32_32x32x16_bf16 v[160:175], v[106:109], v[42:45], 0
    v_cvt_pk_bf16_f32 v10, v144, v145
    v_cvt_pk_bf16_f32 v11, v146, v147
    v_mfma_f32_32x32x16_bf16 v[160:175], v[114:117], v[50:53], v[160:175]
    v_cvt_pk_bf16_f32 v12, v148, v149
    v_cvt_pk_bf16_f32 v13, v150, v151
    ds_write_b128 v6, v[10:13] offset:33024
    v_mfma_f32_32x32x16_bf16 v[160:175], v[110:113], v[46:49], v[160:175]
    v_cvt_pk_bf16_f32 v14, v152, v153
    v_cvt_pk_bf16_f32 v15, v154, v155
    v_cvt_pk_bf16_f32 v16, v156, v157
    v_mfma_f32_32x32x16_bf16 v[160:175], v[118:121], v[54:57], v[160:175]
    v_cvt_pk_bf16_f32 v17, v158, v159
    ds_write_b128 v6, v[14:17] offset:34176
    s_nop 9
    v_cvt_pk_bf16_f32 v18, v160, v161
    v_cvt_pk_bf16_f32 v19, v162, v163
    v_cvt_pk_bf16_f32 v20, v164, v165
    v_cvt_pk_bf16_f32 v21, v166, v167
    ds_write_b128 v6, v[18:21] offset:35456
    v_cvt_pk_bf16_f32 v22, v168, v169
    v_cvt_pk_bf16_f32 v23, v170, v171
    v_cvt_pk_bf16_f32 v24, v172, v173
    v_cvt_pk_bf16_f32 v25, v174, v175
    ds_write_b128 v6, v[22:25] offset:36608
Lb3done_37:
    v_lshlrev_b32 v7, 3, v0
    s_waitcnt lgkmcnt(0)
    s_barrier
    ds_read_b64_tr_b16 v[10:11], v8 offset:33024
    ds_read_b64_tr_b16 v[12:13], v8 offset:42752
    ds_read_b64_tr_b16 v[14:15], v8 offset:33032
    ds_read_b64_tr_b16 v[16:17], v8 offset:42760
    ds_read_b64_tr_b16 v[18:19], v8 offset:34176
    ds_read_b64_tr_b16 v[20:21], v8 offset:43904
    ds_read_b64_tr_b16 v[22:23], v8 offset:34184
    ds_read_b64_tr_b16 v[24:25], v8 offset:43912
    s_waitcnt lgkmcnt(4)
    v_mfma_f32_32x32x16_bf16 v[208:223], v[98:101], v[10:13], v[208:223]
    v_mfma_f32_32x32x16_bf16 v[208:223], v[102:105], v[14:17], v[208:223]
    s_waitcnt lgkmcnt(0)
    v_mfma_f32_32x32x16_bf16 v[224:239], v[98:101], v[18:21], v[224:239]
    v_mfma_f32_32x32x16_bf16 v[224:239], v[102:105], v[22:25], v[224:239]
Lpoll_77:
    s_waitcnt vmcnt(0)
Lchk_79:
    v_xor_b32 v2, s57, v26
    v_bitop3_b32 v2, v2, v27, s57 bitop3:0xf6
    v_bitop3_b32 v2, v2, v28, s57 bitop3:0xf6
    v_bitop3_b32 v2, v2, v29, s57 bitop3:0xf6
    v_bitop3_b32 v2, v2, v30, s57 bitop3:0xf6
    v_bitop3_b32 v2, v2, v31, s57 bitop3:0xf6
    v_bitop3_b32 v2, v2, v32, s57 bitop3:0xf6
    v_bitop3_b32 v2, v2, v33, s57 bitop3:0xf6
    v_bitop3_b32 v2, v2, v34, s57 bitop3:0xf6
    v_bitop3_b32 v2, v2, v35, s57 bitop3:0xf6
    v_bitop3_b32 v2, v2, v36, s57 bitop3:0xf6
    v_bitop3_b32 v2, v2, v37, s57 bitop3:0xf6
    v_bitop3_b32 v2, v2, v38, s57 bitop3:0xf6
    v_bitop3_b32 v2, v2, v39, s57 bitop3:0xf6
    v_bitop3_b32 v2, v2, v40, s57 bitop3:0xf6
    v_bitop3_b32 v2, v2, v41, s57 bitop3:0xf6
    v_and_b32 v2, 65537, v2
    v_cmp_ne_u32 vcc, 0, v2
    s_cbranch_vccz Lok_78
    s_sleep 2
    v_xor_b32 v2, s57, v26
    v_bitop3_b32 v2, v2, v27, s57 bitop3:0xf6
    v_bitop3_b32 v2, v2, v28, s57 bitop3:0xf6
    v_bitop3_b32 v2, v2, v29, s57 bitop3:0xf6
    v_and_b32 v2, 65537, v2
    v_cmp_ne_u32 vcc, 0, v2
    s_cbranch_vccz Lskip_80
    buffer_load_dwordx4 v[26:29], v3, s[40:43], s77 offen sc1
Lskip_80:
    v_xor_b32 v2, s57, v30
    v_bitop3_b32 v2, v2, v31, s57 bitop3:0xf6
    v_bitop3_b32 v2, v2, v32, s57 bitop3:0xf6
    v_bitop3_b32 v2, v2, v33, s57 bitop3:0xf6
    v_and_b32 v2, 65537, v2
    v_cmp_ne_u32 vcc, 0, v2
    s_cbranch_vccz Lskip_81
    buffer_load_dwordx4 v[30:33], v3, s[40:43], s78 offen sc1
Lskip_81:
    v_xor_b32 v2, s57, v34
    v_bitop3_b32 v2, v2, v35, s57 bitop3:0xf6
    v_bitop3_b32 v2, v2, v36, s57 bitop3:0xf6
    v_bitop3_b32 v2, v2, v37, s57 bitop3:0xf6
    v_and_b32 v2, 65537, v2
    v_cmp_ne_u32 vcc, 0, v2
    s_cbranch_vccz Lskip_82
    buffer_load_dwordx4 v[34:37], v3, s[40:43], s68 offen sc1
Lskip_82:
    v_xor_b32 v2, s57, v38
    v_bitop3_b32 v2, v2, v39, s57 bitop3:0xf6
    v_bitop3_b32 v2, v2, v40, s57 bitop3:0xf6
    v_bitop3_b32 v2, v2, v41, s57 bitop3:0xf6
    v_and_b32 v2, 65537, v2
    v_cmp_ne_u32 vcc, 0, v2
    s_cbranch_vccz Lskip_83
    buffer_load_dwordx4 v[38:41], v3, s[40:43], s69 offen sc1
Lskip_83:
    s_add_u32 s74, s74, 1
    s_cmp_lt_u32 s74, 32768
    s_cbranch_scc1 Lpoll_77
    s_waitcnt vmcnt(0)
Lok_78:
    v_mfma_f32_32x32x16_bf16 v[208:223], v[248:251], v[26:29], v[208:223]
    v_mfma_f32_32x32x16_bf16 v[208:223], v[252:255], v[30:33], v[208:223]
    v_mfma_f32_32x32x16_bf16 v[224:239], v[248:251], v[34:37], v[224:239]
    v_mfma_f32_32x32x16_bf16 v[224:239], v[252:255], v[38:41], v[224:239]
Loky2_76:
    s_nop 9
    v_cvt_pk_bf16_f32 v144, v208, v216
    v_cvt_pk_bf16_f32 v146, v209, v217
    v_cvt_pk_bf16_f32 v148, v210, v218
    v_cvt_pk_bf16_f32 v150, v211, v219
    v_cvt_pk_bf16_f32 v152, v212, v220
    v_cvt_pk_bf16_f32 v154, v213, v221
    v_cvt_pk_bf16_f32 v156, v214, v222
    v_cvt_pk_bf16_f32 v158, v215, v223
    v_cvt_pk_bf16_f32 v145, v224, v232
    buffer_store_dwordx2 v[144:145], v7, s[52:55], s24 offen sc1
    v_cvt_pk_bf16_f32 v147, v225, v233
    buffer_store_dwordx2 v[146:147], v7, s[52:55], s25 offen sc1
    v_cvt_pk_bf16_f32 v149, v226, v234
    buffer_store_dwordx2 v[148:149], v7, s[52:55], s26 offen sc1
    v_cvt_pk_bf16_f32 v151, v227, v235
    buffer_store_dwordx2 v[150:151], v7, s[52:55], s27 offen sc1
    v_cvt_pk_bf16_f32 v153, v228, v236
    buffer_store_dwordx2 v[152:153], v7, s[52:55], s28 offen sc1
    v_cvt_pk_bf16_f32 v155, v229, v237
    buffer_store_dwordx2 v[154:155], v7, s[52:55], s29 offen sc1
    v_cvt_pk_bf16_f32 v157, v230, v238
    buffer_store_dwordx2 v[156:157], v7, s[52:55], s30 offen sc1
    v_cvt_pk_bf16_f32 v159, v231, v239
    buffer_store_dwordx2 v[158:159], v7, s[52:55], s31 offen sc1
    s_or_b32 s66, s2, s56
    s_cmp_lg_u32 s66, 0
    s_cbranch_scc1 Lnopub_84
    s_mov_b64 exec, 1
    buffer_store_dword v9, off, s[40:43], 0
    s_mov_b64 exec, -1
Lnopub_84:
    s_endpgm
LpathA:
    s_setprio 0
    s_lshr_b32 s66, s2, 2
    s_lshl_b32 s66, s66, 4
    s_and_b32 s67, s2, 3
    s_add_u32 s66, s66, s67
    s_lshl_b32 s67, s56, 2
    s_add_u32 s61, s66, s67
    s_lshl_b32 s66, s61, 8
    s_lshl_b32 s67, s61, 1
    s_and_b32 s67, s67, 0xfffc
    v_lshl_add_u32 v3, v1, 2, s66
    s_waitcnt lgkmcnt(0)
    s_load_dword s63, s[16:17], s67
    s_load_dword s57, s[40:41], 0
    global_load_dword v210, v3, s[8:9] nt
    global_load_dword v211, v3, s[10:11] nt
    global_load_dword v212, v3, s[12:13] nt
    global_load_dword v213, v3, s[14:15] nt
    s_barrier
    s_mov_b32 s74, 0
    s_mov_b32 s58, 0xfffefffe
    s_mov_b32 s75, 0x05040100
    s_mov_b32 s76, 0x07060302
    s_mul_i32 s62, s56, 3264
    s_add_u32 s62, s62, 135936
    v_lshl_add_u32 v5, v1, 4, s62
    v_mov_b32 v178, 0
    v_mov_b32 v179, 0
    v_mov_b32 v180, 0
    v_mov_b32 v181, 0
    ds_write_b128 v5, v[178:181] offset:0
    ds_write_b128 v5, v[178:181] offset:1024
    ds_write_b128 v5, v[178:181] offset:2048
    s_mov_b64 exec, 0xfff
    ds_write_b128 v5, v[178:181] offset:3072
    s_mov_b64 exec, -1
    s_mul_i32 s77, s56, 16896
    s_add_u32 s77, s77, 68352
    v_lshl_add_u32 v3, v1, 3, s77
    v_and_b32 v5, 31, v1
    v_mul_u32_u24 v4, 528, v5
    v_lshrrev_b32 v6, 5, v1
    v_lshl_add_u32 v4, v6, 4, v4
    v_add_u32 v4, s77, v4
    s_waitcnt lgkmcnt(0)
    s_andn2_b32 s57, 65537, s57
    s_xor_b32 s59, s57, 0x6b2e91d4
    v_mov_b32 v9, s57
    s_lshl_b32 s66, s63, 16
    s_and_b32 s67, s63, 0xffff0000
    s_bitcmp1_b32 s61, 0
    s_cselect_b32 s66, s67, s66
    v_mov_b32 v215, 0x3fb8aa3b
    v_mul_f32 v215, s66, v215
    v_exp_f32 v215, v215
    s_nop 0
    v_cvt_pk_bf16_f32 v215, v215, v215
    v_lshlrev_b32 v215, 16, v215
    s_waitcnt vmcnt(0)
    s_setprio 1
    v_lshlrev_b32 v216, 16, v210
    v_mul_f32 v216, 0x3fb8aa3b, v216
    v_exp_f32 v216, v216
    v_lshlrev_b32 v218, 16, v211
    v_lshlrev_b32 v220, 16, v212
    v_lshlrev_b32 v221, 16, v213
    v_and_b32 v217, 0xffff0000, v210
    v_mul_f32 v217, 0x3fb8aa3b, v217
    v_exp_f32 v217, v217
    v_and_b32 v219, 0xffff0000, v211
    v_and_b32 v222, 0xffff0000, v212
    v_and_b32 v223, 0xffff0000, v213
    v_cvt_pk_bf16_f32 v210, v216, v217
    v_lshlrev_b32 v216, 16, v210
    v_mul_f32 v216, v216, v215
    v_mul_f32 v216, 0xbfb8aa3b, v216
    v_mul_f32 v218, v218, v215
    v_mul_f32 v218, 0.15915494, v218
    v_and_b32 v217, 0xffff0000, v210
    v_mul_f32 v217, v217, v215
    v_mul_f32 v217, 0xbfb8aa3b, v217
    v_mul_f32 v219, v219, v215
    v_mul_f32 v219, 0.15915494, v219
    v_add_f32 v215, v215, v215
    v_mul_f32 v220, v220, v215
    v_mul_f32 v221, v221, v215
    v_mul_f32 v222, v222, v215
    v_mul_f32 v223, v223, v215
    v_exp_f32 v240, v216
    v_fract_f32 v241, v218
    v_exp_f32 v242, v217
    v_fract_f32 v243, v219
    v_cos_f32 v224, v241
    v_sin_f32 v225, v241
    v_cos_f32 v226, v243
    v_sin_f32 v227, v243
    v_mul_f32 v224, v224, v240
    v_mul_f32 v225, v225, v240
    v_mul_f32 v226, v226, v242
    v_mul_f32 v227, v227, v242
    v_mul_f32 v240, 0x43000000, v216
    v_mul_f32 v241, 0x43000000, v218
    v_exp_f32 v240, v240
    v_fract_f32 v241, v241
    v_mul_f32 v242, 0x43000000, v217
    v_mul_f32 v243, 0x43000000, v219
    v_exp_f32 v242, v242
    v_fract_f32 v243, v243
    v_cos_f32 v232, v241
    v_sin_f32 v233, v241
    v_cos_f32 v234, v243
    v_sin_f32 v235, v243
    v_mul_f32 v232, v232, v240
    v_mul_f32 v233, v233, v240
    v_mul_f32 v234, v234, v242
    v_mul_f32 v235, v235, v242
    v_pk_mul_f32 v[106:107], v[224:225], v[224:225] op_sel_hi:[1,0]
    v_pk_mul_f32 v[108:109], v[226:227], v[226:227] op_sel_hi:[1,0]
    v_pk_fma_f32 v[240:241], v[224:225], v[224:225], v[106:107] op_sel:[1,1,0] op_sel_hi:[0,1,1] neg_lo:[1,0,0]
    v_pk_fma_f32 v[242:243], v[226:227], v[226:227], v[108:109] op_sel:[1,1,0] op_sel_hi:[0,1,1] neg_lo:[1,0,0]
    v_pk_mul_f32 v[106:107], v[232:233], v[232:233] op_sel_hi:[1,0]
    v_pk_mul_f32 v[108:109], v[234:235], v[234:235] op_sel_hi:[1,0]
    v_pk_fma_f32 v[236:237], v[232:233], v[232:233], v[106:107] op_sel:[1,1,0] op_sel_hi:[0,1,1] neg_lo:[1,0,0]
    v_pk_fma_f32 v[238:239], v[234:235], v[234:235], v[108:109] op_sel:[1,1,0] op_sel_hi:[0,1,1] neg_lo:[1,0,0]
    v_pk_mul_f32 v[106:107], v[240:241], v[240:241] op_sel_hi:[1,0]
    v_pk_mul_f32 v[108:109], v[242:243], v[242:243] op_sel_hi:[1,0]
    v_pk_fma_f32 v[244:245], v[240:241], v[240:241], v[106:107] op_sel:[1,1,0] op_sel_hi:[0,1,1] neg_lo:[1,0,0]
    v_pk_fma_f32 v[246:247], v[242:243], v[242:243], v[108:109] op_sel:[1,1,0] op_sel_hi:[0,1,1] neg_lo:[1,0,0]
    v_pk_mul_f32 v[106:107], v[244:245], v[244:245] op_sel_hi:[1,0]
    v_pk_mul_f32 v[108:109], v[246:247], v[246:247] op_sel_hi:[1,0]
    v_pk_fma_f32 v[228:229], v[244:245], v[244:245], v[106:107] op_sel:[1,1,0] op_sel_hi:[0,1,1] neg_lo:[1,0,0]
    v_pk_fma_f32 v[230:231], v[246:247], v[246:247], v[108:109] op_sel:[1,1,0] op_sel_hi:[0,1,1] neg_lo:[1,0,0]
    v_cvt_pk_bf16_f32 v110, v220, -v221
    v_cvt_pk_bf16_f32 v111, v222, -v223
    ds_write_b64 v3, v[110:111] offset:0
    v_pk_mul_f32 v[106:107], v[220:221], v[224:225] op_sel_hi:[1,0]
    v_pk_mul_f32 v[108:109], v[222:223], v[226:227] op_sel_hi:[1,0]
    v_pk_fma_f32 v[114:115], v[220:221], v[224:225], v[106:107] op_sel:[1,1,0] op_sel_hi:[0,1,1] neg_lo:[1,0,0]
    v_pk_fma_f32 v[116:117], v[222:223], v[226:227], v[108:109] op_sel:[1,1,0] op_sel_hi:[0,1,1] neg_lo:[1,0,0]
    v_cvt_pk_bf16_f32 v110, v114, -v115
    v_cvt_pk_bf16_f32 v111, v116, -v117
    ds_write_b64 v3, v[110:111] offset:528
    v_pk_mul_f32 v[106:107], v[114:115], v[224:225] op_sel_hi:[1,0]
    v_pk_mul_f32 v[108:109], v[116:117], v[226:227] op_sel_hi:[1,0]
    v_pk_fma_f32 v[114:115], v[114:115], v[224:225], v[106:107] op_sel:[1,1,0] op_sel_hi:[0,1,1] neg_lo:[1,0,0]
    v_pk_fma_f32 v[116:117], v[116:117], v[226:227], v[108:109] op_sel:[1,1,0] op_sel_hi:[0,1,1] neg_lo:[1,0,0]
    v_cvt_pk_bf16_f32 v110, v114, -v115
    v_cvt_pk_bf16_f32 v111, v116, -v117
    ds_write_b64 v3, v[110:111] offset:1056
    v_pk_mul_f32 v[106:107], v[114:115], v[224:225] op_sel_hi:[1,0]
    v_pk_mul_f32 v[108:109], v[116:117], v[226:227] op_sel_hi:[1,0]
    v_pk_fma_f32 v[114:115], v[114:115], v[224:225], v[106:107] op_sel:[1,1,0] op_sel_hi:[0,1,1] neg_lo:[1,0,0]
    v_pk_fma_f32 v[116:117], v[116:117], v[226:227], v[108:109] op_sel:[1,1,0] op_sel_hi:[0,1,1] neg_lo:[1,0,0]
    v_cvt_pk_bf16_f32 v110, v114, -v115
    v_cvt_pk_bf16_f32 v111, v116, -v117
    ds_write_b64 v3, v[110:111] offset:1584
    v_pk_mul_f32 v[106:107], v[114:115], v[224:225] op_sel_hi:[1,0]
    v_pk_mul_f32 v[108:109], v[116:117], v[226:227] op_sel_hi:[1,0]
    v_pk_fma_f32 v[114:115], v[114:115], v[224:225], v[106:107] op_sel:[1,1,0] op_sel_hi:[0,1,1] neg_lo:[1,0,0]
    v_pk_fma_f32 v[116:117], v[116:117], v[226:227], v[108:109] op_sel:[1,1,0] op_sel_hi:[0,1,1] neg_lo:[1,0,0]
    v_cvt_pk_bf16_f32 v110, v114, -v115
    v_cvt_pk_bf16_f32 v111, v116, -v117
    ds_write_b64 v3, v[110:111] offset:2112
    v_pk_mul_f32 v[106:107], v[114:115], v[224:225] op_sel_hi:[1,0]
    v_pk_mul_f32 v[108:109], v[116:117], v[226:227] op_sel_hi:[1,0]
    v_pk_fma_f32 v[114:115], v[114:115], v[224:225], v[106:107] op_sel:[1,1,0] op_sel_hi:[0,1,1] neg_lo:[1,0,0]
    v_pk_fma_f32 v[116:117], v[116:117], v[226:227], v[108:109] op_sel:[1,1,0] op_sel_hi:[0,1,1] neg_lo:[1,0,0]
    v_cvt_pk_bf16_f32 v110, v114, -v115
    v_cvt_pk_bf16_f32 v111, v116, -v117
    ds_write_b64 v3, v[110:111] offset:2640
    v_pk_mul_f32 v[106:107], v[114:115], v[224:225] op_sel_hi:[1,0]
    v_pk_mul_f32 v[108:109], v[116:117], v[226:227] op_sel_hi:[1,0]
    v_pk_fma_f32 v[114:115], v[114:115], v[224:225], v[106:107] op_sel:[1,1,0] op_sel_hi:[0,1,1] neg_lo:[1,0,0]
    v_pk_fma_f32 v[116:117], v[116:117], v[226:227], v[108:109] op_sel:[1,1,0] op_sel_hi:[0,1,1] neg_lo:[1,0,0]
    v_cvt_pk_bf16_f32 v110, v114, -v115
    v_cvt_pk_bf16_f32 v111, v116, -v117
    ds_write_b64 v3, v[110:111] offset:3168
    v_pk_mul_f32 v[106:107], v[114:115], v[224:225] op_sel_hi:[1,0]
    v_pk_mul_f32 v[108:109], v[116:117], v[226:227] op_sel_hi:[1,0]
    v_pk_fma_f32 v[114:115], v[114:115], v[224:225], v[106:107] op_sel:[1,1,0] op_sel_hi:[0,1,1] neg_lo:[1,0,0]
    v_pk_fma_f32 v[116:117], v[116:117], v[226:227], v[108:109] op_sel:[1,1,0] op_sel_hi:[0,1,1] neg_lo:[1,0,0]
    v_cvt_pk_bf16_f32 v110, v114, -v115
    v_cvt_pk_bf16_f32 v111, v116, -v117
    ds_write_b64 v3, v[110:111] offset:3696
    v_pk_mul_f32 v[106:107], v[220:221], v[236:237] op_sel_hi:[1,0]
    v_pk_mul_f32 v[108:109], v[222:223], v[238:239] op_sel_hi:[1,0]
    v_pk_fma_f32 v[118:119], v[220:221], v[236:237], v[106:107] op_sel:[1,1,0] op_sel_hi:[0,1,1] neg_lo:[1,0,0]
    v_pk_fma_f32 v[120:121], v[222:223], v[238:239], v[108:109] op_sel:[1,1,0] op_sel_hi:[0,1,1] neg_lo:[1,0,0]
    v_cvt_pk_bf16_f32 v110, v118, -v119
    v_cvt_pk_bf16_f32 v111, v120, -v121
    ds_write_b64 v3, v[110:111] offset:4224
    v_pk_mul_f32 v[106:107], v[118:119], v[240:241] op_sel_hi:[1,0]
    v_pk_mul_f32 v[108:109], v[120:121], v[242:243] op_sel_hi:[1,0]
    v_pk_fma_f32 v[114:115], v[118:119], v[240:241], v[106:107] op_sel:[1,1,0] op_sel_hi:[0,1,1] neg_lo:[1,0,0]
    v_pk_fma_f32 v[116:117], v[120:121], v[242:243], v[108:109] op_sel:[1,1,0] op_sel_hi:[0,1,1] neg_lo:[1,0,0]
    v_cvt_pk_bf16_f32 v110, v114, -v115
    v_cvt_pk_bf16_f32 v111, v116, -v117
    ds_write_b64 v3, v[110:111] offset:4752
    v_pk_mul_f32 v[106:107], v[114:115], v[240:241] op_sel_hi:[1,0]
    v_pk_mul_f32 v[108:109], v[116:117], v[242:243] op_sel_hi:[1,0]
    v_pk_fma_f32 v[114:115], v[114:115], v[240:241], v[106:107] op_sel:[1,1,0] op_sel_hi:[0,1,1] neg_lo:[1,0,0]
    v_pk_fma_f32 v[116:117], v[116:117], v[242:243], v[108:109] op_sel:[1,1,0] op_sel_hi:[0,1,1] neg_lo:[1,0,0]
    v_cvt_pk_bf16_f32 v110, v114, -v115
    v_cvt_pk_bf16_f32 v111, v116, -v117
    ds_write_b64 v3, v[110:111] offset:5280
    v_pk_mul_f32 v[106:107], v[114:115], v[240:241] op_sel_hi:[1,0]
    v_pk_mul_f32 v[108:109], v[116:117], v[242:243] op_sel_hi:[1,0]
    v_pk_fma_f32 v[114:115], v[114:115], v[240:241], v[106:107] op_sel:[1,1,0] op_sel_hi:[0,1,1] neg_lo:[1,0,0]
    v_pk_fma_f32 v[116:117], v[116:117], v[242:243], v[108:109] op_sel:[1,1,0] op_sel_hi:[0,1,1] neg_lo:[1,0,0]
    v_cvt_pk_bf16_f32 v110, v114, -v115
    v_cvt_pk_bf16_f32 v111, v116, -v117
    ds_write_b64 v3, v[110:111] offset:5808
    v_pk_mul_f32 v[106:107], v[118:119], v[236:237] op_sel_hi:[1,0]
    v_pk_mul_f32 v[108:109], v[120:121], v[238:239] op_sel_hi:[1,0]
    v_pk_fma_f32 v[118:119], v[118:119], v[236:237], v[106:107] op_sel:[1,1,0] op_sel_hi:[0,1,1] neg_lo:[1,0,0]
    v_pk_fma_f32 v[120:121], v[120:121], v[238:239], v[108:109] op_sel:[1,1,0] op_sel_hi:[0,1,1] neg_lo:[1,0,0]
    v_cvt_pk_bf16_f32 v110, v118, -v119
    v_cvt_pk_bf16_f32 v111, v120, -v121
    ds_write_b64 v3, v[110:111] offset:6336
    v_pk_mul_f32 v[106:107], v[118:119], v[244:245] op_sel_hi:[1,0]
    v_pk_mul_f32 v[108:109], v[120:121], v[246:247] op_sel_hi:[1,0]
    v_pk_fma_f32 v[114:115], v[118:119], v[244:245], v[106:107] op_sel:[1,1,0] op_sel_hi:[0,1,1] neg_lo:[1,0,0]
    v_pk_fma_f32 v[116:117], v[120:121], v[246:247], v[108:109] op_sel:[1,1,0] op_sel_hi:[0,1,1] neg_lo:[1,0,0]
    v_cvt_pk_bf16_f32 v110, v114, -v115
    v_cvt_pk_bf16_f32 v111, v116, -v117
    ds_write_b64 v3, v[110:111] offset:6864
    v_pk_mul_f32 v[106:107], v[118:119], v[236:237] op_sel_hi:[1,0]
    v_pk_mul_f32 v[108:109], v[120:121], v[238:239] op_sel_hi:[1,0]
    v_pk_fma_f32 v[118:119], v[118:119], v[236:237], v[106:107] op_sel:[1,1,0] op_sel_hi:[0,1,1] neg_lo:[1,0,0]
    v_pk_fma_f32 v[120:121], v[120:121], v[238:239], v[108:109] op_sel:[1,1,0] op_sel_hi:[0,1,1] neg_lo:[1,0,0]
    v_cvt_pk_bf16_f32 v110, v118, -v119
    v_cvt_pk_bf16_f32 v111, v120, -v121
    ds_write_b64 v3, v[110:111] offset:7392
    v_pk_mul_f32 v[106:107], v[118:119], v[244:245] op_sel_hi:[1,0]
    v_pk_mul_f32 v[108:109], v[120:121], v[246:247] op_sel_hi:[1,0]
    v_pk_fma_f32 v[114:115], v[118:119], v[244:245], v[106:107] op_sel:[1,1,0] op_sel_hi:[0,1,1] neg_lo:[1,0,0]
    v_pk_fma_f32 v[116:117], v[120:121], v[246:247], v[108:109] op_sel:[1,1,0] op_sel_hi:[0,1,1] neg_lo:[1,0,0]
    v_cvt_pk_bf16_f32 v110, v114, -v115
    v_cvt_pk_bf16_f32 v111, v116, -v117
    ds_write_b64 v3, v[110:111] offset:7920
    v_pk_mul_f32 v[106:107], v[118:119], v[236:237] op_sel_hi:[1,0]
    v_pk_mul_f32 v[108:109], v[120:121], v[238:239] op_sel_hi:[1,0]
    v_pk_fma_f32 v[118:119], v[118:119], v[236:237], v[106:107] op_sel:[1,1,0] op_sel_hi:[0,1,1] neg_lo:[1,0,0]
    v_pk_fma_f32 v[120:121], v[120:121], v[238:239], v[108:109] op_sel:[1,1,0] op_sel_hi:[0,1,1] neg_lo:[1,0,0]
    v_cvt_pk_bf16_f32 v110, v118, -v119
    v_cvt_pk_bf16_f32 v111, v120, -v121
    ds_write_b64 v3, v[110:111] offset:8448
    v_pk_mul_f32 v[106:107], v[118:119], v[236:237] op_sel_hi:[1,0]
    v_pk_mul_f32 v[108:109], v[120:121], v[238:239] op_sel_hi:[1,0]
    v_pk_fma_f32 v[118:119], v[118:119], v[236:237], v[106:107] op_sel:[1,1,0] op_sel_hi:[0,1,1] neg_lo:[1,0,0]
    v_pk_fma_f32 v[120:121], v[120:121], v[238:239], v[108:109] op_sel:[1,1,0] op_sel_hi:[0,1,1] neg_lo:[1,0,0]
    v_cvt_pk_bf16_f32 v110, v118, -v119
    v_cvt_pk_bf16_f32 v111, v120, -v121
    ds_write_b64 v3, v[110:111] offset:8976
    v_pk_mul_f32 v[106:107], v[118:119], v[236:237] op_sel_hi:[1,0]
    v_pk_mul_f32 v[108:109], v[120:121], v[238:239] op_sel_hi:[1,0]
    v_pk_fma_f32 v[118:119], v[118:119], v[236:237], v[106:107] op_sel:[1,1,0] op_sel_hi:[0,1,1] neg_lo:[1,0,0]
    v_pk_fma_f32 v[120:121], v[120:121], v[238:239], v[108:109] op_sel:[1,1,0] op_sel_hi:[0,1,1] neg_lo:[1,0,0]
    v_cvt_pk_bf16_f32 v110, v118, -v119
    v_cvt_pk_bf16_f32 v111, v120, -v121
    ds_write_b64 v3, v[110:111] offset:9504
    v_pk_mul_f32 v[106:107], v[118:119], v[236:237] op_sel_hi:[1,0]
    v_pk_mul_f32 v[108:109], v[120:121], v[238:239] op_sel_hi:[1,0]
    v_pk_fma_f32 v[118:119], v[118:119], v[236:237], v[106:107] op_sel:[1,1,0] op_sel_hi:[0,1,1] neg_lo:[1,0,0]
    v_pk_fma_f32 v[120:121], v[120:121], v[238:239], v[108:109] op_sel:[1,1,0] op_sel_hi:[0,1,1] neg_lo:[1,0,0]
    v_cvt_pk_bf16_f32 v110, v118, -v119
    v_cvt_pk_bf16_f32 v111, v120, -v121
    ds_write_b64 v3, v[110:111] offset:10032
    v_pk_mul_f32 v[106:107], v[118:119], v[236:237] op_sel_hi:[1,0]
    v_pk_mul_f32 v[108:109], v[120:121], v[238:239] op_sel_hi:[1,0]
    v_pk_fma_f32 v[118:119], v[118:119], v[236:237], v[106:107] op_sel:[1,1,0] op_sel_hi:[0,1,1] neg_lo:[1,0,0]
    v_pk_fma_f32 v[120:121], v[120:121], v[238:239], v[108:109] op_sel:[1,1,0] op_sel_hi:[0,1,1] neg_lo:[1,0,0]
    v_cvt_pk_bf16_f32 v110, v118, -v119
    v_cvt_pk_bf16_f32 v111, v120, -v121
    ds_write_b64 v3, v[110:111] offset:10560
    ds_read_b128 v[34:37], v4 offset:0
    ds_read_b128 v[38:41], v4 offset:32
    ds_read_b128 v[42:45], v4 offset:64
    ds_read_b128 v[46:49], v4 offset:96
    ds_read_b128 v[50:53], v4 offset:128
    ds_read_b128 v[54:57], v4 offset:160
    ds_read_b128 v[58:61], v4 offset:192
    ds_read_b128 v[62:65], v4 offset:224
    ds_read_b128 v[66:69], v4 offset:256
    ds_read_b128 v[70:73], v4 offset:288
    ds_read_b128 v[74:77], v4 offset:320
    ds_read_b128 v[78:81], v4 offset:352
    ds_read_b128 v[82:85], v4 offset:384
    ds_read_b128 v[86:89], v4 offset:416
    ds_read_b128 v[90:93], v4 offset:448
    ds_read_b128 v[94:97], v4 offset:480
    v_mov_b32 v110, 0x3f80
    v_mov_b32 v111, 0x3f80
    ds_write_b64 v3, v[110:111]
    v_cvt_pk_bf16_f32 v110, v228, v229
    v_cvt_pk_bf16_f32 v111, v230, v231
    ds_write_b64 v3, v[110:111] offset:528
    v_pk_mul_f32 v[106:107], v[228:229], v[228:229] op_sel_hi:[1,0]
    v_pk_mul_f32 v[108:109], v[230:231], v[230:231] op_sel_hi:[1,0]
    v_pk_fma_f32 v[114:115], v[228:229], v[228:229], v[106:107] op_sel:[1,1,0] op_sel_hi:[0,1,1] neg_lo:[1,0,0]
    v_pk_fma_f32 v[116:117], v[230:231], v[230:231], v[108:109] op_sel:[1,1,0] op_sel_hi:[0,1,1] neg_lo:[1,0,0]
    v_cvt_pk_bf16_f32 v110, v114, v115
    v_cvt_pk_bf16_f32 v111, v116, v117
    ds_write_b64 v3, v[110:111] offset:1056
    v_pk_mul_f32 v[106:107], v[114:115], v[228:229] op_sel_hi:[1,0]
    v_pk_mul_f32 v[108:109], v[116:117], v[230:231] op_sel_hi:[1,0]
    v_pk_fma_f32 v[114:115], v[114:115], v[228:229], v[106:107] op_sel:[1,1,0] op_sel_hi:[0,1,1] neg_lo:[1,0,0]
    v_pk_fma_f32 v[116:117], v[116:117], v[230:231], v[108:109] op_sel:[1,1,0] op_sel_hi:[0,1,1] neg_lo:[1,0,0]
    v_cvt_pk_bf16_f32 v110, v114, v115
    v_cvt_pk_bf16_f32 v111, v116, v117
    ds_write_b64 v3, v[110:111] offset:1584
    v_pk_mul_f32 v[106:107], v[114:115], v[228:229] op_sel_hi:[1,0]
    v_pk_mul_f32 v[108:109], v[116:117], v[230:231] op_sel_hi:[1,0]
    v_pk_fma_f32 v[114:115], v[114:115], v[228:229], v[106:107] op_sel:[1,1,0] op_sel_hi:[0,1,1] neg_lo:[1,0,0]
    v_pk_fma_f32 v[116:117], v[116:117], v[230:231], v[108:109] op_sel:[1,1,0] op_sel_hi:[0,1,1] neg_lo:[1,0,0]
    v_cvt_pk_bf16_f32 v110, v114, v115
    v_cvt_pk_bf16_f32 v111, v116, v117
    ds_write_b64 v3, v[110:111] offset:2112
    v_pk_mul_f32 v[106:107], v[114:115], v[228:229] op_sel_hi:[1,0]
    v_pk_mul_f32 v[108:109], v[116:117], v[230:231] op_sel_hi:[1,0]
    v_pk_fma_f32 v[114:115], v[114:115], v[228:229], v[106:107] op_sel:[1,1,0] op_sel_hi:[0,1,1] neg_lo:[1,0,0]
    v_pk_fma_f32 v[116:117], v[116:117], v[230:231], v[108:109] op_sel:[1,1,0] op_sel_hi:[0,1,1] neg_lo:[1,0,0]
    v_cvt_pk_bf16_f32 v110, v114, v115
    v_cvt_pk_bf16_f32 v111, v116, v117
    ds_write_b64 v3, v[110:111] offset:2640
    v_pk_mul_f32 v[106:107], v[114:115], v[228:229] op_sel_hi:[1,0]
    v_pk_mul_f32 v[108:109], v[116:117], v[230:231] op_sel_hi:[1,0]
    v_pk_fma_f32 v[114:115], v[114:115], v[228:229], v[106:107] op_sel:[1,1,0] op_sel_hi:[0,1,1] neg_lo:[1,0,0]
    v_pk_fma_f32 v[116:117], v[116:117], v[230:231], v[108:109] op_sel:[1,1,0] op_sel_hi:[0,1,1] neg_lo:[1,0,0]
    v_cvt_pk_bf16_f32 v110, v114, v115
    v_cvt_pk_bf16_f32 v111, v116, v117
    ds_write_b64 v3, v[110:111] offset:3168
    v_pk_mul_f32 v[106:107], v[114:115], v[228:229] op_sel_hi:[1,0]
    v_pk_mul_f32 v[108:109], v[116:117], v[230:231] op_sel_hi:[1,0]
    v_pk_fma_f32 v[114:115], v[114:115], v[228:229], v[106:107] op_sel:[1,1,0] op_sel_hi:[0,1,1] neg_lo:[1,0,0]
    v_pk_fma_f32 v[116:117], v[116:117], v[230:231], v[108:109] op_sel:[1,1,0] op_sel_hi:[0,1,1] neg_lo:[1,0,0]
    v_cvt_pk_bf16_f32 v110, v114, v115
    v_cvt_pk_bf16_f32 v111, v116, v117
    ds_write_b64 v3, v[110:111] offset:3696
    v_pk_mul_f32 v[106:107], v[114:115], v[228:229] op_sel_hi:[1,0]
    v_pk_mul_f32 v[108:109], v[116:117], v[230:231] op_sel_hi:[1,0]
    v_pk_fma_f32 v[114:115], v[114:115], v[228:229], v[106:107] op_sel:[1,1,0] op_sel_hi:[0,1,1] neg_lo:[1,0,0]
    v_pk_fma_f32 v[116:117], v[116:117], v[230:231], v[108:109] op_sel:[1,1,0] op_sel_hi:[0,1,1] neg_lo:[1,0,0]
    v_cvt_pk_bf16_f32 v110, v114, v115
    v_cvt_pk_bf16_f32 v111, v116, v117
    ds_write_b64 v3, v[110:111] offset:4224
    v_pk_mul_f32 v[106:107], v[114:115], v[228:229] op_sel_hi:[1,0]
    v_pk_mul_f32 v[108:109], v[116:117], v[230:231] op_sel_hi:[1,0]
    v_pk_fma_f32 v[114:115], v[114:115], v[228:229], v[106:107] op_sel:[1,1,0] op_sel_hi:[0,1,1] neg_lo:[1,0,0]
    v_pk_fma_f32 v[116:117], v[116:117], v[230:231], v[108:109] op_sel:[1,1,0] op_sel_hi:[0,1,1] neg_lo:[1,0,0]
    v_cvt_pk_bf16_f32 v110, v114, v115
    v_cvt_pk_bf16_f32 v111, v116, v117
    ds_write_b64 v3, v[110:111] offset:4752
    v_pk_mul_f32 v[106:107], v[114:115], v[228:229] op_sel_hi:[1,0]
    v_pk_mul_f32 v[108:109], v[116:117], v[230:231] op_sel_hi:[1,0]
    v_pk_fma_f32 v[114:115], v[114:115], v[228:229], v[106:107] op_sel:[1,1,0] op_sel_hi:[0,1,1] neg_lo:[1,0,0]
    v_pk_fma_f32 v[116:117], v[116:117], v[230:231], v[108:109] op_sel:[1,1,0] op_sel_hi:[0,1,1] neg_lo:[1,0,0]
    v_cvt_pk_bf16_f32 v110, v114, v115
    v_cvt_pk_bf16_f32 v111, v116, v117
    ds_write_b64 v3, v[110:111] offset:5280
    v_pk_mul_f32 v[106:107], v[114:115], v[228:229] op_sel_hi:[1,0]
    v_pk_mul_f32 v[108:109], v[116:117], v[230:231] op_sel_hi:[1,0]
    v_pk_fma_f32 v[114:115], v[114:115], v[228:229], v[106:107] op_sel:[1,1,0] op_sel_hi:[0,1,1] neg_lo:[1,0,0]
    v_pk_fma_f32 v[116:117], v[116:117], v[230:231], v[108:109] op_sel:[1,1,0] op_sel_hi:[0,1,1] neg_lo:[1,0,0]
    v_cvt_pk_bf16_f32 v110, v114, v115
    v_cvt_pk_bf16_f32 v111, v116, v117
    ds_write_b64 v3, v[110:111] offset:5808
    v_pk_mul_f32 v[106:107], v[114:115], v[228:229] op_sel_hi:[1,0]
    v_pk_mul_f32 v[108:109], v[116:117], v[230:231] op_sel_hi:[1,0]
    v_pk_fma_f32 v[114:115], v[114:115], v[228:229], v[106:107] op_sel:[1,1,0] op_sel_hi:[0,1,1] neg_lo:[1,0,0]
    v_pk_fma_f32 v[116:117], v[116:117], v[230:231], v[108:109] op_sel:[1,1,0] op_sel_hi:[0,1,1] neg_lo:[1,0,0]
    v_cvt_pk_bf16_f32 v110, v114, v115
    v_cvt_pk_bf16_f32 v111, v116, v117
    ds_write_b64 v3, v[110:111] offset:6336
    v_pk_mul_f32 v[106:107], v[114:115], v[228:229] op_sel_hi:[1,0]
    v_pk_mul_f32 v[108:109], v[116:117], v[230:231] op_sel_hi:[1,0]
    v_pk_fma_f32 v[114:115], v[114:115], v[228:229], v[106:107] op_sel:[1,1,0] op_sel_hi:[0,1,1] neg_lo:[1,0,0]
    v_pk_fma_f32 v[116:117], v[116:117], v[230:231], v[108:109] op_sel:[1,1,0] op_sel_hi:[0,1,1] neg_lo:[1,0,0]
    v_cvt_pk_bf16_f32 v110, v114, v115
    v_cvt_pk_bf16_f32 v111, v116, v117
    ds_write_b64 v3, v[110:111] offset:6864
    v_pk_mul_f32 v[106:107], v[114:115], v[228:229] op_sel_hi:[1,0]
    v_pk_mul_f32 v[108:109], v[116:117], v[230:231] op_sel_hi:[1,0]
    v_pk_fma_f32 v[114:115], v[114:115], v[228:229], v[106:107] op_sel:[1,1,0] op_sel_hi:[0,1,1] neg_lo:[1,0,0]
    v_pk_fma_f32 v[116:117], v[116:117], v[230:231], v[108:109] op_sel:[1,1,0] op_sel_hi:[0,1,1] neg_lo:[1,0,0]
    v_cvt_pk_bf16_f32 v110, v114, v115
    v_cvt_pk_bf16_f32 v111, v116, v117
    ds_write_b64 v3, v[110:111] offset:7392
    v_pk_mul_f32 v[106:107], v[114:115], v[228:229] op_sel_hi:[1,0]
    v_pk_mul_f32 v[108:109], v[116:117], v[230:231] op_sel_hi:[1,0]
    v_pk_fma_f32 v[114:115], v[114:115], v[228:229], v[106:107] op_sel:[1,1,0] op_sel_hi:[0,1,1] neg_lo:[1,0,0]
    v_pk_fma_f32 v[116:117], v[116:117], v[230:231], v[108:109] op_sel:[1,1,0] op_sel_hi:[0,1,1] neg_lo:[1,0,0]
    v_cvt_pk_bf16_f32 v110, v114, v115
    v_cvt_pk_bf16_f32 v111, v116, v117
    ds_write_b64 v3, v[110:111] offset:7920
    v_cvt_pk_bf16_f32 v110, v232, v233
    v_cvt_pk_bf16_f32 v111, v234, v235
    ds_write_b64 v3, v[110:111] offset:8448
    v_pk_mul_f32 v[106:107], v[232:233], v[228:229] op_sel_hi:[1,0]
    v_pk_mul_f32 v[108:109], v[234:235], v[230:231] op_sel_hi:[1,0]
    v_pk_fma_f32 v[114:115], v[232:233], v[228:229], v[106:107] op_sel:[1,1,0] op_sel_hi:[0,1,1] neg_lo:[1,0,0]
    v_pk_fma_f32 v[116:117], v[234:235], v[230:231], v[108:109] op_sel:[1,1,0] op_sel_hi:[0,1,1] neg_lo:[1,0,0]
    v_cvt_pk_bf16_f32 v110, v114, v115
    v_cvt_pk_bf16_f32 v111, v116, v117
    ds_write_b64 v3, v[110:111] offset:8976
    v_pk_mul_f32 v[106:107], v[114:115], v[228:229] op_sel_hi:[1,0]
    v_pk_mul_f32 v[108:109], v[116:117], v[230:231] op_sel_hi:[1,0]
    v_pk_fma_f32 v[114:115], v[114:115], v[228:229], v[106:107] op_sel:[1,1,0] op_sel_hi:[0,1,1] neg_lo:[1,0,0]
    v_pk_fma_f32 v[116:117], v[116:117], v[230:231], v[108:109] op_sel:[1,1,0] op_sel_hi:[0,1,1] neg_lo:[1,0,0]
    v_cvt_pk_bf16_f32 v110, v114, v115
    v_cvt_pk_bf16_f32 v111, v116, v117
    ds_write_b64 v3, v[110:111] offset:9504
    v_pk_mul_f32 v[106:107], v[114:115], v[228:229] op_sel_hi:[1,0]
    v_pk_mul_f32 v[108:109], v[116:117], v[230:231] op_sel_hi:[1,0]
    v_pk_fma_f32 v[114:115], v[114:115], v[228:229], v[106:107] op_sel:[1,1,0] op_sel_hi:[0,1,1] neg_lo:[1,0,0]
    v_pk_fma_f32 v[116:117], v[116:117], v[230:231], v[108:109] op_sel:[1,1,0] op_sel_hi:[0,1,1] neg_lo:[1,0,0]
    v_cvt_pk_bf16_f32 v110, v114, v115
    v_cvt_pk_bf16_f32 v111, v116, v117
    ds_write_b64 v3, v[110:111] offset:10032
    v_pk_mul_f32 v[106:107], v[114:115], v[228:229] op_sel_hi:[1,0]
    v_pk_mul_f32 v[108:109], v[116:117], v[230:231] op_sel_hi:[1,0]
    v_pk_fma_f32 v[114:115], v[114:115], v[228:229], v[106:107] op_sel:[1,1,0] op_sel_hi:[0,1,1] neg_lo:[1,0,0]
    v_pk_fma_f32 v[116:117], v[116:117], v[230:231], v[108:109] op_sel:[1,1,0] op_sel_hi:[0,1,1] neg_lo:[1,0,0]
    v_cvt_pk_bf16_f32 v110, v114, v115
    v_cvt_pk_bf16_f32 v111, v116, v117
    ds_write_b64 v3, v[110:111] offset:10560
    v_pk_mul_f32 v[106:107], v[114:115], v[228:229] op_sel_hi:[1,0]
    v_pk_mul_f32 v[108:109], v[116:117], v[230:231] op_sel_hi:[1,0]
    v_pk_fma_f32 v[114:115], v[114:115], v[228:229], v[106:107] op_sel:[1,1,0] op_sel_hi:[0,1,1] neg_lo:[1,0,0]
    v_pk_fma_f32 v[116:117], v[116:117], v[230:231], v[108:109] op_sel:[1,1,0] op_sel_hi:[0,1,1] neg_lo:[1,0,0]
    v_cvt_pk_bf16_f32 v110, v114, v115
    v_cvt_pk_bf16_f32 v111, v116, v117
    ds_write_b64 v3, v[110:111] offset:11088
    v_pk_mul_f32 v[106:107], v[114:115], v[228:229] op_sel_hi:[1,0]
    v_pk_mul_f32 v[108:109], v[116:117], v[230:231] op_sel_hi:[1,0]
    v_pk_fma_f32 v[114:115], v[114:115], v[228:229], v[106:107] op_sel:[1,1,0] op_sel_hi:[0,1,1] neg_lo:[1,0,0]
    v_pk_fma_f32 v[116:117], v[116:117], v[230:231], v[108:109] op_sel:[1,1,0] op_sel_hi:[0,1,1] neg_lo:[1,0,0]
    v_cvt_pk_bf16_f32 v110, v114, v115
    v_cvt_pk_bf16_f32 v111, v116, v117
    ds_write_b64 v3, v[110:111] offset:11616
    v_pk_mul_f32 v[106:107], v[114:115], v[228:229] op_sel_hi:[1,0]
    v_pk_mul_f32 v[108:109], v[116:117], v[230:231] op_sel_hi:[1,0]
    v_pk_fma_f32 v[114:115], v[114:115], v[228:229], v[106:107] op_sel:[1,1,0] op_sel_hi:[0,1,1] neg_lo:[1,0,0]
    v_pk_fma_f32 v[116:117], v[116:117], v[230:231], v[108:109] op_sel:[1,1,0] op_sel_hi:[0,1,1] neg_lo:[1,0,0]
    v_cvt_pk_bf16_f32 v110, v114, v115
    v_cvt_pk_bf16_f32 v111, v116, v117
    ds_write_b64 v3, v[110:111] offset:12144
    v_pk_mul_f32 v[106:107], v[114:115], v[228:229] op_sel_hi:[1,0]
    v_pk_mul_f32 v[108:109], v[116:117], v[230:231] op_sel_hi:[1,0]
    v_pk_fma_f32 v[114:115], v[114:115], v[228:229], v[106:107] op_sel:[1,1,0] op_sel_hi:[0,1,1] neg_lo:[1,0,0]
    v_pk_fma_f32 v[116:117], v[116:117], v[230:231], v[108:109] op_sel:[1,1,0] op_sel_hi:[0,1,1] neg_lo:[1,0,0]
    v_cvt_pk_bf16_f32 v110, v114, v115
    v_cvt_pk_bf16_f32 v111, v116, v117
    ds_write_b64 v3, v[110:111] offset:12672
    v_pk_mul_f32 v[106:107], v[114:115], v[228:229] op_sel_hi:[1,0]
    v_pk_mul_f32 v[108:109], v[116:117], v[230:231] op_sel_hi:[1,0]
    v_pk_fma_f32 v[114:115], v[114:115], v[228:229], v[106:107] op_sel:[1,1,0] op_sel_hi:[0,1,1] neg_lo:[1,0,0]
    v_pk_fma_f32 v[116:117], v[116:117], v[230:231], v[108:109] op_sel:[1,1,0] op_sel_hi:[0,1,1] neg_lo:[1,0,0]
    v_cvt_pk_bf16_f32 v110, v114, v115
    v_cvt_pk_bf16_f32 v111, v116, v117
    ds_write_b64 v3, v[110:111] offset:13200
    v_pk_mul_f32 v[106:107], v[114:115], v[228:229] op_sel_hi:[1,0]
    v_pk_mul_f32 v[108:109], v[116:117], v[230:231] op_sel_hi:[1,0]
    v_pk_fma_f32 v[114:115], v[114:115], v[228:229], v[106:107] op_sel:[1,1,0] op_sel_hi:[0,1,1] neg_lo:[1,0,0]
    v_pk_fma_f32 v[116:117], v[116:117], v[230:231], v[108:109] op_sel:[1,1,0] op_sel_hi:[0,1,1] neg_lo:[1,0,0]
    v_cvt_pk_bf16_f32 v110, v114, v115
    v_cvt_pk_bf16_f32 v111, v116, v117
    ds_write_b64 v3, v[110:111] offset:13728
    v_pk_mul_f32 v[106:107], v[114:115], v[228:229] op_sel_hi:[1,0]
    v_pk_mul_f32 v[108:109], v[116:117], v[230:231] op_sel_hi:[1,0]
    v_pk_fma_f32 v[114:115], v[114:115], v[228:229], v[106:107] op_sel:[1,1,0] op_sel_hi:[0,1,1] neg_lo:[1,0,0]
    v_pk_fma_f32 v[116:117], v[116:117], v[230:231], v[108:109] op_sel:[1,1,0] op_sel_hi:[0,1,1] neg_lo:[1,0,0]
    v_cvt_pk_bf16_f32 v110, v114, v115
    v_cvt_pk_bf16_f32 v111, v116, v117
    ds_write_b64 v3, v[110:111] offset:14256
    v_pk_mul_f32 v[106:107], v[114:115], v[228:229] op_sel_hi:[1,0]
    v_pk_mul_f32 v[108:109], v[116:117], v[230:231] op_sel_hi:[1,0]
    v_pk_fma_f32 v[114:115], v[114:115], v[228:229], v[106:107] op_sel:[1,1,0] op_sel_hi:[0,1,1] neg_lo:[1,0,0]
    v_pk_fma_f32 v[116:117], v[116:117], v[230:231], v[108:109] op_sel:[1,1,0] op_sel_hi:[0,1,1] neg_lo:[1,0,0]
    v_cvt_pk_bf16_f32 v110, v114, v115
    v_cvt_pk_bf16_f32 v111, v116, v117
    ds_write_b64 v3, v[110:111] offset:14784
    v_pk_mul_f32 v[106:107], v[114:115], v[228:229] op_sel_hi:[1,0]
    v_pk_mul_f32 v[108:109], v[116:117], v[230:231] op_sel_hi:[1,0]
    v_pk_fma_f32 v[114:115], v[114:115], v[228:229], v[106:107] op_sel:[1,1,0] op_sel_hi:[0,1,1] neg_lo:[1,0,0]
    v_pk_fma_f32 v[116:117], v[116:117], v[230:231], v[108:109] op_sel:[1,1,0] op_sel_hi:[0,1,1] neg_lo:[1,0,0]
    v_cvt_pk_bf16_f32 v110, v114, v115
    v_cvt_pk_bf16_f32 v111, v116, v117
    ds_write_b64 v3, v[110:111] offset:15312
    v_pk_mul_f32 v[106:107], v[114:115], v[228:229] op_sel_hi:[1,0]
    v_pk_mul_f32 v[108:109], v[116:117], v[230:231] op_sel_hi:[1,0]
    v_pk_fma_f32 v[114:115], v[114:115], v[228:229], v[106:107] op_sel:[1,1,0] op_sel_hi:[0,1,1] neg_lo:[1,0,0]
    v_pk_fma_f32 v[116:117], v[116:117], v[230:231], v[108:109] op_sel:[1,1,0] op_sel_hi:[0,1,1] neg_lo:[1,0,0]
    v_cvt_pk_bf16_f32 v110, v114, v115
    v_cvt_pk_bf16_f32 v111, v116, v117
    ds_write_b64 v3, v[110:111] offset:15840
    v_pk_mul_f32 v[106:107], v[114:115], v[228:229] op_sel_hi:[1,0]
    v_pk_mul_f32 v[108:109], v[116:117], v[230:231] op_sel_hi:[1,0]
    v_pk_fma_f32 v[114:115], v[114:115], v[228:229], v[106:107] op_sel:[1,1,0] op_sel_hi:[0,1,1] neg_lo:[1,0,0]
    v_pk_fma_f32 v[116:117], v[116:117], v[230:231], v[108:109] op_sel:[1,1,0] op_sel_hi:[0,1,1] neg_lo:[1,0,0]
    v_cvt_pk_bf16_f32 v110, v114, v115
    v_cvt_pk_bf16_f32 v111, v116, v117
    ds_write_b64 v3, v[110:111] offset:16368
    ds_read_b128 v[130:133], v4 offset:0
    ds_read_b128 v[134:137], v4 offset:32
    ds_read_b128 v[138:141], v4 offset:64
    ds_read_b128 v[142:145], v4 offset:96
    ds_read_b128 v[146:149], v4 offset:128
    ds_read_b128 v[150:153], v4 offset:160
    ds_read_b128 v[154:157], v4 offset:192
    ds_read_b128 v[158:161], v4 offset:224
    s_waitcnt lgkmcnt(7)
    v_mfma_f32_32x32x16_bf16 v[178:193], v[34:37], v[130:133], 0
    ds_read_b128 v[130:133], v4 offset:256
    s_mul_i32 s78, s56, 16928
    s_add_u32 s78, s78, 68352
    s_waitcnt lgkmcnt(7)
    v_mfma_f32_32x32x16_bf16 v[178:193], v[38:41], v[134:137], v[178:193]
    ds_read_b128 v[134:137], v4 offset:288
    v_mov_b32 v210, 0
    v_and_b32 v5, 31, v1
    s_waitcnt lgkmcnt(7)
    v_mfma_f32_32x32x16_bf16 v[178:193], v[42:45], v[138:141], v[178:193]
    ds_read_b128 v[138:141], v4 offset:320
    v_lshrrev_b32 v6, 2, v1
    v_and_b32 v6, 8, v6
    s_waitcnt lgkmcnt(7)
    v_mfma_f32_32x32x16_bf16 v[178:193], v[46:49], v[142:145], v[178:193]
    ds_read_b128 v[142:145], v4 offset:352
    v_lshlrev_b32 v7, 4, v5
    v_sub_u32 v7, s62, v7
    s_waitcnt lgkmcnt(7)
    v_mfma_f32_32x32x16_bf16 v[178:193], v[50:53], v[146:149], v[178:193]
    ds_read_b128 v[146:149], v4 offset:384
    v_sub_u32 v8, v7, v6
    v_lshl_add_u32 v214, v5, 2, s62
    s_waitcnt lgkmcnt(7)
    v_mfma_f32_32x32x16_bf16 v[178:193], v[54:57], v[150:153], v[178:193]
    ds_read_b128 v[150:153], v4 offset:416
    v_lshl_add_u32 v215, v5, 1, s62
    v_and_b32 v2, 15, v1
    s_waitcnt lgkmcnt(7)
    v_mfma_f32_32x32x16_bf16 v[178:193], v[58:61], v[154:157], v[178:193]
    ds_read_b128 v[154:157], v4 offset:448
    v_lshrrev_b32 v6, 2, v1
    v_and_b32 v6, 12, v6
    s_waitcnt lgkmcnt(7)
    v_mfma_f32_32x32x16_bf16 v[178:193], v[62:65], v[158:161], v[178:193]
    ds_read_b128 v[158:161], v4 offset:480
    v_sub_u32 v3, v2, v6
    v_sub_u32 v2, v3, v6
    s_waitcnt lgkmcnt(7)
    v_mfma_f32_32x32x16_bf16 v[178:193], v[66:69], v[130:133], v[178:193]
    v_add_u32 v5, 1, v1
    v_and_b32 v5, 1, v5
    v_mul_u32_u24 v5, 1218, v5
    s_waitcnt lgkmcnt(6)
    v_mfma_f32_32x32x16_bf16 v[178:193], v[70:73], v[134:137], v[178:193]
    v_lshlrev_b32 v6, 1, v2
    v_sub_u32 v5, v5, v6
    s_add_u32 s67, s62, 38
    s_waitcnt lgkmcnt(5)
    v_mfma_f32_32x32x16_bf16 v[178:193], v[74:77], v[138:141], v[178:193]
    v_add_u32 v216, s67, v5
    v_add_u32 v217, 512, v216
    s_add_u32 s67, s62, 2528
    s_waitcnt lgkmcnt(4)
    v_mfma_f32_32x32x16_bf16 v[178:193], v[78:81], v[142:145], v[178:193]
    s_add_u32 s68, s62, 2992
    v_lshl_add_u32 v230, v3, 3, s67
    v_lshl_add_u32 v231, v3, 2, s68
    s_waitcnt lgkmcnt(3)
    v_mfma_f32_32x32x16_bf16 v[178:193], v[82:85], v[146:149], v[178:193]
    s_waitcnt lgkmcnt(2)
    v_mfma_f32_32x32x16_bf16 v[178:193], v[86:89], v[150:153], v[178:193]
    s_waitcnt lgkmcnt(1)
    v_mfma_f32_32x32x16_bf16 v[178:193], v[90:93], v[154:157], v[178:193]
    s_waitcnt lgkmcnt(0)
    v_mfma_f32_32x32x16_bf16 v[178:193], v[94:97], v[158:161], v[178:193]
    s_nop 11
    v_cvt_pk_bf16_f32 v218, v185, v184
    v_cvt_pk_bf16_f32 v219, v184, v184
    v_cvt_pk_bf16_f32 v220, v183, v182
    v_cvt_pk_bf16_f32 v221, v182, v182
    v_cvt_pk_bf16_f32 v222, v184, v183
    v_cvt_pk_bf16_f32 v224, v186, v187
    v_cvt_pk_bf16_f32 v225, v188, v189
    v_cvt_pk_bf16_f32 v226, v181, v180
    v_cvt_pk_bf16_f32 v227, v179, v178
    v_cvt_pk_bf16_f32 v228, v180, v179
    v_readlane_b32 s66, v224, 0
    s_mov_b32 exec_hi, 0
    ds_write_b32 v7, v218 offset:1788
    ds_write_b32 v7, v219 offset:1792
    ds_write_b32 v7, v220 offset:1796
    ds_write_b32 v7, v221 offset:1800
    ds_write_b16 v7, v218 offset:570
    ds_write_b32 v7, v219 offset:572
    ds_write_b32 v7, v222 offset:576
    ds_write_b32 v7, v221 offset:580
    ds_write_b16 v7, v221 offset:584
    ds_write_b16 v215, v224 offset:3002
    ds_write_b16_d16_hi v215, v224 offset:3066
    ds_write_b16 v215, v225 offset:3130
    ds_write_b16_d16_hi v215, v225 offset:3194
    s_mov_b32 exec_lo, 1
    ds_write_b16 v215, v210 offset:3002
    ds_write_b16 v215, v224 offset:2806
    s_mov_b32 exec_lo, 0
    s_mov_b32 exec_hi, -1
    ds_write_b16_d16_hi v214, v220 offset:2550
    ds_write_b16 v214, v220 offset:2552
    ds_write_b16_d16_hi v214, v218 offset:2678
    ds_write_b16 v214, v218 offset:2680
    s_mov_b32 exec_hi, 1
    ds_write_b16 v214, v210 offset:2550
    ds_write_b16 v214, v224 offset:3258
    ds_write_b16 v214, v221 offset:66
    ds_write_b32 v214, v221 offset:68
    ds_write_b16 v214, v221 offset:72
    ds_write_b32 v214, v221 offset:1284
    ds_write_b32 v214, v221 offset:1288
    s_mov_b64 exec, -1
    ds_write_b64 v8, v[226:227] offset:1088
    ds_write_b16 v8, v226 offset:2306
    ds_write_b32 v8, v228 offset:2308
    ds_write_b16_d16_hi v8, v227 offset:2312
    s_and_b32 s66, s66, 0xffff
    s_mul_i32 s66, s66, 65537
    ds_read2_b32 v[54:55], v217 offset0:16 offset1:17
    ds_read2_b32 v[56:57], v217 offset0:18 offset1:19
    ds_read2_b32 v[58:59], v216 offset0:16 offset1:17
    ds_read2_b32 v[60:61], v216 offset0:18 offset1:19
    ds_read2_b32 v[34:35], v217 offset0:128 offset1:129
    ds_read2_b32 v[36:37], v217 offset0:130 offset1:131
    ds_read2_b32 v[38:39], v216 offset0:128 offset1:129
    ds_read2_b32 v[40:41], v216 offset0:130 offset1:131
    ds_read2_b32 v[42:43], v216 offset0:0 offset1:1
    ds_read2_b32 v[44:45], v216 offset0:2 offset1:3
    s_barrier
    v_lshlrev_b32 v6, 4, v1
    ds_read_b128 v[102:105], v6 offset:5376
    ds_read_b128 v[10:13], v6 offset:256
    ds_read_b128 v[14:17], v6 offset:1280
    ds_read_b128 v[18:21], v6 offset:2304
    ds_read_b128 v[22:25], v6 offset:3328
    ds_read_b128 v[26:29], v6 offset:4352
    v_and_b32 v7, 15, v1
    v_lshrrev_b32 v8, 4, v1
    v_lshlrev_b32 v5, 5, v7
    v_lshl_add_u32 v5, v8, 4, v5
    v_add_u32 v5, s78, v5
    s_waitcnt lgkmcnt(5)
    v_and_b32 v102, s66, v102
    v_and_b32 v103, s66, v103
    v_and_b32 v104, s66, v104
    v_and_b32 v105, s66, v105
    s_waitcnt lgkmcnt(0)
    s_barrier
    s_setprio 1
    ds_read_b128 v[194:197], v5 offset:0
    ds_read_b128 v[198:201], v5 offset:448
    ds_read_b128 v[238:241], v5 offset:432
    ds_read_b128 v[202:205], v5 offset:512
    s_waitcnt lgkmcnt(3)
    v_mfma_f32_16x16x32_bf16 v[146:149], v[194:197], v[54:57], 0
    ds_read_b128 v[206:209], v5 offset:1024
    v_mfma_f32_16x16x32_bf16 v[150:153], v[194:197], v[58:61], 0
    ds_read_b128 v[86:89], v5 offset:1536
    s_waitcnt lgkmcnt(4)
    v_mfma_f32_16x16x32_bf16 v[178:181], v[198:201], v[10:13], 0
    v_mfma_f32_16x16x32_bf16 v[182:185], v[198:201], v[14:17], 0
    v_mfma_f32_16x16x32_bf16 v[186:189], v[198:201], v[18:21], 0
    v_mfma_f32_16x16x32_bf16 v[242:245], v[198:201], v[22:25], 0
    v_mfma_f32_16x16x32_bf16 v[146:149], v[198:201], v[34:37], v[146:149]
    ds_read_b128 v[90:93], v5 offset:2048
    ds_read2_b32 v[106:107], v230 offset0:6 offset1:4
    ds_read2_b32 v[108:109], v230 offset0:2 offset1:0
    v_mfma_f32_16x16x32_bf16 v[150:153], v[198:201], v[38:41], v[150:153]
    ds_read2_b32 v[110:111], v230 offset0:7 offset1:5
    ds_read2_b32 v[112:113], v230 offset0:3 offset1:1
    v_mfma_f32_16x16x32_bf16 v[154:157], v[198:201], v[42:45], 0
    ds_read2_b32 v[114:115], v230 offset0:38 offset1:36
    ds_read2_b32 v[116:117], v230 offset0:34 offset1:32
    v_mfma_f32_16x16x32_bf16 v[162:165], v[198:201], v[102:105], 0
    ds_read2_b32 v[118:119], v230 offset0:39 offset1:37
    ds_read2_b32 v[120:121], v230 offset0:35 offset1:33
    s_waitcnt lgkmcnt(9)
    v_mfma_f32_16x16x32_bf16 v[190:193], v[238:241], v[14:17], 0
    ds_read2_b32 v[122:123], v230 offset0:70 offset1:68
    ds_read2_b32 v[124:125], v230 offset0:66 offset1:64
    v_mfma_f32_16x16x32_bf16 v[246:249], v[238:241], v[26:29], 0
    ds_read2_b32 v[126:127], v230 offset0:71 offset1:69
    ds_read2_b32 v[128:129], v230 offset0:67 offset1:65
    v_mfma_f32_16x16x32_bf16 v[150:153], v[202:205], v[54:57], v[150:153]
    ds_read_b128 v[94:97], v5 offset:2560
    ds_read2_b32 v[130:131], v231 offset0:3 offset1:2
    ds_read2_b32 v[132:133], v231 offset0:1 offset1:0
    v_mfma_f32_16x16x32_bf16 v[154:157], v[202:205], v[58:61], v[154:157]
    ds_read2_b32 v[134:135], v231 offset0:19 offset1:18
    ds_read2_b32 v[136:137], v231 offset0:17 offset1:16
    v_mfma_f32_16x16x32_bf16 v[154:157], v[206:209], v[54:57], v[154:157]
    v_cvt_pk_bf16_f32 v218, v178, v182
    v_cvt_pk_bf16_f32 v219, v179, v183
    v_mfma_f32_16x16x32_bf16 v[158:161], v[206:209], v[58:61], 0
    v_cvt_pk_bf16_f32 v220, v180, v184
    v_cvt_pk_bf16_f32 v221, v181, v185
    v_mfma_f32_16x16x32_bf16 v[158:161], v[86:89], v[54:57], v[158:161]
    v_cvt_pk_bf16_f32 v222, v186, v190
    v_cvt_pk_bf16_f32 v223, v187, v191
    v_mfma_f32_16x16x32_bf16 v[162:165], v[86:89], v[58:61], v[162:165]
    v_cvt_pk_bf16_f32 v224, v188, v192
    v_cvt_pk_bf16_f32 v225, v189, v193
    s_waitcnt lgkmcnt(9)
    v_mfma_f32_16x16x32_bf16 v[162:165], v[90:93], v[54:57], v[162:165]
    v_cvt_pk_bf16_f32 v226, v242, v246
    v_cvt_pk_bf16_f32 v227, v243, v247
    v_mfma_f32_16x16x32_bf16 v[166:169], v[90:93], v[58:61], 0
    v_cvt_pk_bf16_f32 v228, v244, v248
    v_cvt_pk_bf16_f32 v229, v245, v249
    ds_read_b128 v[98:101], v5 offset:3072
    s_waitcnt lgkmcnt(5)
    v_mfma_f32_16x16x32_bf16 v[166:169], v[94:97], v[54:57], v[166:169]
    ds_read_b128 v[70:73], v5 offset:3584
    v_mfma_f32_16x16x32_bf16 v[170:173], v[94:97], v[58:61], 0
    ds_read_b128 v[74:77], v5 offset:64
    ds_read_b128 v[78:81], v5 offset:960
    s_waitcnt lgkmcnt(3)
    v_mfma_f32_16x16x32_bf16 v[170:173], v[98:101], v[54:57], v[170:173]
    ds_read2_b32 v[138:139], v231 offset0:35 offset1:34
    ds_read2_b32 v[140:141], v231 offset0:33 offset1:32
    v_mfma_f32_16x16x32_bf16 v[174:177], v[98:101], v[58:61], 0
    ds_read2_b32 v[142:143], v231 offset0:51 offset1:50
    ds_read2_b32 v[144:145], v231 offset0:49 offset1:48
    v_mfma_f32_16x16x32_bf16 v[154:157], v[106:109], v[218:221], v[154:157]
    ds_read2_b32 v[62:63], v217 offset0:32 offset1:33
    ds_read2_b32 v[64:65], v217 offset0:34 offset1:35
    v_mfma_f32_16x16x32_bf16 v[154:157], v[110:113], v[222:225], v[154:157]
    ds_read2_b32 v[66:67], v216 offset0:32 offset1:33
    ds_read2_b32 v[68:69], v216 offset0:34 offset1:35
    v_mfma_f32_16x16x32_bf16 v[158:161], v[114:117], v[218:221], v[158:161]
    ds_read_b128 v[238:241], v5 offset:944
    v_mfma_f32_16x16x32_bf16 v[158:161], v[118:121], v[222:225], v[158:161]
    ds_read_b128 v[82:85], v5 offset:576
    v_mfma_f32_16x16x32_bf16 v[162:165], v[122:125], v[218:221], v[162:165]
    v_mfma_f32_16x16x32_bf16 v[162:165], v[126:129], v[222:225], v[162:165]
    ds_read_b128 v[194:197], v5 offset:1088
    v_mfma_f32_16x16x32_bf16 v[162:165], v[130:133], v[226:229], v[162:165]
    v_mfma_f32_16x16x32_bf16 v[166:169], v[134:137], v[226:229], v[166:169]
    s_waitcnt lgkmcnt(7)
    v_mfma_f32_16x16x32_bf16 v[170:173], v[138:141], v[226:229], v[170:173]
    v_mfma_f32_16x16x32_bf16 v[174:177], v[142:145], v[226:229], v[174:177]
    v_mfma_f32_16x16x32_bf16 v[174:177], v[70:73], v[54:57], v[174:177]
    s_waitcnt lgkmcnt(2)
    v_mfma_f32_16x16x32_bf16 v[146:149], v[74:77], v[62:65], v[146:149]
    ds_read_b128 v[198:201], v5 offset:1600
    v_mfma_f32_16x16x32_bf16 v[150:153], v[74:77], v[66:69], v[150:153]
    v_mfma_f32_16x16x32_bf16 v[178:181], v[78:81], v[10:13], 0
    v_mfma_f32_16x16x32_bf16 v[182:185], v[78:81], v[14:17], 0
    v_mfma_f32_16x16x32_bf16 v[186:189], v[78:81], v[18:21], 0
    v_mfma_f32_16x16x32_bf16 v[242:245], v[78:81], v[22:25], 0
    v_mfma_f32_16x16x32_bf16 v[150:153], v[78:81], v[34:37], v[150:153]
    ds_read_b128 v[202:205], v5 offset:2112
    v_mfma_f32_16x16x32_bf16 v[154:157], v[78:81], v[38:41], v[154:157]
    v_mfma_f32_16x16x32_bf16 v[158:161], v[78:81], v[42:45], v[158:161]
    v_mfma_f32_16x16x32_bf16 v[166:169], v[78:81], v[102:105], v[166:169]
    v_mfma_f32_16x16x32_bf16 v[190:193], v[238:241], v[14:17], 0
    v_mfma_f32_16x16x32_bf16 v[246:249], v[238:241], v[26:29], 0
    s_waitcnt lgkmcnt(1)
    v_mfma_f32_16x16x32_bf16 v[150:153], v[82:85], v[62:65], v[150:153]
    ds_read_b128 v[206:209], v5 offset:2624
    v_mfma_f32_16x16x32_bf16 v[154:157], v[82:85], v[66:69], v[154:157]
    v_mfma_f32_16x16x32_bf16 v[154:157], v[194:197], v[62:65], v[154:157]
    v_cvt_pk_bf16_f32 v218, v178, v182
    v_cvt_pk_bf16_f32 v219, v179, v183
    v_mfma_f32_16x16x32_bf16 v[158:161], v[194:197], v[66:69], v[158:161]
    v_cvt_pk_bf16_f32 v220, v180, v184
    v_cvt_pk_bf16_f32 v221, v181, v185
    v_mfma_f32_16x16x32_bf16 v[158:161], v[198:201], v[62:65], v[158:161]
    v_cvt_pk_bf16_f32 v222, v186, v190
    v_cvt_pk_bf16_f32 v223, v187, v191
    v_mfma_f32_16x16x32_bf16 v[162:165], v[198:201], v[66:69], v[162:165]
    v_cvt_pk_bf16_f32 v224, v188, v192
    v_cvt_pk_bf16_f32 v225, v189, v193
    s_waitcnt lgkmcnt(1)
    v_mfma_f32_16x16x32_bf16 v[162:165], v[202:205], v[62:65], v[162:165]
    v_cvt_pk_bf16_f32 v226, v242, v246
    v_cvt_pk_bf16_f32 v227, v243, v247
    v_mfma_f32_16x16x32_bf16 v[166:169], v[202:205], v[66:69], v[166:169]
    v_cvt_pk_bf16_f32 v228, v244, v248
    v_cvt_pk_bf16_f32 v229, v245, v249
    ds_read_b128 v[86:89], v5 offset:3136
    s_waitcnt lgkmcnt(1)
    v_mfma_f32_16x16x32_bf16 v[166:169], v[206:209], v[62:65], v[166:169]
    ds_read_b128 v[90:93], v5 offset:3648
    v_mfma_f32_16x16x32_bf16 v[170:173], v[206:209], v[66:69], v[170:173]
    ds_read_b128 v[94:97], v5 offset:128
    ds_read_b128 v[98:101], v5 offset:1472
    s_waitcnt lgkmcnt(3)
    v_mfma_f32_16x16x32_bf16 v[170:173], v[86:89], v[62:65], v[170:173]
    ds_read2_b32 v[46:47], v217 offset0:48 offset1:49
    ds_read2_b32 v[48:49], v217 offset0:50 offset1:51
    v_mfma_f32_16x16x32_bf16 v[174:177], v[86:89], v[66:69], v[174:177]
    ds_read2_b32 v[50:51], v216 offset0:48 offset1:49
    ds_read2_b32 v[52:53], v216 offset0:50 offset1:51
    v_mfma_f32_16x16x32_bf16 v[158:161], v[106:109], v[218:221], v[158:161]
    ds_read_b128 v[238:241], v5 offset:1456
    v_mfma_f32_16x16x32_bf16 v[158:161], v[110:113], v[222:225], v[158:161]
    v_mfma_f32_16x16x32_bf16 v[162:165], v[114:117], v[218:221], v[162:165]
    ds_read_b128 v[70:73], v5 offset:640
    v_mfma_f32_16x16x32_bf16 v[162:165], v[118:121], v[222:225], v[162:165]
    v_mfma_f32_16x16x32_bf16 v[166:169], v[122:125], v[218:221], v[166:169]
    ds_read_b128 v[74:77], v5 offset:1152
    v_mfma_f32_16x16x32_bf16 v[166:169], v[126:129], v[222:225], v[166:169]
    v_mfma_f32_16x16x32_bf16 v[166:169], v[130:133], v[226:229], v[166:169]
    v_mfma_f32_16x16x32_bf16 v[170:173], v[134:137], v[226:229], v[170:173]
    v_mfma_f32_16x16x32_bf16 v[174:177], v[138:141], v[226:229], v[174:177]
    s_waitcnt lgkmcnt(2)
    v_mfma_f32_16x16x32_bf16 v[174:177], v[90:93], v[62:65], v[174:177]
    v_mfma_f32_16x16x32_bf16 v[146:149], v[94:97], v[46:49], v[146:149]
    ds_read_b128 v[78:81], v5 offset:1664
    v_mfma_f32_16x16x32_bf16 v[150:153], v[94:97], v[50:53], v[150:153]
    v_mfma_f32_16x16x32_bf16 v[178:181], v[98:101], v[10:13], 0
    v_mfma_f32_16x16x32_bf16 v[182:185], v[98:101], v[14:17], 0
    v_mfma_f32_16x16x32_bf16 v[186:189], v[98:101], v[18:21], 0
    v_mfma_f32_16x16x32_bf16 v[242:245], v[98:101], v[22:25], 0
    v_mfma_f32_16x16x32_bf16 v[154:157], v[98:101], v[34:37], v[154:157]
    ds_read_b128 v[82:85], v5 offset:2176
    v_mfma_f32_16x16x32_bf16 v[158:161], v[98:101], v[38:41], v[158:161]
    v_mfma_f32_16x16x32_bf16 v[162:165], v[98:101], v[42:45], v[162:165]
    v_mfma_f32_16x16x32_bf16 v[170:173], v[98:101], v[102:105], v[170:173]
    v_mfma_f32_16x16x32_bf16 v[190:193], v[238:241], v[14:17], 0
    v_mfma_f32_16x16x32_bf16 v[246:249], v[238:241], v[26:29], 0
    s_waitcnt lgkmcnt(1)
    v_mfma_f32_16x16x32_bf16 v[150:153], v[70:73], v[46:49], v[150:153]
    ds_read_b128 v[194:197], v5 offset:2688
    v_mfma_f32_16x16x32_bf16 v[154:157], v[70:73], v[50:53], v[154:157]
    v_mfma_f32_16x16x32_bf16 v[154:157], v[74:77], v[46:49], v[154:157]
    v_cvt_pk_bf16_f32 v218, v178, v182
    v_cvt_pk_bf16_f32 v219, v179, v183
    v_mfma_f32_16x16x32_bf16 v[158:161], v[74:77], v[50:53], v[158:161]
    v_cvt_pk_bf16_f32 v220, v180, v184
    v_cvt_pk_bf16_f32 v221, v181, v185
    v_mfma_f32_16x16x32_bf16 v[158:161], v[78:81], v[46:49], v[158:161]
    v_cvt_pk_bf16_f32 v222, v186, v190
    v_cvt_pk_bf16_f32 v223, v187, v191
    v_mfma_f32_16x16x32_bf16 v[162:165], v[78:81], v[50:53], v[162:165]
    v_cvt_pk_bf16_f32 v224, v188, v192
    v_cvt_pk_bf16_f32 v225, v189, v193
    s_waitcnt lgkmcnt(1)
    v_mfma_f32_16x16x32_bf16 v[162:165], v[82:85], v[46:49], v[162:165]
    v_cvt_pk_bf16_f32 v226, v242, v246
    v_cvt_pk_bf16_f32 v227, v243, v247
    v_mfma_f32_16x16x32_bf16 v[166:169], v[82:85], v[50:53], v[166:169]
    v_cvt_pk_bf16_f32 v228, v244, v248
    v_cvt_pk_bf16_f32 v229, v245, v249
    ds_read_b128 v[198:201], v5 offset:3200
    s_waitcnt lgkmcnt(1)
    v_mfma_f32_16x16x32_bf16 v[166:169], v[194:197], v[46:49], v[166:169]
    ds_read_b128 v[202:205], v5 offset:3712
    v_mfma_f32_16x16x32_bf16 v[170:173], v[194:197], v[50:53], v[170:173]
    ds_read_b128 v[206:209], v5 offset:192
    ds_read_b128 v[86:89], v5 offset:1984
    s_waitcnt lgkmcnt(3)
    v_mfma_f32_16x16x32_bf16 v[170:173], v[198:201], v[46:49], v[170:173]
    ds_read2_b32 v[54:55], v217 offset0:64 offset1:65
    ds_read2_b32 v[56:57], v217 offset0:66 offset1:67
    v_mfma_f32_16x16x32_bf16 v[174:177], v[198:201], v[50:53], v[174:177]
    ds_read2_b32 v[58:59], v216 offset0:64 offset1:65
    ds_read2_b32 v[60:61], v216 offset0:66 offset1:67
    v_mfma_f32_16x16x32_bf16 v[162:165], v[106:109], v[218:221], v[162:165]
    ds_read_b128 v[238:241], v5 offset:1968
    v_mfma_f32_16x16x32_bf16 v[162:165], v[110:113], v[222:225], v[162:165]
    ds_read_b128 v[90:93], v5 offset:704
    v_mfma_f32_16x16x32_bf16 v[166:169], v[114:117], v[218:221], v[166:169]
    v_mfma_f32_16x16x32_bf16 v[166:169], v[118:121], v[222:225], v[166:169]
    ds_read_b128 v[94:97], v5 offset:1216
    v_mfma_f32_16x16x32_bf16 v[170:173], v[122:125], v[218:221], v[170:173]
    v_mfma_f32_16x16x32_bf16 v[170:173], v[126:129], v[222:225], v[170:173]
    v_mfma_f32_16x16x32_bf16 v[170:173], v[130:133], v[226:229], v[170:173]
    v_mfma_f32_16x16x32_bf16 v[174:177], v[134:137], v[226:229], v[174:177]
    v_mul_u32_u24 v6, 16896, v8
    s_waitcnt lgkmcnt(3)
    v_mfma_f32_16x16x32_bf16 v[174:177], v[202:205], v[46:49], v[174:177]
    v_mfma_f32_16x16x32_bf16 v[146:149], v[206:209], v[54:57], v[146:149]
    ds_read_b128 v[98:101], v5 offset:1728
    v_mfma_f32_16x16x32_bf16 v[150:153], v[206:209], v[58:61], v[150:153]
    v_lshl_add_u32 v6, v7, 6, v6
    v_mfma_f32_16x16x32_bf16 v[178:181], v[86:89], v[10:13], 0
    v_bfe_u32 v7, v1, 1, 2
    v_mfma_f32_16x16x32_bf16 v[182:185], v[86:89], v[14:17], 0
    v_xor_b32 v7, s56, v7
    v_mfma_f32_16x16x32_bf16 v[186:189], v[86:89], v[18:21], 0
    v_lshl_add_u32 v6, v7, 4, v6
    v_mfma_f32_16x16x32_bf16 v[242:245], v[86:89], v[22:25], 0
    v_add_u32 v6, 68352, v6
    v_mfma_f32_16x16x32_bf16 v[158:161], v[86:89], v[34:37], v[158:161]
    ds_read_b128 v[70:73], v5 offset:2240
    v_mfma_f32_16x16x32_bf16 v[162:165], v[86:89], v[38:41], v[162:165]
    v_bfe_u32 v4, v0, 3, 2
    v_mfma_f32_16x16x32_bf16 v[166:169], v[86:89], v[42:45], v[166:169]
    v_lshlrev_b32 v4, 4, v4
    v_mfma_f32_16x16x32_bf16 v[174:177], v[86:89], v[102:105], v[174:177]
    v_lshlrev_b32 v7, 4, v0
    s_waitcnt lgkmcnt(1)
    v_mfma_f32_16x16x32_bf16 v[190:193], v[238:241], v[14:17], 0
    v_mfma_f32_16x16x32_bf16 v[246:249], v[238:241], v[26:29], 0
    v_xor_b32 v4, v7, v4
    v_mfma_f32_16x16x32_bf16 v[150:153], v[90:93], v[54:57], v[150:153]
    ds_read_b128 v[74:77], v5 offset:2752
    v_mfma_f32_16x16x32_bf16 v[154:157], v[90:93], v[58:61], v[154:157]
    v_add_u32 v4, 76544, v4
    v_mfma_f32_16x16x32_bf16 v[154:157], v[94:97], v[54:57], v[154:157]
    v_cvt_pk_bf16_f32 v218, v178, v182
    v_cvt_pk_bf16_f32 v219, v179, v183
    v_mfma_f32_16x16x32_bf16 v[158:161], v[94:97], v[58:61], v[158:161]
    v_cvt_pk_bf16_f32 v220, v180, v184
    v_cvt_pk_bf16_f32 v221, v181, v185
    v_mfma_f32_16x16x32_bf16 v[158:161], v[98:101], v[54:57], v[158:161]
    v_cvt_pk_bf16_f32 v222, v186, v190
    v_cvt_pk_bf16_f32 v223, v187, v191
    v_mfma_f32_16x16x32_bf16 v[162:165], v[98:101], v[58:61], v[162:165]
    v_cvt_pk_bf16_f32 v224, v188, v192
    v_cvt_pk_bf16_f32 v225, v189, v193
    s_waitcnt lgkmcnt(1)
    v_mfma_f32_16x16x32_bf16 v[162:165], v[70:73], v[54:57], v[162:165]
    v_cvt_pk_bf16_f32 v226, v242, v246
    v_cvt_pk_bf16_f32 v227, v243, v247
    v_mfma_f32_16x16x32_bf16 v[166:169], v[70:73], v[58:61], v[166:169]
    v_cvt_pk_bf16_f32 v228, v244, v248
    v_cvt_pk_bf16_f32 v229, v245, v249
    ds_read_b128 v[78:81], v5 offset:3264
    s_waitcnt lgkmcnt(1)
    v_mfma_f32_16x16x32_bf16 v[166:169], v[74:77], v[54:57], v[166:169]
    ds_read_b128 v[82:85], v5 offset:3776
    v_mfma_f32_16x16x32_bf16 v[170:173], v[74:77], v[58:61], v[170:173]
    ds_read_b128 v[194:197], v5 offset:256
    ds_read_b128 v[198:201], v5 offset:2496
    s_waitcnt lgkmcnt(3)
    v_mfma_f32_16x16x32_bf16 v[170:173], v[78:81], v[54:57], v[170:173]
    ds_read2_b32 v[62:63], v217 offset0:80 offset1:81
    ds_read2_b32 v[64:65], v217 offset0:82 offset1:83
    v_mfma_f32_16x16x32_bf16 v[174:177], v[78:81], v[58:61], v[174:177]
    ds_read_b128 v[238:241], v5 offset:2480
    ds_read2_b32 v[66:67], v216 offset0:80 offset1:81
    ds_read2_b32 v[68:69], v216 offset0:82 offset1:83
    v_mfma_f32_16x16x32_bf16 v[166:169], v[106:109], v[218:221], v[166:169]
    ds_read_b128 v[202:205], v5 offset:768
    ds_read_b128 v[206:209], v5 offset:1280
    v_mfma_f32_16x16x32_bf16 v[166:169], v[110:113], v[222:225], v[166:169]
    v_lshrrev_b32 v3, 2, v0
    v_mfma_f32_16x16x32_bf16 v[170:173], v[114:117], v[218:221], v[170:173]
    v_lshlrev_b32 v3, 14, v3
    v_mfma_f32_16x16x32_bf16 v[170:173], v[118:121], v[222:225], v[170:173]
    v_and_b32 v7, 3, v0
    v_mfma_f32_16x16x32_bf16 v[174:177], v[122:125], v[218:221], v[174:177]
    v_lshl_add_u32 v3, v7, 4, v3
    v_mfma_f32_16x16x32_bf16 v[174:177], v[126:129], v[222:225], v[174:177]
    ds_read_b128 v[86:89], v5 offset:1792
    v_mfma_f32_16x16x32_bf16 v[174:177], v[130:133], v[226:229], v[174:177]
    s_and_b32 s66, s2, 3
    s_waitcnt lgkmcnt(6)
    v_mfma_f32_16x16x32_bf16 v[174:177], v[82:85], v[54:57], v[174:177]
    v_mfma_f32_16x16x32_bf16 v[146:149], v[194:197], v[62:65], v[146:149]
    s_lshl_b32 s66, s66, 12
    s_waitcnt lgkmcnt(1)
    v_mfma_f32_16x16x32_bf16 v[150:153], v[194:197], v[66:69], v[150:153]
    v_mfma_f32_16x16x32_bf16 v[178:181], v[198:201], v[10:13], 0
    s_lshr_b32 s67, s2, 2
    v_mfma_f32_16x16x32_bf16 v[182:185], v[198:201], v[14:17], 0
    ds_read_b128 v[90:93], v5 offset:2304
    v_mfma_f32_16x16x32_bf16 v[186:189], v[198:201], v[18:21], 0
    s_lshl_b32 s67, s67, 6
    v_mfma_f32_16x16x32_bf16 v[162:165], v[198:201], v[34:37], v[162:165]
    ds_read_b128 v[94:97], v5 offset:2816
    v_mfma_f32_16x16x32_bf16 v[166:169], v[198:201], v[38:41], v[166:169]
    s_add_u32 s66, s66, s67
    v_mfma_f32_16x16x32_bf16 v[170:173], v[198:201], v[42:45], v[170:173]
    ds_read_b128 v[98:101], v5 offset:3328
    v_mfma_f32_16x16x32_bf16 v[190:193], v[238:241], v[14:17], 0
    ds_read2_b32 v[46:47], v217 offset0:96 offset1:97
    ds_read2_b32 v[48:49], v217 offset0:98 offset1:99
    v_mfma_f32_16x16x32_bf16 v[150:153], v[202:205], v[62:65], v[150:153]
    ds_read2_b32 v[50:51], v216 offset0:96 offset1:97
    ds_read2_b32 v[52:53], v216 offset0:98 offset1:99
    v_mfma_f32_16x16x32_bf16 v[154:157], v[202:205], v[66:69], v[154:157]
    s_add_u32 s66, s66, 13631488
    v_mfma_f32_16x16x32_bf16 v[154:157], v[206:209], v[62:65], v[154:157]
    v_cvt_pk_bf16_f32 v218, v178, v182
    v_cvt_pk_bf16_f32 v219, v179, v183
    v_mfma_f32_16x16x32_bf16 v[158:161], v[206:209], v[66:69], v[158:161]
    v_cvt_pk_bf16_f32 v220, v180, v184
    v_cvt_pk_bf16_f32 v221, v181, v185
    s_waitcnt lgkmcnt(6)
    v_mfma_f32_16x16x32_bf16 v[158:161], v[86:89], v[62:65], v[158:161]
    v_cvt_pk_bf16_f32 v222, v186, v190
    v_cvt_pk_bf16_f32 v223, v187, v191
    v_mfma_f32_16x16x32_bf16 v[162:165], v[86:89], v[66:69], v[162:165]
    v_cvt_pk_bf16_f32 v224, v188, v192
    v_cvt_pk_bf16_f32 v225, v189, v193
    v_mfma_f32_16x16x32_bf16 v[162:165], v[90:93], v[62:65], v[162:165]
    ds_read_b128 v[70:73], v5 offset:3840
    ds_read_b128 v[74:77], v5 offset:320
    v_mfma_f32_16x16x32_bf16 v[166:169], v[90:93], v[66:69], v[166:169]
    ds_read_b128 v[78:81], v5 offset:3008
    ds_read_b128 v[238:241], v5 offset:2992
    s_waitcnt lgkmcnt(6)
    v_mfma_f32_16x16x32_bf16 v[166:169], v[94:97], v[62:65], v[166:169]
    ds_read_b128 v[82:85], v5 offset:832
    v_mfma_f32_16x16x32_bf16 v[170:173], v[94:97], v[66:69], v[170:173]
    ds_read_b128 v[194:197], v5 offset:1344
    v_mfma_f32_16x16x32_bf16 v[170:173], v[98:101], v[62:65], v[170:173]
    s_add_u32 s67, s66, 1048576
    v_mfma_f32_16x16x32_bf16 v[174:177], v[98:101], v[66:69], v[174:177]
    s_add_u32 s68, s66, 2097152
    v_mfma_f32_16x16x32_bf16 v[170:173], v[106:109], v[218:221], v[170:173]
    s_add_u32 s69, s66, 3145728
    v_mfma_f32_16x16x32_bf16 v[170:173], v[110:113], v[222:225], v[170:173]
    v_mfma_f32_16x16x32_bf16 v[174:177], v[114:117], v[218:221], v[174:177]
    ds_read_b128 v[198:201], v5 offset:1856
    v_mfma_f32_16x16x32_bf16 v[174:177], v[118:121], v[222:225], v[174:177]
    s_waitcnt lgkmcnt(3)
    v_mfma_f32_16x16x32_bf16 v[174:177], v[70:73], v[62:65], v[174:177]
    v_mfma_f32_16x16x32_bf16 v[146:149], v[74:77], v[46:49], v[146:149]
    v_mfma_f32_16x16x32_bf16 v[150:153], v[74:77], v[50:53], v[150:153]
    v_mfma_f32_16x16x32_bf16 v[178:181], v[78:81], v[10:13], 0
    v_mfma_f32_16x16x32_bf16 v[182:185], v[78:81], v[14:17], 0
    ds_read_b128 v[202:205], v5 offset:2368
    v_mfma_f32_16x16x32_bf16 v[186:189], v[78:81], v[18:21], 0
    v_mfma_f32_16x16x32_bf16 v[166:169], v[78:81], v[34:37], v[166:169]
    ds_read_b128 v[206:209], v5 offset:2880
    v_mfma_f32_16x16x32_bf16 v[170:173], v[78:81], v[38:41], v[170:173]
    ds_read2_b32 v[54:55], v217 offset0:112 offset1:113
    ds_read2_b32 v[56:57], v217 offset0:114 offset1:115
    v_mfma_f32_16x16x32_bf16 v[174:177], v[78:81], v[42:45], v[174:177]
    ds_read_b128 v[86:89], v5 offset:3392
    ds_read2_b32 v[58:59], v216 offset0:112 offset1:113
    ds_read2_b32 v[60:61], v216 offset0:114 offset1:115
    v_mfma_f32_16x16x32_bf16 v[190:193], v[238:241], v[14:17], 0
    s_waitcnt lgkmcnt(7)
    v_mfma_f32_16x16x32_bf16 v[150:153], v[82:85], v[46:49], v[150:153]
    v_mfma_f32_16x16x32_bf16 v[154:157], v[82:85], v[50:53], v[154:157]
    v_mfma_f32_16x16x32_bf16 v[154:157], v[194:197], v[46:49], v[154:157]
    v_cvt_pk_bf16_f32 v218, v178, v182
    v_cvt_pk_bf16_f32 v219, v179, v183
    v_mfma_f32_16x16x32_bf16 v[158:161], v[194:197], v[50:53], v[158:161]
    v_cvt_pk_bf16_f32 v220, v180, v184
    v_cvt_pk_bf16_f32 v221, v181, v185
    v_mfma_f32_16x16x32_bf16 v[158:161], v[198:201], v[46:49], v[158:161]
    v_cvt_pk_bf16_f32 v222, v186, v190
    v_cvt_pk_bf16_f32 v223, v187, v191
    v_mfma_f32_16x16x32_bf16 v[162:165], v[198:201], v[50:53], v[162:165]
    v_cvt_pk_bf16_f32 v224, v188, v192
    v_cvt_pk_bf16_f32 v225, v189, v193
    s_waitcnt lgkmcnt(3)
    v_mfma_f32_16x16x32_bf16 v[162:165], v[202:205], v[46:49], v[162:165]
    ds_read_b128 v[90:93], v5 offset:3904
    v_mfma_f32_16x16x32_bf16 v[166:169], v[202:205], v[50:53], v[166:169]
    ds_read_b128 v[94:97], v5 offset:384
    ds_read_b128 v[98:101], v5 offset:3520
    v_mfma_f32_16x16x32_bf16 v[166:169], v[206:209], v[46:49], v[166:169]
    ds_read_b128 v[70:73], v5 offset:896
    ds_read_b128 v[74:77], v5 offset:1408
    v_mfma_f32_16x16x32_bf16 v[170:173], v[206:209], v[50:53], v[170:173]
    ds_read_b128 v[78:81], v5 offset:1920
    ds_read_b128 v[82:85], v5 offset:2432
    s_waitcnt lgkmcnt(7)
    v_mfma_f32_16x16x32_bf16 v[170:173], v[86:89], v[46:49], v[170:173]
    ds_read_b128 v[194:197], v5 offset:2944
    v_mfma_f32_16x16x32_bf16 v[174:177], v[86:89], v[50:53], v[174:177]
    ds_read_b128 v[198:201], v5 offset:3456
    ds_read_b128 v[202:205], v5 offset:3968
    v_mfma_f32_16x16x32_bf16 v[174:177], v[106:109], v[218:221], v[174:177]
    ds_read_b128 v[206:209], v5 offset:4032
    v_mfma_f32_16x16x32_bf16 v[174:177], v[110:113], v[222:225], v[174:177]
    s_waitcnt lgkmcnt(10)
    v_mfma_f32_16x16x32_bf16 v[174:177], v[90:93], v[46:49], v[174:177]
    s_waitcnt lgkmcnt(9)
    v_mfma_f32_16x16x32_bf16 v[146:149], v[94:97], v[54:57], v[146:149]
    v_mfma_f32_16x16x32_bf16 v[150:153], v[94:97], v[58:61], v[150:153]
    s_waitcnt lgkmcnt(6)
    v_mfma_f32_16x16x32_bf16 v[170:173], v[98:101], v[34:37], v[170:173]
    v_mfma_f32_16x16x32_bf16 v[174:177], v[98:101], v[38:41], v[174:177]
    v_mfma_f32_16x16x32_bf16 v[150:153], v[70:73], v[54:57], v[150:153]
    v_mfma_f32_16x16x32_bf16 v[154:157], v[70:73], v[58:61], v[154:157]
    v_mfma_f32_16x16x32_bf16 v[154:157], v[74:77], v[54:57], v[154:157]
    v_mfma_f32_16x16x32_bf16 v[158:161], v[74:77], v[58:61], v[158:161]
    s_waitcnt lgkmcnt(0)
    v_mfma_f32_16x16x32_bf16 v[158:161], v[78:81], v[54:57], v[158:161]
    v_mfma_f32_16x16x32_bf16 v[162:165], v[78:81], v[58:61], v[162:165]
    v_mfma_f32_16x16x32_bf16 v[162:165], v[82:85], v[54:57], v[162:165]
    v_mfma_f32_16x16x32_bf16 v[166:169], v[82:85], v[58:61], v[166:169]
    v_mfma_f32_16x16x32_bf16 v[166:169], v[194:197], v[54:57], v[166:169]
    v_mfma_f32_16x16x32_bf16 v[170:173], v[194:197], v[58:61], v[170:173]
    v_mfma_f32_16x16x32_bf16 v[170:173], v[198:201], v[54:57], v[170:173]
    v_mfma_f32_16x16x32_bf16 v[174:177], v[198:201], v[58:61], v[174:177]
    v_mfma_f32_16x16x32_bf16 v[174:177], v[202:205], v[54:57], v[174:177]
    v_mfma_f32_16x16x32_bf16 v[174:177], v[206:209], v[34:37], v[174:177]
    v_cvt_pk_bf16_f32 v34, v146, v150
    v_and_or_b32 v34, v34, s58, v9
    v_cvt_pk_bf16_f32 v35, v154, v158
    v_and_or_b32 v35, v35, s58, v9
    v_cvt_pk_bf16_f32 v36, v162, v166
    v_and_or_b32 v36, v36, s58, v9
    s_nop 1
    v_cvt_pk_bf16_f32 v37, v170, v174
    v_and_or_b32 v37, v37, s58, v9
    ds_write_b128 v6, v[34:37] offset:8192
    v_cvt_pk_bf16_f32 v38, v147, v151
    v_and_or_b32 v38, v38, s58, v9
    v_cvt_pk_bf16_f32 v39, v155, v159
    v_and_or_b32 v39, v39, s58, v9
    v_cvt_pk_bf16_f32 v40, v163, v167
    v_and_or_b32 v40, v40, s58, v9
    v_cvt_pk_bf16_f32 v41, v171, v175
    v_and_or_b32 v41, v41, s58, v9
    ds_write_b128 v6, v[38:41] offset:9216
    v_cvt_pk_bf16_f32 v42, v148, v152
    v_and_or_b32 v42, v42, s58, v9
    v_cvt_pk_bf16_f32 v43, v156, v160
    v_and_or_b32 v43, v43, s58, v9
    v_cvt_pk_bf16_f32 v44, v164, v168
    v_and_or_b32 v44, v44, s58, v9
    v_cvt_pk_bf16_f32 v45, v172, v176
    v_and_or_b32 v45, v45, s58, v9
    ds_write_b128 v6, v[42:45] offset:10240
    v_cvt_pk_bf16_f32 v46, v149, v153
    v_and_or_b32 v46, v46, s58, v9
    v_cvt_pk_bf16_f32 v47, v157, v161
    v_and_or_b32 v47, v47, s58, v9
    v_cvt_pk_bf16_f32 v48, v165, v169
    v_and_or_b32 v48, v48, s58, v9
    v_cvt_pk_bf16_f32 v49, v173, v177
    v_and_or_b32 v49, v49, s58, v9
    ds_write_b128 v6, v[46:49] offset:11264
    s_waitcnt lgkmcnt(0)
    s_barrier
    ds_read_b128 v[50:53], v4 offset:0
    ds_read_b128 v[54:57], v4 offset:16896
    ds_read_b128 v[58:61], v4 offset:33792
    ds_read_b128 v[62:65], v4 offset:50688
    s_waitcnt lgkmcnt(3)
    buffer_store_dwordx4 v[50:53], v3, s[40:43], s66 offen sc1
    s_waitcnt lgkmcnt(2)
    buffer_store_dwordx4 v[54:57], v3, s[40:43], s67 offen sc1
    s_waitcnt lgkmcnt(1)
    buffer_store_dwordx4 v[58:61], v3, s[40:43], s68 offen sc1
    s_waitcnt lgkmcnt(0)
    buffer_store_dwordx4 v[62:65], v3, s[40:43], s69 offen sc1
Lend:
    s_endpgm
.p2align 8
.type Ltab,@object
Ltab:
.long 0x80003f80,0x80003f80,0x80003f80,0x80003f80,0x80003f80,0xbf353f35,0xbf800000,0xbf35bf35,0x80003f80,0xbf800000,0x8000bf80,0x3f800000,0x80003f80,0xbf35bf35,0x3f800000,0xbf353f35
.long 0x80003f80,0x8000bf80,0x80003f80,0x8000bf80,0x80003f80,0x3f35bf35,0xbf800000,0x3f353f35,0x80003f80,0x3f800000,0x8000bf80,0xbf800000,0x80003f80,0x3f353f35,0x3f800000,0x3f35bf35
.long 0x80003f80,0xbe483f7b,0xbec43f6d,0xbf0e3f55,0x80003f80,0xbf553f0e,0xbf6dbec4,0xbe48bf7b,0x80003f80,0xbf7bbe48,0x3ec4bf6d,0x3f553f0e,0x80003f80,0xbf0ebf55,0x3f6d3ec4,0xbf7b3e48
.long 0x80003f80,0x3e48bf7b,0xbec43f6d,0x3f0ebf55,0x80003f80,0x3f55bf0e,0xbf6dbec4,0x3e483f7b,0x80003f80,0x3f7b3e48,0x3ec4bf6d,0xbf55bf0e,0x80003f80,0x3f0e3f55,0x3f6d3ec4,0x3f7bbe48
.long 0x80003f80,0xbec43f6d,0xbf353f35,0xbf6d3ec4,0x80003f80,0xbf6d3ec4,0xbf35bf35,0x3ec4bf6d,0x80003f80,0xbf6dbec4,0x3f35bf35,0x3ec43f6d,0x80003f80,0xbec4bf6d,0x3f353f35,0xbf6dbec4
.long 0x80003f80,0x3ec4bf6d,0xbf353f35,0x3f6dbec4,0x80003f80,0x3f6dbec4,0xbf35bf35,0xbec43f6d,0x80003f80,0x3f6d3ec4,0x3f35bf35,0xbec4bf6d,0x80003f80,0x3ec43f6d,0x3f353f35,0x3f6d3ec4
.long 0x80003f80,0xbf0e3f55,0xbf6d3ec4,0xbf7bbe48,0x80003f80,0xbf7b3e48,0xbec4bf6d,0x3f55bf0e,0x80003f80,0xbf55bf0e,0x3f6dbec4,0xbe483f7b,0x80003f80,0xbe48bf7b,0x3ec43f6d,0xbf0ebf55
.long 0x80003f80,0x3f0ebf55,0xbf6d3ec4,0x3f7b3e48,0x80003f80,0x3f7bbe48,0xbec4bf6d,0xbf553f0e,0x80003f80,0x3f553f0e,0x3f6dbec4,0x3e48bf7b,0x80003f80,0x3e483f7b,0x3ec43f6d,0x3f0e3f55
.long 0x80003f80,0x80003f80,0x80003f80,0x80003f80,0x8000bf80,0x3f35bf35,0x3f800000,0x3f353f35,0x80003f80,0xbf800000,0x8000bf80,0x3f800000,0x8000bf80,0x3f353f35,0xbf800000,0x3f35bf35
.long 0x80003f80,0x8000bf80,0x80003f80,0x8000bf80,0x8000bf80,0xbf353f35,0x3f800000,0xbf35bf35,0x80003f80,0x3f800000,0x8000bf80,0xbf800000,0x8000bf80,0xbf35bf35,0xbf800000,0xbf353f35
.long 0xbf353f35,0xbf553f0e,0xbf6d3ec4,0xbf7b3e48,0x3f35bf35,0x3f7b3e48,0x3ec43f6d,0xbf0e3f55,0xbf353f35,0xbf0ebf55,0x3f6dbec4,0x3e483f7b,0x3f35bf35,0xbe483f7b,0xbec4bf6d,0x3f553f0e
.long 0xbf353f35,0x3f55bf0e,0xbf6d3ec4,0x3f7bbe48,0x3f35bf35,0xbf7bbe48,0x3ec43f6d,0x3f0ebf55,0xbf353f35,0x3f0e3f55,0x3f6dbec4,0xbe48bf7b,0x3f35bf35,0x3e48bf7b,0xbec4bf6d,0xbf55bf0e
.long 0xbf800000,0xbf6dbec4,0xbf35bf35,0xbec4bf6d,0x3f800000,0x3ec43f6d,0xbf353f35,0xbf6dbec4,0xbf800000,0x3ec4bf6d,0x3f353f35,0xbf6d3ec4,0x3f800000,0xbf6d3ec4,0x3f35bf35,0xbec43f6d
.long 0xbf800000,0x3f6d3ec4,0xbf35bf35,0x3ec43f6d,0x3f800000,0xbec4bf6d,0xbf353f35,0x3f6d3ec4,0xbf800000,0xbec43f6d,0x3f353f35,0x3f6dbec4,0x3f800000,0x3f6dbec4,0x3f35bf35,0x3ec4bf6d
.long 0xbf35bf35,0xbe48bf7b,0x3ec4bf6d,0x3f55bf0e,0x3f353f35,0xbf0e3f55,0xbf6dbec4,0x3e48bf7b,0xbf35bf35,0x3f7bbe48,0xbec43f6d,0xbf0ebf55,0x3f353f35,0xbf55bf0e,0x3f6d3ec4,0xbf7bbe48
.long 0xbf35bf35,0x3e483f7b,0x3ec4bf6d,0xbf553f0e,0x3f353f35,0x3f0ebf55,0xbf6dbec4,0xbe483f7b,0xbf35bf35,0xbf7b3e48,0xbec43f6d,0x3f0e3f55,0x3f353f35,0x3f553f0e,0x3f6d3ec4,0x3f7b3e48
.long 0x3f800000,0x3f800000,0x3f800000,0x3f800000,0x3f800000,0x3f353f35,0x3f80,0xbf353f35,0x3f800000,0x3f80,0xbf800000,0xbf80,0x3f800000,0xbf353f35,0xbf80,0x3f353f35
.long 0x3f800000,0xbf800000,0x3f800000,0xbf800000,0x3f800000,0xbf35bf35,0x3f80,0x3f35bf35,0x3f800000,0xbf80,0xbf800000,0x3f80,0x3f800000,0x3f35bf35,0xbf80,0xbf35bf35
.long 0x3f800000,0x3f7b3e48,0x3f6d3ec4,0x3f553f0e,0x3f800000,0x3f0e3f55,0xbec43f6d,0xbf7b3e48,0x3f800000,0xbe483f7b,0xbf6dbec4,0x3f0ebf55,0x3f800000,0xbf553f0e,0x3ec4bf6d,0x3e483f7b
.long 0x3f800000,0xbf7bbe48,0x3f6d3ec4,0xbf55bf0e,0x3f800000,0xbf0ebf55,0xbec43f6d,0x3f7bbe48,0x3f800000,0x3e48bf7b,0xbf6dbec4,0xbf0e3f55,0x3f800000,0x3f55bf0e,0x3ec4bf6d,0xbe48bf7b
.long 0x3f800000,0x3f6d3ec4,0x3f353f35,0x3ec43f6d,0x3f800000,0x3ec43f6d,0xbf353f35,0xbf6dbec4,0x3f800000,0xbec43f6d,0xbf35bf35,0x3f6dbec4,0x3f800000,0xbf6d3ec4,0x3f35bf35,0xbec43f6d
.long 0x3f800000,0xbf6dbec4,0x3f353f35,0xbec4bf6d,0x3f800000,0xbec4bf6d,0xbf353f35,0x3f6d3ec4,0x3f800000,0x3ec4bf6d,0xbf35bf35,0xbf6d3ec4,0x3f800000,0x3f6dbec4,0x3f35bf35,0x3ec4bf6d
.long 0x3f800000,0x3f553f0e,0x3ec43f6d,0xbe483f7b,0x3f800000,0x3e483f7b,0xbf6d3ec4,0xbf0ebf55,0x3f800000,0xbf0e3f55,0xbec4bf6d,0x3f7b3e48,0x3f800000,0xbf7b3e48,0x3f6dbec4,0xbf553f0e
.long 0x3f800000,0xbf55bf0e,0x3ec43f6d,0x3e48bf7b,0x3f800000,0xbe48bf7b,0xbf6d3ec4,0x3f0e3f55,0x3f800000,0x3f0ebf55,0xbec4bf6d,0xbf7bbe48,0x3f800000,0x3f7bbe48,0x3f6dbec4,0x3f55bf0e
.long 0x3f800000,0x3f800000,0x3f800000,0x3f800000,0xbf800000,0xbf35bf35,0xbf80,0x3f35bf35,0x3f800000,0x3f80,0xbf800000,0xbf80,0xbf800000,0x3f35bf35,0x3f80,0xbf35bf35
.long 0x3f800000,0xbf800000,0x3f800000,0xbf800000,0xbf800000,0x3f353f35,0xbf80,0xbf353f35,0x3f800000,0xbf80,0xbf800000,0x3f80,0xbf800000,0xbf353f35,0x3f80,0x3f353f35
.long 0x3f353f35,0x3f0e3f55,0x3ec43f6d,0x3e483f7b,0xbf35bf35,0x3e48bf7b,0x3f6dbec4,0x3f553f0e,0x3f353f35,0xbf553f0e,0xbec4bf6d,0x3f7bbe48,0xbf35bf35,0x3f7b3e48,0xbf6d3ec4,0x3f0ebf55
.long 0x3f353f35,0xbf0ebf55,0x3ec43f6d,0xbe48bf7b,0xbf35bf35,0xbe483f7b,0x3f6dbec4,0xbf55bf0e,0x3f353f35,0x3f55bf0e,0xbec4bf6d,0xbf7b3e48,0xbf35bf35,0xbf7bbe48,0xbf6d3ec4,0xbf0e3f55
.long 0x3f80,0xbec43f6d,0xbf353f35,0xbf6d3ec4,0xbf80,0x3f6dbec4,0x3f353f35,0xbec43f6d,0x3f80,0xbf6dbec4,0x3f35bf35,0x3ec43f6d,0xbf80,0x3ec43f6d,0xbf35bf35,0x3f6d3ec4
.long 0x3f80,0x3ec4bf6d,0xbf353f35,0x3f6dbec4,0xbf80,0xbf6d3ec4,0x3f353f35,0x3ec4bf6d,0x3f80,0x3f6d3ec4,0x3f35bf35,0xbec4bf6d,0xbf80,0xbec4bf6d,0xbf35bf35,0xbf6dbec4
.long 0xbf353f35,0xbf7b3e48,0xbf6dbec4,0xbf0ebf55,0x3f35bf35,0x3f553f0e,0xbec43f6d,0xbf7bbe48,0xbf353f35,0xbe48bf7b,0x3f6d3ec4,0xbf553f0e,0x3f35bf35,0xbf0e3f55,0x3ec4bf6d,0xbe483f7b
.long 0xbf353f35,0x3f7bbe48,0xbf6dbec4,0x3f0e3f55,0x3f35bf35,0xbf55bf0e,0xbec43f6d,0x3f7b3e48,0xbf353f35,0x3e483f7b,0x3f6d3ec4,0x3f55bf0e,0x3f35bf35,0x3f0ebf55,0x3ec4bf6d,0x3e48bf7b
.long 0x80003f80,0x80003f80,0x80003f80,0x80003f80,0x80003f80,0xbf353f35,0xbf800000,0xbf35bf35,0x80003f80,0xbf800000,0x8000bf80,0x3f800000,0x80003f80,0xbf35bf35,0x3f800000,0xbf353f35
.long 0x80003f80,0x8000bf80,0x80003f80,0x8000bf80,0x80003f80,0x3f35bf35,0xbf800000,0x3f353f35,0x80003f80,0x3f800000,0x8000bf80,0xbf800000,0x80003f80,0x3f353f35,0x3f800000,0x3f35bf35
.long 0xbf800000,0xbf7bbe48,0xbf6dbec4,0xbf55bf0e,0xbf800000,0xbf0ebf55,0x3ec4bf6d,0x3f7bbe48,0xbf800000,0x3e48bf7b,0x3f6d3ec4,0xbf0e3f55,0xbf800000,0x3f55bf0e,0xbec43f6d,0xbe48bf7b
.long 0xbf800000,0x3f7b3e48,0xbf6dbec4,0x3f553f0e,0xbf800000,0x3f0e3f55,0x3ec4bf6d,0xbf7b3e48,0xbf800000,0xbe483f7b,0x3f6d3ec4,0x3f0ebf55,0xbf800000,0xbf553f0e,0xbec43f6d,0x3e483f7b
.long 0x8000bf80,0x3ec4bf6d,0x3f35bf35,0x3f6dbec4,0x8000bf80,0x3f6dbec4,0x3f353f35,0xbec43f6d,0x8000bf80,0x3f6d3ec4,0xbf353f35,0xbec4bf6d,0x8000bf80,0x3ec43f6d,0xbf35bf35,0x3f6d3ec4
.long 0x8000bf80,0xbec43f6d,0x3f35bf35,0xbf6d3ec4,0x8000bf80,0xbf6d3ec4,0x3f353f35,0x3ec4bf6d,0x8000bf80,0xbf6dbec4,0xbf353f35,0x3ec43f6d,0x8000bf80,0xbec4bf6d,0xbf35bf35,0xbf6dbec4
.long 0x3f800000,0x3f553f0e,0x3ec43f6d,0xbe483f7b,0x3f800000,0x3e483f7b,0xbf6d3ec4,0xbf0ebf55,0x3f800000,0xbf0e3f55,0xbec4bf6d,0x3f7b3e48,0x3f800000,0xbf7b3e48,0x3f6dbec4,0xbf553f0e
.long 0x3f800000,0xbf55bf0e,0x3ec43f6d,0x3e48bf7b,0x3f800000,0xbe48bf7b,0xbf6d3ec4,0x3f0e3f55,0x3f800000,0x3f0ebf55,0xbec4bf6d,0xbf7bbe48,0x3f800000,0x3f7bbe48,0x3f6dbec4,0x3f55bf0e
.long 0x80003f80,0x80003f80,0x80003f80,0x80003f80,0x8000bf80,0x3f35bf35,0x3f800000,0x3f353f35,0x80003f80,0xbf800000,0x8000bf80,0x3f800000,0x8000bf80,0x3f353f35,0xbf800000,0x3f35bf35
.long 0x80003f80,0x8000bf80,0x80003f80,0x8000bf80,0x8000bf80,0xbf353f35,0x3f800000,0xbf35bf35,0x80003f80,0x3f800000,0x8000bf80,0xbf800000,0x8000bf80,0xbf35bf35,0xbf800000,0xbf353f35
.long 0xbf35bf35,0xbf0ebf55,0xbec4bf6d,0xbe48bf7b,0x3f353f35,0xbe483f7b,0xbf6d3ec4,0xbf55bf0e,0xbf35bf35,0x3f55bf0e,0x3ec43f6d,0xbf7b3e48,0x3f353f35,0xbf7bbe48,0x3f6dbec4,0xbf0e3f55
.long 0xbf35bf35,0x3f0e3f55,0xbec4bf6d,0x3e483f7b,0x3f353f35,0x3e48bf7b,0xbf6d3ec4,0x3f553f0e,0xbf35bf35,0xbf553f0e,0x3ec43f6d,0x3f7bbe48,0x3f353f35,0x3f7b3e48,0x3f6dbec4,0x3f0ebf55
.long 0x3f800000,0x3f6d3ec4,0x3f353f35,0x3ec43f6d,0xbf800000,0xbec4bf6d,0x3f35bf35,0x3f6d3ec4,0x3f800000,0xbec43f6d,0xbf35bf35,0x3f6dbec4,0xbf800000,0x3f6dbec4,0xbf353f35,0x3ec4bf6d
.long 0x3f800000,0xbf6dbec4,0x3f353f35,0xbec4bf6d,0xbf800000,0x3ec43f6d,0x3f35bf35,0xbf6dbec4,0x3f800000,0x3ec4bf6d,0xbf35bf35,0xbf6d3ec4,0xbf800000,0xbf6d3ec4,0xbf353f35,0xbec43f6d
.long 0xbf353f35,0xbf7b3e48,0xbf6dbec4,0xbf0ebf55,0x3f35bf35,0x3f553f0e,0xbec43f6d,0xbf7bbe48,0xbf353f35,0xbe48bf7b,0x3f6d3ec4,0xbf553f0e,0x3f35bf35,0xbf0e3f55,0x3ec4bf6d,0xbe483f7b
.long 0xbf353f35,0x3f7bbe48,0xbf6dbec4,0x3f0e3f55,0x3f35bf35,0xbf55bf0e,0xbec43f6d,0x3f7b3e48,0xbf353f35,0x3e483f7b,0x3f6d3ec4,0x3f55bf0e,0x3f35bf35,0x3f0ebf55,0x3ec4bf6d,0x3e48bf7b
.long 0x3f800000,0x3f800000,0x3f800000,0x3f800000,0x3f800000,0x3f353f35,0x3f80,0xbf353f35,0x3f800000,0x3f80,0xbf800000,0xbf80,0x3f800000,0xbf353f35,0xbf80,0x3f353f35
.long 0x3f800000,0xbf800000,0x3f800000,0xbf800000,0x3f800000,0xbf35bf35,0x3f80,0x3f35bf35,0x3f800000,0xbf80,0xbf800000,0x3f80,0x3f800000,0x3f35bf35,0xbf80,0xbf35bf35
.long 0x3f80,0xbe483f7b,0xbec43f6d,0xbf0e3f55,0x3f80,0xbf553f0e,0xbf6dbec4,0xbe48bf7b,0x3f80,0xbf7bbe48,0x3ec4bf6d,0x3f553f0e,0x3f80,0xbf0ebf55,0x3f6d3ec4,0xbf7b3e48
.long 0x3f80,0x3e48bf7b,0xbec43f6d,0x3f0ebf55,0x3f80,0x3f55bf0e,0xbf6dbec4,0x3e483f7b,0x3f80,0x3f7b3e48,0x3ec4bf6d,0xbf55bf0e,0x3f80,0x3f0e3f55,0x3f6d3ec4,0x3f7bbe48
.long 0xbf800000,0xbf6dbec4,0xbf35bf35,0xbec4bf6d,0xbf800000,0xbec4bf6d,0x3f35bf35,0x3f6d3ec4,0xbf800000,0x3ec4bf6d,0x3f353f35,0xbf6d3ec4,0xbf800000,0x3f6dbec4,0xbf353f35,0x3ec4bf6d
.long 0xbf800000,0x3f6d3ec4,0xbf35bf35,0x3ec43f6d,0xbf800000,0x3ec43f6d,0x3f35bf35,0xbf6dbec4,0xbf800000,0xbec43f6d,0x3f353f35,0x3f6dbec4,0xbf800000,0xbf6d3ec4,0xbf353f35,0xbec43f6d
.long 0xbf80,0x3f0ebf55,0x3f6dbec4,0x3f7b3e48,0xbf80,0x3f7bbe48,0x3ec43f6d,0xbf553f0e,0xbf80,0x3f553f0e,0xbf6d3ec4,0x3e48bf7b,0xbf80,0x3e483f7b,0xbec4bf6d,0x3f0e3f55
.long 0xbf80,0xbf0e3f55,0x3f6dbec4,0xbf7bbe48,0xbf80,0xbf7b3e48,0x3ec43f6d,0x3f55bf0e,0xbf80,0xbf55bf0e,0xbf6d3ec4,0xbe483f7b,0xbf80,0xbe48bf7b,0xbec4bf6d,0xbf0ebf55
.long 0x3f800000,0x3f800000,0x3f800000,0x3f800000,0xbf800000,0xbf35bf35,0xbf80,0x3f35bf35,0x3f800000,0x3f80,0xbf800000,0xbf80,0xbf800000,0x3f35bf35,0x3f80,0xbf35bf35
.long 0x3f800000,0xbf800000,0x3f800000,0xbf800000,0xbf800000,0x3f353f35,0xbf80,0xbf353f35,0x3f800000,0xbf80,0xbf800000,0x3f80,0xbf800000,0xbf353f35,0x3f80,0x3f353f35
.long 0xbf353f35,0xbf553f0e,0xbf6d3ec4,0xbf7b3e48,0x3f35bf35,0x3f7b3e48,0x3ec43f6d,0xbf0e3f55,0xbf353f35,0xbf0ebf55,0x3f6dbec4,0x3e483f7b,0x3f35bf35,0xbe483f7b,0xbec4bf6d,0x3f553f0e
.long 0xbf353f35,0x3f55bf0e,0xbf6d3ec4,0x3f7bbe48,0x3f35bf35,0xbf7bbe48,0x3ec43f6d,0x3f0ebf55,0xbf353f35,0x3f0e3f55,0x3f6dbec4,0xbe48bf7b,0x3f35bf35,0x3e48bf7b,0xbec4bf6d,0xbf55bf0e
.long 0xbf80,0x3ec4bf6d,0x3f35bf35,0x3f6dbec4,0x3f80,0xbf6d3ec4,0xbf35bf35,0x3ec4bf6d,0xbf80,0x3f6d3ec4,0xbf353f35,0xbec4bf6d,0x3f80,0xbec4bf6d,0x3f353f35,0xbf6dbec4
.long 0xbf80,0xbec43f6d,0x3f35bf35,0xbf6d3ec4,0x3f80,0x3f6dbec4,0xbf35bf35,0xbec43f6d,0xbf80,0xbf6dbec4,0xbf353f35,0x3ec43f6d,0x3f80,0x3ec43f6d,0x3f353f35,0x3f6d3ec4
.long 0x3f353f35,0x3e483f7b,0xbec43f6d,0xbf553f0e,0xbf35bf35,0x3f0ebf55,0x3f6d3ec4,0xbe483f7b,0x3f353f35,0xbf7b3e48,0x3ec4bf6d,0x3f0e3f55,0xbf35bf35,0x3f553f0e,0xbf6dbec4,0x3f7b3e48
.long 0x3f353f35,0xbe48bf7b,0xbec43f6d,0x3f55bf0e,0xbf35bf35,0xbf0e3f55,0x3f6d3ec4,0x3e48bf7b,0x3f353f35,0x3f7bbe48,0x3ec4bf6d,0xbf0ebf55,0xbf35bf35,0xbf55bf0e,0xbf6dbec4,0xbf7bbe48
.long 0x3f80,0x3f80,0x3f80,0x3f80,0x3f80,0x3f353f35,0x3f800000,0x3f35bf35,0x3f80,0x3f800000,0xbf80,0xbf800000,0x3f80,0x3f35bf35,0xbf800000,0x3f353f35
.long 0x3f80,0xbf80,0x3f80,0xbf80,0x3f80,0xbf35bf35,0x3f800000,0xbf353f35,0x3f80,0xbf800000,0xbf80,0x3f800000,0x3f80,0xbf353f35,0xbf800000,0xbf35bf35
.long 0xbf80,0xbe48bf7b,0xbec4bf6d,0xbf0ebf55,0xbf80,0xbf55bf0e,0xbf6d3ec4,0xbe483f7b,0xbf80,0xbf7b3e48,0x3ec43f6d,0x3f55bf0e,0xbf80,0xbf0e3f55,0x3f6dbec4,0xbf7bbe48
.long 0xbf80,0x3e483f7b,0xbec4bf6d,0x3f0e3f55,0xbf80,0x3f553f0e,0xbf6d3ec4,0x3e48bf7b,0xbf80,0x3f7bbe48,0x3ec43f6d,0xbf553f0e,0xbf80,0x3f0ebf55,0x3f6dbec4,0x3f7b3e48
.long 0x3f80,0x3ec43f6d,0x3f353f35,0x3f6d3ec4,0x3f80,0x3f6d3ec4,0x3f35bf35,0xbec4bf6d,0x3f80,0x3f6dbec4,0xbf35bf35,0xbec43f6d,0x3f80,0x3ec4bf6d,0xbf353f35,0x3f6dbec4
.long 0x3f80,0xbec4bf6d,0x3f353f35,0xbf6dbec4,0x3f80,0xbf6dbec4,0x3f35bf35,0x3ec43f6d,0x3f80,0xbf6d3ec4,0xbf35bf35,0x3ec4bf6d,0x3f80,0xbec43f6d,0xbf353f35,0xbf6d3ec4
.long 0xbf80,0xbf0ebf55,0xbf6dbec4,0xbf7b3e48,0xbf80,0xbf7bbe48,0xbec43f6d,0x3f553f0e,0xbf80,0xbf553f0e,0x3f6d3ec4,0xbe48bf7b,0xbf80,0xbe483f7b,0x3ec4bf6d,0xbf0e3f55
.long 0xbf80,0x3f0e3f55,0xbf6dbec4,0x3f7bbe48,0xbf80,0x3f7b3e48,0xbec43f6d,0xbf55bf0e,0xbf80,0x3f55bf0e,0x3f6d3ec4,0x3e483f7b,0xbf80,0x3e48bf7b,0x3ec4bf6d,0x3f0ebf55
.long 0x3f80,0x3f80,0x3f80,0x3f80,0xbf80,0xbf35bf35,0xbf800000,0xbf353f35,0x3f80,0x3f800000,0xbf80,0xbf800000,0xbf80,0xbf353f35,0x3f800000,0xbf35bf35
.long 0x3f80,0xbf80,0x3f80,0xbf80,0xbf80,0x3f353f35,0xbf800000,0x3f35bf35,0x3f80,0xbf800000,0xbf80,0x3f800000,0xbf80,0x3f35bf35,0x3f800000,0x3f353f35
.long 0xbf35bf35,0xbf55bf0e,0xbf6dbec4,0xbf7bbe48,0x3f353f35,0x3f7bbe48,0x3ec4bf6d,0xbf0ebf55,0xbf35bf35,0xbf0e3f55,0x3f6d3ec4,0x3e48bf7b,0x3f353f35,0xbe48bf7b,0xbec43f6d,0x3f55bf0e
.long 0xbf35bf35,0x3f553f0e,0xbf6dbec4,0x3f7b3e48,0x3f353f35,0xbf7b3e48,0x3ec4bf6d,0x3f0e3f55,0xbf35bf35,0x3f0ebf55,0x3f6d3ec4,0xbe483f7b,0x3f353f35,0x3e483f7b,0xbec43f6d,0xbf553f0e
.long 0x3f800000,0x3f6dbec4,0x3f35bf35,0x3ec4bf6d,0xbf800000,0xbec43f6d,0x3f353f35,0x3f6dbec4,0x3f800000,0xbec4bf6d,0xbf353f35,0x3f6d3ec4,0xbf800000,0x3f6d3ec4,0xbf35bf35,0x3ec43f6d
.long 0x3f800000,0xbf6d3ec4,0x3f35bf35,0xbec43f6d,0xbf800000,0x3ec4bf6d,0x3f353f35,0xbf6d3ec4,0x3f800000,0x3ec43f6d,0xbf353f35,0xbf6dbec4,0xbf800000,0xbf6dbec4,0xbf35bf35,0xbec4bf6d
.long 0xbf353f35,0xbe483f7b,0x3ec43f6d,0x3f553f0e,0x3f35bf35,0xbf0ebf55,0xbf6d3ec4,0x3e483f7b,0xbf353f35,0x3f7b3e48,0xbec4bf6d,0xbf0e3f55,0x3f35bf35,0xbf553f0e,0x3f6dbec4,0xbf7b3e48
.long 0xbf353f35,0x3e48bf7b,0x3ec43f6d,0xbf55bf0e,0x3f35bf35,0x3f0e3f55,0xbf6d3ec4,0xbe48bf7b,0xbf353f35,0xbf7bbe48,0xbec4bf6d,0x3f0ebf55,0x3f35bf35,0x3f55bf0e,0x3f6dbec4,0x3f7bbe48
.long 0xbf800000,0xbf800000,0xbf800000,0xbf800000,0xbf800000,0xbf353f35,0x80003f80,0x3f353f35,0xbf800000,0x80003f80,0x3f800000,0x8000bf80,0xbf800000,0x3f353f35,0x8000bf80,0xbf353f35
.long 0xbf800000,0x3f800000,0xbf800000,0x3f800000,0xbf800000,0x3f35bf35,0x80003f80,0xbf35bf35,0xbf800000,0x8000bf80,0x3f800000,0x80003f80,0xbf800000,0xbf35bf35,0x8000bf80,0x3f35bf35
.long 0x3f800000,0x3f7bbe48,0x3f6dbec4,0x3f55bf0e,0x3f800000,0x3f0ebf55,0xbec4bf6d,0xbf7bbe48,0x3f800000,0xbe48bf7b,0xbf6d3ec4,0x3f0e3f55,0x3f800000,0xbf55bf0e,0x3ec43f6d,0x3e48bf7b
.long 0x3f800000,0xbf7b3e48,0x3f6dbec4,0xbf553f0e,0x3f800000,0xbf0e3f55,0xbec4bf6d,0x3f7b3e48,0x3f800000,0x3e483f7b,0xbf6d3ec4,0xbf0ebf55,0x3f800000,0x3f553f0e,0x3ec43f6d,0xbe483f7b
.long 0xbf800000,0xbf6d3ec4,0xbf353f35,0xbec43f6d,0xbf800000,0xbec43f6d,0x3f353f35,0x3f6dbec4,0xbf800000,0x3ec43f6d,0x3f35bf35,0xbf6dbec4,0xbf800000,0x3f6d3ec4,0xbf35bf35,0x3ec43f6d
.long 0xbf800000,0x3f6dbec4,0xbf353f35,0x3ec4bf6d,0xbf800000,0x3ec4bf6d,0x3f353f35,0xbf6d3ec4,0xbf800000,0xbec4bf6d,0x3f35bf35,0x3f6d3ec4,0xbf800000,0xbf6dbec4,0xbf35bf35,0xbec4bf6d
.long 0x3f800000,0x3f55bf0e,0x3ec4bf6d,0xbe48bf7b,0x3f800000,0x3e48bf7b,0xbf6dbec4,0xbf0e3f55,0x3f800000,0xbf0ebf55,0xbec43f6d,0x3f7bbe48,0x3f800000,0xbf7bbe48,0x3f6d3ec4,0xbf55bf0e
.long 0x3f800000,0xbf553f0e,0x3ec4bf6d,0x3e483f7b,0x3f800000,0xbe483f7b,0xbf6dbec4,0x3f0ebf55,0x3f800000,0x3f0e3f55,0xbec43f6d,0xbf7b3e48,0x3f800000,0x3f7b3e48,0x3f6d3ec4,0x3f553f0e
.long 0xbf800000,0xbf800000,0xbf800000,0xbf800000,0x3f800000,0x3f35bf35,0x8000bf80,0xbf35bf35,0xbf800000,0x80003f80,0x3f800000,0x8000bf80,0x3f800000,0xbf35bf35,0x80003f80,0x3f35bf35
.long 0xbf800000,0x3f800000,0xbf800000,0x3f800000,0x3f800000,0xbf353f35,0x8000bf80,0x3f353f35,0xbf800000,0x8000bf80,0x3f800000,0x80003f80,0x3f800000,0x3f353f35,0x80003f80,0xbf353f35
.long 0x3f35bf35,0x3f0ebf55,0x3ec4bf6d,0x3e48bf7b,0xbf353f35,0x3e483f7b,0x3f6d3ec4,0x3f55bf0e,0x3f35bf35,0xbf55bf0e,0xbec43f6d,0x3f7b3e48,0xbf353f35,0x3f7bbe48,0xbf6dbec4,0x3f0e3f55
.long 0x3f35bf35,0xbf0e3f55,0x3ec4bf6d,0xbe483f7b,0xbf353f35,0xbe48bf7b,0x3f6d3ec4,0xbf553f0e,0x3f35bf35,0x3f553f0e,0xbec43f6d,0xbf7bbe48,0xbf353f35,0xbf7b3e48,0xbf6dbec4,0xbf0ebf55
.long 0x80003f80,0x3ec43f6d,0x3f353f35,0x3f6d3ec4,0x8000bf80,0xbf6dbec4,0xbf353f35,0x3ec43f6d,0x80003f80,0x3f6dbec4,0xbf35bf35,0xbec43f6d,0x8000bf80,0xbec43f6d,0x3f35bf35,0xbf6d3ec4
.long 0x80003f80,0xbec4bf6d,0x3f353f35,0xbf6dbec4,0x8000bf80,0x3f6d3ec4,0xbf353f35,0xbec4bf6d,0x80003f80,0xbf6d3ec4,0xbf35bf35,0x3ec4bf6d,0x8000bf80,0x3ec4bf6d,0x3f35bf35,0x3f6dbec4
.long 0xbf35bf35,0xbf7bbe48,0xbf6d3ec4,0xbf0e3f55,0x3f353f35,0x3f55bf0e,0xbec4bf6d,0xbf7b3e48,0xbf35bf35,0xbe483f7b,0x3f6dbec4,0xbf55bf0e,0x3f353f35,0xbf0ebf55,0x3ec43f6d,0xbe48bf7b
.long 0xbf35bf35,0x3f7b3e48,0xbf6d3ec4,0x3f0ebf55,0x3f353f35,0xbf553f0e,0xbec4bf6d,0x3f7bbe48,0xbf35bf35,0x3e48bf7b,0x3f6dbec4,0x3f553f0e,0x3f353f35,0x3f0e3f55,0x3ec43f6d,0x3e483f7b
.long 0x3f80,0x3f80,0x3f80,0x3f80,0x3f80,0x3f353f35,0x3f800000,0x3f35bf35,0x3f80,0x3f800000,0xbf80,0xbf800000,0x3f80,0x3f35bf35,0xbf800000,0x3f353f35
.long 0x3f80,0xbf80,0x3f80,0xbf80,0x3f80,0xbf35bf35,0x3f800000,0xbf353f35,0x3f80,0xbf800000,0xbf80,0x3f800000,0x3f80,0xbf353f35,0xbf800000,0xbf35bf35
.long 0xbf800000,0xbf7b3e48,0xbf6d3ec4,0xbf553f0e,0xbf800000,0xbf0e3f55,0x3ec43f6d,0x3f7b3e48,0xbf800000,0x3e483f7b,0x3f6dbec4,0xbf0ebf55,0xbf800000,0x3f553f0e,0xbec4bf6d,0xbe483f7b
.long 0xbf800000,0x3f7bbe48,0xbf6d3ec4,0x3f55bf0e,0xbf800000,0x3f0ebf55,0x3ec43f6d,0xbf7bbe48,0xbf800000,0xbe48bf7b,0x3f6dbec4,0x3f0e3f55,0xbf800000,0xbf55bf0e,0xbec4bf6d,0x3e48bf7b
.long 0xbf80,0xbec4bf6d,0xbf35bf35,0xbf6dbec4,0xbf80,0xbf6dbec4,0xbf353f35,0x3ec43f6d,0xbf80,0xbf6d3ec4,0x3f353f35,0x3ec4bf6d,0xbf80,0xbec43f6d,0x3f35bf35,0xbf6d3ec4
.long 0xbf80,0x3ec43f6d,0xbf35bf35,0x3f6d3ec4,0xbf80,0x3f6d3ec4,0xbf353f35,0xbec4bf6d,0xbf80,0x3f6dbec4,0x3f353f35,0xbec43f6d,0xbf80,0x3ec4bf6d,0x3f35bf35,0x3f6dbec4
.long 0x3f800000,0x3f55bf0e,0x3ec4bf6d,0xbe48bf7b,0x3f800000,0x3e48bf7b,0xbf6dbec4,0xbf0e3f55,0x3f800000,0xbf0ebf55,0xbec43f6d,0x3f7bbe48,0x3f800000,0xbf7bbe48,0x3f6d3ec4,0xbf55bf0e
.long 0x3f800000,0xbf553f0e,0x3ec4bf6d,0x3e483f7b,0x3f800000,0xbe483f7b,0xbf6dbec4,0x3f0ebf55,0x3f800000,0x3f0e3f55,0xbec43f6d,0xbf7b3e48,0x3f800000,0x3f7b3e48,0x3f6d3ec4,0x3f553f0e
.long 0x3f80,0x3f80,0x3f80,0x3f80,0xbf80,0xbf35bf35,0xbf800000,0xbf353f35,0x3f80,0x3f800000,0xbf80,0xbf800000,0xbf80,0xbf353f35,0x3f800000,0xbf35bf35
.long 0x3f80,0xbf80,0x3f80,0xbf80,0xbf80,0x3f353f35,0xbf800000,0x3f35bf35,0x3f80,0xbf800000,0xbf80,0x3f800000,0xbf80,0x3f35bf35,0x3f800000,0x3f353f35
.long 0xbf353f35,0xbf0e3f55,0xbec43f6d,0xbe483f7b,0x3f35bf35,0xbe48bf7b,0xbf6dbec4,0xbf553f0e,0xbf353f35,0x3f553f0e,0x3ec4bf6d,0xbf7bbe48,0x3f35bf35,0xbf7b3e48,0x3f6d3ec4,0xbf0ebf55
.long 0xbf353f35,0x3f0ebf55,0xbec43f6d,0x3e48bf7b,0x3f35bf35,0x3e483f7b,0xbf6dbec4,0x3f55bf0e,0xbf353f35,0xbf55bf0e,0x3ec4bf6d,0x3f7b3e48,0x3f35bf35,0x3f7bbe48,0x3f6d3ec4,0x3f0e3f55
.long 0xbf800000,0xbf6d3ec4,0xbf353f35,0xbec43f6d,0x3f800000,0x3ec4bf6d,0xbf35bf35,0xbf6d3ec4,0xbf800000,0x3ec43f6d,0x3f35bf35,0xbf6dbec4,0x3f800000,0xbf6dbec4,0x3f353f35,0xbec4bf6d
.long 0xbf800000,0x3f6dbec4,0xbf353f35,0x3ec4bf6d,0x3f800000,0xbec43f6d,0xbf35bf35,0x3f6dbec4,0xbf800000,0xbec4bf6d,0x3f35bf35,0x3f6d3ec4,0x3f800000,0x3f6d3ec4,0x3f353f35,0x3ec43f6d
.long 0xbf35bf35,0xbf7bbe48,0xbf6d3ec4,0xbf0e3f55,0x3f353f35,0x3f55bf0e,0xbec4bf6d,0xbf7b3e48,0xbf35bf35,0xbe483f7b,0x3f6dbec4,0xbf55bf0e,0x3f353f35,0xbf0ebf55,0x3ec43f6d,0xbe48bf7b
.long 0xbf35bf35,0x3f7b3e48,0xbf6d3ec4,0x3f0ebf55,0x3f353f35,0xbf553f0e,0xbec4bf6d,0x3f7bbe48,0xbf35bf35,0x3e48bf7b,0x3f6dbec4,0x3f553f0e,0x3f353f35,0x3f0e3f55,0x3ec43f6d,0x3e483f7b
.long 0xbf800000,0xbf800000,0xbf800000,0xbf800000,0xbf800000,0xbf353f35,0x80003f80,0x3f353f35,0xbf800000,0x80003f80,0x3f800000,0x8000bf80,0xbf800000,0x3f353f35,0x8000bf80,0xbf353f35
.long 0xbf800000,0x3f800000,0xbf800000,0x3f800000,0xbf800000,0x3f35bf35,0x80003f80,0xbf35bf35,0xbf800000,0x8000bf80,0x3f800000,0x80003f80,0xbf800000,0xbf35bf35,0x8000bf80,0x3f35bf35
.long 0x8000bf80,0xbe48bf7b,0xbec4bf6d,0xbf0ebf55,0x8000bf80,0xbf55bf0e,0xbf6d3ec4,0xbe483f7b,0x8000bf80,0xbf7b3e48,0x3ec43f6d,0x3f55bf0e,0x8000bf80,0xbf0e3f55,0x3f6dbec4,0xbf7bbe48
.long 0x8000bf80,0x3e483f7b,0xbec4bf6d,0x3f0e3f55,0x8000bf80,0x3f553f0e,0xbf6d3ec4,0x3e48bf7b,0x8000bf80,0x3f7bbe48,0x3ec43f6d,0xbf553f0e,0x8000bf80,0x3f0ebf55,0x3f6dbec4,0x3f7b3e48
.long 0x3f800000,0x3f6dbec4,0x3f35bf35,0x3ec4bf6d,0x3f800000,0x3ec4bf6d,0xbf35bf35,0xbf6d3ec4,0x3f800000,0xbec4bf6d,0xbf353f35,0x3f6d3ec4,0x3f800000,0xbf6dbec4,0x3f353f35,0xbec4bf6d
.long 0x3f800000,0xbf6d3ec4,0x3f35bf35,0xbec43f6d,0x3f800000,0xbec43f6d,0xbf35bf35,0x3f6dbec4,0x3f800000,0x3ec43f6d,0xbf353f35,0xbf6dbec4,0x3f800000,0x3f6d3ec4,0x3f353f35,0x3ec43f6d
.long 0x80003f80,0x3f0e3f55,0x3f6d3ec4,0x3f7bbe48,0x80003f80,0x3f7b3e48,0x3ec4bf6d,0xbf55bf0e,0x80003f80,0x3f55bf0e,0xbf6dbec4,0x3e483f7b,0x80003f80,0x3e48bf7b,0xbec43f6d,0x3f0ebf55
.long 0x80003f80,0xbf0ebf55,0x3f6d3ec4,0xbf7b3e48,0x80003f80,0xbf7bbe48,0x3ec4bf6d,0x3f553f0e,0x80003f80,0xbf553f0e,0xbf6dbec4,0xbe48bf7b,0x80003f80,0xbe483f7b,0xbec43f6d,0xbf0e3f55
.long 0xbf800000,0xbf800000,0xbf800000,0xbf800000,0x3f800000,0x3f35bf35,0x8000bf80,0xbf35bf35,0xbf800000,0x80003f80,0x3f800000,0x8000bf80,0x3f800000,0xbf35bf35,0x80003f80,0x3f35bf35
.long 0xbf800000,0x3f800000,0xbf800000,0x3f800000,0x3f800000,0xbf353f35,0x8000bf80,0x3f353f35,0xbf800000,0x8000bf80,0x3f800000,0x80003f80,0x3f800000,0x3f353f35,0x80003f80,0xbf353f35
.long 0xbf35bf35,0xbf55bf0e,0xbf6dbec4,0xbf7bbe48,0x3f353f35,0x3f7bbe48,0x3ec4bf6d,0xbf0ebf55,0xbf35bf35,0xbf0e3f55,0x3f6d3ec4,0x3e48bf7b,0x3f353f35,0xbe48bf7b,0xbec43f6d,0x3f55bf0e
.long 0xbf35bf35,0x3f553f0e,0xbf6dbec4,0x3f7b3e48,0x3f353f35,0xbf7b3e48,0x3ec4bf6d,0x3f0e3f55,0xbf35bf35,0x3f0ebf55,0x3f6d3ec4,0xbe483f7b,0x3f353f35,0x3e483f7b,0xbec43f6d,0xbf553f0e
.long 0x8000bf80,0xbec4bf6d,0xbf35bf35,0xbf6dbec4,0x80003f80,0x3f6d3ec4,0x3f35bf35,0xbec4bf6d,0x8000bf80,0xbf6d3ec4,0x3f353f35,0x3ec4bf6d,0x80003f80,0x3ec4bf6d,0xbf353f35,0x3f6dbec4
.long 0x8000bf80,0x3ec43f6d,0xbf35bf35,0x3f6d3ec4,0x80003f80,0xbf6dbec4,0x3f35bf35,0x3ec43f6d,0x8000bf80,0x3f6dbec4,0x3f353f35,0xbec43f6d,0x80003f80,0xbec43f6d,0xbf353f35,0xbf6d3ec4
.long 0x3f35bf35,0x3e48bf7b,0xbec4bf6d,0xbf55bf0e,0xbf353f35,0x3f0e3f55,0x3f6dbec4,0xbe48bf7b,0x3f35bf35,0xbf7bbe48,0x3ec43f6d,0x3f0ebf55,0xbf353f35,0x3f55bf0e,0xbf6d3ec4,0x3f7bbe48
.long 0x3f35bf35,0xbe483f7b,0xbec4bf6d,0x3f553f0e,0xbf353f35,0xbf0ebf55,0x3f6dbec4,0x3e483f7b,0x3f35bf35,0x3f7b3e48,0x3ec43f6d,0xbf0e3f55,0xbf353f35,0xbf553f0e,0xbf6d3ec4,0xbf7b3e48
.long 0x3f800000,0x3f800000,0x3f800000,0x3f800000,0x3f800000,0x3f7fec43,0x3f7fb10f,0x3f7f4e6d,0x3f800000,0x3f7fb10f,0x3f7ec46d,0x3f7d3aac,0x3f800000,0x3f7f4e6d,0x3f7d3aac,0x3f79c79d
.long 0x3f800000,0x3f7ec46d,0x3f7b14be,0x3f74fa0b,0x3f800000,0x3f7e1324,0x3f7853f8,0x3f6ed89e,0x3f800000,0x3f7d3aac,0x3f74fa0b,0x3f676bd8,0x3f800000,0x3f7c3b28,0x3f710908,0x3f5ebe05
.long 0x3f800000,0x3f7ffec4,0x3f7ffb11,0x3f7ff4e6,0x3f800000,0x3f7fe129,0x3f7f84ab,0x3f7eea9d,0x3f800000,0x3f7f9c18,0x3f7e70b0,0x3f7c7eb0,0x3f800000,0x3f7f2f9d,0x3f7cbfc9,0x3f78b47b
.long 0x3f800000,0x3f7e9bc9,0x3f7a7302,0x3f73913f,0x3f800000,0x3f7de0b1,0x3f778bc5,0x3f6d1c1d,0x3f800000,0x3f7cfe73,0x3f740bdd,0x3f655e0b,0x3f800000,0x3f7bf531,0x3f6ff573,0x3f5c61c7
.long 0x3f800000,0x3f7ffb11,0x3f7fec43,0x3f7fd397,0x3f800000,0x3f7fd397,0x3f7f4e6d,0x3f7e70b0,0x3f800000,0x3f7f84ab,0x3f7e1324,0x3f7baccd,0x3f800000,0x3f7f0e58,0x3f7c3b28,0x3f778bc5
.long 0x3f800000,0x3f7e70b0,0x3f79c79d,0x3f721352,0x3f800000,0x3f7dabcc,0x3f76ba07,0x3f6b4b0c,0x3f800000,0x3f7cbfc9,0x3f731447,0x3f633c5a,0x3f800000,0x3f7baccd,0x3f6ed89e,0x3f59f26a
.long 0x3f800000,0x3f7ff4e6,0x3f7fd397,0x3f7f9c18,0x3f800000,0x3f7fc38f,0x3f7f0e58,0x3f7de0b1,0x3f800000,0x3f7f6ac7,0x3f7dabcc,0x3f7ac516,0x3f800000,0x3f7eea9d,0x3f7baccd,0x3f764d97
.long 0x3f800000,0x3f7e4323,0x3f791298,0x3f708066,0x3f800000,0x3f7d7474,0x3f75dec6,0x3f696591,0x3f800000,0x3f7c7eb0,0x3f721352,0x3f6106f2,0x3f800000,0x3f7b61fc,0x3f6db293,0x3f577026
.long 0x3f800000,0x3f800000,0x3f800000,0x3f800000,0x3f7ec46d,0x3f7e1324,0x3f7d3aac,0x3f7c3b28,0x3f7b14be,0x3f7853f8,0x3f74fa0b,0x3f710908,0x3f74fa0b,0x3f6ed89e,0x3f676bd8,0x3f5ebe05
.long 0x3f6c835e,0x3f61c598,0x3f54db31,0x3f45e403,0x3f61c598,0x3f514d3d,0x3f3daef9,0x3f273656,0x3f54db31,0x3f3daef9,0x3f226799,0x3f039c3d,0x3f45e403,0x3f273656,0x3f039c3d,0x3eb8442a
.long 0x3f7fec43,0x3f7fe129,0x3f7fd397,0x3f7fc38f,0x3f7e1324,0x3f7cfe73,0x3f7baccd,0x3f7a1e84,0x3f79c79d,0x3f764d97,0x3f721352,0x3f6d1c1d,0x3f731447,0x3f6be858,0x3f633c5a,0x3f591e6a
.long 0x3f6a09a7,0x3f5df6be,0x3f4f7a1f,0x3f3ebc1b,0x3f5ebe05,0x3f4cae79,0x3f373a23,0x3f1ebc12,0x3f514d3d,0x3f385216,0x3f1b02c6,0x3ef41f07,0x3f41d870,0x3f212ff9,0x3ef6e0cb,0x3ea395c5
.long 0x3f7fb10f,0x3f7f84ab,0x3f7f4e6d,0x3f7f0e58,0x3f7d3aac,0x3f7baccd,0x3f79c79d,0x3f778bc5,0x3f7853f8,0x3f740bdd,0x3f6ed89e,0x3f68bf3c,0x3f710908,0x3f68bf3c,0x3f5ebe05,0x3f531849
.long 0x3f676bd8,0x3f59f26a,0x3f49d112,0x3f373a23,0x3f5b941a,0x3f47de65,0x3f3085bb,0x3f15f6d9,0x3f4d9f02,0x3f32c8c9,0x3f13682a,0x3ee0924f,0x3f3daef9,0x3f1b02c6,0x3ee63375,0x3e8e9a22
.long 0x3f7f4e6d,0x3f7eea9d,0x3f7e70b0,0x3f7de0b1,0x3f7c3b28,0x3f7a1e84,0x3f778bc5,0x3f748422,0x3f76ba07,0x3f718f57,0x3f6b4b0c,0x3f63f473,0x3f6ed89e,0x3f655e0b,0x3f59f26a,0x3f4cae79
.long 0x3f64aa59,0x3f55b993,0x3f43e200,0x3f2f61a5,0x3f584853,0x3f42de29,0x3f299415,0x3f0cead0,0x3f49d112,0x3f2d1469,0x3f0b9a6b,0x3ecc9b8b,0x3f396842,0x3f14b039,0x3ed53641,0x3e72b651
.long 0x3f800000,0x3f800000,0x3f800000,0x3f800000,0x3f7b14be,0x3f79c79d,0x3f7853f8,0x3f76ba07,0x3f6c835e,0x3f676bd8,0x3f61c598,0x3f5b941a,0x3f54db31,0x3f49d112,0x3f3daef9,0x3f3085bb
.long 0x3f3504f3,0x3f226799,0x3f0e39da,0x3ef15aea,0x3f0e39da,0x3ee63375,0x3eac7cd4,0x3e605c13,0x3ec3ef15,0x3e78cfcc,0x3dc8bd36,0xbd48fb30,0x3e47c5c2,0x3cc90ab0,0xbe164083,0xbea09ae5
.long 0x3f7fb10f,0x3f7f9c18,0x3f7f84ab,0x3f7f6ac7,0x3f7853f8,0x3f764d97,0x3f740bdd,0x3f718f57,0x3f676bd8,0x3f6106f2,0x3f59f26a,0x3f5233c6,0x3f4d9f02,0x3f40d0da,0x3f32c8c9,0x3f239da9
.long 0x3f2beb4a,0x3f173c07,0x3f00e7e4,0x3ed25a09,0x3f039c3d,0x3ecc9b8b,0x3e8e9a22,0x3e1c76de,0x3eac7cd4,0x3e419b37,0x3d16c32c,0xbdee3876,0x3e164083,0xbcfb49ba,0xbe541501,0xbec1071e
.long 0x3f7ec46d,0x3f7e70b0,0x3f7e1324,0x3f7dabcc,0x3f74fa0b,0x3f721352,0x3f6ed89e,0x3f6b4b0c,0x3f61c598,0x3f59f26a,0x3f514d3d,0x3f47de65,0x3f45e403,0x3f373a23,0x3f273656,0x3f15f6d9
.long 0x3f226799,0x3f0b9a6b,0x3ee63375,0x3eb263ef,0x3ef15aea,0x3eb263ef,0x3e605c13,0x3dafb680,0x3e94a031,0x3e09cf86,0xbcc90ab0,0xbe3b6ecf,0x3dc8bd36,0xbdafb680,0xbe888e93,0xbee0924f
.long 0x3f7d3aac,0x3f7c7eb0,0x3f7baccd,0x3f7ac516,0x3f710908,0x3f6d1c1d,0x3f68bf3c,0x3f63f473,0x3f5b941a,0x3f5233c6,0x3f47de65,0x3f3ca003,0x3f3daef9,0x3f2d1469,0x3f1b02c6,0x3f07a136
.long 0x3f187fc0,0x3eff17b2,0x3ec9b953,0x3e919ddd,0x3edae880,0x3e97a117,0x3e22abb6,0x3c96c9b6,0x3e78cfcc,0x3da3308c,0xbdafb680,0xbe7ee6e1,0x3d48fb30,0xbe1008b7,0xbea68f12,0xbeff17b2
.long 0x3f800000,0x3f800000,0x3f800000,0x3f800000,0x3f74fa0b,0x3f731447,0x3f710908,0x3f6ed89e,0x3f54db31,0x3f4d9f02,0x3f45e403,0x3f3daef9,0x3f226799,0x3f13682a,0x3f039c3d,0x3ee63375
.long 0x3ec3ef15,0x3e94a031,0x3e47c5c2,0x3dc8bd36,0x3dc8bd36,0xbcc90ab0,0xbe164083,0xbe888e93,0xbe47c5c2,0xbeac7cd4,0xbef15aea,0xbf187fc0,0xbef15aea,0xbf1d7fd1,0xbf3daef9,0xbf584853
.long 0x3f7f4e6d,0x3f7f2f9d,0x3f7f0e58,0x3f7eea9d,0x3f6ed89e,0x3f6be858,0x3f68bf3c,0x3f655e0b,0x3f49d112,0x3f40d0da,0x3f373a23,0x3f2d1469,0x3f13682a,0x3f0242b1,0x3ee0924f,0x3ebb31a0
.long 0x3ea09ae5,0x3e5a3997,0x3de1bc2e,0x3bc90f88,0x3cc90ab0,0xbdd53db9,0xbe6c9a7f,0xbeb554ec,0xbe888e93,0xbed25a09,0xbf0b9a6b,0xbf2ac082,0xbf08f59b,0xbf2d1469,0xbf4bbbf8,0xbf63f473
.long 0x3f7d3aac,0x3f7cbfc9,0x3f7c3b28,0x3f7baccd,0x3f676bd8,0x3f633c5a,0x3f5ebe05,0x3f59f26a,0x3f3daef9,0x3f32c8c9,0x3f273656,0x3f1b02c6,0x3f039c3d,0x3ee0924f,0x3eb8442a,0x3e8e9a22
.long 0x3e78cfcc,0x3e09cf86,0x3cc90ab0,0xbdafb680,0xbd48fb30,0xbe3b6ecf,0xbea09ae5,0xbee0924f,0xbeac7cd4,0xbef6e0cb,0xbf1d7fd1,0xbf3b8f3b,0xbf187fc0,0xbf3b8f3b,0xbf584853,0xbf6db293
.long 0x3f79c79d,0x3f78b47b,0x3f778bc5,0x3f764d97,0x3f5ebe05,0x3f591e6a,0x3f531849,0x3f4cae79,0x3f3085bb,0x3f239da9,0x3f15f6d9,0x3f07a136,0x3ee63375,0x3ebb31a0,0x3e8e9a22,0x3e419b37
.long 0x3e2f10a2,0x3d621469,0xbd7b2b74,0xbe354098,0xbdfab273,0xbe8586ce,0xbec9b953,0xbf04f484,0xbecf7bca,0xbf0cead0,0xbf2e3bde,0xbf4ac77f,0xbf273656,0xbf48d8b3,0xbf633c5a,0xbf756d97
.long 0x3f800000,0x3f800000,0x3f800000,0x3f800000,0x3f6c835e,0x3f6a09a7,0x3f676bd8,0x3f64aa59,0x3f3504f3,0x3f2beb4a,0x3f226799,0x3f187fc0,0x3ec3ef15,0x3ea09ae5,0x3e78cfcc,0x3e2f10a2
.long 0x0,0xbdc8bd36,0xbe47c5c2,0xbe94a031,0xbec3ef15,0xbefc5d27,0xbf187fc0,0xbf3085bb,0xbf3504f3,0xbf4d9f02,0xbf61c598,0xbf710908,0xbf6c835e,0xbf79c79d,0xbf7fb10f,0xbf7e1324
.long 0x3f7ec46d,0x3f7e9bc9,0x3f7e70b0,0x3f7e4323,0x3f61c598,0x3f5df6be,0x3f59f26a,0x3f55b993,0x3f226799,0x3f173c07,0x3f0b9a6b,0x3eff17b2,0x3e94a031,0x3e5a3997,0x3e09cf86,0x3d621469
.long 0xbdc8bd36,0xbe4dee60,0xbe9aa086,0xbecc9b8b,0xbef15aea,0xbf14b039,0xbf2e3bde,0xbf44e3f5,0xbf45e403,0xbf5c61c7,0xbf6db293,0xbf796e4e,0xbf74fa0b,0xbf7e4323,0xbf7f84ab,0xbf78b47b
.long 0x3f7b14be,0x3f7a7302,0x3f79c79d,0x3f791298,0x3f54db31,0x3f4f7a1f,0x3f49d112,0x3f43e200,0x3f0e39da,0x3f00e7e4,0x3ee63375,0x3ec9b953,0x3e47c5c2,0x3de1bc2e,0x3cc90ab0,0xbd7b2b74
.long 0xbe47c5c2,0xbe9aa086,0xbecf7bca,0xbf00e7e4,0xbf0e39da,0xbf299415,0xbf41d870,0xbf5695e5,0xbf54db31,0xbf68bf3c,0xbf76ba07,0xbf7e70b0,0xbf7b14be,0xbf7ffb11,0xbf7c3b28,0xbf6ff573
.long 0x3f74fa0b,0x3f73913f,0x3f721352,0x3f708066,0x3f45e403,0x3f3ebc1b,0x3f373a23,0x3f2f61a5,0x3ef15aea,0x3ed25a09,0x3eb263ef,0x3e919ddd,0x3dc8bd36,0x3bc90f88,0xbdafb680,0xbe354098
.long 0xbe94a031,0xbecc9b8b,0xbf00e7e4,0xbf19c200,0xbf226799,0xbf3ca003,0xbf531849,0xbf655e0b,0xbf61c598,0xbf7294f8,0xbf7cbfc9,0xbf7ffec4,0xbf7ec46d,0xbf7eea9d,0xbf75dec6,0xbf63f473
.long 0x3f800000,0x3f800000,0x3f800000,0x3f800000,0x3f61c598,0x3f5ebe05,0x3f5b941a,0x3f584853,0x3f0e39da,0x3f039c3d,0x3ef15aea,0x3edae880,0x3dc8bd36,0x3cc90ab0,0xbd48fb30,0xbdfab273
.long 0xbec3ef15,0xbef15aea,0xbf0e39da,0xbf226799,0xbf45e403,0xbf584853,0xbf676bd8,0xbf731447,0xbf7b14be,0xbf7fb10f,0xbf7ec46d,0xbf7853f8,0xbf74fa0b,0xbf64aa59,0xbf4d9f02,0xbf3085bb
.long 0x3f7e1324,0x3f7de0b1,0x3f7dabcc,0x3f7d7474,0x3f514d3d,0x3f4cae79,0x3f47de65,0x3f42de29,0x3ee63375,0x3ecc9b8b,0x3eb263ef,0x3e97a117,0xbcc90ab0,0xbdd53db9,0xbe3b6ecf,0xbe8586ce
.long 0xbefc5d27,0xbf14b039,0xbf299415,0xbf3ca003,0xbf584853,0xbf6816a8,0xbf740bdd,0xbf7bf531,0xbf7f4e6d,0xbf7f2f9d,0xbf791298,0xbf6d1c1d,0xbf6a09a7,0xbf53fac3,0xbf373a23,0xbf14b039
.long 0x3f7853f8,0x3f778bc5,0x3f76ba07,0x3f75dec6,0x3f3daef9,0x3f373a23,0x3f3085bb,0x3f299415,0x3eac7cd4,0x3e8e9a22,0x3e605c13,0x3e22abb6,0xbe164083,0xbe6c9a7f,0xbea09ae5,0xbec9b953
.long 0xbf187fc0,0xbf2e3bde,0xbf41d870,0xbf531849,0xbf676bd8,0xbf740bdd,0xbf7c3b28,0xbf7fd397,0xbf7fb10f,0xbf7a7302,0xbf6ed89e,0xbf5d2d53,0xbf5b941a,0xbf3fc767,0xbf1d7fd1,0xbeebcbbb
.long 0x3f6ed89e,0x3f6d1c1d,0x3f6b4b0c,0x3f696591,0x3f273656,0x3f1ebc12,0x3f15f6d9,0x3f0cead0,0x3e605c13,0x3e1c76de,0x3dafb680,0x3c96c9b6,0xbe888e93,0xbeb554ec,0xbee0924f,0xbf04f484
.long 0xbf3085bb,0xbf44e3f5,0xbf5695e5,0xbf655e0b,0xbf731447,0xbf7bf531,0xbf7fd397,0xbf7e9bc9,0xbf7c3b28,0xbf718f57,0xbf604621,0xbf48d8b3,0xbf49d112,0xbf286605,0xbf00e7e4,0xbea986c4
.long 0x3f800000,0x3f800000,0x3f800000,0x3f800000,0x3f54db31,0x3f514d3d,0x3f4d9f02,0x3f49d112,0x3ec3ef15,0x3eac7cd4,0x3e94a031,0x3e78cfcc,0xbe47c5c2,0xbe888e93,0xbeac7cd4,0xbecf7bca
.long 0xbf3504f3,0xbf45e403,0xbf54db31,0xbf61c598,0xbf7b14be,0xbf7f4e6d,0xbf7fb10f,0xbf7c3b28,0xbf6c835e,0xbf5b941a,0xbf45e403,0xbf2beb4a,0xbf0e39da,0xbecf7bca,0xbe78cfcc,0xbd96a905
.long 0x3f7d3aac,0x3f7cfe73,0x3f7cbfc9,0x3f7c7eb0,0x3f3daef9,0x3f385216,0x3f32c8c9,0x3f2d1469,0x3e78cfcc,0x3e419b37,0x3e09cf86,0x3da3308c,0xbeac7cd4,0xbed25a09,0xbef6e0cb,0xbf0cead0
.long 0xbf4d9f02,0xbf5c61c7,0xbf68bf3c,0xbf7294f8,0xbf7fb10f,0xbf7f2f9d,0xbf7a7302,0xbf718f57,0xbf5b941a,0xbf44e3f5,0xbf299415,0xbf0a48ad,0xbedae880,0xbe8586ce,0xbdafb680,0x3dbc3ac3
.long 0x3f74fa0b,0x3f740bdd,0x3f731447,0x3f721352,0x3f226799,0x3f1b02c6,0x3f13682a,0x3f0b9a6b,0x3dc8bd36,0x3d16c32c,0xbcc90ab0,0xbdafb680,0xbef15aea,0xbf0b9a6b,0xbf1d7fd1,0xbf2e3bde
.long 0xbf61c598,0xbf6db293,0xbf76ba07,0xbf7cbfc9,0xbf7ec46d,0xbf791298,0xbf6ed89e,0xbf604621,0xbf45e403,0xbf299415,0xbf08f59b,0xbec9b953,0xbe94a031,0xbde1bc2e,0x3d96a905,0x3e827dc0
.long 0x3f676bd8,0x3f655e0b,0x3f633c5a,0x3f6106f2,0x3f039c3d,0x3ef41f07,0x3ee0924f,0x3ecc9b8b,0xbd48fb30,0xbdee3876,0xbe3b6ecf,0xbe7ee6e1,0xbf187fc0,0xbf2ac082,0xbf3b8f3b,0xbf4ac77f
.long 0xbf710908,0xbf796e4e,0xbf7e70b0,0xbf7ffec4,0xbf7853f8,0xbf6d1c1d,0xbf5d2d53,0xbf48d8b3,0xbf2beb4a,0xbf0a48ad,0xbec9b953,0xbe72b651,0xbe164083,0x3d2fe007,0x3e6c9a7f,0x3ed25a09
.long 0x3f800000,0x3f800000,0x3f800000,0x3f800000,0x3f45e403,0x3f41d870,0x3f3daef9,0x3f396842,0x3e47c5c2,0x3e164083,0x3dc8bd36,0x3d48fb30,0xbef15aea,0xbf08f59b,0xbf187fc0,0xbf273656
.long 0xbf6c835e,0xbf74fa0b,0xbf7b14be,0xbf7ec46d,0xbf74fa0b,0xbf6a09a7,0xbf5b941a,0xbf49d112,0xbf0e39da,0xbedae880,0xbe94a031,0xbe164083,0x3dc8bd36,0x3e888e93,0x3edae880,0x3f13682a
.long 0x3f7c3b28,0x3f7bf531,0x3f7baccd,0x3f7b61fc,0x3f273656,0x3f212ff9,0x3f1b02c6,0x3f14b039,0x3cc90ab0,0xbcfb49ba,0xbdafb680,0xbe1008b7,0xbf1d7fd1,0xbf2d1469,0xbf3b8f3b,0xbf48d8b3
.long 0xbf79c79d,0xbf7e4323,0xbf7ffb11,0xbf7eea9d,0xbf64aa59,0xbf53fac3,0xbf3fc767,0xbf286605,0xbecf7bca,0xbe8586ce,0xbde1bc2e,0x3d2fe007,0x3e888e93,0x3eddbe79,0x3f15f6d9,0x3f385216
.long 0x3f710908,0x3f6ff573,0x3f6ed89e,0x3f6db293,0x3f039c3d,0x3ef6e0cb,0x3ee63375,0x3ed53641,0xbe164083,0xbe541501,0xbe888e93,0xbea68f12,0xbf3daef9,0xbf4bbbf8,0xbf584853,0xbf633c5a
.long 0xbf7fb10f,0xbf7f84ab,0xbf7c3b28,0xbf75dec6,0xbf4d9f02,0xbf373a23,0xbf1d7fd1,0xbf00e7e4,0xbe78cfcc,0xbdafb680,0x3d96a905,0x3e6c9a7f,0x3edae880,0x3f15f6d9,0x3f396842,0x3f5695e5
.long 0x3f5ebe05,0x3f5c61c7,0x3f59f26a,0x3f577026,0x3eb8442a,0x3ea395c5,0x3e8e9a22,0x3e72b651,0xbea09ae5,0xbec1071e,0xbee0924f,0xbeff17b2,0xbf584853,0xbf63f473,0xbf6db293,0xbf756d97
.long 0xbf7e1324,0xbf78b47b,0xbf6ff573,0xbf63f473,0xbf3085bb,0xbf14b039,0xbeebcbbb,0xbea986c4,0xbd96a905,0x3dbc3ac3,0x3e827dc0,0x3ed25a09,0x3f13682a,0x3f385216,0x3f5695e5,0x3f6d1c1d
.long 0x0,0x0,0x0,0x0,0x0,0x3cc90ab0,0x3d48fb30,0x3d96a905,0x0,0x3d48fb30,0x3dc8bd36,0x3e164083,0x0,0x3d96a905,0x3e164083,0x3e605c13
.long 0x0,0x3dc8bd36,0x3e47c5c2,0x3e94a031,0x0,0x3dfab273,0x3e78cfcc,0x3eb8442a,0x0,0x3e164083,0x3e94a031,0x3edae880,0x0,0x3e2f10a2,0x3eac7cd4,0x3efc5d27
.long 0x0,0x3bc90f88,0x3c490e90,0x3c96c9b6,0x0,0x3cfb49ba,0x3d7b2b74,0x3dbc3ac3,0x0,0x3d621469,0x3de1bc2e,0x3e28defc,0x0,0x3da3308c,0x3e22abb6,0x3e72b651
.long 0x0,0x3dd53db9,0x3e541501,0x3e9d9e78,0x0,0x3e039502,0x3e827dc0,0x3ec1071e,0x0,0x3e1c76de,0x3e9aa086,0x3ee363fa,0x0,0x3e354098,0x3eb263ef,0x3f0242b1
.long 0x0,0x3c490e90,0x3cc90ab0,0x3d16c32c,0x0,0x3d16c32c,0x3d96a905,0x3de1bc2e,0x0,0x3d7b2b74,0x3dfab273,0x3e3b6ecf,0x0,0x3dafb680,0x3e2f10a2,0x3e827dc0
.long 0x0,0x3de1bc2e,0x3e605c13,0x3ea68f12,0x0,0x3e09cf86,0x3e888e93,0x3ec9b953,0x0,0x3e22abb6,0x3ea09ae5,0x3eebcbbb,0x0,0x3e3b6ecf,0x3eb8442a,0x3f064b82
.long 0x0,0x3c96c9b6,0x3d16c32c,0x3d621469,0x0,0x3d2fe007,0x3dafb680,0x3e039502,0x0,0x3d8a200a,0x3e09cf86,0x3e4dee60,0x0,0x3dbc3ac3,0x3e3b6ecf,0x3e8b9507
.long 0x0,0x3dee3876,0x3e6c9a7f,0x3eaf713a,0x0,0x3e1008b7,0x3e8e9a22,0x3ed25a09,0x0,0x3e28defc,0x3ea68f12,0x3ef41f07,0x0,0x3e419b37,0x3ebe1d4a,0x3f0a48ad
.long 0x0,0x0,0x0,0x0,0x3dc8bd36,0x3dfab273,0x3e164083,0x3e2f10a2,0x3e47c5c2,0x3e78cfcc,0x3e94a031,0x3eac7cd4,0x3e94a031,0x3eb8442a,0x3edae880,0x3efc5d27
.long 0x3ec3ef15,0x3ef15aea,0x3f0e39da,0x3f226799,0x3ef15aea,0x3f13682a,0x3f2beb4a,0x3f41d870,0x3f0e39da,0x3f2beb4a,0x3f45e403,0x3f5b941a,0x3f226799,0x3f41d870,0x3f5b941a,0x3f6ed89e
.long 0x3cc90ab0,0x3cfb49ba,0x3d16c32c,0x3d2fe007,0x3dfab273,0x3e1c76de,0x3e3b6ecf,0x3e5a3997,0x3e605c13,0x3e8b9507,0x3ea68f12,0x3ec1071e,0x3ea09ae5,0x3ec6d529,0x3eebcbbb,0x3f07a136
.long 0x3ecf7bca,0x3eff17b2,0x3f15f6d9,0x3f2ac082,0x3efc5d27,0x3f19c200,0x3f32c8c9,0x3f48d8b3,0x3f13682a,0x3f31a81d,0x3f4bbbf8,0x3f6106f2,0x3f273656,0x3f46e22a,0x3f604621,0x3f7294f8
.long 0x3d48fb30,0x3d7b2b74,0x3d96a905,0x3dafb680,0x3e164083,0x3e3b6ecf,0x3e605c13,0x3e827dc0,0x3e78cfcc,0x3e9aa086,0x3eb8442a,0x3ed53641,0x3eac7cd4,0x3ed53641,0x3efc5d27,0x3f10d3cd
.long 0x3edae880,0x3f064b82,0x3f1d7fd1,0x3f32c8c9,0x3f039c3d,0x3f1ff6cb,0x3f396842,0x3f4f7a1f,0x3f187fc0,0x3f373a23,0x3f514d3d,0x3f660f88,0x3f2beb4a,0x3f4bbbf8,0x3f64aa59,0x3f75dec6
.long 0x3d96a905,0x3dbc3ac3,0x3de1bc2e,0x3e039502,0x3e2f10a2,0x3e5a3997,0x3e827dc0,0x3e97a117,0x3e888e93,0x3ea986c4,0x3ec9b953,0x3ee900b7,0x3eb8442a,0x3ee363fa,0x3f064b82,0x3f19c200
.long 0x3ee63375,0x3f0cead0,0x3f24d225,0x3f3a7ca4,0x3f08f59b,0x3f26050a,0x3f3fc767,0x3f55b993,0x3f1d7fd1,0x3f3ca003,0x3f5695e5,0x3f6aab7b,0x3f3085bb,0x3f5064af,0x3f68bf3c,0x3f78b47b
.long 0x0,0x0,0x0,0x0,0x3e47c5c2,0x3e605c13,0x3e78cfcc,0x3e888e93,0x3ec3ef15,0x3edae880,0x3ef15aea,0x3f039c3d,0x3f0e39da,0x3f1d7fd1,0x3f2beb4a,0x3f396842
.long 0x3f3504f3,0x3f45e403,0x3f54db31,0x3f61c598,0x3f54db31,0x3f64aa59,0x3f710908,0x3f79c79d,0x3f6c835e,0x3f7853f8,0x3f7ec46d,0x3f7fb10f,0x3f7b14be,0x3f7fec43,0x3f7d3aac,0x3f731447
.long 0x3d48fb30,0x3d621469,0x3d7b2b74,0x3d8a200a,0x3e78cfcc,0x3e8b9507,0x3e9aa086,0x3ea986c4,0x3edae880,0x3ef41f07,0x3f064b82,0x3f121eb0,0x3f187fc0,0x3f286605,0x3f373a23,0x3f44e3f5
.long 0x3f3daef9,0x3f4e8d90,0x3f5d2d53,0x3f696591,0x3f5b941a,0x3f6aab7b,0x3f75dec6,0x3f7cfe73,0x3f710908,0x3f7b61fc,0x3f7fd397,0x3f7e4323,0x3f7d3aac,0x3f7fe129,0x3f7a7302,0x3f6d1c1d
.long 0x3dc8bd36,0x3de1bc2e,0x3dfab273,0x3e09cf86,0x3e94a031,0x3ea68f12,0x3eb8442a,0x3ec9b953,0x3ef15aea,0x3f064b82,0x3f13682a,0x3f1ff6cb,0x3f226799,0x3f32c8c9,0x3f41d870,0x3f4f7a1f
.long 0x3f45e403,0x3f5695e5,0x3f64aa59,0x3f6ff573,0x3f61c598,0x3f6ff573,0x3f79c79d,0x3f7f0e58,0x3f74fa0b,0x3f7dabcc,0x3f7fec43,0x3f7baccd,0x3f7ec46d,0x3f7f0e58,0x3f76ba07,0x3f660f88
.long 0x3e164083,0x3e28defc,0x3e3b6ecf,0x3e4dee60,0x3eac7cd4,0x3ec1071e,0x3ed53641,0x3ee900b7,0x3f039c3d,0x3f121eb0,0x3f1ff6cb,0x3f2d1469,0x3f2beb4a,0x3f3ca003,0x3f4bbbf8,0x3f591e6a
.long 0x3f4d9f02,0x3f5df6be,0x3f6b4b0c,0x3f756d97,0x3f676bd8,0x3f748422,0x3f7cbfc9,0x3f7ff4e6,0x3f7853f8,0x3f7f2f9d,0x3f7f0e58,0x3f77f110,0x3f7fb10f,0x3f7d7474,0x3f721352,0x3f5df6be
.long 0x0,0x0,0x0,0x0,0x3e94a031,0x3ea09ae5,0x3eac7cd4,0x3eb8442a,0x3f0e39da,0x3f187fc0,0x3f226799,0x3f2beb4a,0x3f45e403,0x3f514d3d,0x3f5b941a,0x3f64aa59
.long 0x3f6c835e,0x3f74fa0b,0x3f7b14be,0x3f7ec46d,0x3f7ec46d,0x3f7fec43,0x3f7d3aac,0x3f76ba07,0x3f7b14be,0x3f710908,0x3f61c598,0x3f4d9f02,0x3f61c598,0x3f49d112,0x3f2beb4a,0x3f08f59b
.long 0x3d96a905,0x3da3308c,0x3dafb680,0x3dbc3ac3,0x3eb8442a,0x3ec6d529,0x3ed53641,0x3ee363fa,0x3f1d7fd1,0x3f286605,0x3f32c8c9,0x3f3ca003,0x3f514d3d,0x3f5c61c7,0x3f660f88,0x3f6e46be
.long 0x3f731447,0x3f7a1e84,0x3f7e70b0,0x3f7ffec4,0x3f7fec43,0x3f7e9bc9,0x3f791298,0x3f6f6830,0x3f76ba07,0x3f696591,0x3f5695e5,0x3f3ebc1b,0x3f584853,0x3f3ca003,0x3f1b02c6,0x3ee900b7
.long 0x3e164083,0x3e22abb6,0x3e2f10a2,0x3e3b6ecf,0x3edae880,0x3eebcbbb,0x3efc5d27,0x3f064b82,0x3f2beb4a,0x3f373a23,0x3f41d870,0x3f4bbbf8,0x3f5b941a,0x3f660f88,0x3f6ed89e,0x3f75dec6
.long 0x3f7853f8,0x3f7dabcc,0x3f7fec43,0x3f7f0e58,0x3f7fb10f,0x3f7baccd,0x3f731447,0x3f660f88,0x3f710908,0x3f604621,0x3f49d112,0x3f2e3bde,0x3f4d9f02,0x3f2e3bde,0x3f08f59b,0x3ebe1d4a
.long 0x3e605c13,0x3e72b651,0x3e827dc0,0x3e8b9507,0x3efc5d27,0x3f07a136,0x3f10d3cd,0x3f19c200,0x3f396842,0x3f44e3f5,0x3f4f7a1f,0x3f591e6a,0x3f64aa59,0x3f6e46be,0x3f75dec6,0x3f7b61fc
.long 0x3f7c3b28,0x3f7f9c18,0x3f7f84ab,0x3f7bf531,0x3f7e1324,0x3f772417,0x3f6b4b0c,0x3f5ac450,0x3f6a09a7,0x3f55b993,0x3f3b8f3b,0x3f1c420c,0x3f41d870,0x3f1ebc12,0x3eebcbbb,0x3e919ddd
.long 0x0,0x0,0x0,0x0,0x3ec3ef15,0x3ecf7bca,0x3edae880,0x3ee63375,0x3f3504f3,0x3f3daef9,0x3f45e403,0x3f4d9f02,0x3f6c835e,0x3f731447,0x3f7853f8,0x3f7c3b28
.long 0x3f800000,0x3f7ec46d,0x3f7b14be,0x3f74fa0b,0x3f6c835e,0x3f5ebe05,0x3f4d9f02,0x3f396842,0x3f3504f3,0x3f187fc0,0x3ef15aea,0x3eac7cd4,0x3ec3ef15,0x3e605c13,0x3d48fb30,0xbdfab273
.long 0x3dc8bd36,0x3dd53db9,0x3de1bc2e,0x3dee3876,0x3ef15aea,0x3eff17b2,0x3f064b82,0x3f0cead0,0x3f45e403,0x3f4e8d90,0x3f5695e5,0x3f5df6be,0x3f74fa0b,0x3f7a1e84,0x3f7dabcc,0x3f7f9c18
.long 0x3f7ec46d,0x3f7ac516,0x3f740bdd,0x3f6aab7b,0x3f61c598,0x3f5064af,0x3f3b8f3b,0x3f239da9,0x3f226799,0x3f0242b1,0x3ebe1d4a,0x3e667c66,0x3e94a031,0x3dee3876,0xbd7b2b74,0xbe72b651
.long 0x3e47c5c2,0x3e541501,0x3e605c13,0x3e6c9a7f,0x3f0e39da,0x3f15f6d9,0x3f1d7fd1,0x3f24d225,0x3f54db31,0x3f5d2d53,0x3f64aa59,0x3f6b4b0c,0x3f7b14be,0x3f7e70b0,0x3f7fec43,0x3f7f84ab
.long 0x3f7b14be,0x3f740bdd,0x3f6a09a7,0x3f5d2d53,0x3f54db31,0x3f3fc767,0x3f273656,0x3f0b9a6b,0x3f0e39da,0x3ed53641,0x3e888e93,0x3de1bc2e,0x3e47c5c2,0x3c490e90,0xbe2f10a2,0xbeb263ef
.long 0x3e94a031,0x3e9d9e78,0x3ea68f12,0x3eaf713a,0x3f226799,0x3f2ac082,0x3f32c8c9,0x3f3a7ca4,0x3f61c598,0x3f696591,0x3f6ff573,0x3f756d97,0x3f7ec46d,0x3f7ffec4,0x3f7f0e58,0x3f7bf531
.long 0x3f74fa0b,0x3f6aab7b,0x3f5d2d53,0x3f4cae79,0x3f45e403,0x3f2d1469,0x3f10d3cd,0x3ee363fa,0x3ef15aea,0x3ea395c5,0x3e22abb6,0xbbc90f88,0x3dc8bd36,0xbdbc3ac3,0xbe8e9a22,0xbee900b7
.long 0x0,0x0,0x0,0x0,0x3ef15aea,0x3efc5d27,0x3f039c3d,0x3f08f59b,0x3f54db31,0x3f5b941a,0x3f61c598,0x3f676bd8,0x3f7ec46d,0x3f7fec43,0x3f7fb10f,0x3f7e1324
.long 0x3f6c835e,0x3f61c598,0x3f54db31,0x3f45e403,0x3f226799,0x3f08f59b,0x3edae880,0x3ea09ae5,0x3e47c5c2,0x3d48fb30,0xbdc8bd36,0xbe78cfcc,0xbe94a031,0xbee63375,0xbf187fc0,0xbf396842
.long 0x3dfab273,0x3e039502,0x3e09cf86,0x3e1008b7,0x3f13682a,0x3f19c200,0x3f1ff6cb,0x3f26050a,0x3f64aa59,0x3f6aab7b,0x3f6ff573,0x3f748422,0x3f7fec43,0x3f7e9bc9,0x3f7baccd,0x3f772417
.long 0x3f5ebe05,0x3f5064af,0x3f3fc767,0x3f2d1469,0x3f08f59b,0x3ed8106b,0x3e9aa086,0x3e354098,0x3d96a905,0xbda3308c,0xbe6c9a7f,0xbec1071e,0xbecf7bca,0xbf0f8784,0xbf32c8c9,0xbf5064af
.long 0x3e78cfcc,0x3e827dc0,0x3e888e93,0x3e8e9a22,0x3f2beb4a,0x3f32c8c9,0x3f396842,0x3f3fc767,0x3f710908,0x3f75dec6,0x3f79c79d,0x3f7cbfc9,0x3f7d3aac,0x3f791298,0x3f731447,0x3f6b4b0c
.long 0x3f4d9f02,0x3f3b8f3b,0x3f273656,0x3f10d3cd,0x3edae880,0x3e9aa086,0x3e2f10a2,0x3d16c32c,0xbd48fb30,0xbe541501,0xbeb8442a,0xbf00e7e4,0xbf039c3d,0xbf299415,0xbf49d112,0xbf633c5a
.long 0x3eb8442a,0x3ec1071e,0x3ec9b953,0x3ed25a09,0x3f41d870,0x3f48d8b3,0x3f4f7a1f,0x3f55b993,0x3f79c79d,0x3f7cfe73,0x3f7f0e58,0x3f7ff4e6,0x3f76ba07,0x3f6f6830,0x3f660f88,0x3f5ac450
.long 0x3f396842,0x3f239da9,0x3f0b9a6b,0x3ee363fa,0x3ea09ae5,0x3e354098,0x3d16c32c,0xbdd53db9,0xbe2f10a2,0xbea986c4,0xbef6e0cb,0xbf1ebc12,0xbf1d7fd1,0xbf40d0da,0xbf5d2d53,0xbf718f57
.long 0x0,0x0,0x0,0x0,0x3f0e39da,0x3f13682a,0x3f187fc0,0x3f1d7fd1,0x3f6c835e,0x3f710908,0x3f74fa0b,0x3f7853f8,0x3f7b14be,0x3f76ba07,0x3f710908,0x3f6a09a7
.long 0x3f3504f3,0x3f226799,0x3f0e39da,0x3ef15aea,0x3e47c5c2,0x3d96a905,0xbd48fb30,0xbe2f10a2,0xbec3ef15,0xbf039c3d,0xbf226799,0xbf3daef9,0xbf54db31,0xbf6a09a7,0xbf7853f8,0xbf7f4e6d
.long 0x3e164083,0x3e1c76de,0x3e22abb6,0x3e28defc,0x3f2beb4a,0x3f31a81d,0x3f373a23,0x3f3ca003,0x3f7853f8,0x3f7b61fc,0x3f7dabcc,0x3f7f2f9d,0x3f710908,0x3f696591,0x3f604621,0x3f55b993
.long 0x3f187fc0,0x3f0242b1,0x3ed53641,0x3ea395c5,0x3d48fb30,0xbda3308c,0xbe541501,0xbea986c4,0xbf039c3d,0xbf239da9,0xbf3fc767,0xbf577026,0xbf676bd8,0xbf772417,0xbf7f0e58,0xbf7eea9d
.long 0x3e94a031,0x3e9aa086,0x3ea09ae5,0x3ea68f12,0x3f45e403,0x3f4bbbf8,0x3f514d3d,0x3f5695e5,0x3f7ec46d,0x3f7fd397,0x3f7fec43,0x3f7f0e58,0x3f61c598,0x3f5695e5,0x3f49d112,0x3f3b8f3b
.long 0x3ef15aea,0x3ebe1d4a,0x3e888e93,0x3e22abb6,0xbdc8bd36,0xbe6c9a7f,0xbeb8442a,0xbef6e0cb,0xbf226799,0xbf3fc767,0xbf584853,0xbf6b4b0c,0xbf74fa0b,0xbf7e70b0,0xbf7f4e6d,0xbf778bc5
.long 0x3edae880,0x3ee363fa,0x3eebcbbb,0x3ef41f07,0x3f5b941a,0x3f6106f2,0x3f660f88,0x3f6aab7b,0x3f7fb10f,0x3f7e4323,0x3f7baccd,0x3f77f110,0x3f4d9f02,0x3f3ebc1b,0x3f2e3bde,0x3f1c420c
.long 0x3eac7cd4,0x3e667c66,0x3de1bc2e,0xbbc90f88,0xbe78cfcc,0xbec1071e,0xbf00e7e4,0xbf1ebc12,0xbf3daef9,0xbf577026,0xbf6b4b0c,0xbf78b47b,0xbf7d3aac,0xbf7fc38f,0xbf791298,0xbf696591
.long 0x0,0x0,0x0,0x0,0x3f226799,0x3f273656,0x3f2beb4a,0x3f3085bb,0x3f7b14be,0x3f7d3aac,0x3f7ec46d,0x3f7fb10f,0x3f61c598,0x3f584853,0x3f4d9f02,0x3f41d870
.long 0x3ec3ef15,0x3e94a031,0x3e47c5c2,0x3dc8bd36,0xbe94a031,0xbecf7bca,0xbf039c3d,0xbf1d7fd1,0xbf54db31,0xbf676bd8,0xbf74fa0b,0xbf7d3aac,0xbf7ec46d,0xbf76ba07,0xbf676bd8,0xbf514d3d
.long 0x3e2f10a2,0x3e354098,0x3e3b6ecf,0x3e419b37,0x3f41d870,0x3f46e22a,0x3f4bbbf8,0x3f5064af,0x3f7fec43,0x3f7fe129,0x3f7f0e58,0x3f7d7474,0x3f49d112,0x3f3ca003,0x3f2e3bde,0x3f1ebc12
.long 0x3e605c13,0x3dee3876,0x3c490e90,0xbdbc3ac3,0xbee63375,0xbf0f8784,0xbf299415,0xbf40d0da,0xbf6a09a7,0xbf772417,0xbf7e70b0,0xbf7fc38f,0xbf76ba07,0xbf66becc,0xbf4f7a1f,0xbf31a81d
.long 0x3eac7cd4,0x3eb263ef,0x3eb8442a,0x3ebe1d4a,0x3f5b941a,0x3f604621,0x3f64aa59,0x3f68bf3c,0x3f7d3aac,0x3f7a7302,0x3f76ba07,0x3f721352,0x3f2beb4a,0x3f1b02c6,0x3f08f59b,0x3eebcbbb
.long 0x3d48fb30,0xbd7b2b74,0xbe2f10a2,0xbe8e9a22,0xbf187fc0,0xbf32c8c9,0xbf49d112,0xbf5d2d53,0xbf7853f8,0xbf7f0e58,0xbf7f4e6d,0xbf791298,0xbf676bd8,0xbf4f7a1f,0xbf3085bb,0xbf0b9a6b
.long 0x3efc5d27,0x3f0242b1,0x3f064b82,0x3f0a48ad,0x3f6ed89e,0x3f7294f8,0x3f75dec6,0x3f78b47b,0x3f731447,0x3f6d1c1d,0x3f660f88,0x3f5df6be,0x3f08f59b,0x3ee900b7,0x3ebe1d4a,0x3e919ddd
.long 0xbdfab273,0xbe72b651,0xbeb263ef,0xbee900b7,0xbf396842,0xbf5064af,0xbf633c5a,0xbf718f57,0xbf7f4e6d,0xbf7eea9d,0xbf778bc5,0xbf696591,0xbf514d3d,0xbf31a81d,0xbf0b9a6b,0xbec1071e
.long 0x3f803f80,0x3f803f80,0x3f803f80,0x3f803f80,0x3f7b3f80,0x3f553f6d,0xbe480000,0xbf0ebec4,0x3f6d3f80,0x3ec43f35,0xbf6dbf80,0xbec4bf35,0x3f553f80,0xbe483ec4,0x3f0e0000,0x3f7b3f6d
.long 0x3f353f80,0xbf350000,0x3f353f80,0xbf350000,0x3f0e3f80,0xbf7bbec4,0xbf550000,0xbe48bf6d,0x3ec43f80,0xbf6dbf35,0xbec4bf80,0x3f6d3f35,0x3e483f80,0xbf0ebf6d,0x3f7b0000,0xbf553ec4
.long 0x3f80,0xbf80,0x3f80,0xbf80,0xbe483f80,0x3f0ebf6d,0xbf7b0000,0x3f553ec4,0xbec43f80,0x3f6dbf35,0x3ec4bf80,0xbf6d3f35,0xbf0e3f80,0x3f7bbec4,0x3f550000,0x3e48bf6d
.long 0xbf353f80,0x3f350000,0xbf353f80,0x3f350000,0xbf553f80,0x3e483ec4,0xbf0e0000,0xbf7b3f6d,0xbf6d3f80,0xbec43f35,0x3f6dbf80,0x3ec4bf35,0xbf7b3f80,0xbf553f6d,0x3e480000,0x3f0ebec4
.long 0xbf803f80,0xbf803f80,0xbf803f80,0xbf803f80,0xbf7b3f80,0xbf553f6d,0x3e480000,0x3f0ebec4,0xbf6d3f80,0xbec43f35,0x3f6dbf80,0x3ec4bf35,0xbf553f80,0x3e483ec4,0xbf0e0000,0xbf7b3f6d
.long 0xbf353f80,0x3f350000,0xbf353f80,0x3f350000,0xbf0e3f80,0x3f7bbec4,0x3f550000,0x3e48bf6d,0xbec43f80,0x3f6dbf35,0x3ec4bf80,0xbf6d3f35,0xbe483f80,0x3f0ebf6d,0xbf7b0000,0x3f553ec4
.long 0x3f80,0xbf80,0x3f80,0xbf80,0x3e483f80,0xbf0ebf6d,0x3f7b0000,0xbf553ec4,0x3ec43f80,0xbf6dbf35,0xbec4bf80,0x3f6d3f35,0x3f0e3f80,0xbf7bbec4,0xbf550000,0xbe48bf6d
.long 0x3f353f80,0xbf350000,0x3f353f80,0xbf350000,0x3f553f80,0xbe483ec4,0x3f0e0000,0x3f7b3f6d,0x3f6d3f80,0x3ec43f35,0xbf6dbf80,0xbec4bf35,0x3f7b3f80,0x3f553f6d,0xbe480000,0xbf0ebec4
.long 0x3f803f80,0x3f803f80,0x3f803f80,0x3f803f80,0x3f0e3f35,0x3e483ec4,0xbf55bf35,0xbf7bbf6d,0xbec40000,0xbf6dbf35,0x3ec40000,0x3f6d3f35,0xbf7bbf35,0xbf0ebf6d,0x3e483f35,0xbf55bec4
.long 0xbf35bf80,0x3f350000,0xbf35bf80,0x3f350000,0x3e48bf35,0x3f553f6d,0x3f7b3f35,0xbf0e3ec4,0x3f6d0000,0xbec43f35,0xbf6d0000,0x3ec4bf35,0x3f553f35,0xbf7bbec4,0x3f0ebf35,0xbe483f6d
.long 0x3f80,0xbf80,0x3f80,0xbf80,0xbf553f35,0x3f7bbec4,0xbf0ebf35,0x3e483f6d,0xbf6d0000,0x3ec43f35,0x3f6d0000,0xbec4bf35,0xbe48bf35,0xbf553f6d,0xbf7b3f35,0x3f0e3ec4
.long 0x3f35bf80,0xbf350000,0x3f35bf80,0xbf350000,0x3f7bbf35,0x3f0ebf6d,0xbe483f35,0x3f55bec4,0x3ec40000,0x3f6dbf35,0xbec40000,0xbf6d3f35,0xbf0e3f35,0xbe483ec4,0x3f55bf35,0x3f7bbf6d
.long 0xbf803f80,0xbf803f80,0xbf803f80,0xbf803f80,0xbf0e3f35,0xbe483ec4,0x3f55bf35,0x3f7bbf6d,0x3ec40000,0x3f6dbf35,0xbec40000,0xbf6d3f35,0x3f7bbf35,0x3f0ebf6d,0xbe483f35,0x3f55bec4
.long 0x3f35bf80,0xbf350000,0x3f35bf80,0xbf350000,0xbe48bf35,0xbf553f6d,0xbf7b3f35,0x3f0e3ec4,0xbf6d0000,0x3ec43f35,0x3f6d0000,0xbec4bf35,0xbf553f35,0x3f7bbec4,0xbf0ebf35,0x3e483f6d
.long 0x3f80,0xbf80,0x3f80,0xbf80,0x3f553f35,0xbf7bbec4,0x3f0ebf35,0xbe483f6d,0x3f6d0000,0xbec43f35,0xbf6d0000,0x3ec4bf35,0x3e48bf35,0x3f553f6d,0x3f7b3f35,0xbf0e3ec4
.long 0xbf35bf80,0x3f350000,0xbf35bf80,0x3f350000,0xbf7bbf35,0xbf0ebf6d,0x3e483f35,0xbf55bec4,0xbec40000,0xbf6dbf35,0x3ec40000,0x3f6d3f35,0x3f0e3f35,0x3e483ec4,0xbf55bf35,0xbf7bbf6d
.long 0x3f803f80,0x3f803f80,0x3f803f80,0x3f803f80,0xbf7bbf80,0xbf55bf6d,0x3e480000,0x3f0e3ec4,0x3f6d3f80,0x3ec43f35,0xbf6dbf80,0xbec4bf35,0xbf55bf80,0x3e48bec4,0xbf0e0000,0xbf7bbf6d
.long 0x3f353f80,0xbf350000,0x3f353f80,0xbf350000,0xbf0ebf80,0x3f7b3ec4,0x3f550000,0x3e483f6d,0x3ec43f80,0xbf6dbf35,0xbec4bf80,0x3f6d3f35,0xbe48bf80,0x3f0e3f6d,0xbf7b0000,0x3f55bec4
.long 0x3f80,0xbf80,0x3f80,0xbf80,0x3e48bf80,0xbf0e3f6d,0x3f7b0000,0xbf55bec4,0xbec43f80,0x3f6dbf35,0x3ec4bf80,0xbf6d3f35,0x3f0ebf80,0xbf7b3ec4,0xbf550000,0xbe483f6d
.long 0xbf353f80,0x3f350000,0xbf353f80,0x3f350000,0x3f55bf80,0xbe48bec4,0x3f0e0000,0x3f7bbf6d,0xbf6d3f80,0xbec43f35,0x3f6dbf80,0x3ec4bf35,0x3f7bbf80,0x3f55bf6d,0xbe480000,0xbf0e3ec4
.long 0xbf803f80,0xbf803f80,0xbf803f80,0xbf803f80,0x3f7bbf80,0x3f55bf6d,0xbe480000,0xbf0e3ec4,0xbf6d3f80,0xbec43f35,0x3f6dbf80,0x3ec4bf35,0x3f55bf80,0xbe48bec4,0x3f0e0000,0x3f7bbf6d
.long 0xbf353f80,0x3f350000,0xbf353f80,0x3f350000,0x3f0ebf80,0xbf7b3ec4,0xbf550000,0xbe483f6d,0xbec43f80,0x3f6dbf35,0x3ec4bf80,0xbf6d3f35,0x3e48bf80,0xbf0e3f6d,0x3f7b0000,0xbf55bec4
.long 0x3f80,0xbf80,0x3f80,0xbf80,0xbe48bf80,0x3f0e3f6d,0xbf7b0000,0x3f55bec4,0x3ec43f80,0xbf6dbf35,0xbec4bf80,0x3f6d3f35,0xbf0ebf80,0x3f7b3ec4,0x3f550000,0x3e483f6d
.long 0x3f353f80,0xbf350000,0x3f353f80,0xbf350000,0xbf55bf80,0x3e48bec4,0xbf0e0000,0xbf7bbf6d,0x3f6d3f80,0x3ec43f35,0xbf6dbf80,0xbec4bf35,0xbf7bbf80,0xbf55bf6d,0x3e480000,0x3f0e3ec4
.long 0x3f803f80,0x3f803f80,0x3f803f80,0x3f803f80,0xbf0ebf35,0xbe48bec4,0x3f553f35,0x3f7b3f6d,0xbec40000,0xbf6dbf35,0x3ec40000,0x3f6d3f35,0x3f7b3f35,0x3f0e3f6d,0xbe48bf35,0x3f553ec4
.long 0xbf35bf80,0x3f350000,0xbf35bf80,0x3f350000,0xbe483f35,0xbf55bf6d,0xbf7bbf35,0x3f0ebec4,0x3f6d0000,0xbec43f35,0xbf6d0000,0x3ec4bf35,0xbf55bf35,0x3f7b3ec4,0xbf0e3f35,0x3e48bf6d
.long 0x3f80,0xbf80,0x3f80,0xbf80,0x3f55bf35,0xbf7b3ec4,0x3f0e3f35,0xbe48bf6d,0xbf6d0000,0x3ec43f35,0x3f6d0000,0xbec4bf35,0x3e483f35,0x3f55bf6d,0x3f7bbf35,0xbf0ebec4
.long 0x3f35bf80,0xbf350000,0x3f35bf80,0xbf350000,0xbf7b3f35,0xbf0e3f6d,0x3e48bf35,0xbf553ec4,0x3ec40000,0x3f6dbf35,0xbec40000,0xbf6d3f35,0x3f0ebf35,0x3e48bec4,0xbf553f35,0xbf7b3f6d
.long 0xbf803f80,0xbf803f80,0xbf803f80,0xbf803f80,0x3f0ebf35,0x3e48bec4,0xbf553f35,0xbf7b3f6d,0x3ec40000,0x3f6dbf35,0xbec40000,0xbf6d3f35,0xbf7b3f35,0xbf0e3f6d,0x3e48bf35,0xbf553ec4
.long 0x3f35bf80,0xbf350000,0x3f35bf80,0xbf350000,0x3e483f35,0x3f55bf6d,0x3f7bbf35,0xbf0ebec4,0xbf6d0000,0x3ec43f35,0x3f6d0000,0xbec4bf35,0x3f55bf35,0xbf7b3ec4,0x3f0e3f35,0xbe48bf6d
.long 0x3f80,0xbf80,0x3f80,0xbf80,0xbf55bf35,0x3f7b3ec4,0xbf0e3f35,0x3e48bf6d,0x3f6d0000,0xbec43f35,0xbf6d0000,0x3ec4bf35,0xbe483f35,0xbf55bf6d,0xbf7bbf35,0x3f0ebec4
.long 0xbf35bf80,0x3f350000,0xbf35bf80,0x3f350000,0x3f7b3f35,0x3f0e3f6d,0xbe48bf35,0x3f553ec4,0xbec40000,0xbf6dbf35,0x3ec40000,0x3f6d3f35,0xbf0ebf35,0xbe48bec4,0x3f553f35,0x3f7b3f6d
.long 0x80008000,0x80008000,0x80008000,0x80008000,0xbe488000,0xbf0ebec4,0xbf7bbf80,0xbf55bf6d,0xbec48000,0xbf6dbf35,0x3ec48000,0x3f6d3f35,0xbf0e8000,0xbf7bbf6d,0x3f553f80,0xbe483ec4
.long 0xbf358000,0xbf35bf80,0xbf358000,0xbf35bf80,0xbf558000,0xbe48bf6d,0xbf0ebf80,0x3f7b3ec4,0xbf6d8000,0x3ec4bf35,0x3f6d8000,0xbec43f35,0xbf7b8000,0x3f55bec4,0x3e483f80,0xbf0ebf6d
.long 0xbf808000,0x3f808000,0xbf808000,0x3f808000,0xbf7b8000,0x3f553ec4,0x3e48bf80,0xbf0e3f6d,0xbf6d8000,0x3ec43f35,0x3f6d8000,0xbec4bf35,0xbf558000,0xbe483f6d,0xbf0e3f80,0x3f7bbec4
.long 0xbf358000,0xbf353f80,0xbf358000,0xbf353f80,0xbf0e8000,0xbf7b3f6d,0x3f55bf80,0xbe48bec4,0xbec48000,0xbf6d3f35,0x3ec48000,0x3f6dbf35,0xbe488000,0xbf0e3ec4,0xbf7b3f80,0xbf553f6d
.long 0x80008000,0x80008000,0x80008000,0x80008000,0x3e488000,0x3f0ebec4,0x3f7bbf80,0x3f55bf6d,0x3ec48000,0x3f6dbf35,0xbec48000,0xbf6d3f35,0x3f0e8000,0x3f7bbf6d,0xbf553f80,0x3e483ec4
.long 0x3f358000,0x3f35bf80,0x3f358000,0x3f35bf80,0x3f558000,0x3e48bf6d,0x3f0ebf80,0xbf7b3ec4,0x3f6d8000,0xbec4bf35,0xbf6d8000,0x3ec43f35,0x3f7b8000,0xbf55bec4,0xbe483f80,0x3f0ebf6d
.long 0x3f808000,0xbf808000,0x3f808000,0xbf808000,0x3f7b8000,0xbf553ec4,0xbe48bf80,0x3f0e3f6d,0x3f6d8000,0xbec43f35,0xbf6d8000,0x3ec4bf35,0x3f558000,0x3e483f6d,0x3f0e3f80,0xbf7bbec4
.long 0x3f358000,0x3f353f80,0x3f358000,0x3f353f80,0x3f0e8000,0x3f7b3f6d,0xbf55bf80,0x3e48bec4,0x3ec48000,0x3f6d3f35,0xbec48000,0xbf6dbf35,0x3e488000,0x3f0e3ec4,0x3f7b3f80,0x3f553f6d
.long 0x80008000,0x80008000,0x80008000,0x80008000,0xbf55bf35,0xbf7bbf6d,0xbf0ebf35,0xbe48bec4,0xbf6dbf80,0xbec4bf35,0x3f6d3f80,0x3ec43f35,0xbe48bf35,0x3f553ec4,0xbf7bbf35,0xbf0ebf6d
.long 0x3f358000,0x3f353f80,0x3f358000,0x3f353f80,0x3f7b3f35,0xbf0e3ec4,0xbe483f35,0xbf55bf6d,0x3ec43f80,0xbf6dbf35,0xbec4bf80,0x3f6d3f35,0xbf0e3f35,0x3e48bf6d,0x3f553f35,0xbf7bbec4
.long 0xbf808000,0x3f808000,0xbf808000,0x3f808000,0xbf0ebf35,0x3e483f6d,0x3f55bf35,0xbf7b3ec4,0x3ec4bf80,0xbf6d3f35,0xbec43f80,0x3f6dbf35,0x3f7bbf35,0xbf0ebec4,0xbe48bf35,0xbf553f6d
.long 0x3f358000,0x3f35bf80,0x3f358000,0x3f35bf80,0xbe483f35,0x3f55bec4,0xbf7b3f35,0xbf0e3f6d,0xbf6d3f80,0xbec43f35,0x3f6dbf80,0x3ec4bf35,0xbf553f35,0xbf7b3f6d,0xbf0e3f35,0xbe483ec4
.long 0x80008000,0x80008000,0x80008000,0x80008000,0x3f55bf35,0x3f7bbf6d,0x3f0ebf35,0x3e48bec4,0x3f6dbf80,0x3ec4bf35,0xbf6d3f80,0xbec43f35,0x3e48bf35,0xbf553ec4,0x3f7bbf35,0x3f0ebf6d
.long 0xbf358000,0xbf353f80,0xbf358000,0xbf353f80,0xbf7b3f35,0x3f0e3ec4,0x3e483f35,0x3f55bf6d,0xbec43f80,0x3f6dbf35,0x3ec4bf80,0xbf6d3f35,0x3f0e3f35,0xbe48bf6d,0xbf553f35,0x3f7bbec4
.long 0x3f808000,0xbf808000,0x3f808000,0xbf808000,0x3f0ebf35,0xbe483f6d,0xbf55bf35,0x3f7b3ec4,0xbec4bf80,0x3f6d3f35,0x3ec43f80,0xbf6dbf35,0xbf7bbf35,0x3f0ebec4,0x3e48bf35,0x3f553f6d
.long 0xbf358000,0xbf35bf80,0xbf358000,0xbf35bf80,0x3e483f35,0xbf55bec4,0x3f7b3f35,0x3f0e3f6d,0x3f6d3f80,0x3ec43f35,0xbf6dbf80,0xbec4bf35,0x3f553f35,0x3f7b3f6d,0x3f0e3f35,0x3e483ec4
.long 0x80008000,0x80008000,0x80008000,0x80008000,0x3e488000,0x3f0e3ec4,0x3f7b3f80,0x3f553f6d,0xbec48000,0xbf6dbf35,0x3ec48000,0x3f6d3f35,0x3f0e8000,0x3f7b3f6d,0xbf55bf80,0x3e48bec4
.long 0xbf358000,0xbf35bf80,0xbf358000,0xbf35bf80,0x3f558000,0x3e483f6d,0x3f0e3f80,0xbf7bbec4,0xbf6d8000,0x3ec4bf35,0x3f6d8000,0xbec43f35,0x3f7b8000,0xbf553ec4,0xbe48bf80,0x3f0e3f6d
.long 0xbf808000,0x3f808000,0xbf808000,0x3f808000,0x3f7b8000,0xbf55bec4,0xbe483f80,0x3f0ebf6d,0xbf6d8000,0x3ec43f35,0x3f6d8000,0xbec4bf35,0x3f558000,0x3e48bf6d,0x3f0ebf80,0xbf7b3ec4
.long 0xbf358000,0xbf353f80,0xbf358000,0xbf353f80,0x3f0e8000,0x3f7bbf6d,0xbf553f80,0x3e483ec4,0xbec48000,0xbf6d3f35,0x3ec48000,0x3f6dbf35,0x3e488000,0x3f0ebec4,0x3f7bbf80,0x3f55bf6d
.long 0x80008000,0x80008000,0x80008000,0x80008000,0xbe488000,0xbf0e3ec4,0xbf7b3f80,0xbf553f6d,0x3ec48000,0x3f6dbf35,0xbec48000,0xbf6d3f35,0xbf0e8000,0xbf7b3f6d,0x3f55bf80,0xbe48bec4
.long 0x3f358000,0x3f35bf80,0x3f358000,0x3f35bf80,0xbf558000,0xbe483f6d,0xbf0e3f80,0x3f7bbec4,0x3f6d8000,0xbec4bf35,0xbf6d8000,0x3ec43f35,0xbf7b8000,0x3f553ec4,0x3e48bf80,0xbf0e3f6d
.long 0x3f808000,0xbf808000,0x3f808000,0xbf808000,0xbf7b8000,0x3f55bec4,0x3e483f80,0xbf0ebf6d,0x3f6d8000,0xbec43f35,0xbf6d8000,0x3ec4bf35,0xbf558000,0xbe48bf6d,0xbf0ebf80,0x3f7b3ec4
.long 0x3f358000,0x3f353f80,0x3f358000,0x3f353f80,0xbf0e8000,0xbf7bbf6d,0x3f553f80,0xbe483ec4,0x3ec48000,0x3f6d3f35,0xbec48000,0xbf6dbf35,0xbe488000,0xbf0ebec4,0xbf7bbf80,0xbf55bf6d
.long 0x80008000,0x80008000,0x80008000,0x80008000,0x3f553f35,0x3f7b3f6d,0x3f0e3f35,0x3e483ec4,0xbf6dbf80,0xbec4bf35,0x3f6d3f80,0x3ec43f35,0x3e483f35,0xbf55bec4,0x3f7b3f35,0x3f0e3f6d
.long 0x3f358000,0x3f353f80,0x3f358000,0x3f353f80,0xbf7bbf35,0x3f0ebec4,0x3e48bf35,0x3f553f6d,0x3ec43f80,0xbf6dbf35,0xbec4bf80,0x3f6d3f35,0x3f0ebf35,0xbe483f6d,0xbf55bf35,0x3f7b3ec4
.long 0xbf808000,0x3f808000,0xbf808000,0x3f808000,0x3f0e3f35,0xbe48bf6d,0xbf553f35,0x3f7bbec4,0x3ec4bf80,0xbf6d3f35,0xbec43f80,0x3f6dbf35,0xbf7b3f35,0x3f0e3ec4,0x3e483f35,0x3f55bf6d
.long 0x3f358000,0x3f35bf80,0x3f358000,0x3f35bf80,0x3e48bf35,0xbf553ec4,0x3f7bbf35,0x3f0ebf6d,0xbf6d3f80,0xbec43f35,0x3f6dbf80,0x3ec4bf35,0x3f55bf35,0x3f7bbf6d,0x3f0ebf35,0x3e48bec4
.long 0x80008000,0x80008000,0x80008000,0x80008000,0xbf553f35,0xbf7b3f6d,0xbf0e3f35,0xbe483ec4,0x3f6dbf80,0x3ec4bf35,0xbf6d3f80,0xbec43f35,0xbe483f35,0x3f55bec4,0xbf7b3f35,0xbf0e3f6d
.long 0xbf358000,0xbf353f80,0xbf358000,0xbf353f80,0x3f7bbf35,0xbf0ebec4,0xbe48bf35,0xbf553f6d,0xbec43f80,0x3f6dbf35,0x3ec4bf80,0xbf6d3f35,0xbf0ebf35,0x3e483f6d,0x3f55bf35,0xbf7b3ec4
.long 0x3f808000,0xbf808000,0x3f808000,0xbf808000,0xbf0e3f35,0x3e48bf6d,0x3f553f35,0xbf7bbec4,0xbec4bf80,0x3f6d3f35,0x3ec43f80,0xbf6dbf35,0x3f7b3f35,0xbf0e3ec4,0xbe483f35,0xbf55bf6d
.long 0xbf358000,0xbf35bf80,0xbf358000,0xbf35bf80,0xbe48bf35,0x3f553ec4,0xbf7bbf35,0xbf0ebf6d,0x3f6d3f80,0x3ec43f35,0xbf6dbf80,0xbec4bf35,0xbf55bf35,0xbf7bbf6d,0xbf0ebf35,0xbe48bec4
.long 0x0,0x0,0x0,0x0,0x3e480000,0x3f0e3ec4,0x3f7b3f80,0x3f553f6d,0x3ec40000,0x3f6d3f35,0xbec40000,0xbf6dbf35,0x3f0e0000,0x3f7b3f6d,0xbf55bf80,0x3e48bec4
.long 0x3f350000,0x3f353f80,0x3f350000,0x3f353f80,0x3f550000,0x3e483f6d,0x3f0e3f80,0xbf7bbec4,0x3f6d0000,0xbec43f35,0xbf6d0000,0x3ec4bf35,0x3f7b0000,0xbf553ec4,0xbe48bf80,0x3f0e3f6d
.long 0x3f800000,0xbf800000,0x3f800000,0xbf800000,0x3f7b0000,0xbf55bec4,0xbe483f80,0x3f0ebf6d,0x3f6d0000,0xbec4bf35,0xbf6d0000,0x3ec43f35,0x3f550000,0x3e48bf6d,0x3f0ebf80,0xbf7b3ec4
.long 0x3f350000,0x3f35bf80,0x3f350000,0x3f35bf80,0x3f0e0000,0x3f7bbf6d,0xbf553f80,0x3e483ec4,0x3ec40000,0x3f6dbf35,0xbec40000,0xbf6d3f35,0x3e480000,0x3f0ebec4,0x3f7bbf80,0x3f55bf6d
.long 0x0,0x0,0x0,0x0,0xbe480000,0xbf0e3ec4,0xbf7b3f80,0xbf553f6d,0xbec40000,0xbf6d3f35,0x3ec40000,0x3f6dbf35,0xbf0e0000,0xbf7b3f6d,0x3f55bf80,0xbe48bec4
.long 0xbf350000,0xbf353f80,0xbf350000,0xbf353f80,0xbf550000,0xbe483f6d,0xbf0e3f80,0x3f7bbec4,0xbf6d0000,0x3ec43f35,0x3f6d0000,0xbec4bf35,0xbf7b0000,0x3f553ec4,0x3e48bf80,0xbf0e3f6d
.long 0xbf800000,0x3f800000,0xbf800000,0x3f800000,0xbf7b0000,0x3f55bec4,0x3e483f80,0xbf0ebf6d,0xbf6d0000,0x3ec4bf35,0x3f6d0000,0xbec43f35,0xbf550000,0xbe48bf6d,0xbf0ebf80,0x3f7b3ec4
.long 0xbf350000,0xbf35bf80,0xbf350000,0xbf35bf80,0xbf0e0000,0xbf7bbf6d,0x3f553f80,0xbe483ec4,0xbec40000,0xbf6dbf35,0x3ec40000,0x3f6d3f35,0xbe480000,0xbf0ebec4,0xbf7bbf80,0xbf55bf6d
.long 0x0,0x0,0x0,0x0,0x3f553f35,0x3f7b3f6d,0x3f0e3f35,0x3e483ec4,0x3f6d3f80,0x3ec43f35,0xbf6dbf80,0xbec4bf35,0x3e483f35,0xbf55bec4,0x3f7b3f35,0x3f0e3f6d
.long 0xbf350000,0xbf35bf80,0xbf350000,0xbf35bf80,0xbf7bbf35,0x3f0ebec4,0x3e48bf35,0x3f553f6d,0xbec4bf80,0x3f6d3f35,0x3ec43f80,0xbf6dbf35,0x3f0ebf35,0xbe483f6d,0xbf55bf35,0x3f7b3ec4
.long 0x3f800000,0xbf800000,0x3f800000,0xbf800000,0x3f0e3f35,0xbe48bf6d,0xbf553f35,0x3f7bbec4,0xbec43f80,0x3f6dbf35,0x3ec4bf80,0xbf6d3f35,0xbf7b3f35,0x3f0e3ec4,0x3e483f35,0x3f55bf6d
.long 0xbf350000,0xbf353f80,0xbf350000,0xbf353f80,0x3e48bf35,0xbf553ec4,0x3f7bbf35,0x3f0ebf6d,0x3f6dbf80,0x3ec4bf35,0xbf6d3f80,0xbec43f35,0x3f55bf35,0x3f7bbf6d,0x3f0ebf35,0x3e48bec4
.long 0x0,0x0,0x0,0x0,0xbf553f35,0xbf7b3f6d,0xbf0e3f35,0xbe483ec4,0xbf6d3f80,0xbec43f35,0x3f6dbf80,0x3ec4bf35,0xbe483f35,0x3f55bec4,0xbf7b3f35,0xbf0e3f6d
.long 0x3f350000,0x3f35bf80,0x3f350000,0x3f35bf80,0x3f7bbf35,0xbf0ebec4,0xbe48bf35,0xbf553f6d,0x3ec4bf80,0xbf6d3f35,0xbec43f80,0x3f6dbf35,0xbf0ebf35,0x3e483f6d,0x3f55bf35,0xbf7b3ec4
.long 0xbf800000,0x3f800000,0xbf800000,0x3f800000,0xbf0e3f35,0x3e48bf6d,0x3f553f35,0xbf7bbec4,0x3ec43f80,0xbf6dbf35,0xbec4bf80,0x3f6d3f35,0x3f7b3f35,0xbf0e3ec4,0xbe483f35,0xbf55bf6d
.long 0x3f350000,0x3f353f80,0x3f350000,0x3f353f80,0xbe48bf35,0x3f553ec4,0xbf7bbf35,0xbf0ebf6d,0xbf6dbf80,0xbec4bf35,0x3f6d3f80,0x3ec43f35,0xbf55bf35,0xbf7bbf6d,0xbf0ebf35,0xbe48bec4
.long 0x0,0x0,0x0,0x0,0xbe480000,0xbf0ebec4,0xbf7bbf80,0xbf55bf6d,0x3ec40000,0x3f6d3f35,0xbec40000,0xbf6dbf35,0xbf0e0000,0xbf7bbf6d,0x3f553f80,0xbe483ec4
.long 0x3f350000,0x3f353f80,0x3f350000,0x3f353f80,0xbf550000,0xbe48bf6d,0xbf0ebf80,0x3f7b3ec4,0x3f6d0000,0xbec43f35,0xbf6d0000,0x3ec4bf35,0xbf7b0000,0x3f55bec4,0x3e483f80,0xbf0ebf6d
.long 0x3f800000,0xbf800000,0x3f800000,0xbf800000,0xbf7b0000,0x3f553ec4,0x3e48bf80,0xbf0e3f6d,0x3f6d0000,0xbec4bf35,0xbf6d0000,0x3ec43f35,0xbf550000,0xbe483f6d,0xbf0e3f80,0x3f7bbec4
.long 0x3f350000,0x3f35bf80,0x3f350000,0x3f35bf80,0xbf0e0000,0xbf7b3f6d,0x3f55bf80,0xbe48bec4,0x3ec40000,0x3f6dbf35,0xbec40000,0xbf6d3f35,0xbe480000,0xbf0e3ec4,0xbf7b3f80,0xbf553f6d
.long 0x0,0x0,0x0,0x0,0x3e480000,0x3f0ebec4,0x3f7bbf80,0x3f55bf6d,0xbec40000,0xbf6d3f35,0x3ec40000,0x3f6dbf35,0x3f0e0000,0x3f7bbf6d,0xbf553f80,0x3e483ec4
.long 0xbf350000,0xbf353f80,0xbf350000,0xbf353f80,0x3f550000,0x3e48bf6d,0x3f0ebf80,0xbf7b3ec4,0xbf6d0000,0x3ec43f35,0x3f6d0000,0xbec4bf35,0x3f7b0000,0xbf55bec4,0xbe483f80,0x3f0ebf6d
.long 0xbf800000,0x3f800000,0xbf800000,0x3f800000,0x3f7b0000,0xbf553ec4,0xbe48bf80,0x3f0e3f6d,0xbf6d0000,0x3ec4bf35,0x3f6d0000,0xbec43f35,0x3f550000,0x3e483f6d,0x3f0e3f80,0xbf7bbec4
.long 0xbf350000,0xbf35bf80,0xbf350000,0xbf35bf80,0x3f0e0000,0x3f7b3f6d,0xbf55bf80,0x3e48bec4,0xbec40000,0xbf6dbf35,0x3ec40000,0x3f6d3f35,0x3e480000,0x3f0e3ec4,0x3f7b3f80,0x3f553f6d
.long 0x0,0x0,0x0,0x0,0xbf55bf35,0xbf7bbf6d,0xbf0ebf35,0xbe48bec4,0x3f6d3f80,0x3ec43f35,0xbf6dbf80,0xbec4bf35,0xbe48bf35,0x3f553ec4,0xbf7bbf35,0xbf0ebf6d
.long 0xbf350000,0xbf35bf80,0xbf350000,0xbf35bf80,0x3f7b3f35,0xbf0e3ec4,0xbe483f35,0xbf55bf6d,0xbec4bf80,0x3f6d3f35,0x3ec43f80,0xbf6dbf35,0xbf0e3f35,0x3e48bf6d,0x3f553f35,0xbf7bbec4
.long 0x3f800000,0xbf800000,0x3f800000,0xbf800000,0xbf0ebf35,0x3e483f6d,0x3f55bf35,0xbf7b3ec4,0xbec43f80,0x3f6dbf35,0x3ec4bf80,0xbf6d3f35,0x3f7bbf35,0xbf0ebec4,0xbe48bf35,0xbf553f6d
.long 0xbf350000,0xbf353f80,0xbf350000,0xbf353f80,0xbe483f35,0x3f55bec4,0xbf7b3f35,0xbf0e3f6d,0x3f6dbf80,0x3ec4bf35,0xbf6d3f80,0xbec43f35,0xbf553f35,0xbf7b3f6d,0xbf0e3f35,0xbe483ec4
.long 0x0,0x0,0x0,0x0,0x3f55bf35,0x3f7bbf6d,0x3f0ebf35,0x3e48bec4,0xbf6d3f80,0xbec43f35,0x3f6dbf80,0x3ec4bf35,0x3e48bf35,0xbf553ec4,0x3f7bbf35,0x3f0ebf6d
.long 0x3f350000,0x3f35bf80,0x3f350000,0x3f35bf80,0xbf7b3f35,0x3f0e3ec4,0x3e483f35,0x3f55bf6d,0x3ec4bf80,0xbf6d3f35,0xbec43f80,0x3f6dbf35,0x3f0e3f35,0xbe48bf6d,0xbf553f35,0x3f7bbec4
.long 0xbf800000,0x3f800000,0xbf800000,0x3f800000,0x3f0ebf35,0xbe483f6d,0xbf55bf35,0x3f7b3ec4,0x3ec43f80,0xbf6dbf35,0xbec4bf80,0x3f6d3f35,0xbf7bbf35,0x3f0ebec4,0x3e48bf35,0x3f553f6d
.long 0x3f350000,0x3f353f80,0x3f350000,0x3f353f80,0x3e483f35,0xbf55bec4,0x3f7b3f35,0x3f0e3f6d,0xbf6dbf80,0xbec4bf35,0x3f6d3f80,0x3ec43f35,0x3f553f35,0x3f7b3f6d,0x3f0e3f35,0x3e483ec4
.long 0x3f800000,0x3f800000,0x3f800000,0x3f800000,0x3f800000,0x3f7ffec4,0x3f7ffb11,0x3f7ff4e6,0x3f800000,0x3f7ffb11,0x3f7fec43,0x3f7fd397,0x3f800000,0x3f7ff4e6,0x3f7fd397,0x3f7f9c18
.long 0x3f800000,0x3f7fec43,0x3f7fb10f,0x3f7f4e6d,0x3f800000,0x3f7fe129,0x3f7f84ab,0x3f7eea9d,0x3f800000,0x3f7fd397,0x3f7f4e6d,0x3f7e70b0,0x3f800000,0x3f7fc38f,0x3f7f0e58,0x3f7de0b1
.long 0x3f800000,0x3f7fb10f,0x3f7ec46d,0x3f7d3aac,0x3f800000,0x3f7f9c18,0x3f7e70b0,0x3f7c7eb0,0x3f800000,0x3f7f84ab,0x3f7e1324,0x3f7baccd,0x3f800000,0x3f7f6ac7,0x3f7dabcc,0x3f7ac516
.long 0x3f800000,0x3f7f4e6d,0x3f7d3aac,0x3f79c79d,0x3f800000,0x3f7f2f9d,0x3f7cbfc9,0x3f78b47b,0x3f800000,0x3f7f0e58,0x3f7c3b28,0x3f778bc5,0x3f800000,0x3f7eea9d,0x3f7baccd,0x3f764d97
.long 0x3f800000,0x3f7ec46d,0x3f7b14be,0x3f74fa0b,0x3f800000,0x3f7e9bc9,0x3f7a7302,0x3f73913f,0x3f800000,0x3f7e70b0,0x3f79c79d,0x3f721352,0x3f800000,0x3f7e4323,0x3f791298,0x3f708066
.long 0x3f800000,0x3f7e1324,0x3f7853f8,0x3f6ed89e,0x3f800000,0x3f7de0b1,0x3f778bc5,0x3f6d1c1d,0x3f800000,0x3f7dabcc,0x3f76ba07,0x3f6b4b0c,0x3f800000,0x3f7d7474,0x3f75dec6,0x3f696591
.long 0x3f800000,0x3f7d3aac,0x3f74fa0b,0x3f676bd8,0x3f800000,0x3f7cfe73,0x3f740bdd,0x3f655e0b,0x3f800000,0x3f7cbfc9,0x3f731447,0x3f633c5a,0x3f800000,0x3f7c7eb0,0x3f721352,0x3f6106f2
.long 0x3f800000,0x3f7c3b28,0x3f710908,0x3f5ebe05,0x3f800000,0x3f7bf531,0x3f6ff573,0x3f5c61c7,0x3f800000,0x3f7baccd,0x3f6ed89e,0x3f59f26a,0x3f800000,0x3f7b61fc,0x3f6db293,0x3f577026
.long 0x3f800000,0x3f800000,0x3f800000,0x3f800000,0x3f7fec43,0x3f7fe129,0x3f7fd397,0x3f7fc38f,0x3f7fb10f,0x3f7f84ab,0x3f7f4e6d,0x3f7f0e58,0x3f7f4e6d,0x3f7eea9d,0x3f7e70b0,0x3f7de0b1
.long 0x3f7ec46d,0x3f7e1324,0x3f7d3aac,0x3f7c3b28,0x3f7e1324,0x3f7cfe73,0x3f7baccd,0x3f7a1e84,0x3f7d3aac,0x3f7baccd,0x3f79c79d,0x3f778bc5,0x3f7c3b28,0x3f7a1e84,0x3f778bc5,0x3f748422
.long 0x3f7b14be,0x3f7853f8,0x3f74fa0b,0x3f710908,0x3f79c79d,0x3f764d97,0x3f721352,0x3f6d1c1d,0x3f7853f8,0x3f740bdd,0x3f6ed89e,0x3f68bf3c,0x3f76ba07,0x3f718f57,0x3f6b4b0c,0x3f63f473
.long 0x3f74fa0b,0x3f6ed89e,0x3f676bd8,0x3f5ebe05,0x3f731447,0x3f6be858,0x3f633c5a,0x3f591e6a,0x3f710908,0x3f68bf3c,0x3f5ebe05,0x3f531849,0x3f6ed89e,0x3f655e0b,0x3f59f26a,0x3f4cae79
.long 0x3f6c835e,0x3f61c598,0x3f54db31,0x3f45e403,0x3f6a09a7,0x3f5df6be,0x3f4f7a1f,0x3f3ebc1b,0x3f676bd8,0x3f59f26a,0x3f49d112,0x3f373a23,0x3f64aa59,0x3f55b993,0x3f43e200,0x3f2f61a5
.long 0x3f61c598,0x3f514d3d,0x3f3daef9,0x3f273656,0x3f5ebe05,0x3f4cae79,0x3f373a23,0x3f1ebc12,0x3f5b941a,0x3f47de65,0x3f3085bb,0x3f15f6d9,0x3f584853,0x3f42de29,0x3f299415,0x3f0cead0
.long 0x3f54db31,0x3f3daef9,0x3f226799,0x3f039c3d,0x3f514d3d,0x3f385216,0x3f1b02c6,0x3ef41f07,0x3f4d9f02,0x3f32c8c9,0x3f13682a,0x3ee0924f,0x3f49d112,0x3f2d1469,0x3f0b9a6b,0x3ecc9b8b
.long 0x3f45e403,0x3f273656,0x3f039c3d,0x3eb8442a,0x3f41d870,0x3f212ff9,0x3ef6e0cb,0x3ea395c5,0x3f3daef9,0x3f1b02c6,0x3ee63375,0x3e8e9a22,0x3f396842,0x3f14b039,0x3ed53641,0x3e72b651
.long 0x3f800000,0x3f800000,0x3f800000,0x3f800000,0x3f7fb10f,0x3f7f9c18,0x3f7f84ab,0x3f7f6ac7,0x3f7ec46d,0x3f7e70b0,0x3f7e1324,0x3f7dabcc,0x3f7d3aac,0x3f7c7eb0,0x3f7baccd,0x3f7ac516
.long 0x3f7b14be,0x3f79c79d,0x3f7853f8,0x3f76ba07,0x3f7853f8,0x3f764d97,0x3f740bdd,0x3f718f57,0x3f74fa0b,0x3f721352,0x3f6ed89e,0x3f6b4b0c,0x3f710908,0x3f6d1c1d,0x3f68bf3c,0x3f63f473
.long 0x3f6c835e,0x3f676bd8,0x3f61c598,0x3f5b941a,0x3f676bd8,0x3f6106f2,0x3f59f26a,0x3f5233c6,0x3f61c598,0x3f59f26a,0x3f514d3d,0x3f47de65,0x3f5b941a,0x3f5233c6,0x3f47de65,0x3f3ca003
.long 0x3f54db31,0x3f49d112,0x3f3daef9,0x3f3085bb,0x3f4d9f02,0x3f40d0da,0x3f32c8c9,0x3f239da9,0x3f45e403,0x3f373a23,0x3f273656,0x3f15f6d9,0x3f3daef9,0x3f2d1469,0x3f1b02c6,0x3f07a136
.long 0x3f3504f3,0x3f226799,0x3f0e39da,0x3ef15aea,0x3f2beb4a,0x3f173c07,0x3f00e7e4,0x3ed25a09,0x3f226799,0x3f0b9a6b,0x3ee63375,0x3eb263ef,0x3f187fc0,0x3eff17b2,0x3ec9b953,0x3e919ddd
.long 0x3f0e39da,0x3ee63375,0x3eac7cd4,0x3e605c13,0x3f039c3d,0x3ecc9b8b,0x3e8e9a22,0x3e1c76de,0x3ef15aea,0x3eb263ef,0x3e605c13,0x3dafb680,0x3edae880,0x3e97a117,0x3e22abb6,0x3c96c9b6
.long 0x3ec3ef15,0x3e78cfcc,0x3dc8bd36,0xbd48fb30,0x3eac7cd4,0x3e419b37,0x3d16c32c,0xbdee3876,0x3e94a031,0x3e09cf86,0xbcc90ab0,0xbe3b6ecf,0x3e78cfcc,0x3da3308c,0xbdafb680,0xbe7ee6e1
.long 0x3e47c5c2,0x3cc90ab0,0xbe164083,0xbea09ae5,0x3e164083,0xbcfb49ba,0xbe541501,0xbec1071e,0x3dc8bd36,0xbdafb680,0xbe888e93,0xbee0924f,0x3d48fb30,0xbe1008b7,0xbea68f12,0xbeff17b2
.long 0x3f800000,0x3f800000,0x3f800000,0x3f800000,0x3f7f4e6d,0x3f7f2f9d,0x3f7f0e58,0x3f7eea9d,0x3f7d3aac,0x3f7cbfc9,0x3f7c3b28,0x3f7baccd,0x3f79c79d,0x3f78b47b,0x3f778bc5,0x3f764d97
.long 0x3f74fa0b,0x3f731447,0x3f710908,0x3f6ed89e,0x3f6ed89e,0x3f6be858,0x3f68bf3c,0x3f655e0b,0x3f676bd8,0x3f633c5a,0x3f5ebe05,0x3f59f26a,0x3f5ebe05,0x3f591e6a,0x3f531849,0x3f4cae79
.long 0x3f54db31,0x3f4d9f02,0x3f45e403,0x3f3daef9,0x3f49d112,0x3f40d0da,0x3f373a23,0x3f2d1469,0x3f3daef9,0x3f32c8c9,0x3f273656,0x3f1b02c6,0x3f3085bb,0x3f239da9,0x3f15f6d9,0x3f07a136
.long 0x3f226799,0x3f13682a,0x3f039c3d,0x3ee63375,0x3f13682a,0x3f0242b1,0x3ee0924f,0x3ebb31a0,0x3f039c3d,0x3ee0924f,0x3eb8442a,0x3e8e9a22,0x3ee63375,0x3ebb31a0,0x3e8e9a22,0x3e419b37
.long 0x3ec3ef15,0x3e94a031,0x3e47c5c2,0x3dc8bd36,0x3ea09ae5,0x3e5a3997,0x3de1bc2e,0x3bc90f88,0x3e78cfcc,0x3e09cf86,0x3cc90ab0,0xbdafb680,0x3e2f10a2,0x3d621469,0xbd7b2b74,0xbe354098
.long 0x3dc8bd36,0xbcc90ab0,0xbe164083,0xbe888e93,0x3cc90ab0,0xbdd53db9,0xbe6c9a7f,0xbeb554ec,0xbd48fb30,0xbe3b6ecf,0xbea09ae5,0xbee0924f,0xbdfab273,0xbe8586ce,0xbec9b953,0xbf04f484
.long 0xbe47c5c2,0xbeac7cd4,0xbef15aea,0xbf187fc0,0xbe888e93,0xbed25a09,0xbf0b9a6b,0xbf2ac082,0xbeac7cd4,0xbef6e0cb,0xbf1d7fd1,0xbf3b8f3b,0xbecf7bca,0xbf0cead0,0xbf2e3bde,0xbf4ac77f
.long 0xbef15aea,0xbf1d7fd1,0xbf3daef9,0xbf584853,0xbf08f59b,0xbf2d1469,0xbf4bbbf8,0xbf63f473,0xbf187fc0,0xbf3b8f3b,0xbf584853,0xbf6db293,0xbf273656,0xbf48d8b3,0xbf633c5a,0xbf756d97
.long 0x3f800000,0x3f800000,0x3f800000,0x3f800000,0x3f7ec46d,0x3f7e9bc9,0x3f7e70b0,0x3f7e4323,0x3f7b14be,0x3f7a7302,0x3f79c79d,0x3f791298,0x3f74fa0b,0x3f73913f,0x3f721352,0x3f708066
.long 0x3f6c835e,0x3f6a09a7,0x3f676bd8,0x3f64aa59,0x3f61c598,0x3f5df6be,0x3f59f26a,0x3f55b993,0x3f54db31,0x3f4f7a1f,0x3f49d112,0x3f43e200,0x3f45e403,0x3f3ebc1b,0x3f373a23,0x3f2f61a5
.long 0x3f3504f3,0x3f2beb4a,0x3f226799,0x3f187fc0,0x3f226799,0x3f173c07,0x3f0b9a6b,0x3eff17b2,0x3f0e39da,0x3f00e7e4,0x3ee63375,0x3ec9b953,0x3ef15aea,0x3ed25a09,0x3eb263ef,0x3e919ddd
.long 0x3ec3ef15,0x3ea09ae5,0x3e78cfcc,0x3e2f10a2,0x3e94a031,0x3e5a3997,0x3e09cf86,0x3d621469,0x3e47c5c2,0x3de1bc2e,0x3cc90ab0,0xbd7b2b74,0x3dc8bd36,0x3bc90f88,0xbdafb680,0xbe354098
.long 0x0,0xbdc8bd36,0xbe47c5c2,0xbe94a031,0xbdc8bd36,0xbe4dee60,0xbe9aa086,0xbecc9b8b,0xbe47c5c2,0xbe9aa086,0xbecf7bca,0xbf00e7e4,0xbe94a031,0xbecc9b8b,0xbf00e7e4,0xbf19c200
.long 0xbec3ef15,0xbefc5d27,0xbf187fc0,0xbf3085bb,0xbef15aea,0xbf14b039,0xbf2e3bde,0xbf44e3f5,0xbf0e39da,0xbf299415,0xbf41d870,0xbf5695e5,0xbf226799,0xbf3ca003,0xbf531849,0xbf655e0b
.long 0xbf3504f3,0xbf4d9f02,0xbf61c598,0xbf710908,0xbf45e403,0xbf5c61c7,0xbf6db293,0xbf796e4e,0xbf54db31,0xbf68bf3c,0xbf76ba07,0xbf7e70b0,0xbf61c598,0xbf7294f8,0xbf7cbfc9,0xbf7ffec4
.long 0xbf6c835e,0xbf79c79d,0xbf7fb10f,0xbf7e1324,0xbf74fa0b,0xbf7e4323,0xbf7f84ab,0xbf78b47b,0xbf7b14be,0xbf7ffb11,0xbf7c3b28,0xbf6ff573,0xbf7ec46d,0xbf7eea9d,0xbf75dec6,0xbf63f473
.long 0x3f800000,0x3f800000,0x3f800000,0x3f800000,0x3f7e1324,0x3f7de0b1,0x3f7dabcc,0x3f7d7474,0x3f7853f8,0x3f778bc5,0x3f76ba07,0x3f75dec6,0x3f6ed89e,0x3f6d1c1d,0x3f6b4b0c,0x3f696591
.long 0x3f61c598,0x3f5ebe05,0x3f5b941a,0x3f584853,0x3f514d3d,0x3f4cae79,0x3f47de65,0x3f42de29,0x3f3daef9,0x3f373a23,0x3f3085bb,0x3f299415,0x3f273656,0x3f1ebc12,0x3f15f6d9,0x3f0cead0
.long 0x3f0e39da,0x3f039c3d,0x3ef15aea,0x3edae880,0x3ee63375,0x3ecc9b8b,0x3eb263ef,0x3e97a117,0x3eac7cd4,0x3e8e9a22,0x3e605c13,0x3e22abb6,0x3e605c13,0x3e1c76de,0x3dafb680,0x3c96c9b6
.long 0x3dc8bd36,0x3cc90ab0,0xbd48fb30,0xbdfab273,0xbcc90ab0,0xbdd53db9,0xbe3b6ecf,0xbe8586ce,0xbe164083,0xbe6c9a7f,0xbea09ae5,0xbec9b953,0xbe888e93,0xbeb554ec,0xbee0924f,0xbf04f484
.long 0xbec3ef15,0xbef15aea,0xbf0e39da,0xbf226799,0xbefc5d27,0xbf14b039,0xbf299415,0xbf3ca003,0xbf187fc0,0xbf2e3bde,0xbf41d870,0xbf531849,0xbf3085bb,0xbf44e3f5,0xbf5695e5,0xbf655e0b
.long 0xbf45e403,0xbf584853,0xbf676bd8,0xbf731447,0xbf584853,0xbf6816a8,0xbf740bdd,0xbf7bf531,0xbf676bd8,0xbf740bdd,0xbf7c3b28,0xbf7fd397,0xbf731447,0xbf7bf531,0xbf7fd397,0xbf7e9bc9
.long 0xbf7b14be,0xbf7fb10f,0xbf7ec46d,0xbf7853f8,0xbf7f4e6d,0xbf7f2f9d,0xbf791298,0xbf6d1c1d,0xbf7fb10f,0xbf7a7302,0xbf6ed89e,0xbf5d2d53,0xbf7c3b28,0xbf718f57,0xbf604621,0xbf48d8b3
.long 0xbf74fa0b,0xbf64aa59,0xbf4d9f02,0xbf3085bb,0xbf6a09a7,0xbf53fac3,0xbf373a23,0xbf14b039,0xbf5b941a,0xbf3fc767,0xbf1d7fd1,0xbeebcbbb,0xbf49d112,0xbf286605,0xbf00e7e4,0xbea986c4
.long 0x3f800000,0x3f800000,0x3f800000,0x3f800000,0x3f7d3aac,0x3f7cfe73,0x3f7cbfc9,0x3f7c7eb0,0x3f74fa0b,0x3f740bdd,0x3f731447,0x3f721352,0x3f676bd8,0x3f655e0b,0x3f633c5a,0x3f6106f2
.long 0x3f54db31,0x3f514d3d,0x3f4d9f02,0x3f49d112,0x3f3daef9,0x3f385216,0x3f32c8c9,0x3f2d1469,0x3f226799,0x3f1b02c6,0x3f13682a,0x3f0b9a6b,0x3f039c3d,0x3ef41f07,0x3ee0924f,0x3ecc9b8b
.long 0x3ec3ef15,0x3eac7cd4,0x3e94a031,0x3e78cfcc,0x3e78cfcc,0x3e419b37,0x3e09cf86,0x3da3308c,0x3dc8bd36,0x3d16c32c,0xbcc90ab0,0xbdafb680,0xbd48fb30,0xbdee3876,0xbe3b6ecf,0xbe7ee6e1
.long 0xbe47c5c2,0xbe888e93,0xbeac7cd4,0xbecf7bca,0xbeac7cd4,0xbed25a09,0xbef6e0cb,0xbf0cead0,0xbef15aea,0xbf0b9a6b,0xbf1d7fd1,0xbf2e3bde,0xbf187fc0,0xbf2ac082,0xbf3b8f3b,0xbf4ac77f
.long 0xbf3504f3,0xbf45e403,0xbf54db31,0xbf61c598,0xbf4d9f02,0xbf5c61c7,0xbf68bf3c,0xbf7294f8,0xbf61c598,0xbf6db293,0xbf76ba07,0xbf7cbfc9,0xbf710908,0xbf796e4e,0xbf7e70b0,0xbf7ffec4
.long 0xbf7b14be,0xbf7f4e6d,0xbf7fb10f,0xbf7c3b28,0xbf7fb10f,0xbf7f2f9d,0xbf7a7302,0xbf718f57,0xbf7ec46d,0xbf791298,0xbf6ed89e,0xbf604621,0xbf7853f8,0xbf6d1c1d,0xbf5d2d53,0xbf48d8b3
.long 0xbf6c835e,0xbf5b941a,0xbf45e403,0xbf2beb4a,0xbf5b941a,0xbf44e3f5,0xbf299415,0xbf0a48ad,0xbf45e403,0xbf299415,0xbf08f59b,0xbec9b953,0xbf2beb4a,0xbf0a48ad,0xbec9b953,0xbe72b651
.long 0xbf0e39da,0xbecf7bca,0xbe78cfcc,0xbd96a905,0xbedae880,0xbe8586ce,0xbdafb680,0x3dbc3ac3,0xbe94a031,0xbde1bc2e,0x3d96a905,0x3e827dc0,0xbe164083,0x3d2fe007,0x3e6c9a7f,0x3ed25a09
.long 0x3f800000,0x3f800000,0x3f800000,0x3f800000,0x3f7c3b28,0x3f7bf531,0x3f7baccd,0x3f7b61fc,0x3f710908,0x3f6ff573,0x3f6ed89e,0x3f6db293,0x3f5ebe05,0x3f5c61c7,0x3f59f26a,0x3f577026
.long 0x3f45e403,0x3f41d870,0x3f3daef9,0x3f396842,0x3f273656,0x3f212ff9,0x3f1b02c6,0x3f14b039,0x3f039c3d,0x3ef6e0cb,0x3ee63375,0x3ed53641,0x3eb8442a,0x3ea395c5,0x3e8e9a22,0x3e72b651
.long 0x3e47c5c2,0x3e164083,0x3dc8bd36,0x3d48fb30,0x3cc90ab0,0xbcfb49ba,0xbdafb680,0xbe1008b7,0xbe164083,0xbe541501,0xbe888e93,0xbea68f12,0xbea09ae5,0xbec1071e,0xbee0924f,0xbeff17b2
.long 0xbef15aea,0xbf08f59b,0xbf187fc0,0xbf273656,0xbf1d7fd1,0xbf2d1469,0xbf3b8f3b,0xbf48d8b3,0xbf3daef9,0xbf4bbbf8,0xbf584853,0xbf633c5a,0xbf584853,0xbf63f473,0xbf6db293,0xbf756d97
.long 0xbf6c835e,0xbf74fa0b,0xbf7b14be,0xbf7ec46d,0xbf79c79d,0xbf7e4323,0xbf7ffb11,0xbf7eea9d,0xbf7fb10f,0xbf7f84ab,0xbf7c3b28,0xbf75dec6,0xbf7e1324,0xbf78b47b,0xbf6ff573,0xbf63f473
.long 0xbf74fa0b,0xbf6a09a7,0xbf5b941a,0xbf49d112,0xbf64aa59,0xbf53fac3,0xbf3fc767,0xbf286605,0xbf4d9f02,0xbf373a23,0xbf1d7fd1,0xbf00e7e4,0xbf3085bb,0xbf14b039,0xbeebcbbb,0xbea986c4
.long 0xbf0e39da,0xbedae880,0xbe94a031,0xbe164083,0xbecf7bca,0xbe8586ce,0xbde1bc2e,0x3d2fe007,0xbe78cfcc,0xbdafb680,0x3d96a905,0x3e6c9a7f,0xbd96a905,0x3dbc3ac3,0x3e827dc0,0x3ed25a09
.long 0x3dc8bd36,0x3e888e93,0x3edae880,0x3f13682a,0x3e888e93,0x3eddbe79,0x3f15f6d9,0x3f385216,0x3edae880,0x3f15f6d9,0x3f396842,0x3f5695e5,0x3f13682a,0x3f385216,0x3f5695e5,0x3f6d1c1d
.long 0x0,0x0,0x0,0x0,0x0,0x3bc90f88,0x3c490e90,0x3c96c9b6,0x0,0x3c490e90,0x3cc90ab0,0x3d16c32c,0x0,0x3c96c9b6,0x3d16c32c,0x3d621469
.long 0x0,0x3cc90ab0,0x3d48fb30,0x3d96a905,0x0,0x3cfb49ba,0x3d7b2b74,0x3dbc3ac3,0x0,0x3d16c32c,0x3d96a905,0x3de1bc2e,0x0,0x3d2fe007,0x3dafb680,0x3e039502
.long 0x0,0x3d48fb30,0x3dc8bd36,0x3e164083,0x0,0x3d621469,0x3de1bc2e,0x3e28defc,0x0,0x3d7b2b74,0x3dfab273,0x3e3b6ecf,0x0,0x3d8a200a,0x3e09cf86,0x3e4dee60
.long 0x0,0x3d96a905,0x3e164083,0x3e605c13,0x0,0x3da3308c,0x3e22abb6,0x3e72b651,0x0,0x3dafb680,0x3e2f10a2,0x3e827dc0,0x0,0x3dbc3ac3,0x3e3b6ecf,0x3e8b9507
.long 0x0,0x3dc8bd36,0x3e47c5c2,0x3e94a031,0x0,0x3dd53db9,0x3e541501,0x3e9d9e78,0x0,0x3de1bc2e,0x3e605c13,0x3ea68f12,0x0,0x3dee3876,0x3e6c9a7f,0x3eaf713a
.long 0x0,0x3dfab273,0x3e78cfcc,0x3eb8442a,0x0,0x3e039502,0x3e827dc0,0x3ec1071e,0x0,0x3e09cf86,0x3e888e93,0x3ec9b953,0x0,0x3e1008b7,0x3e8e9a22,0x3ed25a09
.long 0x0,0x3e164083,0x3e94a031,0x3edae880,0x0,0x3e1c76de,0x3e9aa086,0x3ee363fa,0x0,0x3e22abb6,0x3ea09ae5,0x3eebcbbb,0x0,0x3e28defc,0x3ea68f12,0x3ef41f07
.long 0x0,0x3e2f10a2,0x3eac7cd4,0x3efc5d27,0x0,0x3e354098,0x3eb263ef,0x3f0242b1,0x0,0x3e3b6ecf,0x3eb8442a,0x3f064b82,0x0,0x3e419b37,0x3ebe1d4a,0x3f0a48ad
.long 0x0,0x0,0x0,0x0,0x3cc90ab0,0x3cfb49ba,0x3d16c32c,0x3d2fe007,0x3d48fb30,0x3d7b2b74,0x3d96a905,0x3dafb680,0x3d96a905,0x3dbc3ac3,0x3de1bc2e,0x3e039502
.long 0x3dc8bd36,0x3dfab273,0x3e164083,0x3e2f10a2,0x3dfab273,0x3e1c76de,0x3e3b6ecf,0x3e5a3997,0x3e164083,0x3e3b6ecf,0x3e605c13,0x3e827dc0,0x3e2f10a2,0x3e5a3997,0x3e827dc0,0x3e97a117
.long 0x3e47c5c2,0x3e78cfcc,0x3e94a031,0x3eac7cd4,0x3e605c13,0x3e8b9507,0x3ea68f12,0x3ec1071e,0x3e78cfcc,0x3e9aa086,0x3eb8442a,0x3ed53641,0x3e888e93,0x3ea986c4,0x3ec9b953,0x3ee900b7
.long 0x3e94a031,0x3eb8442a,0x3edae880,0x3efc5d27,0x3ea09ae5,0x3ec6d529,0x3eebcbbb,0x3f07a136,0x3eac7cd4,0x3ed53641,0x3efc5d27,0x3f10d3cd,0x3eb8442a,0x3ee363fa,0x3f064b82,0x3f19c200
.long 0x3ec3ef15,0x3ef15aea,0x3f0e39da,0x3f226799,0x3ecf7bca,0x3eff17b2,0x3f15f6d9,0x3f2ac082,0x3edae880,0x3f064b82,0x3f1d7fd1,0x3f32c8c9,0x3ee63375,0x3f0cead0,0x3f24d225,0x3f3a7ca4
.long 0x3ef15aea,0x3f13682a,0x3f2beb4a,0x3f41d870,0x3efc5d27,0x3f19c200,0x3f32c8c9,0x3f48d8b3,0x3f039c3d,0x3f1ff6cb,0x3f396842,0x3f4f7a1f,0x3f08f59b,0x3f26050a,0x3f3fc767,0x3f55b993
.long 0x3f0e39da,0x3f2beb4a,0x3f45e403,0x3f5b941a,0x3f13682a,0x3f31a81d,0x3f4bbbf8,0x3f6106f2,0x3f187fc0,0x3f373a23,0x3f514d3d,0x3f660f88,0x3f1d7fd1,0x3f3ca003,0x3f5695e5,0x3f6aab7b
.long 0x3f226799,0x3f41d870,0x3f5b941a,0x3f6ed89e,0x3f273656,0x3f46e22a,0x3f604621,0x3f7294f8,0x3f2beb4a,0x3f4bbbf8,0x3f64aa59,0x3f75dec6,0x3f3085bb,0x3f5064af,0x3f68bf3c,0x3f78b47b
.long 0x0,0x0,0x0,0x0,0x3d48fb30,0x3d621469,0x3d7b2b74,0x3d8a200a,0x3dc8bd36,0x3de1bc2e,0x3dfab273,0x3e09cf86,0x3e164083,0x3e28defc,0x3e3b6ecf,0x3e4dee60
.long 0x3e47c5c2,0x3e605c13,0x3e78cfcc,0x3e888e93,0x3e78cfcc,0x3e8b9507,0x3e9aa086,0x3ea986c4,0x3e94a031,0x3ea68f12,0x3eb8442a,0x3ec9b953,0x3eac7cd4,0x3ec1071e,0x3ed53641,0x3ee900b7
.long 0x3ec3ef15,0x3edae880,0x3ef15aea,0x3f039c3d,0x3edae880,0x3ef41f07,0x3f064b82,0x3f121eb0,0x3ef15aea,0x3f064b82,0x3f13682a,0x3f1ff6cb,0x3f039c3d,0x3f121eb0,0x3f1ff6cb,0x3f2d1469
.long 0x3f0e39da,0x3f1d7fd1,0x3f2beb4a,0x3f396842,0x3f187fc0,0x3f286605,0x3f373a23,0x3f44e3f5,0x3f226799,0x3f32c8c9,0x3f41d870,0x3f4f7a1f,0x3f2beb4a,0x3f3ca003,0x3f4bbbf8,0x3f591e6a
.long 0x3f3504f3,0x3f45e403,0x3f54db31,0x3f61c598,0x3f3daef9,0x3f4e8d90,0x3f5d2d53,0x3f696591,0x3f45e403,0x3f5695e5,0x3f64aa59,0x3f6ff573,0x3f4d9f02,0x3f5df6be,0x3f6b4b0c,0x3f756d97
.long 0x3f54db31,0x3f64aa59,0x3f710908,0x3f79c79d,0x3f5b941a,0x3f6aab7b,0x3f75dec6,0x3f7cfe73,0x3f61c598,0x3f6ff573,0x3f79c79d,0x3f7f0e58,0x3f676bd8,0x3f748422,0x3f7cbfc9,0x3f7ff4e6
.long 0x3f6c835e,0x3f7853f8,0x3f7ec46d,0x3f7fb10f,0x3f710908,0x3f7b61fc,0x3f7fd397,0x3f7e4323,0x3f74fa0b,0x3f7dabcc,0x3f7fec43,0x3f7baccd,0x3f7853f8,0x3f7f2f9d,0x3f7f0e58,0x3f77f110
.long 0x3f7b14be,0x3f7fec43,0x3f7d3aac,0x3f731447,0x3f7d3aac,0x3f7fe129,0x3f7a7302,0x3f6d1c1d,0x3f7ec46d,0x3f7f0e58,0x3f76ba07,0x3f660f88,0x3f7fb10f,0x3f7d7474,0x3f721352,0x3f5df6be
.long 0x0,0x0,0x0,0x0,0x3d96a905,0x3da3308c,0x3dafb680,0x3dbc3ac3,0x3e164083,0x3e22abb6,0x3e2f10a2,0x3e3b6ecf,0x3e605c13,0x3e72b651,0x3e827dc0,0x3e8b9507
.long 0x3e94a031,0x3ea09ae5,0x3eac7cd4,0x3eb8442a,0x3eb8442a,0x3ec6d529,0x3ed53641,0x3ee363fa,0x3edae880,0x3eebcbbb,0x3efc5d27,0x3f064b82,0x3efc5d27,0x3f07a136,0x3f10d3cd,0x3f19c200
.long 0x3f0e39da,0x3f187fc0,0x3f226799,0x3f2beb4a,0x3f1d7fd1,0x3f286605,0x3f32c8c9,0x3f3ca003,0x3f2beb4a,0x3f373a23,0x3f41d870,0x3f4bbbf8,0x3f396842,0x3f44e3f5,0x3f4f7a1f,0x3f591e6a
.long 0x3f45e403,0x3f514d3d,0x3f5b941a,0x3f64aa59,0x3f514d3d,0x3f5c61c7,0x3f660f88,0x3f6e46be,0x3f5b941a,0x3f660f88,0x3f6ed89e,0x3f75dec6,0x3f64aa59,0x3f6e46be,0x3f75dec6,0x3f7b61fc
.long 0x3f6c835e,0x3f74fa0b,0x3f7b14be,0x3f7ec46d,0x3f731447,0x3f7a1e84,0x3f7e70b0,0x3f7ffec4,0x3f7853f8,0x3f7dabcc,0x3f7fec43,0x3f7f0e58,0x3f7c3b28,0x3f7f9c18,0x3f7f84ab,0x3f7bf531
.long 0x3f7ec46d,0x3f7fec43,0x3f7d3aac,0x3f76ba07,0x3f7fec43,0x3f7e9bc9,0x3f791298,0x3f6f6830,0x3f7fb10f,0x3f7baccd,0x3f731447,0x3f660f88,0x3f7e1324,0x3f772417,0x3f6b4b0c,0x3f5ac450
.long 0x3f7b14be,0x3f710908,0x3f61c598,0x3f4d9f02,0x3f76ba07,0x3f696591,0x3f5695e5,0x3f3ebc1b,0x3f710908,0x3f604621,0x3f49d112,0x3f2e3bde,0x3f6a09a7,0x3f55b993,0x3f3b8f3b,0x3f1c420c
.long 0x3f61c598,0x3f49d112,0x3f2beb4a,0x3f08f59b,0x3f584853,0x3f3ca003,0x3f1b02c6,0x3ee900b7,0x3f4d9f02,0x3f2e3bde,0x3f08f59b,0x3ebe1d4a,0x3f41d870,0x3f1ebc12,0x3eebcbbb,0x3e919ddd
.long 0x0,0x0,0x0,0x0,0x3dc8bd36,0x3dd53db9,0x3de1bc2e,0x3dee3876,0x3e47c5c2,0x3e541501,0x3e605c13,0x3e6c9a7f,0x3e94a031,0x3e9d9e78,0x3ea68f12,0x3eaf713a
.long 0x3ec3ef15,0x3ecf7bca,0x3edae880,0x3ee63375,0x3ef15aea,0x3eff17b2,0x3f064b82,0x3f0cead0,0x3f0e39da,0x3f15f6d9,0x3f1d7fd1,0x3f24d225,0x3f226799,0x3f2ac082,0x3f32c8c9,0x3f3a7ca4
.long 0x3f3504f3,0x3f3daef9,0x3f45e403,0x3f4d9f02,0x3f45e403,0x3f4e8d90,0x3f5695e5,0x3f5df6be,0x3f54db31,0x3f5d2d53,0x3f64aa59,0x3f6b4b0c,0x3f61c598,0x3f696591,0x3f6ff573,0x3f756d97
.long 0x3f6c835e,0x3f731447,0x3f7853f8,0x3f7c3b28,0x3f74fa0b,0x3f7a1e84,0x3f7dabcc,0x3f7f9c18,0x3f7b14be,0x3f7e70b0,0x3f7fec43,0x3f7f84ab,0x3f7ec46d,0x3f7ffec4,0x3f7f0e58,0x3f7bf531
.long 0x3f800000,0x3f7ec46d,0x3f7b14be,0x3f74fa0b,0x3f7ec46d,0x3f7ac516,0x3f740bdd,0x3f6aab7b,0x3f7b14be,0x3f740bdd,0x3f6a09a7,0x3f5d2d53,0x3f74fa0b,0x3f6aab7b,0x3f5d2d53,0x3f4cae79
.long 0x3f6c835e,0x3f5ebe05,0x3f4d9f02,0x3f396842,0x3f61c598,0x3f5064af,0x3f3b8f3b,0x3f239da9,0x3f54db31,0x3f3fc767,0x3f273656,0x3f0b9a6b,0x3f45e403,0x3f2d1469,0x3f10d3cd,0x3ee363fa
.long 0x3f3504f3,0x3f187fc0,0x3ef15aea,0x3eac7cd4,0x3f226799,0x3f0242b1,0x3ebe1d4a,0x3e667c66,0x3f0e39da,0x3ed53641,0x3e888e93,0x3de1bc2e,0x3ef15aea,0x3ea395c5,0x3e22abb6,0xbbc90f88
.long 0x3ec3ef15,0x3e605c13,0x3d48fb30,0xbdfab273,0x3e94a031,0x3dee3876,0xbd7b2b74,0xbe72b651,0x3e47c5c2,0x3c490e90,0xbe2f10a2,0xbeb263ef,0x3dc8bd36,0xbdbc3ac3,0xbe8e9a22,0xbee900b7
.long 0x0,0x0,0x0,0x0,0x3dfab273,0x3e039502,0x3e09cf86,0x3e1008b7,0x3e78cfcc,0x3e827dc0,0x3e888e93,0x3e8e9a22,0x3eb8442a,0x3ec1071e,0x3ec9b953,0x3ed25a09
.long 0x3ef15aea,0x3efc5d27,0x3f039c3d,0x3f08f59b,0x3f13682a,0x3f19c200,0x3f1ff6cb,0x3f26050a,0x3f2beb4a,0x3f32c8c9,0x3f396842,0x3f3fc767,0x3f41d870,0x3f48d8b3,0x3f4f7a1f,0x3f55b993
.long 0x3f54db31,0x3f5b941a,0x3f61c598,0x3f676bd8,0x3f64aa59,0x3f6aab7b,0x3f6ff573,0x3f748422,0x3f710908,0x3f75dec6,0x3f79c79d,0x3f7cbfc9,0x3f79c79d,0x3f7cfe73,0x3f7f0e58,0x3f7ff4e6
.long 0x3f7ec46d,0x3f7fec43,0x3f7fb10f,0x3f7e1324,0x3f7fec43,0x3f7e9bc9,0x3f7baccd,0x3f772417,0x3f7d3aac,0x3f791298,0x3f731447,0x3f6b4b0c,0x3f76ba07,0x3f6f6830,0x3f660f88,0x3f5ac450
.long 0x3f6c835e,0x3f61c598,0x3f54db31,0x3f45e403,0x3f5ebe05,0x3f5064af,0x3f3fc767,0x3f2d1469,0x3f4d9f02,0x3f3b8f3b,0x3f273656,0x3f10d3cd,0x3f396842,0x3f239da9,0x3f0b9a6b,0x3ee363fa
.long 0x3f226799,0x3f08f59b,0x3edae880,0x3ea09ae5,0x3f08f59b,0x3ed8106b,0x3e9aa086,0x3e354098,0x3edae880,0x3e9aa086,0x3e2f10a2,0x3d16c32c,0x3ea09ae5,0x3e354098,0x3d16c32c,0xbdd53db9
.long 0x3e47c5c2,0x3d48fb30,0xbdc8bd36,0xbe78cfcc,0x3d96a905,0xbda3308c,0xbe6c9a7f,0xbec1071e,0xbd48fb30,0xbe541501,0xbeb8442a,0xbf00e7e4,0xbe2f10a2,0xbea986c4,0xbef6e0cb,0xbf1ebc12
.long 0xbe94a031,0xbee63375,0xbf187fc0,0xbf396842,0xbecf7bca,0xbf0f8784,0xbf32c8c9,0xbf5064af,0xbf039c3d,0xbf299415,0xbf49d112,0xbf633c5a,0xbf1d7fd1,0xbf40d0da,0xbf5d2d53,0xbf718f57
.long 0x0,0x0,0x0,0x0,0x3e164083,0x3e1c76de,0x3e22abb6,0x3e28defc,0x3e94a031,0x3e9aa086,0x3ea09ae5,0x3ea68f12,0x3edae880,0x3ee363fa,0x3eebcbbb,0x3ef41f07
.long 0x3f0e39da,0x3f13682a,0x3f187fc0,0x3f1d7fd1,0x3f2beb4a,0x3f31a81d,0x3f373a23,0x3f3ca003,0x3f45e403,0x3f4bbbf8,0x3f514d3d,0x3f5695e5,0x3f5b941a,0x3f6106f2,0x3f660f88,0x3f6aab7b
.long 0x3f6c835e,0x3f710908,0x3f74fa0b,0x3f7853f8,0x3f7853f8,0x3f7b61fc,0x3f7dabcc,0x3f7f2f9d,0x3f7ec46d,0x3f7fd397,0x3f7fec43,0x3f7f0e58,0x3f7fb10f,0x3f7e4323,0x3f7baccd,0x3f77f110
.long 0x3f7b14be,0x3f76ba07,0x3f710908,0x3f6a09a7,0x3f710908,0x3f696591,0x3f604621,0x3f55b993,0x3f61c598,0x3f5695e5,0x3f49d112,0x3f3b8f3b,0x3f4d9f02,0x3f3ebc1b,0x3f2e3bde,0x3f1c420c
.long 0x3f3504f3,0x3f226799,0x3f0e39da,0x3ef15aea,0x3f187fc0,0x3f0242b1,0x3ed53641,0x3ea395c5,0x3ef15aea,0x3ebe1d4a,0x3e888e93,0x3e22abb6,0x3eac7cd4,0x3e667c66,0x3de1bc2e,0xbbc90f88
.long 0x3e47c5c2,0x3d96a905,0xbd48fb30,0xbe2f10a2,0x3d48fb30,0xbda3308c,0xbe541501,0xbea986c4,0xbdc8bd36,0xbe6c9a7f,0xbeb8442a,0xbef6e0cb,0xbe78cfcc,0xbec1071e,0xbf00e7e4,0xbf1ebc12
.long 0xbec3ef15,0xbf039c3d,0xbf226799,0xbf3daef9,0xbf039c3d,0xbf239da9,0xbf3fc767,0xbf577026,0xbf226799,0xbf3fc767,0xbf584853,0xbf6b4b0c,0xbf3daef9,0xbf577026,0xbf6b4b0c,0xbf78b47b
.long 0xbf54db31,0xbf6a09a7,0xbf7853f8,0xbf7f4e6d,0xbf676bd8,0xbf772417,0xbf7f0e58,0xbf7eea9d,0xbf74fa0b,0xbf7e70b0,0xbf7f4e6d,0xbf778bc5,0xbf7d3aac,0xbf7fc38f,0xbf791298,0xbf696591
.long 0x0,0x0,0x0,0x0,0x3e2f10a2,0x3e354098,0x3e3b6ecf,0x3e419b37,0x3eac7cd4,0x3eb263ef,0x3eb8442a,0x3ebe1d4a,0x3efc5d27,0x3f0242b1,0x3f064b82,0x3f0a48ad
.long 0x3f226799,0x3f273656,0x3f2beb4a,0x3f3085bb,0x3f41d870,0x3f46e22a,0x3f4bbbf8,0x3f5064af,0x3f5b941a,0x3f604621,0x3f64aa59,0x3f68bf3c,0x3f6ed89e,0x3f7294f8,0x3f75dec6,0x3f78b47b
.long 0x3f7b14be,0x3f7d3aac,0x3f7ec46d,0x3f7fb10f,0x3f7fec43,0x3f7fe129,0x3f7f0e58,0x3f7d7474,0x3f7d3aac,0x3f7a7302,0x3f76ba07,0x3f721352,0x3f731447,0x3f6d1c1d,0x3f660f88,0x3f5df6be
.long 0x3f61c598,0x3f584853,0x3f4d9f02,0x3f41d870,0x3f49d112,0x3f3ca003,0x3f2e3bde,0x3f1ebc12,0x3f2beb4a,0x3f1b02c6,0x3f08f59b,0x3eebcbbb,0x3f08f59b,0x3ee900b7,0x3ebe1d4a,0x3e919ddd
.long 0x3ec3ef15,0x3e94a031,0x3e47c5c2,0x3dc8bd36,0x3e605c13,0x3dee3876,0x3c490e90,0xbdbc3ac3,0x3d48fb30,0xbd7b2b74,0xbe2f10a2,0xbe8e9a22,0xbdfab273,0xbe72b651,0xbeb263ef,0xbee900b7
.long 0xbe94a031,0xbecf7bca,0xbf039c3d,0xbf1d7fd1,0xbee63375,0xbf0f8784,0xbf299415,0xbf40d0da,0xbf187fc0,0xbf32c8c9,0xbf49d112,0xbf5d2d53,0xbf396842,0xbf5064af,0xbf633c5a,0xbf718f57
.long 0xbf54db31,0xbf676bd8,0xbf74fa0b,0xbf7d3aac,0xbf6a09a7,0xbf772417,0xbf7e70b0,0xbf7fc38f,0xbf7853f8,0xbf7f0e58,0xbf7f4e6d,0xbf791298,0xbf7f4e6d,0xbf7eea9d,0xbf778bc5,0xbf696591
.long 0xbf7ec46d,0xbf76ba07,0xbf676bd8,0xbf514d3d,0xbf76ba07,0xbf66becc,0xbf4f7a1f,0xbf31a81d,0xbf676bd8,0xbf4f7a1f,0xbf3085bb,0xbf0b9a6b,0xbf514d3d,0xbf31a81d,0xbf0b9a6b,0xbec1071e
.long 0x3f803f80,0x3f803f80,0x3f803f80,0x3f803f80,0x0,0x0,0x0,0x0,0x3f7b3f80,0x3f553f6d,0xbe480000,0xbf0ebec4,0xbe480000,0xbf0ebec4,0xbf7bbf80,0xbf55bf6d
.long 0x3f6d3f80,0x3ec43f35,0xbf6dbf80,0xbec4bf35,0xbec40000,0xbf6dbf35,0x3ec40000,0x3f6d3f35,0x3f553f80,0xbe483ec4,0x3f0e0000,0x3f7b3f6d,0xbf0e0000,0xbf7bbf6d,0x3f553f80,0xbe483ec4
.long 0x3f353f80,0xbf350000,0x3f353f80,0xbf350000,0xbf350000,0xbf35bf80,0xbf350000,0xbf35bf80,0x3f0e3f80,0xbf7bbec4,0xbf550000,0xbe48bf6d,0xbf550000,0xbe48bf6d,0xbf0ebf80,0x3f7b3ec4
.long 0x3ec43f80,0xbf6dbf35,0xbec4bf80,0x3f6d3f35,0xbf6d0000,0x3ec4bf35,0x3f6d0000,0xbec43f35,0x3e483f80,0xbf0ebf6d,0x3f7b0000,0xbf553ec4,0xbf7b0000,0x3f55bec4,0x3e483f80,0xbf0ebf6d
.long 0x3f80,0xbf80,0x3f80,0xbf80,0xbf800000,0x3f800000,0xbf800000,0x3f800000,0xbe483f80,0x3f0ebf6d,0xbf7b0000,0x3f553ec4,0xbf7b0000,0x3f553ec4,0x3e48bf80,0xbf0e3f6d
.long 0xbec43f80,0x3f6dbf35,0x3ec4bf80,0xbf6d3f35,0xbf6d0000,0x3ec43f35,0x3f6d0000,0xbec4bf35,0xbf0e3f80,0x3f7bbec4,0x3f550000,0x3e48bf6d,0xbf550000,0xbe483f6d,0xbf0e3f80,0x3f7bbec4
.long 0xbf353f80,0x3f350000,0xbf353f80,0x3f350000,0xbf350000,0xbf353f80,0xbf350000,0xbf353f80,0xbf553f80,0x3e483ec4,0xbf0e0000,0xbf7b3f6d,0xbf0e0000,0xbf7b3f6d,0x3f55bf80,0xbe48bec4
.long 0xbf6d3f80,0xbec43f35,0x3f6dbf80,0x3ec4bf35,0xbec40000,0xbf6d3f35,0x3ec40000,0x3f6dbf35,0xbf7b3f80,0xbf553f6d,0x3e480000,0x3f0ebec4,0xbe480000,0xbf0e3ec4,0xbf7b3f80,0xbf553f6d
.long 0x3f803f80,0x3f803f80,0x3f803f80,0x3f803f80,0x0,0x0,0x0,0x0,0x3f0e3f35,0x3e483ec4,0xbf55bf35,0xbf7bbf6d,0xbf55bf35,0xbf7bbf6d,0xbf0ebf35,0xbe48bec4
.long 0xbec40000,0xbf6dbf35,0x3ec40000,0x3f6d3f35,0xbf6dbf80,0xbec4bf35,0x3f6d3f80,0x3ec43f35,0xbf7bbf35,0xbf0ebf6d,0x3e483f35,0xbf55bec4,0xbe48bf35,0x3f553ec4,0xbf7bbf35,0xbf0ebf6d
.long 0xbf35bf80,0x3f350000,0xbf35bf80,0x3f350000,0x3f350000,0x3f353f80,0x3f350000,0x3f353f80,0x3e48bf35,0x3f553f6d,0x3f7b3f35,0xbf0e3ec4,0x3f7b3f35,0xbf0e3ec4,0xbe483f35,0xbf55bf6d
.long 0x3f6d0000,0xbec43f35,0xbf6d0000,0x3ec4bf35,0x3ec43f80,0xbf6dbf35,0xbec4bf80,0x3f6d3f35,0x3f553f35,0xbf7bbec4,0x3f0ebf35,0xbe483f6d,0xbf0e3f35,0x3e48bf6d,0x3f553f35,0xbf7bbec4
.long 0x3f80,0xbf80,0x3f80,0xbf80,0xbf800000,0x3f800000,0xbf800000,0x3f800000,0xbf553f35,0x3f7bbec4,0xbf0ebf35,0x3e483f6d,0xbf0ebf35,0x3e483f6d,0x3f55bf35,0xbf7b3ec4
.long 0xbf6d0000,0x3ec43f35,0x3f6d0000,0xbec4bf35,0x3ec4bf80,0xbf6d3f35,0xbec43f80,0x3f6dbf35,0xbe48bf35,0xbf553f6d,0xbf7b3f35,0x3f0e3ec4,0x3f7bbf35,0xbf0ebec4,0xbe48bf35,0xbf553f6d
.long 0x3f35bf80,0xbf350000,0x3f35bf80,0xbf350000,0x3f350000,0x3f35bf80,0x3f350000,0x3f35bf80,0x3f7bbf35,0x3f0ebf6d,0xbe483f35,0x3f55bec4,0xbe483f35,0x3f55bec4,0xbf7b3f35,0xbf0e3f6d
.long 0x3ec40000,0x3f6dbf35,0xbec40000,0xbf6d3f35,0xbf6d3f80,0xbec43f35,0x3f6dbf80,0x3ec4bf35,0xbf0e3f35,0xbe483ec4,0x3f55bf35,0x3f7bbf6d,0xbf553f35,0xbf7b3f6d,0xbf0e3f35,0xbe483ec4
.long 0x3f803f80,0x3f803f80,0x3f803f80,0x3f803f80,0x0,0x0,0x0,0x0,0xbf7bbf80,0xbf55bf6d,0x3e480000,0x3f0e3ec4,0x3e480000,0x3f0e3ec4,0x3f7b3f80,0x3f553f6d
.long 0x3f6d3f80,0x3ec43f35,0xbf6dbf80,0xbec4bf35,0xbec40000,0xbf6dbf35,0x3ec40000,0x3f6d3f35,0xbf55bf80,0x3e48bec4,0xbf0e0000,0xbf7bbf6d,0x3f0e0000,0x3f7b3f6d,0xbf55bf80,0x3e48bec4
.long 0x3f353f80,0xbf350000,0x3f353f80,0xbf350000,0xbf350000,0xbf35bf80,0xbf350000,0xbf35bf80,0xbf0ebf80,0x3f7b3ec4,0x3f550000,0x3e483f6d,0x3f550000,0x3e483f6d,0x3f0e3f80,0xbf7bbec4
.long 0x3ec43f80,0xbf6dbf35,0xbec4bf80,0x3f6d3f35,0xbf6d0000,0x3ec4bf35,0x3f6d0000,0xbec43f35,0xbe48bf80,0x3f0e3f6d,0xbf7b0000,0x3f55bec4,0x3f7b0000,0xbf553ec4,0xbe48bf80,0x3f0e3f6d
.long 0x3f80,0xbf80,0x3f80,0xbf80,0xbf800000,0x3f800000,0xbf800000,0x3f800000,0x3e48bf80,0xbf0e3f6d,0x3f7b0000,0xbf55bec4,0x3f7b0000,0xbf55bec4,0xbe483f80,0x3f0ebf6d
.long 0xbec43f80,0x3f6dbf35,0x3ec4bf80,0xbf6d3f35,0xbf6d0000,0x3ec43f35,0x3f6d0000,0xbec4bf35,0x3f0ebf80,0xbf7b3ec4,0xbf550000,0xbe483f6d,0x3f550000,0x3e48bf6d,0x3f0ebf80,0xbf7b3ec4
.long 0xbf353f80,0x3f350000,0xbf353f80,0x3f350000,0xbf350000,0xbf353f80,0xbf350000,0xbf353f80,0x3f55bf80,0xbe48bec4,0x3f0e0000,0x3f7bbf6d,0x3f0e0000,0x3f7bbf6d,0xbf553f80,0x3e483ec4
.long 0xbf6d3f80,0xbec43f35,0x3f6dbf80,0x3ec4bf35,0xbec40000,0xbf6d3f35,0x3ec40000,0x3f6dbf35,0x3f7bbf80,0x3f55bf6d,0xbe480000,0xbf0e3ec4,0x3e480000,0x3f0ebec4,0x3f7bbf80,0x3f55bf6d
.long 0x3f803f80,0x3f803f80,0x3f803f80,0x3f803f80,0x0,0x0,0x0,0x0,0xbf0ebf35,0xbe48bec4,0x3f553f35,0x3f7b3f6d,0x3f553f35,0x3f7b3f6d,0x3f0e3f35,0x3e483ec4
.long 0xbec40000,0xbf6dbf35,0x3ec40000,0x3f6d3f35,0xbf6dbf80,0xbec4bf35,0x3f6d3f80,0x3ec43f35,0x3f7b3f35,0x3f0e3f6d,0xbe48bf35,0x3f553ec4,0x3e483f35,0xbf55bec4,0x3f7b3f35,0x3f0e3f6d
.long 0xbf35bf80,0x3f350000,0xbf35bf80,0x3f350000,0x3f350000,0x3f353f80,0x3f350000,0x3f353f80,0xbe483f35,0xbf55bf6d,0xbf7bbf35,0x3f0ebec4,0xbf7bbf35,0x3f0ebec4,0x3e48bf35,0x3f553f6d
.long 0x3f6d0000,0xbec43f35,0xbf6d0000,0x3ec4bf35,0x3ec43f80,0xbf6dbf35,0xbec4bf80,0x3f6d3f35,0xbf55bf35,0x3f7b3ec4,0xbf0e3f35,0x3e48bf6d,0x3f0ebf35,0xbe483f6d,0xbf55bf35,0x3f7b3ec4
.long 0x3f80,0xbf80,0x3f80,0xbf80,0xbf800000,0x3f800000,0xbf800000,0x3f800000,0x3f55bf35,0xbf7b3ec4,0x3f0e3f35,0xbe48bf6d,0x3f0e3f35,0xbe48bf6d,0xbf553f35,0x3f7bbec4
.long 0xbf6d0000,0x3ec43f35,0x3f6d0000,0xbec4bf35,0x3ec4bf80,0xbf6d3f35,0xbec43f80,0x3f6dbf35,0x3e483f35,0x3f55bf6d,0x3f7bbf35,0xbf0ebec4,0xbf7b3f35,0x3f0e3ec4,0x3e483f35,0x3f55bf6d
.long 0x3f35bf80,0xbf350000,0x3f35bf80,0xbf350000,0x3f350000,0x3f35bf80,0x3f350000,0x3f35bf80,0xbf7b3f35,0xbf0e3f6d,0x3e48bf35,0xbf553ec4,0x3e48bf35,0xbf553ec4,0x3f7bbf35,0x3f0ebf6d
.long 0x3ec40000,0x3f6dbf35,0xbec40000,0xbf6d3f35,0xbf6d3f80,0xbec43f35,0x3f6dbf80,0x3ec4bf35,0x3f0ebf35,0x3e48bec4,0xbf553f35,0xbf7b3f6d,0x3f55bf35,0x3f7bbf6d,0x3f0ebf35,0x3e48bec4
.long 0x0,0x0,0x0,0x0,0x3f803f80,0x3f803f80,0x3f803f80,0x3f803f80,0x3e480000,0x3f0e3ec4,0x3f7b3f80,0x3f553f6d,0x3f7b3f80,0x3f553f6d,0xbe480000,0xbf0ebec4
.long 0x3ec40000,0x3f6d3f35,0xbec40000,0xbf6dbf35,0x3f6d3f80,0x3ec43f35,0xbf6dbf80,0xbec4bf35,0x3f0e0000,0x3f7b3f6d,0xbf55bf80,0x3e48bec4,0x3f553f80,0xbe483ec4,0x3f0e0000,0x3f7b3f6d
.long 0x3f350000,0x3f353f80,0x3f350000,0x3f353f80,0x3f353f80,0xbf350000,0x3f353f80,0xbf350000,0x3f550000,0x3e483f6d,0x3f0e3f80,0xbf7bbec4,0x3f0e3f80,0xbf7bbec4,0xbf550000,0xbe48bf6d
.long 0x3f6d0000,0xbec43f35,0xbf6d0000,0x3ec4bf35,0x3ec43f80,0xbf6dbf35,0xbec4bf80,0x3f6d3f35,0x3f7b0000,0xbf553ec4,0xbe48bf80,0x3f0e3f6d,0x3e483f80,0xbf0ebf6d,0x3f7b0000,0xbf553ec4
.long 0x3f800000,0xbf800000,0x3f800000,0xbf800000,0x3f80,0xbf80,0x3f80,0xbf80,0x3f7b0000,0xbf55bec4,0xbe483f80,0x3f0ebf6d,0xbe483f80,0x3f0ebf6d,0xbf7b0000,0x3f553ec4
.long 0x3f6d0000,0xbec4bf35,0xbf6d0000,0x3ec43f35,0xbec43f80,0x3f6dbf35,0x3ec4bf80,0xbf6d3f35,0x3f550000,0x3e48bf6d,0x3f0ebf80,0xbf7b3ec4,0xbf0e3f80,0x3f7bbec4,0x3f550000,0x3e48bf6d
.long 0x3f350000,0x3f35bf80,0x3f350000,0x3f35bf80,0xbf353f80,0x3f350000,0xbf353f80,0x3f350000,0x3f0e0000,0x3f7bbf6d,0xbf553f80,0x3e483ec4,0xbf553f80,0x3e483ec4,0xbf0e0000,0xbf7b3f6d
.long 0x3ec40000,0x3f6dbf35,0xbec40000,0xbf6d3f35,0xbf6d3f80,0xbec43f35,0x3f6dbf80,0x3ec4bf35,0x3e480000,0x3f0ebec4,0x3f7bbf80,0x3f55bf6d,0xbf7b3f80,0xbf553f6d,0x3e480000,0x3f0ebec4
.long 0x0,0x0,0x0,0x0,0x3f803f80,0x3f803f80,0x3f803f80,0x3f803f80,0x3f553f35,0x3f7b3f6d,0x3f0e3f35,0x3e483ec4,0x3f0e3f35,0x3e483ec4,0xbf55bf35,0xbf7bbf6d
.long 0x3f6d3f80,0x3ec43f35,0xbf6dbf80,0xbec4bf35,0xbec40000,0xbf6dbf35,0x3ec40000,0x3f6d3f35,0x3e483f35,0xbf55bec4,0x3f7b3f35,0x3f0e3f6d,0xbf7bbf35,0xbf0ebf6d,0x3e483f35,0xbf55bec4
.long 0xbf350000,0xbf35bf80,0xbf350000,0xbf35bf80,0xbf35bf80,0x3f350000,0xbf35bf80,0x3f350000,0xbf7bbf35,0x3f0ebec4,0x3e48bf35,0x3f553f6d,0x3e48bf35,0x3f553f6d,0x3f7b3f35,0xbf0e3ec4
.long 0xbec4bf80,0x3f6d3f35,0x3ec43f80,0xbf6dbf35,0x3f6d0000,0xbec43f35,0xbf6d0000,0x3ec4bf35,0x3f0ebf35,0xbe483f6d,0xbf55bf35,0x3f7b3ec4,0x3f553f35,0xbf7bbec4,0x3f0ebf35,0xbe483f6d
.long 0x3f800000,0xbf800000,0x3f800000,0xbf800000,0x3f80,0xbf80,0x3f80,0xbf80,0x3f0e3f35,0xbe48bf6d,0xbf553f35,0x3f7bbec4,0xbf553f35,0x3f7bbec4,0xbf0ebf35,0x3e483f6d
.long 0xbec43f80,0x3f6dbf35,0x3ec4bf80,0xbf6d3f35,0xbf6d0000,0x3ec43f35,0x3f6d0000,0xbec4bf35,0xbf7b3f35,0x3f0e3ec4,0x3e483f35,0x3f55bf6d,0xbe48bf35,0xbf553f6d,0xbf7b3f35,0x3f0e3ec4
.long 0xbf350000,0xbf353f80,0xbf350000,0xbf353f80,0x3f35bf80,0xbf350000,0x3f35bf80,0xbf350000,0x3e48bf35,0xbf553ec4,0x3f7bbf35,0x3f0ebf6d,0x3f7bbf35,0x3f0ebf6d,0xbe483f35,0x3f55bec4
.long 0x3f6dbf80,0x3ec4bf35,0xbf6d3f80,0xbec43f35,0x3ec40000,0x3f6dbf35,0xbec40000,0xbf6d3f35,0x3f55bf35,0x3f7bbf6d,0x3f0ebf35,0x3e48bec4,0xbf0e3f35,0xbe483ec4,0x3f55bf35,0x3f7bbf6d
.long 0x0,0x0,0x0,0x0,0x3f803f80,0x3f803f80,0x3f803f80,0x3f803f80,0xbe480000,0xbf0ebec4,0xbf7bbf80,0xbf55bf6d,0xbf7bbf80,0xbf55bf6d,0x3e480000,0x3f0e3ec4
.long 0x3ec40000,0x3f6d3f35,0xbec40000,0xbf6dbf35,0x3f6d3f80,0x3ec43f35,0xbf6dbf80,0xbec4bf35,0xbf0e0000,0xbf7bbf6d,0x3f553f80,0xbe483ec4,0xbf55bf80,0x3e48bec4,0xbf0e0000,0xbf7bbf6d
.long 0x3f350000,0x3f353f80,0x3f350000,0x3f353f80,0x3f353f80,0xbf350000,0x3f353f80,0xbf350000,0xbf550000,0xbe48bf6d,0xbf0ebf80,0x3f7b3ec4,0xbf0ebf80,0x3f7b3ec4,0x3f550000,0x3e483f6d
.long 0x3f6d0000,0xbec43f35,0xbf6d0000,0x3ec4bf35,0x3ec43f80,0xbf6dbf35,0xbec4bf80,0x3f6d3f35,0xbf7b0000,0x3f55bec4,0x3e483f80,0xbf0ebf6d,0xbe48bf80,0x3f0e3f6d,0xbf7b0000,0x3f55bec4
.long 0x3f800000,0xbf800000,0x3f800000,0xbf800000,0x3f80,0xbf80,0x3f80,0xbf80,0xbf7b0000,0x3f553ec4,0x3e48bf80,0xbf0e3f6d,0x3e48bf80,0xbf0e3f6d,0x3f7b0000,0xbf55bec4
.long 0x3f6d0000,0xbec4bf35,0xbf6d0000,0x3ec43f35,0xbec43f80,0x3f6dbf35,0x3ec4bf80,0xbf6d3f35,0xbf550000,0xbe483f6d,0xbf0e3f80,0x3f7bbec4,0x3f0ebf80,0xbf7b3ec4,0xbf550000,0xbe483f6d
.long 0x3f350000,0x3f35bf80,0x3f350000,0x3f35bf80,0xbf353f80,0x3f350000,0xbf353f80,0x3f350000,0xbf0e0000,0xbf7b3f6d,0x3f55bf80,0xbe48bec4,0x3f55bf80,0xbe48bec4,0x3f0e0000,0x3f7bbf6d
.long 0x3ec40000,0x3f6dbf35,0xbec40000,0xbf6d3f35,0xbf6d3f80,0xbec43f35,0x3f6dbf80,0x3ec4bf35,0xbe480000,0xbf0e3ec4,0xbf7b3f80,0xbf553f6d,0x3f7bbf80,0x3f55bf6d,0xbe480000,0xbf0e3ec4
.long 0x0,0x0,0x0,0x0,0x3f803f80,0x3f803f80,0x3f803f80,0x3f803f80,0xbf55bf35,0xbf7bbf6d,0xbf0ebf35,0xbe48bec4,0xbf0ebf35,0xbe48bec4,0x3f553f35,0x3f7b3f6d
.long 0x3f6d3f80,0x3ec43f35,0xbf6dbf80,0xbec4bf35,0xbec40000,0xbf6dbf35,0x3ec40000,0x3f6d3f35,0xbe48bf35,0x3f553ec4,0xbf7bbf35,0xbf0ebf6d,0x3f7b3f35,0x3f0e3f6d,0xbe48bf35,0x3f553ec4
.long 0xbf350000,0xbf35bf80,0xbf350000,0xbf35bf80,0xbf35bf80,0x3f350000,0xbf35bf80,0x3f350000,0x3f7b3f35,0xbf0e3ec4,0xbe483f35,0xbf55bf6d,0xbe483f35,0xbf55bf6d,0xbf7bbf35,0x3f0ebec4
.long 0xbec4bf80,0x3f6d3f35,0x3ec43f80,0xbf6dbf35,0x3f6d0000,0xbec43f35,0xbf6d0000,0x3ec4bf35,0xbf0e3f35,0x3e48bf6d,0x3f553f35,0xbf7bbec4,0xbf55bf35,0x3f7b3ec4,0xbf0e3f35,0x3e48bf6d
.long 0x3f800000,0xbf800000,0x3f800000,0xbf800000,0x3f80,0xbf80,0x3f80,0xbf80,0xbf0ebf35,0x3e483f6d,0x3f55bf35,0xbf7b3ec4,0x3f55bf35,0xbf7b3ec4,0x3f0e3f35,0xbe48bf6d
.long 0xbec43f80,0x3f6dbf35,0x3ec4bf80,0xbf6d3f35,0xbf6d0000,0x3ec43f35,0x3f6d0000,0xbec4bf35,0x3f7bbf35,0xbf0ebec4,0xbe48bf35,0xbf553f6d,0x3e483f35,0x3f55bf6d,0x3f7bbf35,0xbf0ebec4
.long 0xbf350000,0xbf353f80,0xbf350000,0xbf353f80,0x3f35bf80,0xbf350000,0x3f35bf80,0xbf350000,0xbe483f35,0x3f55bec4,0xbf7b3f35,0xbf0e3f6d,0xbf7b3f35,0xbf0e3f6d,0x3e48bf35,0xbf553ec4
.long 0x3f6dbf80,0x3ec4bf35,0xbf6d3f80,0xbec43f35,0x3ec40000,0x3f6dbf35,0xbec40000,0xbf6d3f35,0xbf553f35,0xbf7b3f6d,0xbf0e3f35,0xbe483ec4,0x3f0ebf35,0x3e48bec4,0xbf553f35,0xbf7b3f6d
.long 0x0,0x0,0x0,0x0,0x0,0x0,0x0,0x0,0x0,0x0,0x0,0x0,0x0,0x0,0x0,0x0
.long 0x0,0x0,0x0,0x0,0x0,0x0,0x0,0x0,0x0,0x0,0x0,0x0,0x0,0x0,0x0,0x0
.long 0x0,0x0,0x0,0x0,0x0,0x0,0x0,0x0,0x0,0x0,0x0,0x0,0x0,0x0,0x0,0x0
.long 0x0,0x0,0x0,0x0,0x0,0x0,0x0,0x0,0x0,0x0,0x0,0x0,0x0,0x0,0x0,0x0
.long 0x0,0x3f800000,0x3f803f80,0x0,0x0,0x0,0x3f803f80,0x3f80,0x0,0x0,0x3f800000,0x3f803f80,0x0,0x0,0x0,0x3f803f80
.long 0x0,0x0,0x0,0x3f800000,0x0,0x0,0x0,0x0,0x0,0x0,0x0,0x0,0x0,0x0,0x0,0x0
.long 0x0,0x0,0x0,0x0,0x0,0x0,0x0,0x0,0x0,0x0,0x0,0x0,0x0,0x0,0x0,0x0
.long 0x0,0x0,0x0,0x0,0x0,0x0,0x0,0x0,0x0,0x0,0x0,0x0,0x0,0x0,0x0,0x0
.long 0x0,0x0,0x0,0x0,0x0,0x0,0x0,0x0,0x0,0x0,0x0,0x0,0x3f80,0x0,0x0,0x0
.long 0x3f803f80,0x0,0x0,0x0,0x3f803f80,0x3f80,0x0,0x0,0x3f800000,0x3f803f80,0x0,0x0,0x0,0x3f803f80,0x3f80,0x0
.long 0x0,0x3f800000,0x3f803f80,0x0,0x0,0x0,0x3f803f80,0x3f80,0x0,0x0,0x3f800000,0x3f803f80,0x0,0x0,0x0,0x3f803f80
.long 0x0,0x0,0x0,0x3f800000,0x0,0x0,0x0,0x0,0x0,0x0,0x0,0x0,0x0,0x0,0x0,0x0
.long 0x0,0x0,0x0,0x0,0x0,0x0,0x0,0x0,0x0,0x0,0x0,0x0,0x0,0x0,0x0,0x0
.long 0x0,0x0,0x0,0x0,0x0,0x0,0x0,0x0,0x0,0x0,0x0,0x0,0x0,0x0,0x0,0x0
.long 0x0,0x0,0x0,0x0,0x0,0x0,0x0,0x0,0x0,0x0,0x0,0x0,0x3f80,0x0,0x0,0x0
.long 0x3f803f80,0x0,0x0,0x0,0x3f803f80,0x3f80,0x0,0x0,0x3f800000,0x3f803f80,0x0,0x0,0x0,0x3f803f80,0x3f80,0x0
.long 0x0,0x0,0x0,0x3f803f80,0x0,0x0,0x0,0x3f800000,0x0,0x0,0x0,0x0,0x0,0x0,0x0,0x0
.long 0x0,0x0,0x0,0x0,0x0,0x0,0x0,0x0,0x0,0x0,0x0,0x0,0x0,0x0,0x0,0x0
.long 0x0,0x0,0x0,0x0,0x0,0x0,0x0,0x0,0x0,0x0,0x0,0x0,0x0,0x0,0x0,0x0
.long 0x0,0x0,0x0,0x0,0x0,0x0,0x0,0x0,0x0,0x0,0x0,0x0,0x0,0x0,0x0,0x0
.long 0x3f803f80,0x3f80,0x0,0x0,0x3f803f80,0x3f803f80,0x0,0x0,0x3f803f80,0x3f803f80,0x3f80,0x0,0x3f800000,0x3f803f80,0x3f803f80,0x0
.long 0x0,0x3f803f80,0x3f803f80,0x3f80,0x0,0x3f800000,0x3f803f80,0x3f803f80,0x0,0x0,0x3f803f80,0x3f803f80,0x0,0x0,0x3f800000,0x3f803f80
.long 0x0,0x0,0x0,0x3f803f80,0x0,0x0,0x0,0x3f800000,0x0,0x0,0x0,0x0,0x0,0x0,0x0,0x0
.long 0x0,0x0,0x0,0x0,0x0,0x0,0x0,0x0,0x0,0x0,0x0,0x0,0x0,0x0,0x0,0x0
.long 0x0,0x0,0x0,0x0,0x0,0x0,0x0,0x0,0x0,0x0,0x0,0x0,0x0,0x0,0x0,0x0
.long 0x0,0x0,0x0,0x0,0x0,0x0,0x0,0x0,0x3f80,0x0,0x0,0x0,0x3f803f80,0x0,0x0,0x0
.long 0x3f803f80,0x3f80,0x0,0x0,0x3f803f80,0x3f803f80,0x0,0x0,0x3f803f80,0x3f803f80,0x3f80,0x0,0x3f800000,0x3f803f80,0x3f803f80,0x0
.long 0x0,0x3f803f80,0x3f803f80,0x3f80,0x0,0x3f800000,0x3f803f80,0x3f803f80,0x0,0x0,0x3f803f80,0x3f803f80,0x0,0x0,0x3f800000,0x3f803f80
.long 0x0,0x0,0x0,0x0,0x0,0x0,0x0,0x0,0x0,0x0,0x0,0x0,0x0,0x0,0x0,0x0
.long 0x0,0x0,0x0,0x0,0x0,0x0,0x0,0x0,0x0,0x0,0x0,0x0,0x0,0x0,0x0,0x0
.long 0x0,0x0,0x0,0x0,0x0,0x0,0x0,0x0,0x0,0x0,0x0,0x0,0x0,0x0,0x0,0x0
.long 0x0,0x0,0x0,0x0,0x0,0x0,0x0,0x0,0x3f80,0x0,0x0,0x0,0x3f803f80,0x0,0x0,0x0
.long 0x0,0x3f800000,0x3f803f80,0x0,0x0,0x0,0x3f803f80,0x3f80,0x0,0x0,0x3f800000,0x3f803f80,0x0,0x0,0x0,0x3f803f80
.long 0x0,0x0,0x0,0x3f800000,0x0,0x0,0x0,0x0,0x0,0x0,0x0,0x0,0x0,0x0,0x0,0x0
.long 0x0,0x0,0x0,0x0,0x0,0x0,0x0,0x0,0x0,0x0,0x0,0x0,0x0,0x0,0x0,0x0
.long 0x0,0x0,0x0,0x0,0x0,0x0,0x0,0x0,0x0,0x0,0x0,0x0,0x0,0x0,0x0,0x0
.long 0x0,0x0,0x0,0x0,0x0,0x0,0x0,0x0,0x0,0x0,0x0,0x0,0x3f80,0x0,0x0,0x0
.long 0x3f803f80,0x0,0x0,0x0,0x3f803f80,0x3f80,0x0,0x0,0x3f800000,0x3f803f80,0x0,0x0,0x0,0x3f803f80,0x3f80,0x0
.long 0x0,0x3f800000,0x3f803f80,0x0,0x0,0x0,0x3f803f80,0x3f80,0x0,0x0,0x3f800000,0x3f803f80,0x0,0x0,0x0,0x3f803f80
.long 0x0,0x0,0x0,0x3f800000,0x0,0x0,0x0,0x0,0x0,0x0,0x0,0x0,0x0,0x0,0x0,0x0
.long 0x0,0x0,0x0,0x0,0x0,0x0,0x0,0x0,0x0,0x0,0x0,0x0,0x0,0x0,0x0,0x0
.long 0x0,0x0,0x0,0x0,0x0,0x0,0x0,0x0,0x0,0x0,0x0,0x0,0x0,0x0,0x0,0x0
.long 0x0,0x0,0x0,0x0,0x0,0x0,0x0,0x0,0x0,0x0,0x0,0x0,0x3f80,0x0,0x0,0x0
.long 0x3f803f80,0x0,0x0,0x0,0x3f803f80,0x3f80,0x0,0x0,0x3f800000,0x3f803f80,0x0,0x0,0x0,0x3f803f80,0x3f80,0x0
.long 0x0,0x0,0x0,0x0,0x0,0x0,0x0,0x0,0x0,0x0,0x0,0x0,0x0,0x0,0x0,0x0
.long 0x0,0x0,0x0,0x0,0x0,0x0,0x0,0x0,0x0,0x0,0x0,0x0,0x0,0x0,0x0,0x0
.long 0x0,0x0,0x0,0x0,0x0,0x0,0x0,0x0,0x0,0x0,0x0,0x0,0x0,0x0,0x0,0x0
.long 0x0,0x0,0x0,0x0,0x0,0x0,0x0,0x0,0x0,0x0,0x0,0x0,0x0,0x0,0x0,0x0
.long 0x0,0x0,0x3f800000,0x3f803f80,0x0,0x0,0x0,0x3f803f80,0x0,0x0,0x0,0x3f800000,0x0,0x0,0x0,0x0
.long 0x0,0x0,0x0,0x0,0x0,0x0,0x0,0x0,0x0,0x0,0x0,0x0,0x0,0x0,0x0,0x0
.long 0x0,0x0,0x0,0x0,0x0,0x0,0x0,0x0,0x0,0x0,0x0,0x0,0x0,0x0,0x0,0x0
.long 0x0,0x0,0x0,0x0,0x0,0x0,0x0,0x0,0x0,0x0,0x0,0x0,0x0,0x0,0x0,0x0
.long 0x3f803f80,0x3f803f80,0x0,0x0,0x3f803f80,0x3f803f80,0x3f80,0x0,0x3f803f80,0x3f803f80,0x3f803f80,0x0,0x3f803f80,0x3f803f80,0x3f803f80,0x3f80
.long 0x3f800000,0x3f803f80,0x3f803f80,0x3f803f80,0x0,0x3f803f80,0x3f803f80,0x3f803f80,0x0,0x3f800000,0x3f803f80,0x3f803f80,0x0,0x0,0x3f803f80,0x3f803f80
.long 0x0,0x0,0x3f800000,0x3f803f80,0x0,0x0,0x0,0x3f803f80,0x0,0x0,0x0,0x3f800000,0x0,0x0,0x0,0x0
.long 0x0,0x0,0x0,0x0,0x0,0x0,0x0,0x0,0x0,0x0,0x0,0x0,0x0,0x0,0x0,0x0
.long 0x0,0x0,0x0,0x0,0x0,0x0,0x0,0x0,0x0,0x0,0x0,0x0,0x0,0x0,0x0,0x0
.long 0x0,0x0,0x0,0x0,0x3f80,0x0,0x0,0x0,0x3f803f80,0x0,0x0,0x0,0x3f803f80,0x3f80,0x0,0x0
.long 0x3f803f80,0x3f803f80,0x0,0x0,0x3f803f80,0x3f803f80,0x3f80,0x0,0x3f803f80,0x3f803f80,0x3f803f80,0x0,0x3f803f80,0x3f803f80,0x3f803f80,0x3f80
.long 0x3f800000,0x3f803f80,0x3f803f80,0x3f803f80,0x0,0x3f803f80,0x3f803f80,0x3f803f80,0x0,0x3f800000,0x3f803f80,0x3f803f80,0x0,0x0,0x3f803f80,0x3f803f80
.long 0x0,0x0,0x0,0x0,0x0,0x0,0x0,0x0,0x0,0x0,0x0,0x0,0x0,0x0,0x0,0x0
.long 0x0,0x0,0x0,0x0,0x0,0x0,0x0,0x0,0x0,0x0,0x0,0x0,0x0,0x0,0x0,0x0
.long 0x0,0x0,0x0,0x0,0x0,0x0,0x0,0x0,0x0,0x0,0x0,0x0,0x0,0x0,0x0,0x0
.long 0x0,0x0,0x0,0x0,0x3f80,0x0,0x0,0x0,0x3f803f80,0x0,0x0,0x0,0x3f803f80,0x3f80,0x0,0x0
.long 0x0,0x0,0x3f803f80,0x3f803f80,0x0,0x0,0x3f800000,0x3f803f80,0x0,0x0,0x0,0x3f803f80,0x0,0x0,0x0,0x3f800000
.long 0x0,0x0,0x0,0x0,0x0,0x0,0x0,0x0,0x0,0x0,0x0,0x0,0x0,0x0,0x0,0x0
.long 0x0,0x0,0x0,0x0,0x0,0x0,0x0,0x0,0x0,0x0,0x0,0x0,0x0,0x0,0x0,0x0
.long 0x0,0x0,0x0,0x0,0x0,0x0,0x0,0x0,0x0,0x0,0x0,0x0,0x0,0x0,0x0,0x0
.long 0x3f803f80,0x3f803f80,0x3f80,0x0,0x3f803f80,0x3f803f80,0x3f803f80,0x0,0x3f803f80,0x3f803f80,0x3f803f80,0x3f80,0x3f803f80,0x3f803f80,0x3f803f80,0x3f803f80
.long 0x3f803f80,0x3f803f80,0x3f803f80,0x3f803f80,0x3f800000,0x3f803f80,0x3f803f80,0x3f803f80,0x0,0x3f803f80,0x3f803f80,0x3f803f80,0x0,0x3f800000,0x3f803f80,0x3f803f80
.long 0x0,0x0,0x3f803f80,0x3f803f80,0x0,0x0,0x3f800000,0x3f803f80,0x0,0x0,0x0,0x3f803f80,0x0,0x0,0x0,0x3f800000
.long 0x0,0x0,0x0,0x0,0x0,0x0,0x0,0x0,0x0,0x0,0x0,0x0,0x0,0x0,0x0,0x0
.long 0x0,0x0,0x0,0x0,0x0,0x0,0x0,0x0,0x0,0x0,0x0,0x0,0x0,0x0,0x0,0x0
.long 0x3f80,0x0,0x0,0x0,0x3f803f80,0x0,0x0,0x0,0x3f803f80,0x3f80,0x0,0x0,0x3f803f80,0x3f803f80,0x0,0x0
.long 0x3f803f80,0x3f803f80,0x3f80,0x0,0x3f803f80,0x3f803f80,0x3f803f80,0x0,0x3f803f80,0x3f803f80,0x3f803f80,0x3f80,0x3f803f80,0x3f803f80,0x3f803f80,0x3f803f80
.long 0x3f803f80,0x3f803f80,0x3f803f80,0x3f803f80,0x3f800000,0x3f803f80,0x3f803f80,0x3f803f80,0x0,0x3f803f80,0x3f803f80,0x3f803f80,0x0,0x3f800000,0x3f803f80,0x3f803f80
.long 0x0,0x0,0x0,0x0,0x0,0x0,0x0,0x0,0x0,0x0,0x0,0x0,0x0,0x0,0x0,0x0
.long 0x0,0x0,0x0,0x0,0x0,0x0,0x0,0x0,0x0,0x0,0x0,0x0,0x0,0x0,0x0,0x0
.long 0x0,0x0,0x0,0x0,0x0,0x0,0x0,0x0,0x0,0x0,0x0,0x0,0x0,0x0,0x0,0x0
.long 0x3f80,0x0,0x0,0x0,0x3f803f80,0x0,0x0,0x0,0x3f803f80,0x3f80,0x0,0x0,0x3f803f80,0x3f803f80,0x0,0x0
.long 0x0,0x0,0x0,0x0,0x0,0x0,0x0,0x0,0x0,0x0,0x0,0x0,0x0,0x0,0x0,0x0
.long 0x0,0x0,0x0,0x0,0x0,0x0,0x0,0x0,0x0,0x0,0x0,0x0,0x0,0x0,0x0,0x0
.long 0x0,0x0,0x0,0x0,0x0,0x0,0x0,0x0,0x0,0x0,0x0,0x0,0x0,0x0,0x0,0x0
.long 0x0,0x0,0x0,0x0,0x0,0x0,0x0,0x0,0x0,0x0,0x0,0x0,0x0,0x0,0x0,0x0
.long 0x0,0x0,0xffffffff,0x0,0x0,0x0,0xffff0000,0xffff,0x0,0x0,0x0,0xffffffff,0x0,0x0,0x0,0xffff0000
.long 0x0,0x0,0x0,0x0,0x0,0x0,0x0,0x0,0x0,0x0,0x0,0x0,0x0,0x0,0x0,0x0
.long 0x0,0x0,0x0,0x0,0x0,0x0,0x0,0x0,0x0,0x0,0x0,0x0,0x0,0x0,0x0,0x0
.long 0x0,0x0,0x0,0x0,0x0,0x0,0x0,0x0,0x0,0x0,0x0,0x0,0x0,0x0,0x0,0x0
.long 0x0,0x0,0x0,0x0,0x0,0x0,0x0,0x0,0x0,0x0,0x0,0x0,0xffff,0x0,0x0,0x0
.long 0xffffffff,0x0,0x0,0x0,0xffff0000,0xffff,0x0,0x0,0x0,0xffffffff,0x0,0x0,0x0,0xffff0000,0xffff,0x0
.long 0x0,0x0,0xffffffff,0x0,0x0,0x0,0xffff0000,0xffff,0x0,0x0,0x0,0xffffffff,0x0,0x0,0x0,0xffff0000
.long 0x0,0x0,0x0,0x0,0x0,0x0,0x0,0x0,0x0,0x0,0x0,0x0,0x0,0x0,0x0,0x0
.long 0x0,0x0,0x0,0x0,0x0,0x0,0x0,0x0,0x0,0x0,0x0,0x0,0x0,0x0,0x0,0x0
.long 0x0,0x0,0x0,0x0,0x0,0x0,0x0,0x0,0x0,0x0,0x0,0x0,0x0,0x0,0x0,0x0
.long 0x0,0x0,0x0,0x0,0x0,0x0,0x0,0x0,0x0,0x0,0x0,0x0,0xffff,0x0,0x0,0x0
.long 0xffffffff,0x0,0x0,0x0,0xffff0000,0xffff,0x0,0x0,0x0,0xffffffff,0x0,0x0,0x0,0xffff0000,0xffff,0x0
.long 0x3f80,0x3f80,0x3f80,0x3f80,0x3f80,0x3ec43f6d,0x3f353f35,0x3f6d3ec4,0x3f80,0x3f353f35,0x3f800000,0x3f35bf35,0x3f80,0x3f6d3ec4,0x3f35bf35,0xbec4bf6d
.long 0x3f80,0x3f800000,0xbf80,0xbf800000,0x3f80,0x3f6dbec4,0xbf35bf35,0xbec43f6d,0x3f80,0x3f35bf35,0xbf800000,0x3f353f35,0x3f80,0x3ec4bf6d,0xbf353f35,0x3f6dbec4
.long 0x3f80,0xbf80,0x3f80,0xbf80,0x3f80,0xbec4bf6d,0x3f353f35,0xbf6dbec4,0x3f80,0xbf35bf35,0x3f800000,0xbf353f35,0x3f80,0xbf6dbec4,0x3f35bf35,0x3ec43f6d
.long 0x3f80,0xbf800000,0xbf80,0x3f800000,0x3f80,0xbf6d3ec4,0xbf35bf35,0x3ec4bf6d,0x3f80,0xbf353f35,0xbf800000,0xbf35bf35,0x3f80,0xbec43f6d,0xbf353f35,0xbf6d3ec4
.long 0x3f80,0x3f80,0x3f80,0x3f80,0x3f800000,0x3f6dbec4,0x3f35bf35,0x3ec4bf6d,0xbf80,0xbf35bf35,0xbf800000,0xbf353f35,0xbf800000,0xbec43f6d,0x3f353f35,0x3f6dbec4
.long 0x3f80,0x3f800000,0xbf80,0xbf800000,0x3f800000,0xbec4bf6d,0xbf353f35,0x3f6d3ec4,0xbf80,0xbf353f35,0x3f800000,0xbf35bf35,0xbf800000,0x3f6d3ec4,0xbf35bf35,0x3ec43f6d
.long 0x3f80,0xbf80,0x3f80,0xbf80,0x3f800000,0xbf6d3ec4,0x3f35bf35,0xbec43f6d,0xbf80,0x3f353f35,0xbf800000,0x3f35bf35,0xbf800000,0x3ec4bf6d,0x3f353f35,0xbf6d3ec4
.long 0x3f80,0xbf800000,0xbf80,0x3f800000,0x3f800000,0x3ec43f6d,0xbf353f35,0xbf6dbec4,0xbf80,0x3f35bf35,0x3f800000,0x3f353f35,0xbf800000,0xbf6dbec4,0xbf35bf35,0xbec4bf6d
.long 0x3f80,0x3f80,0x3f80,0x3f80,0xbf80,0xbec4bf6d,0xbf35bf35,0xbf6dbec4,0x3f80,0x3f353f35,0x3f800000,0x3f35bf35,0xbf80,0xbf6dbec4,0xbf353f35,0x3ec43f6d
.long 0x3f80,0x3f800000,0xbf80,0xbf800000,0xbf80,0xbf6d3ec4,0x3f353f35,0x3ec4bf6d,0x3f80,0x3f35bf35,0xbf800000,0x3f353f35,0xbf80,0xbec43f6d,0x3f35bf35,0xbf6d3ec4
.long 0x3f80,0xbf80,0x3f80,0xbf80,0xbf80,0x3ec43f6d,0xbf35bf35,0x3f6d3ec4,0x3f80,0xbf35bf35,0x3f800000,0xbf353f35,0xbf80,0x3f6d3ec4,0xbf353f35,0xbec4bf6d
.long 0x3f80,0xbf800000,0xbf80,0x3f800000,0xbf80,0x3f6dbec4,0x3f353f35,0xbec43f6d,0x3f80,0xbf353f35,0xbf800000,0xbf35bf35,0xbf80,0x3ec4bf6d,0x3f35bf35,0x3f6dbec4
.long 0x3f80,0x3f80,0x3f80,0x3f80,0xbf800000,0xbf6d3ec4,0xbf353f35,0xbec43f6d,0xbf80,0xbf35bf35,0xbf800000,0xbf353f35,0x3f800000,0x3ec4bf6d,0xbf35bf35,0xbf6d3ec4
.long 0x3f80,0x3f800000,0xbf80,0xbf800000,0xbf800000,0x3ec43f6d,0x3f35bf35,0xbf6dbec4,0xbf80,0xbf353f35,0x3f800000,0xbf35bf35,0x3f800000,0xbf6dbec4,0x3f353f35,0xbec4bf6d
.long 0x3f80,0xbf80,0x3f80,0xbf80,0xbf800000,0x3f6dbec4,0xbf353f35,0x3ec4bf6d,0xbf80,0x3f353f35,0xbf800000,0x3f35bf35,0x3f800000,0xbec43f6d,0xbf35bf35,0x3f6dbec4
.long 0x3f80,0xbf800000,0xbf80,0x3f800000,0xbf800000,0xbec4bf6d,0x3f35bf35,0x3f6d3ec4,0xbf80,0x3f35bf35,0x3f800000,0x3f353f35,0x3f800000,0x3f6d3ec4,0x3f353f35,0x3ec43f6d
.long 0x3f808000,0x3f808000,0x3f808000,0x3f808000,0x3f808000,0x3f6dbec4,0x3f35bf35,0x3ec4bf6d,0x3f808000,0x3f35bf35,0xbf80,0xbf35bf35,0x3f808000,0x3ec4bf6d,0xbf35bf35,0xbf6d3ec4
.long 0x3f808000,0xbf80,0xbf808000,0x3f80,0x3f808000,0xbec4bf6d,0xbf353f35,0x3f6d3ec4,0x3f808000,0xbf35bf35,0x3f80,0x3f35bf35,0x3f808000,0xbf6dbec4,0x3f353f35,0xbec4bf6d
.long 0x3f808000,0xbf808000,0x3f808000,0xbf808000,0x3f808000,0xbf6d3ec4,0x3f35bf35,0xbec43f6d,0x3f808000,0xbf353f35,0xbf80,0x3f353f35,0x3f808000,0xbec43f6d,0xbf35bf35,0x3f6dbec4
.long 0x3f808000,0x3f80,0xbf808000,0xbf80,0x3f808000,0x3ec43f6d,0xbf353f35,0xbf6dbec4,0x3f808000,0x3f353f35,0x3f80,0xbf353f35,0x3f808000,0x3f6d3ec4,0x3f353f35,0x3ec43f6d
.long 0x3f808000,0x3f808000,0x3f808000,0x3f808000,0xbf80,0xbec4bf6d,0xbf35bf35,0xbf6dbec4,0xbf808000,0xbf353f35,0x3f80,0x3f353f35,0x3f80,0x3f6d3ec4,0x3f35bf35,0xbec4bf6d
.long 0x3f808000,0xbf80,0xbf808000,0x3f80,0xbf80,0xbf6d3ec4,0x3f353f35,0x3ec4bf6d,0xbf808000,0x3f353f35,0xbf80,0xbf353f35,0x3f80,0x3ec4bf6d,0xbf353f35,0x3f6dbec4
.long 0x3f808000,0xbf808000,0x3f808000,0xbf808000,0xbf80,0x3ec43f6d,0xbf35bf35,0x3f6d3ec4,0xbf808000,0x3f35bf35,0x3f80,0xbf35bf35,0x3f80,0xbf6dbec4,0x3f35bf35,0x3ec43f6d
.long 0x3f808000,0x3f80,0xbf808000,0xbf80,0xbf80,0x3f6dbec4,0x3f353f35,0xbec43f6d,0xbf808000,0xbf35bf35,0xbf80,0x3f35bf35,0x3f80,0xbec43f6d,0xbf353f35,0xbf6d3ec4
.long 0x3f808000,0x3f808000,0x3f808000,0x3f808000,0xbf808000,0xbf6d3ec4,0xbf353f35,0xbec43f6d,0x3f808000,0x3f35bf35,0xbf80,0xbf35bf35,0xbf808000,0xbec43f6d,0x3f353f35,0x3f6dbec4
.long 0x3f808000,0xbf80,0xbf808000,0x3f80,0xbf808000,0x3ec43f6d,0x3f35bf35,0xbf6dbec4,0x3f808000,0xbf35bf35,0x3f80,0x3f35bf35,0xbf808000,0x3f6d3ec4,0xbf35bf35,0x3ec43f6d
.long 0x3f808000,0xbf808000,0x3f808000,0xbf808000,0xbf808000,0x3f6dbec4,0xbf353f35,0x3ec4bf6d,0x3f808000,0xbf353f35,0xbf80,0x3f353f35,0xbf808000,0x3ec4bf6d,0x3f353f35,0xbf6d3ec4
.long 0x3f808000,0x3f80,0xbf808000,0xbf80,0xbf808000,0xbec4bf6d,0x3f35bf35,0x3f6d3ec4,0x3f808000,0x3f353f35,0x3f80,0xbf353f35,0xbf808000,0xbf6dbec4,0xbf35bf35,0xbec4bf6d
.long 0x3f808000,0x3f808000,0x3f808000,0x3f808000,0x3f80,0x3ec43f6d,0x3f353f35,0x3f6d3ec4,0xbf808000,0xbf353f35,0x3f80,0x3f353f35,0xbf80,0xbf6dbec4,0xbf353f35,0x3ec43f6d
.long 0x3f808000,0xbf80,0xbf808000,0x3f80,0x3f80,0x3f6dbec4,0xbf35bf35,0xbec43f6d,0xbf808000,0x3f353f35,0xbf80,0xbf353f35,0xbf80,0xbec43f6d,0x3f35bf35,0xbf6d3ec4
.long 0x3f808000,0xbf808000,0x3f808000,0xbf808000,0x3f80,0xbec4bf6d,0x3f353f35,0xbf6dbec4,0xbf808000,0x3f35bf35,0x3f80,0xbf35bf35,0xbf80,0x3f6d3ec4,0xbf353f35,0xbec4bf6d
.long 0x3f808000,0x3f80,0xbf808000,0xbf80,0x3f80,0xbf6d3ec4,0xbf35bf35,0x3ec4bf6d,0xbf808000,0xbf35bf35,0xbf80,0x3f35bf35,0xbf80,0x3ec4bf6d,0x3f35bf35,0x3f6dbec4
.long 0x3f80,0x3f80,0x3f80,0x3f80,0x3f80,0x3ec43f6d,0x3f353f35,0x3f6d3ec4,0x3f80,0x3f353f35,0x3f800000,0x3f35bf35,0x3f80,0x3f6d3ec4,0x3f35bf35,0xbec4bf6d
.long 0x3f80,0x3f800000,0xbf80,0xbf800000,0x3f80,0x3f6dbec4,0xbf35bf35,0xbec43f6d,0x3f80,0x3f35bf35,0xbf800000,0x3f353f35,0x3f80,0x3ec4bf6d,0xbf353f35,0x3f6dbec4
.long 0x3f80,0xbf80,0x3f80,0xbf80,0x3f80,0xbec4bf6d,0x3f353f35,0xbf6dbec4,0x3f80,0xbf35bf35,0x3f800000,0xbf353f35,0x3f80,0xbf6dbec4,0x3f35bf35,0x3ec43f6d
.long 0x3f80,0xbf800000,0xbf80,0x3f800000,0x3f80,0xbf6d3ec4,0xbf35bf35,0x3ec4bf6d,0x3f80,0xbf353f35,0xbf800000,0xbf35bf35,0x3f80,0xbec43f6d,0xbf353f35,0xbf6d3ec4
.long 0x3f80,0x3f80,0x3f80,0x3f80,0x3f800000,0x3f6dbec4,0x3f35bf35,0x3ec4bf6d,0xbf80,0xbf35bf35,0xbf800000,0xbf353f35,0xbf800000,0xbec43f6d,0x3f353f35,0x3f6dbec4
.long 0x3f80,0x3f800000,0xbf80,0xbf800000,0x3f800000,0xbec4bf6d,0xbf353f35,0x3f6d3ec4,0xbf80,0xbf353f35,0x3f800000,0xbf35bf35,0xbf800000,0x3f6d3ec4,0xbf35bf35,0x3ec43f6d
.long 0x3f80,0xbf80,0x3f80,0xbf80,0x3f800000,0xbf6d3ec4,0x3f35bf35,0xbec43f6d,0xbf80,0x3f353f35,0xbf800000,0x3f35bf35,0xbf800000,0x3ec4bf6d,0x3f353f35,0xbf6d3ec4
.long 0x3f80,0xbf800000,0xbf80,0x3f800000,0x3f800000,0x3ec43f6d,0xbf353f35,0xbf6dbec4,0xbf80,0x3f35bf35,0x3f800000,0x3f353f35,0xbf800000,0xbf6dbec4,0xbf35bf35,0xbec4bf6d
.long 0x3f80,0x3f80,0x3f80,0x3f80,0xbf80,0xbec4bf6d,0xbf35bf35,0xbf6dbec4,0x3f80,0x3f353f35,0x3f800000,0x3f35bf35,0xbf80,0xbf6dbec4,0xbf353f35,0x3ec43f6d
.long 0x3f80,0x3f800000,0xbf80,0xbf800000,0xbf80,0xbf6d3ec4,0x3f353f35,0x3ec4bf6d,0x3f80,0x3f35bf35,0xbf800000,0x3f353f35,0xbf80,0xbec43f6d,0x3f35bf35,0xbf6d3ec4
.long 0x3f80,0xbf80,0x3f80,0xbf80,0xbf80,0x3ec43f6d,0xbf35bf35,0x3f6d3ec4,0x3f80,0xbf35bf35,0x3f800000,0xbf353f35,0xbf80,0x3f6d3ec4,0xbf353f35,0xbec4bf6d
.long 0x3f80,0xbf800000,0xbf80,0x3f800000,0xbf80,0x3f6dbec4,0x3f353f35,0xbec43f6d,0x3f80,0xbf353f35,0xbf800000,0xbf35bf35,0xbf80,0x3ec4bf6d,0x3f35bf35,0x3f6dbec4
.long 0x3f80,0x3f80,0x3f80,0x3f80,0xbf800000,0xbf6d3ec4,0xbf353f35,0xbec43f6d,0xbf80,0xbf35bf35,0xbf800000,0xbf353f35,0x3f800000,0x3ec4bf6d,0xbf35bf35,0xbf6d3ec4
.long 0x3f80,0x3f800000,0xbf80,0xbf800000,0xbf800000,0x3ec43f6d,0x3f35bf35,0xbf6dbec4,0xbf80,0xbf353f35,0x3f800000,0xbf35bf35,0x3f800000,0xbf6dbec4,0x3f353f35,0xbec4bf6d
.long 0x3f80,0xbf80,0x3f80,0xbf80,0xbf800000,0x3f6dbec4,0xbf353f35,0x3ec4bf6d,0xbf80,0x3f353f35,0xbf800000,0x3f35bf35,0x3f800000,0xbec43f6d,0xbf35bf35,0x3f6dbec4
.long 0x3f80,0xbf800000,0xbf80,0x3f800000,0xbf800000,0xbec4bf6d,0x3f35bf35,0x3f6d3ec4,0xbf80,0x3f35bf35,0x3f800000,0x3f353f35,0x3f800000,0x3f6d3ec4,0x3f353f35,0x3ec43f6d
.long 0x3f808000,0x3f808000,0x3f808000,0x3f808000,0x3f808000,0x3f6dbec4,0x3f35bf35,0x3ec4bf6d,0x3f808000,0x3f35bf35,0xbf80,0xbf35bf35,0x3f808000,0x3ec4bf6d,0xbf35bf35,0xbf6d3ec4
.long 0x3f808000,0xbf80,0xbf808000,0x3f80,0x3f808000,0xbec4bf6d,0xbf353f35,0x3f6d3ec4,0x3f808000,0xbf35bf35,0x3f80,0x3f35bf35,0x3f808000,0xbf6dbec4,0x3f353f35,0xbec4bf6d
.long 0x3f808000,0xbf808000,0x3f808000,0xbf808000,0x3f808000,0xbf6d3ec4,0x3f35bf35,0xbec43f6d,0x3f808000,0xbf353f35,0xbf80,0x3f353f35,0x3f808000,0xbec43f6d,0xbf35bf35,0x3f6dbec4
.long 0x3f808000,0x3f80,0xbf808000,0xbf80,0x3f808000,0x3ec43f6d,0xbf353f35,0xbf6dbec4,0x3f808000,0x3f353f35,0x3f80,0xbf353f35,0x3f808000,0x3f6d3ec4,0x3f353f35,0x3ec43f6d
.long 0x3f808000,0x3f808000,0x3f808000,0x3f808000,0xbf80,0xbec4bf6d,0xbf35bf35,0xbf6dbec4,0xbf808000,0xbf353f35,0x3f80,0x3f353f35,0x3f80,0x3f6d3ec4,0x3f35bf35,0xbec4bf6d
.long 0x3f808000,0xbf80,0xbf808000,0x3f80,0xbf80,0xbf6d3ec4,0x3f353f35,0x3ec4bf6d,0xbf808000,0x3f353f35,0xbf80,0xbf353f35,0x3f80,0x3ec4bf6d,0xbf353f35,0x3f6dbec4
.long 0x3f808000,0xbf808000,0x3f808000,0xbf808000,0xbf80,0x3ec43f6d,0xbf35bf35,0x3f6d3ec4,0xbf808000,0x3f35bf35,0x3f80,0xbf35bf35,0x3f80,0xbf6dbec4,0x3f35bf35,0x3ec43f6d
.long 0x3f808000,0x3f80,0xbf808000,0xbf80,0xbf80,0x3f6dbec4,0x3f353f35,0xbec43f6d,0xbf808000,0xbf35bf35,0xbf80,0x3f35bf35,0x3f80,0xbec43f6d,0xbf353f35,0xbf6d3ec4
.long 0x3f808000,0x3f808000,0x3f808000,0x3f808000,0xbf808000,0xbf6d3ec4,0xbf353f35,0xbec43f6d,0x3f808000,0x3f35bf35,0xbf80,0xbf35bf35,0xbf808000,0xbec43f6d,0x3f353f35,0x3f6dbec4
.long 0x3f808000,0xbf80,0xbf808000,0x3f80,0xbf808000,0x3ec43f6d,0x3f35bf35,0xbf6dbec4,0x3f808000,0xbf35bf35,0x3f80,0x3f35bf35,0xbf808000,0x3f6d3ec4,0xbf35bf35,0x3ec43f6d
.long 0x3f808000,0xbf808000,0x3f808000,0xbf808000,0xbf808000,0x3f6dbec4,0xbf353f35,0x3ec4bf6d,0x3f808000,0xbf353f35,0xbf80,0x3f353f35,0xbf808000,0x3ec4bf6d,0x3f353f35,0xbf6d3ec4
.long 0x3f808000,0x3f80,0xbf808000,0xbf80,0xbf808000,0xbec4bf6d,0x3f35bf35,0x3f6d3ec4,0x3f808000,0x3f353f35,0x3f80,0xbf353f35,0xbf808000,0xbf6dbec4,0xbf35bf35,0xbec4bf6d
.long 0x3f808000,0x3f808000,0x3f808000,0x3f808000,0x3f80,0x3ec43f6d,0x3f353f35,0x3f6d3ec4,0xbf808000,0xbf353f35,0x3f80,0x3f353f35,0xbf80,0xbf6dbec4,0xbf353f35,0x3ec43f6d
.long 0x3f808000,0xbf80,0xbf808000,0x3f80,0x3f80,0x3f6dbec4,0xbf35bf35,0xbec43f6d,0xbf808000,0x3f353f35,0xbf80,0xbf353f35,0xbf80,0xbec43f6d,0x3f35bf35,0xbf6d3ec4
.long 0x3f808000,0xbf808000,0x3f808000,0xbf808000,0x3f80,0xbec4bf6d,0x3f353f35,0xbf6dbec4,0xbf808000,0x3f35bf35,0x3f80,0xbf35bf35,0xbf80,0x3f6d3ec4,0xbf353f35,0xbec4bf6d
.long 0x3f808000,0x3f80,0xbf808000,0xbf80,0x3f80,0xbf6d3ec4,0xbf35bf35,0x3ec4bf6d,0xbf808000,0xbf35bf35,0xbf80,0x3f35bf35,0xbf80,0x3ec4bf6d,0x3f35bf35,0x3f6dbec4
.long 0x80003f80,0x80003f80,0x80003f80,0x80003f80,0x80003f80,0xbec43f6d,0xbf353f35,0xbf6d3ec4,0x80003f80,0xbf353f35,0xbf800000,0xbf35bf35,0x80003f80,0xbf6d3ec4,0xbf35bf35,0x3ec4bf6d
.long 0x80003f80,0xbf800000,0x8000bf80,0x3f800000,0x80003f80,0xbf6dbec4,0x3f35bf35,0x3ec43f6d,0x80003f80,0xbf35bf35,0x3f800000,0xbf353f35,0x80003f80,0xbec4bf6d,0x3f353f35,0xbf6dbec4
.long 0x80003f80,0x8000bf80,0x80003f80,0x8000bf80,0x80003f80,0x3ec4bf6d,0xbf353f35,0x3f6dbec4,0x80003f80,0x3f35bf35,0xbf800000,0x3f353f35,0x80003f80,0x3f6dbec4,0xbf35bf35,0xbec43f6d
.long 0x80003f80,0x3f800000,0x8000bf80,0xbf800000,0x80003f80,0x3f6d3ec4,0x3f35bf35,0xbec4bf6d,0x80003f80,0x3f353f35,0x3f800000,0x3f35bf35,0x80003f80,0x3ec43f6d,0x3f353f35,0x3f6d3ec4
.long 0x80003f80,0x80003f80,0x80003f80,0x80003f80,0xbf800000,0xbf6dbec4,0xbf35bf35,0xbec4bf6d,0x8000bf80,0x3f35bf35,0x3f800000,0x3f353f35,0x3f800000,0x3ec43f6d,0xbf353f35,0xbf6dbec4
.long 0x80003f80,0xbf800000,0x8000bf80,0x3f800000,0xbf800000,0x3ec4bf6d,0x3f353f35,0xbf6d3ec4,0x8000bf80,0x3f353f35,0xbf800000,0x3f35bf35,0x3f800000,0xbf6d3ec4,0x3f35bf35,0xbec43f6d
.long 0x80003f80,0x8000bf80,0x80003f80,0x8000bf80,0xbf800000,0x3f6d3ec4,0xbf35bf35,0x3ec43f6d,0x8000bf80,0xbf353f35,0x3f800000,0xbf35bf35,0x3f800000,0xbec4bf6d,0xbf353f35,0x3f6d3ec4
.long 0x80003f80,0x3f800000,0x8000bf80,0xbf800000,0xbf800000,0xbec43f6d,0x3f353f35,0x3f6dbec4,0x8000bf80,0xbf35bf35,0xbf800000,0xbf353f35,0x3f800000,0x3f6dbec4,0x3f35bf35,0x3ec4bf6d
.long 0x80003f80,0x80003f80,0x80003f80,0x80003f80,0x8000bf80,0x3ec4bf6d,0x3f35bf35,0x3f6dbec4,0x80003f80,0xbf353f35,0xbf800000,0xbf35bf35,0x8000bf80,0x3f6dbec4,0x3f353f35,0xbec43f6d
.long 0x80003f80,0xbf800000,0x8000bf80,0x3f800000,0x8000bf80,0x3f6d3ec4,0xbf353f35,0xbec4bf6d,0x80003f80,0xbf35bf35,0x3f800000,0xbf353f35,0x8000bf80,0x3ec43f6d,0xbf35bf35,0x3f6d3ec4
.long 0x80003f80,0x8000bf80,0x80003f80,0x8000bf80,0x8000bf80,0xbec43f6d,0x3f35bf35,0xbf6d3ec4,0x80003f80,0x3f35bf35,0xbf800000,0x3f353f35,0x8000bf80,0xbf6d3ec4,0x3f353f35,0x3ec4bf6d
.long 0x80003f80,0x3f800000,0x8000bf80,0xbf800000,0x8000bf80,0xbf6dbec4,0xbf353f35,0x3ec43f6d,0x80003f80,0x3f353f35,0x3f800000,0x3f35bf35,0x8000bf80,0xbec4bf6d,0xbf35bf35,0xbf6dbec4
.long 0x80003f80,0x80003f80,0x80003f80,0x80003f80,0x3f800000,0x3f6d3ec4,0x3f353f35,0x3ec43f6d,0x8000bf80,0x3f35bf35,0x3f800000,0x3f353f35,0xbf800000,0xbec4bf6d,0x3f35bf35,0x3f6d3ec4
.long 0x80003f80,0xbf800000,0x8000bf80,0x3f800000,0x3f800000,0xbec43f6d,0xbf35bf35,0x3f6dbec4,0x8000bf80,0x3f353f35,0xbf800000,0x3f35bf35,0xbf800000,0x3f6dbec4,0xbf353f35,0x3ec4bf6d
.long 0x80003f80,0x8000bf80,0x80003f80,0x8000bf80,0x3f800000,0xbf6dbec4,0x3f353f35,0xbec4bf6d,0x8000bf80,0xbf353f35,0x3f800000,0xbf35bf35,0xbf800000,0x3ec43f6d,0x3f35bf35,0xbf6dbec4
.long 0x80003f80,0x3f800000,0x8000bf80,0xbf800000,0x3f800000,0x3ec4bf6d,0xbf35bf35,0xbf6d3ec4,0x8000bf80,0xbf35bf35,0xbf800000,0xbf353f35,0xbf800000,0xbf6d3ec4,0xbf353f35,0xbec43f6d
.long 0x3f800000,0x3f800000,0x3f800000,0x3f800000,0x3f800000,0x3f6d3ec4,0x3f353f35,0x3ec43f6d,0x3f800000,0x3f353f35,0x3f80,0xbf353f35,0x3f800000,0x3ec43f6d,0xbf353f35,0xbf6dbec4
.long 0x3f800000,0x3f80,0xbf800000,0xbf80,0x3f800000,0xbec43f6d,0xbf35bf35,0x3f6dbec4,0x3f800000,0xbf353f35,0xbf80,0x3f353f35,0x3f800000,0xbf6d3ec4,0x3f35bf35,0xbec43f6d
.long 0x3f800000,0xbf800000,0x3f800000,0xbf800000,0x3f800000,0xbf6dbec4,0x3f353f35,0xbec4bf6d,0x3f800000,0xbf35bf35,0x3f80,0x3f35bf35,0x3f800000,0xbec4bf6d,0xbf353f35,0x3f6d3ec4
.long 0x3f800000,0xbf80,0xbf800000,0x3f80,0x3f800000,0x3ec4bf6d,0xbf35bf35,0xbf6d3ec4,0x3f800000,0x3f35bf35,0xbf80,0xbf35bf35,0x3f800000,0x3f6dbec4,0x3f35bf35,0x3ec4bf6d
.long 0x3f800000,0x3f800000,0x3f800000,0x3f800000,0x3f80,0xbec43f6d,0xbf353f35,0xbf6d3ec4,0xbf800000,0xbf35bf35,0xbf80,0x3f35bf35,0xbf80,0x3f6dbec4,0x3f353f35,0xbec43f6d
.long 0x3f800000,0x3f80,0xbf800000,0xbf80,0x3f80,0xbf6dbec4,0x3f35bf35,0x3ec43f6d,0xbf800000,0x3f35bf35,0x3f80,0xbf35bf35,0xbf80,0x3ec43f6d,0xbf35bf35,0x3f6d3ec4
.long 0x3f800000,0xbf800000,0x3f800000,0xbf800000,0x3f80,0x3ec4bf6d,0xbf353f35,0x3f6dbec4,0xbf800000,0x3f353f35,0xbf80,0xbf353f35,0xbf80,0xbf6d3ec4,0x3f353f35,0x3ec4bf6d
.long 0x3f800000,0xbf80,0xbf800000,0x3f80,0x3f80,0x3f6d3ec4,0x3f35bf35,0xbec4bf6d,0xbf800000,0xbf353f35,0x3f80,0x3f353f35,0xbf80,0xbec4bf6d,0xbf35bf35,0xbf6dbec4
.long 0x3f800000,0x3f800000,0x3f800000,0x3f800000,0xbf800000,0xbf6dbec4,0xbf35bf35,0xbec4bf6d,0x3f800000,0x3f353f35,0x3f80,0xbf353f35,0xbf800000,0xbec4bf6d,0x3f35bf35,0x3f6d3ec4
.long 0x3f800000,0x3f80,0xbf800000,0xbf80,0xbf800000,0x3ec4bf6d,0x3f353f35,0xbf6d3ec4,0x3f800000,0xbf353f35,0xbf80,0x3f353f35,0xbf800000,0x3f6dbec4,0xbf353f35,0x3ec4bf6d
.long 0x3f800000,0xbf800000,0x3f800000,0xbf800000,0xbf800000,0x3f6d3ec4,0xbf35bf35,0x3ec43f6d,0x3f800000,0xbf35bf35,0x3f80,0x3f35bf35,0xbf800000,0x3ec43f6d,0x3f35bf35,0xbf6dbec4
.long 0x3f800000,0xbf80,0xbf800000,0x3f80,0xbf800000,0xbec43f6d,0x3f353f35,0x3f6dbec4,0x3f800000,0x3f35bf35,0xbf80,0xbf35bf35,0xbf800000,0xbf6d3ec4,0xbf353f35,0xbec43f6d
.long 0x3f800000,0x3f800000,0x3f800000,0x3f800000,0xbf80,0x3ec4bf6d,0x3f35bf35,0x3f6dbec4,0xbf800000,0xbf35bf35,0xbf80,0x3f35bf35,0x3f80,0xbf6d3ec4,0xbf35bf35,0x3ec4bf6d
.long 0x3f800000,0x3f80,0xbf800000,0xbf80,0xbf80,0x3f6d3ec4,0xbf353f35,0xbec4bf6d,0xbf800000,0x3f35bf35,0x3f80,0xbf35bf35,0x3f80,0xbec4bf6d,0x3f353f35,0xbf6dbec4
.long 0x3f800000,0xbf800000,0x3f800000,0xbf800000,0xbf80,0xbec43f6d,0x3f35bf35,0xbf6d3ec4,0xbf800000,0x3f353f35,0xbf80,0xbf353f35,0x3f80,0x3f6dbec4,0xbf35bf35,0xbec43f6d
.long 0x3f800000,0xbf80,0xbf800000,0x3f80,0xbf80,0xbf6dbec4,0xbf353f35,0x3ec43f6d,0xbf800000,0xbf353f35,0x3f80,0x3f353f35,0x3f80,0x3ec43f6d,0x3f353f35,0x3f6d3ec4
.long 0x3f800000,0x3f800000,0x3f800000,0x3f800000,0x3f800000,0x3f7fec43,0x3f7fb10f,0x3f7f4e6d,0x3f800000,0x3f7fb10f,0x3f7ec46d,0x3f7d3aac,0x3f800000,0x3f7f4e6d,0x3f7d3aac,0x3f79c79d
.long 0x3f800000,0x3f7ec46d,0x3f7b14be,0x3f74fa0b,0x3f800000,0x3f7e1324,0x3f7853f8,0x3f6ed89e,0x3f800000,0x3f7d3aac,0x3f74fa0b,0x3f676bd8,0x3f800000,0x3f7c3b28,0x3f710908,0x3f5ebe05
.long 0x3f800000,0x3f7b14be,0x3f6c835e,0x3f54db31,0x3f800000,0x3f79c79d,0x3f676bd8,0x3f49d112,0x3f800000,0x3f7853f8,0x3f61c598,0x3f3daef9,0x3f800000,0x3f76ba07,0x3f5b941a,0x3f3085bb
.long 0x3f800000,0x3f74fa0b,0x3f54db31,0x3f226799,0x3f800000,0x3f731447,0x3f4d9f02,0x3f13682a,0x3f800000,0x3f710908,0x3f45e403,0x3f039c3d,0x3f800000,0x3f6ed89e,0x3f3daef9,0x3ee63375
.long 0x3f800000,0x3f800000,0x3f800000,0x3f800000,0x3f7ec46d,0x3f7e1324,0x3f7d3aac,0x3f7c3b28,0x3f7b14be,0x3f7853f8,0x3f74fa0b,0x3f710908,0x3f74fa0b,0x3f6ed89e,0x3f676bd8,0x3f5ebe05
.long 0x3f6c835e,0x3f61c598,0x3f54db31,0x3f45e403,0x3f61c598,0x3f514d3d,0x3f3daef9,0x3f273656,0x3f54db31,0x3f3daef9,0x3f226799,0x3f039c3d,0x3f45e403,0x3f273656,0x3f039c3d,0x3eb8442a
.long 0x3f3504f3,0x3f0e39da,0x3ec3ef15,0x3e47c5c2,0x3f226799,0x3ee63375,0x3e78cfcc,0x3cc90ab0,0x3f0e39da,0x3eac7cd4,0x3dc8bd36,0xbe164083,0x3ef15aea,0x3e605c13,0xbd48fb30,0xbea09ae5
.long 0x3ec3ef15,0x3dc8bd36,0xbe47c5c2,0xbef15aea,0x3e94a031,0xbcc90ab0,0xbeac7cd4,0xbf1d7fd1,0x3e47c5c2,0xbe164083,0xbef15aea,0xbf3daef9,0x3dc8bd36,0xbe888e93,0xbf187fc0,0xbf584853
.long 0x3f800000,0x3f800000,0x3f800000,0x3f800000,0x3f7b14be,0x3f79c79d,0x3f7853f8,0x3f76ba07,0x3f6c835e,0x3f676bd8,0x3f61c598,0x3f5b941a,0x3f54db31,0x3f49d112,0x3f3daef9,0x3f3085bb
.long 0x3f3504f3,0x3f226799,0x3f0e39da,0x3ef15aea,0x3f0e39da,0x3ee63375,0x3eac7cd4,0x3e605c13,0x3ec3ef15,0x3e78cfcc,0x3dc8bd36,0xbd48fb30,0x3e47c5c2,0x3cc90ab0,0xbe164083,0xbea09ae5
.long 0x0,0xbe47c5c2,0xbec3ef15,0xbf0e39da,0xbe47c5c2,0xbecf7bca,0xbf187fc0,0xbf41d870,0xbec3ef15,0xbf187fc0,0xbf45e403,0xbf676bd8,0xbf0e39da,0xbf41d870,0xbf676bd8,0xbf7c3b28
.long 0xbf3504f3,0xbf61c598,0xbf7b14be,0xbf7ec46d,0xbf54db31,0xbf76ba07,0xbf7fb10f,0xbf6ed89e,0xbf6c835e,0xbf7fb10f,0xbf74fa0b,0xbf4d9f02,0xbf7b14be,0xbf7c3b28,0xbf5b941a,0xbf1d7fd1
.long 0x3f800000,0x3f800000,0x3f800000,0x3f800000,0x3f74fa0b,0x3f731447,0x3f710908,0x3f6ed89e,0x3f54db31,0x3f4d9f02,0x3f45e403,0x3f3daef9,0x3f226799,0x3f13682a,0x3f039c3d,0x3ee63375
.long 0x3ec3ef15,0x3e94a031,0x3e47c5c2,0x3dc8bd36,0x3dc8bd36,0xbcc90ab0,0xbe164083,0xbe888e93,0xbe47c5c2,0xbeac7cd4,0xbef15aea,0xbf187fc0,0xbef15aea,0xbf1d7fd1,0xbf3daef9,0xbf584853
.long 0xbf3504f3,0xbf54db31,0xbf6c835e,0xbf7b14be,0xbf61c598,0xbf76ba07,0xbf7fb10f,0xbf7c3b28,0xbf7b14be,0xbf7fb10f,0xbf74fa0b,0xbf5b941a,0xbf7ec46d,0xbf6ed89e,0xbf4d9f02,0xbf1d7fd1
.long 0xbf6c835e,0xbf45e403,0xbf0e39da,0xbe94a031,0xbf45e403,0xbf08f59b,0xbe78cfcc,0x3d96a905,0xbf0e39da,0xbe78cfcc,0x3dc8bd36,0x3edae880,0xbe94a031,0x3d96a905,0x3edae880,0x3f396842
.long 0x0,0x0,0x0,0x0,0x0,0x3cc90ab0,0x3d48fb30,0x3d96a905,0x0,0x3d48fb30,0x3dc8bd36,0x3e164083,0x0,0x3d96a905,0x3e164083,0x3e605c13
.long 0x0,0x3dc8bd36,0x3e47c5c2,0x3e94a031,0x0,0x3dfab273,0x3e78cfcc,0x3eb8442a,0x0,0x3e164083,0x3e94a031,0x3edae880,0x0,0x3e2f10a2,0x3eac7cd4,0x3efc5d27
.long 0x0,0x3e47c5c2,0x3ec3ef15,0x3f0e39da,0x0,0x3e605c13,0x3edae880,0x3f1d7fd1,0x0,0x3e78cfcc,0x3ef15aea,0x3f2beb4a,0x0,0x3e888e93,0x3f039c3d,0x3f396842
.long 0x0,0x3e94a031,0x3f0e39da,0x3f45e403,0x0,0x3ea09ae5,0x3f187fc0,0x3f514d3d,0x0,0x3eac7cd4,0x3f226799,0x3f5b941a,0x0,0x3eb8442a,0x3f2beb4a,0x3f64aa59
.long 0x0,0x0,0x0,0x0,0x3dc8bd36,0x3dfab273,0x3e164083,0x3e2f10a2,0x3e47c5c2,0x3e78cfcc,0x3e94a031,0x3eac7cd4,0x3e94a031,0x3eb8442a,0x3edae880,0x3efc5d27
.long 0x3ec3ef15,0x3ef15aea,0x3f0e39da,0x3f226799,0x3ef15aea,0x3f13682a,0x3f2beb4a,0x3f41d870,0x3f0e39da,0x3f2beb4a,0x3f45e403,0x3f5b941a,0x3f226799,0x3f41d870,0x3f5b941a,0x3f6ed89e
.long 0x3f3504f3,0x3f54db31,0x3f6c835e,0x3f7b14be,0x3f45e403,0x3f64aa59,0x3f7853f8,0x3f7fec43,0x3f54db31,0x3f710908,0x3f7ec46d,0x3f7d3aac,0x3f61c598,0x3f79c79d,0x3f7fb10f,0x3f731447
.long 0x3f6c835e,0x3f7ec46d,0x3f7b14be,0x3f61c598,0x3f74fa0b,0x3f7fec43,0x3f710908,0x3f49d112,0x3f7b14be,0x3f7d3aac,0x3f61c598,0x3f2beb4a,0x3f7ec46d,0x3f76ba07,0x3f4d9f02,0x3f08f59b
.long 0x0,0x0,0x0,0x0,0x3e47c5c2,0x3e605c13,0x3e78cfcc,0x3e888e93,0x3ec3ef15,0x3edae880,0x3ef15aea,0x3f039c3d,0x3f0e39da,0x3f1d7fd1,0x3f2beb4a,0x3f396842
.long 0x3f3504f3,0x3f45e403,0x3f54db31,0x3f61c598,0x3f54db31,0x3f64aa59,0x3f710908,0x3f79c79d,0x3f6c835e,0x3f7853f8,0x3f7ec46d,0x3f7fb10f,0x3f7b14be,0x3f7fec43,0x3f7d3aac,0x3f731447
.long 0x3f800000,0x3f7b14be,0x3f6c835e,0x3f54db31,0x3f7b14be,0x3f6a09a7,0x3f4d9f02,0x3f273656,0x3f6c835e,0x3f4d9f02,0x3f226799,0x3edae880,0x3f54db31,0x3f273656,0x3edae880,0x3e2f10a2
.long 0x3f3504f3,0x3ef15aea,0x3e47c5c2,0xbdc8bd36,0x3f0e39da,0x3e888e93,0xbd48fb30,0xbeb8442a,0x3ec3ef15,0x3d48fb30,0xbe94a031,0xbf187fc0,0x3e47c5c2,0xbe2f10a2,0xbf039c3d,0xbf49d112
.long 0x0,0x0,0x0,0x0,0x3e94a031,0x3ea09ae5,0x3eac7cd4,0x3eb8442a,0x3f0e39da,0x3f187fc0,0x3f226799,0x3f2beb4a,0x3f45e403,0x3f514d3d,0x3f5b941a,0x3f64aa59
.long 0x3f6c835e,0x3f74fa0b,0x3f7b14be,0x3f7ec46d,0x3f7ec46d,0x3f7fec43,0x3f7d3aac,0x3f76ba07,0x3f7b14be,0x3f710908,0x3f61c598,0x3f4d9f02,0x3f61c598,0x3f49d112,0x3f2beb4a,0x3f08f59b
.long 0x3f3504f3,0x3f0e39da,0x3ec3ef15,0x3e47c5c2,0x3ef15aea,0x3e888e93,0x3d48fb30,0xbe2f10a2,0x3e47c5c2,0xbd48fb30,0xbe94a031,0xbf039c3d,0xbdc8bd36,0xbeb8442a,0xbf187fc0,0xbf49d112
.long 0xbec3ef15,0xbf226799,0xbf54db31,0xbf74fa0b,0xbf226799,0xbf584853,0xbf7853f8,0xbf7f4e6d,0xbf54db31,0xbf7853f8,0xbf7ec46d,0xbf676bd8,0xbf74fa0b,0xbf7f4e6d,0xbf676bd8,0xbf3085bb
.long 0x3f800000,0x3f800000,0x3f800000,0x3f800000,0x3f800000,0x3f7fec43,0x3f7fb10f,0x3f7f4e6d,0x3f800000,0x3f7fb10f,0x3f7ec46d,0x3f7d3aac,0x3f800000,0x3f7f4e6d,0x3f7d3aac,0x3f79c79d
.long 0x3f800000,0x3f7ec46d,0x3f7b14be,0x3f74fa0b,0x3f800000,0x3f7e1324,0x3f7853f8,0x3f6ed89e,0x3f800000,0x3f7d3aac,0x3f74fa0b,0x3f676bd8,0x3f800000,0x3f7c3b28,0x3f710908,0x3f5ebe05
.long 0x3f800000,0x3f7b14be,0x3f6c835e,0x3f54db31,0x3f800000,0x3f79c79d,0x3f676bd8,0x3f49d112,0x3f800000,0x3f7853f8,0x3f61c598,0x3f3daef9,0x3f800000,0x3f76ba07,0x3f5b941a,0x3f3085bb
.long 0x3f800000,0x3f74fa0b,0x3f54db31,0x3f226799,0x3f800000,0x3f731447,0x3f4d9f02,0x3f13682a,0x3f800000,0x3f710908,0x3f45e403,0x3f039c3d,0x3f800000,0x3f6ed89e,0x3f3daef9,0x3ee63375
.long 0x3f800000,0x3f800000,0x3f800000,0x3f800000,0x3f7ec46d,0x3f7e1324,0x3f7d3aac,0x3f7c3b28,0x3f7b14be,0x3f7853f8,0x3f74fa0b,0x3f710908,0x3f74fa0b,0x3f6ed89e,0x3f676bd8,0x3f5ebe05
.long 0x3f6c835e,0x3f61c598,0x3f54db31,0x3f45e403,0x3f61c598,0x3f514d3d,0x3f3daef9,0x3f273656,0x3f54db31,0x3f3daef9,0x3f226799,0x3f039c3d,0x3f45e403,0x3f273656,0x3f039c3d,0x3eb8442a
.long 0x3f3504f3,0x3f0e39da,0x3ec3ef15,0x3e47c5c2,0x3f226799,0x3ee63375,0x3e78cfcc,0x3cc90ab0,0x3f0e39da,0x3eac7cd4,0x3dc8bd36,0xbe164083,0x3ef15aea,0x3e605c13,0xbd48fb30,0xbea09ae5
.long 0x3ec3ef15,0x3dc8bd36,0xbe47c5c2,0xbef15aea,0x3e94a031,0xbcc90ab0,0xbeac7cd4,0xbf1d7fd1,0x3e47c5c2,0xbe164083,0xbef15aea,0xbf3daef9,0x3dc8bd36,0xbe888e93,0xbf187fc0,0xbf584853
.long 0x3f800000,0x3f800000,0x3f800000,0x3f800000,0x3f7b14be,0x3f79c79d,0x3f7853f8,0x3f76ba07,0x3f6c835e,0x3f676bd8,0x3f61c598,0x3f5b941a,0x3f54db31,0x3f49d112,0x3f3daef9,0x3f3085bb
.long 0x3f3504f3,0x3f226799,0x3f0e39da,0x3ef15aea,0x3f0e39da,0x3ee63375,0x3eac7cd4,0x3e605c13,0x3ec3ef15,0x3e78cfcc,0x3dc8bd36,0xbd48fb30,0x3e47c5c2,0x3cc90ab0,0xbe164083,0xbea09ae5
.long 0x0,0xbe47c5c2,0xbec3ef15,0xbf0e39da,0xbe47c5c2,0xbecf7bca,0xbf187fc0,0xbf41d870,0xbec3ef15,0xbf187fc0,0xbf45e403,0xbf676bd8,0xbf0e39da,0xbf41d870,0xbf676bd8,0xbf7c3b28
.long 0xbf3504f3,0xbf61c598,0xbf7b14be,0xbf7ec46d,0xbf54db31,0xbf76ba07,0xbf7fb10f,0xbf6ed89e,0xbf6c835e,0xbf7fb10f,0xbf74fa0b,0xbf4d9f02,0xbf7b14be,0xbf7c3b28,0xbf5b941a,0xbf1d7fd1
.long 0x3f800000,0x3f800000,0x3f800000,0x3f800000,0x3f74fa0b,0x3f731447,0x3f710908,0x3f6ed89e,0x3f54db31,0x3f4d9f02,0x3f45e403,0x3f3daef9,0x3f226799,0x3f13682a,0x3f039c3d,0x3ee63375
.long 0x3ec3ef15,0x3e94a031,0x3e47c5c2,0x3dc8bd36,0x3dc8bd36,0xbcc90ab0,0xbe164083,0xbe888e93,0xbe47c5c2,0xbeac7cd4,0xbef15aea,0xbf187fc0,0xbef15aea,0xbf1d7fd1,0xbf3daef9,0xbf584853
.long 0xbf3504f3,0xbf54db31,0xbf6c835e,0xbf7b14be,0xbf61c598,0xbf76ba07,0xbf7fb10f,0xbf7c3b28,0xbf7b14be,0xbf7fb10f,0xbf74fa0b,0xbf5b941a,0xbf7ec46d,0xbf6ed89e,0xbf4d9f02,0xbf1d7fd1
.long 0xbf6c835e,0xbf45e403,0xbf0e39da,0xbe94a031,0xbf45e403,0xbf08f59b,0xbe78cfcc,0x3d96a905,0xbf0e39da,0xbe78cfcc,0x3dc8bd36,0x3edae880,0xbe94a031,0x3d96a905,0x3edae880,0x3f396842
.long 0x0,0x0,0x0,0x0,0x0,0x3cc90ab0,0x3d48fb30,0x3d96a905,0x0,0x3d48fb30,0x3dc8bd36,0x3e164083,0x0,0x3d96a905,0x3e164083,0x3e605c13
.long 0x0,0x3dc8bd36,0x3e47c5c2,0x3e94a031,0x0,0x3dfab273,0x3e78cfcc,0x3eb8442a,0x0,0x3e164083,0x3e94a031,0x3edae880,0x0,0x3e2f10a2,0x3eac7cd4,0x3efc5d27
.long 0x0,0x3e47c5c2,0x3ec3ef15,0x3f0e39da,0x0,0x3e605c13,0x3edae880,0x3f1d7fd1,0x0,0x3e78cfcc,0x3ef15aea,0x3f2beb4a,0x0,0x3e888e93,0x3f039c3d,0x3f396842
.long 0x0,0x3e94a031,0x3f0e39da,0x3f45e403,0x0,0x3ea09ae5,0x3f187fc0,0x3f514d3d,0x0,0x3eac7cd4,0x3f226799,0x3f5b941a,0x0,0x3eb8442a,0x3f2beb4a,0x3f64aa59
.long 0x0,0x0,0x0,0x0,0x3dc8bd36,0x3dfab273,0x3e164083,0x3e2f10a2,0x3e47c5c2,0x3e78cfcc,0x3e94a031,0x3eac7cd4,0x3e94a031,0x3eb8442a,0x3edae880,0x3efc5d27
.long 0x3ec3ef15,0x3ef15aea,0x3f0e39da,0x3f226799,0x3ef15aea,0x3f13682a,0x3f2beb4a,0x3f41d870,0x3f0e39da,0x3f2beb4a,0x3f45e403,0x3f5b941a,0x3f226799,0x3f41d870,0x3f5b941a,0x3f6ed89e
.long 0x3f3504f3,0x3f54db31,0x3f6c835e,0x3f7b14be,0x3f45e403,0x3f64aa59,0x3f7853f8,0x3f7fec43,0x3f54db31,0x3f710908,0x3f7ec46d,0x3f7d3aac,0x3f61c598,0x3f79c79d,0x3f7fb10f,0x3f731447
.long 0x3f6c835e,0x3f7ec46d,0x3f7b14be,0x3f61c598,0x3f74fa0b,0x3f7fec43,0x3f710908,0x3f49d112,0x3f7b14be,0x3f7d3aac,0x3f61c598,0x3f2beb4a,0x3f7ec46d,0x3f76ba07,0x3f4d9f02,0x3f08f59b
.long 0x0,0x0,0x0,0x0,0x3e47c5c2,0x3e605c13,0x3e78cfcc,0x3e888e93,0x3ec3ef15,0x3edae880,0x3ef15aea,0x3f039c3d,0x3f0e39da,0x3f1d7fd1,0x3f2beb4a,0x3f396842
.long 0x3f3504f3,0x3f45e403,0x3f54db31,0x3f61c598,0x3f54db31,0x3f64aa59,0x3f710908,0x3f79c79d,0x3f6c835e,0x3f7853f8,0x3f7ec46d,0x3f7fb10f,0x3f7b14be,0x3f7fec43,0x3f7d3aac,0x3f731447
.long 0x3f800000,0x3f7b14be,0x3f6c835e,0x3f54db31,0x3f7b14be,0x3f6a09a7,0x3f4d9f02,0x3f273656,0x3f6c835e,0x3f4d9f02,0x3f226799,0x3edae880,0x3f54db31,0x3f273656,0x3edae880,0x3e2f10a2
.long 0x3f3504f3,0x3ef15aea,0x3e47c5c2,0xbdc8bd36,0x3f0e39da,0x3e888e93,0xbd48fb30,0xbeb8442a,0x3ec3ef15,0x3d48fb30,0xbe94a031,0xbf187fc0,0x3e47c5c2,0xbe2f10a2,0xbf039c3d,0xbf49d112
.long 0x0,0x0,0x0,0x0,0x3e94a031,0x3ea09ae5,0x3eac7cd4,0x3eb8442a,0x3f0e39da,0x3f187fc0,0x3f226799,0x3f2beb4a,0x3f45e403,0x3f514d3d,0x3f5b941a,0x3f64aa59
.long 0x3f6c835e,0x3f74fa0b,0x3f7b14be,0x3f7ec46d,0x3f7ec46d,0x3f7fec43,0x3f7d3aac,0x3f76ba07,0x3f7b14be,0x3f710908,0x3f61c598,0x3f4d9f02,0x3f61c598,0x3f49d112,0x3f2beb4a,0x3f08f59b
.long 0x3f3504f3,0x3f0e39da,0x3ec3ef15,0x3e47c5c2,0x3ef15aea,0x3e888e93,0x3d48fb30,0xbe2f10a2,0x3e47c5c2,0xbd48fb30,0xbe94a031,0xbf039c3d,0xbdc8bd36,0xbeb8442a,0xbf187fc0,0xbf49d112
.long 0xbec3ef15,0xbf226799,0xbf54db31,0xbf74fa0b,0xbf226799,0xbf584853,0xbf7853f8,0xbf7f4e6d,0xbf54db31,0xbf7853f8,0xbf7ec46d,0xbf676bd8,0xbf74fa0b,0xbf7f4e6d,0xbf676bd8,0xbf3085bb
.long 0x3f80,0x3d493f80,0x3dc93f7f,0x3e163f7d,0x3f80,0x3edb3f67,0x3f463f22,0x3f783e79,0x3f80,0x3f3e3f2c,0x3f7fbdc9,0x3f18bf4e,0x3f80,0x3f713eac,0x3f22bf46,0xbf04bf5c
.long 0x3f80,0x3f80bd49,0xbdc9bf7f,0xbf7d3e16,0x3f80,0x3f67bedb,0xbf46bf22,0xbe793f78,0x3f80,0x3f2cbf3e,0xbf7f3dc9,0x3f4e3f18,0x3f80,0x3eacbf71,0xbf223f46,0x3f5cbf04
.long 0x3f80,0xbd49bf80,0x3dc93f7f,0xbe16bf7d,0x3f80,0xbedbbf67,0x3f463f22,0xbf78be79,0x3f80,0xbf3ebf2c,0x3f7fbdc9,0xbf183f4e,0x3f80,0xbf71beac,0x3f22bf46,0x3f043f5c
.long 0x3f80,0xbf803d49,0xbdc9bf7f,0x3f7dbe16,0x3f80,0xbf673edb,0xbf46bf22,0x3e79bf78,0x3f80,0xbf2c3f3e,0xbf7f3dc9,0xbf4ebf18,0x3f80,0xbeac3f71,0xbf223f46,0xbf5c3f04
.long 0x3e483f7b,0x3e793f78,0x3e953f75,0x3eac3f71,0x3f7bbe48,0x3f4ebf18,0x3ef1bf62,0x3d49bf80,0xbe48bf7b,0xbf5cbf04,0xbf753e95,0xbedb3f67,0xbf7b3e48,0xbe163f7d,0x3f623ef1,0x3f3ebf2c
.long 0x3e483f7b,0x3f78be79,0xbe95bf75,0xbf713eac,0x3f7bbe48,0xbf18bf4e,0xbef13f62,0x3f803d49,0xbe48bf7b,0xbf043f5c,0x3f75be95,0xbf67bedb,0xbf7b3e48,0x3f7d3e16,0xbf62bef1,0x3f2c3f3e
.long 0x3e483f7b,0xbe79bf78,0x3e953f75,0xbeacbf71,0x3f7bbe48,0xbf4e3f18,0x3ef1bf62,0xbd493f80,0xbe48bf7b,0x3f5c3f04,0xbf753e95,0x3edbbf67,0xbf7b3e48,0x3e16bf7d,0x3f623ef1,0xbf3e3f2c
.long 0x3e483f7b,0xbf783e79,0xbe95bf75,0x3f71beac,0x3f7bbe48,0x3f183f4e,0xbef13f62,0xbf80bd49,0xbe48bf7b,0x3f04bf5c,0x3f75be95,0x3f673edb,0xbf7b3e48,0xbf7dbe16,0xbf62bef1,0xbf2cbf3e
.long 0x3ec43f6d,0x3edb3f67,0x3ef13f62,0x3f043f5c,0xbec4bf6d,0xbf3ebf2c,0xbf75be95,0xbf7d3e16,0x3ec43f6d,0x3f713eac,0x3f62bef1,0x3e79bf78,0xbec4bf6d,0xbf803d49,0xbe953f75,0x3f4e3f18
.long 0x3ec43f6d,0x3f67bedb,0xbef1bf62,0xbf5c3f04,0xbec4bf6d,0xbf2c3f3e,0x3f753e95,0xbe16bf7d,0x3ec43f6d,0x3eacbf71,0xbf623ef1,0x3f783e79,0xbec4bf6d,0x3d493f80,0x3e95bf75,0xbf183f4e
.long 0x3ec43f6d,0xbedbbf67,0x3ef13f62,0xbf04bf5c,0xbec4bf6d,0x3f3e3f2c,0xbf75be95,0x3f7dbe16,0x3ec43f6d,0xbf71beac,0x3f62bef1,0xbe793f78,0xbec4bf6d,0x3f80bd49,0xbe953f75,0xbf4ebf18
.long 0x3ec43f6d,0xbf673edb,0xbef1bf62,0x3f5cbf04,0xbec4bf6d,0x3f2cbf3e,0x3f753e95,0x3e163f7d,0x3ec43f6d,0xbeac3f71,0xbf623ef1,0xbf78be79,0xbec4bf6d,0xbd49bf80,0x3e95bf75,0x3f18bf4e
.long 0x3f0e3f55,0x3f183f4e,0x3f223f46,0x3f2c3f3e,0xbf553f0e,0xbf043f5c,0xbdc93f7f,0x3eac3f71,0xbf0ebf55,0xbf7dbe16,0xbf463f22,0xbd493f80,0x3f55bf0e,0xbe79bf78,0xbf7fbdc9,0xbedb3f67
.long 0x3f0e3f55,0x3f4ebf18,0xbf22bf46,0xbf3e3f2c,0xbf553f0e,0x3f5c3f04,0x3dc9bf7f,0xbf713eac,0xbf0ebf55,0xbe163f7d,0x3f46bf22,0xbf80bd49,0x3f55bf0e,0xbf783e79,0x3f7f3dc9,0xbf67bedb
.long 0x3f0e3f55,0xbf18bf4e,0x3f223f46,0xbf2cbf3e,0xbf553f0e,0x3f04bf5c,0xbdc93f7f,0xbeacbf71,0xbf0ebf55,0x3f7d3e16,0xbf463f22,0x3d49bf80,0x3f55bf0e,0x3e793f78,0xbf7fbdc9,0x3edbbf67
.long 0x3f0e3f55,0xbf4e3f18,0xbf22bf46,0x3f3ebf2c,0xbf553f0e,0xbf5cbf04,0x3dc9bf7f,0x3f71beac,0xbf0ebf55,0x3e16bf7d,0x3f46bf22,0x3f803d49,0x3f55bf0e,0x3f78be79,0x3f7f3dc9,0x3f673edb
.long 0x3f808000,0x3f80bd49,0x3f7fbdc9,0x3f7dbe16,0x3f808000,0x3f67bedb,0x3f22bf46,0x3e79bf78,0x3f808000,0x3f2cbf3e,0xbdc9bf7f,0xbf4ebf18,0x3f808000,0x3eacbf71,0xbf46bf22,0xbf5c3f04
.long 0x3f808000,0xbd49bf80,0xbf7f3dc9,0x3e163f7d,0x3f808000,0xbedbbf67,0xbf223f46,0x3f783e79,0x3f808000,0xbf3ebf2c,0x3dc93f7f,0x3f18bf4e,0x3f808000,0xbf71beac,0x3f463f22,0xbf04bf5c
.long 0x3f808000,0xbf803d49,0x3f7fbdc9,0xbf7d3e16,0x3f808000,0xbf673edb,0x3f22bf46,0xbe793f78,0x3f808000,0xbf2c3f3e,0xbdc9bf7f,0x3f4e3f18,0x3f808000,0xbeac3f71,0xbf46bf22,0x3f5cbf04
.long 0x3f808000,0x3d493f80,0xbf7f3dc9,0xbe16bf7d,0x3f808000,0x3edb3f67,0xbf223f46,0xbf78be79,0x3f808000,0x3f3e3f2c,0x3dc93f7f,0xbf183f4e,0x3f808000,0x3f713eac,0x3f463f22,0x3f043f5c
.long 0x3f7bbe48,0x3f78be79,0x3f75be95,0x3f71beac,0xbe48bf7b,0xbf18bf4e,0xbf62bef1,0xbf80bd49,0xbf7b3e48,0xbf043f5c,0x3e953f75,0x3f673edb,0x3e483f7b,0x3f7d3e16,0x3ef1bf62,0xbf2cbf3e
.long 0x3f7bbe48,0xbe79bf78,0xbf753e95,0x3eac3f71,0xbe48bf7b,0xbf4e3f18,0x3f623ef1,0x3d49bf80,0xbf7b3e48,0x3f5c3f04,0xbe95bf75,0xbedb3f67,0x3e483f7b,0x3e16bf7d,0xbef13f62,0x3f3ebf2c
.long 0x3f7bbe48,0xbf783e79,0x3f75be95,0xbf713eac,0xbe48bf7b,0x3f183f4e,0xbf62bef1,0x3f803d49,0xbf7b3e48,0x3f04bf5c,0x3e953f75,0xbf67bedb,0x3e483f7b,0xbf7dbe16,0x3ef1bf62,0x3f2c3f3e
.long 0x3f7bbe48,0x3e793f78,0xbf753e95,0xbeacbf71,0xbe48bf7b,0x3f4ebf18,0x3f623ef1,0xbd493f80,0xbf7b3e48,0xbf5cbf04,0xbe95bf75,0x3edbbf67,0x3e483f7b,0xbe163f7d,0xbef13f62,0xbf3e3f2c
.long 0x3f6dbec4,0x3f67bedb,0x3f62bef1,0x3f5cbf04,0xbf6d3ec4,0xbf2c3f3e,0xbe953f75,0x3e163f7d,0x3f6dbec4,0x3eacbf71,0xbef1bf62,0xbf78be79,0xbf6d3ec4,0x3d493f80,0x3f753e95,0x3f18bf4e
.long 0x3f6dbec4,0xbedbbf67,0xbf623ef1,0x3f043f5c,0xbf6d3ec4,0x3f3e3f2c,0x3e95bf75,0xbf7d3e16,0x3f6dbec4,0xbf71beac,0x3ef13f62,0x3e79bf78,0xbf6d3ec4,0x3f80bd49,0xbf75be95,0x3f4e3f18
.long 0x3f6dbec4,0xbf673edb,0x3f62bef1,0xbf5c3f04,0xbf6d3ec4,0x3f2cbf3e,0xbe953f75,0xbe16bf7d,0x3f6dbec4,0xbeac3f71,0xbef1bf62,0x3f783e79,0xbf6d3ec4,0xbd49bf80,0x3f753e95,0xbf183f4e
.long 0x3f6dbec4,0x3edb3f67,0xbf623ef1,0xbf04bf5c,0xbf6d3ec4,0xbf3ebf2c,0x3e95bf75,0x3f7dbe16,0x3f6dbec4,0x3f713eac,0x3ef13f62,0xbe793f78,0xbf6d3ec4,0xbf803d49,0xbf75be95,0xbf4ebf18
.long 0x3f55bf0e,0x3f4ebf18,0x3f46bf22,0x3f3ebf2c,0x3f0e3f55,0x3f5c3f04,0x3f7f3dc9,0x3f71beac,0xbf553f0e,0xbe163f7d,0x3f223f46,0x3f803d49,0xbf0ebf55,0xbf783e79,0xbdc93f7f,0x3f673edb
.long 0x3f55bf0e,0xbf18bf4e,0xbf463f22,0x3f2c3f3e,0x3f0e3f55,0x3f04bf5c,0xbf7fbdc9,0x3eac3f71,0xbf553f0e,0x3f7d3e16,0xbf22bf46,0xbd493f80,0xbf0ebf55,0x3e793f78,0x3dc9bf7f,0xbedb3f67
.long 0x3f55bf0e,0xbf4e3f18,0x3f46bf22,0xbf3e3f2c,0x3f0e3f55,0xbf5cbf04,0x3f7f3dc9,0xbf713eac,0xbf553f0e,0x3e16bf7d,0x3f223f46,0xbf80bd49,0xbf0ebf55,0x3f78be79,0xbdc93f7f,0xbf67bedb
.long 0x3f55bf0e,0x3f183f4e,0xbf463f22,0xbf2cbf3e,0x3f0e3f55,0xbf043f5c,0xbf7fbdc9,0xbeacbf71,0xbf553f0e,0xbf7dbe16,0xbf22bf46,0x3d49bf80,0xbf0ebf55,0xbe79bf78,0x3dc9bf7f,0x3edbbf67
.long 0x80003f80,0x80003f80,0x80003f80,0x80003f80,0xbd493f80,0xbedb3f67,0xbf3e3f2c,0xbf713eac,0xbdc93f7f,0xbf463f22,0xbf7fbdc9,0xbf22bf46,0xbe163f7d,0xbf783e79,0xbf18bf4e,0x3f04bf5c
.long 0xbe483f7b,0xbf7bbe48,0x3e48bf7b,0x3f7b3e48,0xbe793f78,0xbf4ebf18,0x3f5cbf04,0x3e163f7d,0xbe953f75,0xbef1bf62,0x3f753e95,0xbf623ef1,0xbeac3f71,0xbd49bf80,0x3edb3f67,0xbf3ebf2c
.long 0xbec43f6d,0x3ec4bf6d,0xbec43f6d,0x3ec4bf6d,0xbedb3f67,0x3f3ebf2c,0xbf713eac,0x3f803d49,0xbef13f62,0x3f75be95,0xbf62bef1,0x3e953f75,0xbf043f5c,0x3f7d3e16,0xbe79bf78,0xbf4e3f18
.long 0xbf0e3f55,0x3f553f0e,0x3f0ebf55,0xbf55bf0e,0xbf183f4e,0x3f043f5c,0x3f7dbe16,0x3e79bf78,0xbf223f46,0x3dc93f7f,0x3f463f22,0x3f7fbdc9,0xbf2c3f3e,0xbeac3f71,0x3d493f80,0x3edb3f67
.long 0x80003f80,0x80003f80,0x80003f80,0x80003f80,0xbf80bd49,0xbf67bedb,0xbf2cbf3e,0xbeacbf71,0x3dc9bf7f,0x3f46bf22,0x3f7f3dc9,0x3f223f46,0x3f7d3e16,0x3e793f78,0xbf4e3f18,0xbf5cbf04
.long 0xbe483f7b,0xbf7bbe48,0x3e48bf7b,0x3f7b3e48,0xbf78be79,0x3f18bf4e,0x3f043f5c,0xbf7d3e16,0x3e95bf75,0x3ef13f62,0xbf75be95,0x3f62bef1,0x3f713eac,0xbf803d49,0x3f67bedb,0xbf2c3f3e
.long 0xbec43f6d,0x3ec4bf6d,0xbec43f6d,0x3ec4bf6d,0xbf67bedb,0x3f2c3f3e,0xbeacbf71,0xbd493f80,0x3ef1bf62,0xbf753e95,0x3f623ef1,0xbe95bf75,0x3f5c3f04,0x3e16bf7d,0xbf783e79,0x3f183f4e
.long 0xbf0e3f55,0x3f553f0e,0x3f0ebf55,0xbf55bf0e,0xbf4ebf18,0xbf5c3f04,0x3e163f7d,0x3f783e79,0x3f22bf46,0xbdc9bf7f,0xbf46bf22,0xbf7f3dc9,0x3f3e3f2c,0x3f713eac,0x3f80bd49,0x3f67bedb
.long 0x80003f80,0x80003f80,0x80003f80,0x80003f80,0x3d49bf80,0x3edbbf67,0x3f3ebf2c,0x3f71beac,0xbdc93f7f,0xbf463f22,0xbf7fbdc9,0xbf22bf46,0x3e16bf7d,0x3f78be79,0x3f183f4e,0xbf043f5c
.long 0xbe483f7b,0xbf7bbe48,0x3e48bf7b,0x3f7b3e48,0x3e79bf78,0x3f4e3f18,0xbf5c3f04,0xbe16bf7d,0xbe953f75,0xbef1bf62,0x3f753e95,0xbf623ef1,0x3eacbf71,0x3d493f80,0xbedbbf67,0x3f3e3f2c
.long 0xbec43f6d,0x3ec4bf6d,0xbec43f6d,0x3ec4bf6d,0x3edbbf67,0xbf3e3f2c,0x3f71beac,0xbf80bd49,0xbef13f62,0x3f75be95,0xbf62bef1,0x3e953f75,0x3f04bf5c,0xbf7dbe16,0x3e793f78,0x3f4ebf18
.long 0xbf0e3f55,0x3f553f0e,0x3f0ebf55,0xbf55bf0e,0x3f18bf4e,0xbf04bf5c,0xbf7d3e16,0xbe793f78,0xbf223f46,0x3dc93f7f,0x3f463f22,0x3f7fbdc9,0x3f2cbf3e,0x3eacbf71,0xbd49bf80,0xbedbbf67
.long 0x80003f80,0x80003f80,0x80003f80,0x80003f80,0x3f803d49,0x3f673edb,0x3f2c3f3e,0x3eac3f71,0x3dc9bf7f,0x3f46bf22,0x3f7f3dc9,0x3f223f46,0xbf7dbe16,0xbe79bf78,0x3f4ebf18,0x3f5c3f04
.long 0xbe483f7b,0xbf7bbe48,0x3e48bf7b,0x3f7b3e48,0x3f783e79,0xbf183f4e,0xbf04bf5c,0x3f7dbe16,0x3e95bf75,0x3ef13f62,0xbf75be95,0x3f62bef1,0xbf71beac,0x3f80bd49,0xbf673edb,0x3f2cbf3e
.long 0xbec43f6d,0x3ec4bf6d,0xbec43f6d,0x3ec4bf6d,0x3f673edb,0xbf2cbf3e,0x3eac3f71,0x3d49bf80,0x3ef1bf62,0xbf753e95,0x3f623ef1,0xbe95bf75,0xbf5cbf04,0xbe163f7d,0x3f78be79,0xbf18bf4e
.long 0xbf0e3f55,0x3f553f0e,0x3f0ebf55,0xbf55bf0e,0x3f4e3f18,0x3f5cbf04,0xbe16bf7d,0xbf78be79,0x3f22bf46,0xbdc9bf7f,0xbf46bf22,0xbf7f3dc9,0xbf3ebf2c,0xbf71beac,0xbf803d49,0xbf673edb
.long 0x3f800000,0x3f800000,0x3f800000,0x3f800000,0x3f803d49,0x3f673edb,0x3f2c3f3e,0x3eac3f71,0x3f7f3dc9,0x3f223f46,0xbdc93f7f,0xbf463f22,0x3f7d3e16,0x3e793f78,0xbf4e3f18,0xbf5cbf04
.long 0x3f7b3e48,0xbe483f7b,0xbf7bbe48,0x3e48bf7b,0x3f783e79,0xbf183f4e,0xbf04bf5c,0x3f7dbe16,0x3f753e95,0xbf623ef1,0x3e95bf75,0x3ef13f62,0x3f713eac,0xbf803d49,0x3f67bedb,0xbf2c3f3e
.long 0x3f6d3ec4,0xbf6dbec4,0x3f6d3ec4,0xbf6dbec4,0x3f673edb,0xbf2cbf3e,0x3eac3f71,0x3d49bf80,0x3f623ef1,0xbe95bf75,0xbef13f62,0x3f75be95,0x3f5c3f04,0x3e16bf7d,0xbf783e79,0x3f183f4e
.long 0x3f553f0e,0x3f0ebf55,0xbf55bf0e,0xbf0e3f55,0x3f4e3f18,0x3f5cbf04,0xbe16bf7d,0xbf78be79,0x3f463f22,0x3f7fbdc9,0x3f22bf46,0xbdc9bf7f,0x3f3e3f2c,0x3f713eac,0x3f80bd49,0x3f67bedb
.long 0x3f800000,0x3f800000,0x3f800000,0x3f800000,0xbd493f80,0xbedb3f67,0xbf3e3f2c,0xbf713eac,0xbf7fbdc9,0xbf22bf46,0x3dc9bf7f,0x3f46bf22,0x3e16bf7d,0x3f78be79,0x3f183f4e,0xbf043f5c
.long 0x3f7b3e48,0xbe483f7b,0xbf7bbe48,0x3e48bf7b,0xbe793f78,0xbf4ebf18,0x3f5cbf04,0x3e163f7d,0xbf75be95,0x3f62bef1,0xbe953f75,0xbef1bf62,0x3eacbf71,0x3d493f80,0xbedbbf67,0x3f3e3f2c
.long 0x3f6d3ec4,0xbf6dbec4,0x3f6d3ec4,0xbf6dbec4,0xbedb3f67,0x3f3ebf2c,0xbf713eac,0x3f803d49,0xbf62bef1,0x3e953f75,0x3ef1bf62,0xbf753e95,0x3f04bf5c,0xbf7dbe16,0x3e793f78,0x3f4ebf18
.long 0x3f553f0e,0x3f0ebf55,0xbf55bf0e,0xbf0e3f55,0xbf183f4e,0x3f043f5c,0x3f7dbe16,0x3e79bf78,0xbf46bf22,0xbf7f3dc9,0xbf223f46,0x3dc93f7f,0x3f2cbf3e,0x3eacbf71,0xbd49bf80,0xbedbbf67
.long 0x3f800000,0x3f800000,0x3f800000,0x3f800000,0xbf80bd49,0xbf67bedb,0xbf2cbf3e,0xbeacbf71,0x3f7f3dc9,0x3f223f46,0xbdc93f7f,0xbf463f22,0xbf7dbe16,0xbe79bf78,0x3f4ebf18,0x3f5c3f04
.long 0x3f7b3e48,0xbe483f7b,0xbf7bbe48,0x3e48bf7b,0xbf78be79,0x3f18bf4e,0x3f043f5c,0xbf7d3e16,0x3f753e95,0xbf623ef1,0x3e95bf75,0x3ef13f62,0xbf71beac,0x3f80bd49,0xbf673edb,0x3f2cbf3e
.long 0x3f6d3ec4,0xbf6dbec4,0x3f6d3ec4,0xbf6dbec4,0xbf67bedb,0x3f2c3f3e,0xbeacbf71,0xbd493f80,0x3f623ef1,0xbe95bf75,0xbef13f62,0x3f75be95,0xbf5cbf04,0xbe163f7d,0x3f78be79,0xbf18bf4e
.long 0x3f553f0e,0x3f0ebf55,0xbf55bf0e,0xbf0e3f55,0xbf4ebf18,0xbf5c3f04,0x3e163f7d,0x3f783e79,0x3f463f22,0x3f7fbdc9,0x3f22bf46,0xbdc9bf7f,0xbf3ebf2c,0xbf71beac,0xbf803d49,0xbf673edb
.long 0x3f800000,0x3f800000,0x3f800000,0x3f800000,0x3d49bf80,0x3edbbf67,0x3f3ebf2c,0x3f71beac,0xbf7fbdc9,0xbf22bf46,0x3dc9bf7f,0x3f46bf22,0xbe163f7d,0xbf783e79,0xbf18bf4e,0x3f04bf5c
.long 0x3f7b3e48,0xbe483f7b,0xbf7bbe48,0x3e48bf7b,0x3e79bf78,0x3f4e3f18,0xbf5c3f04,0xbe16bf7d,0xbf75be95,0x3f62bef1,0xbe953f75,0xbef1bf62,0xbeac3f71,0xbd49bf80,0x3edb3f67,0xbf3ebf2c
.long 0x3f6d3ec4,0xbf6dbec4,0x3f6d3ec4,0xbf6dbec4,0x3edbbf67,0xbf3e3f2c,0x3f71beac,0xbf80bd49,0xbf62bef1,0x3e953f75,0x3ef1bf62,0xbf753e95,0xbf043f5c,0x3f7d3e16,0xbe79bf78,0xbf4e3f18
.long 0x3f553f0e,0x3f0ebf55,0xbf55bf0e,0xbf0e3f55,0x3f18bf4e,0xbf04bf5c,0xbf7d3e16,0xbe793f78,0xbf46bf22,0xbf7f3dc9,0xbf223f46,0x3dc93f7f,0xbf2c3f3e,0xbeac3f71,0x3d493f80,0x3edb3f67
.long 0x3f800000,0x3f7fffb1,0x3f7ffec4,0x3f7ffd39,0x3f800000,0x3f7fe705,0x3f7f9c18,0x3f7f1f49,0x3f800000,0x3f7fa6e3,0x3f7e9bc9,0x3f7cdf6c,0x3f800000,0x3f7f3f54,0x3f7cfe73,0x3f7940c0
.long 0x3f800000,0x3f7eb069,0x3f7ac516,0x3f74484b,0x3f800000,0x3f7dfa38,0x3f77f110,0x3f6dfcf2,0x3f800000,0x3f7d1cdd,0x3f748422,0x3f666771,0x3f800000,0x3f7c187a,0x3f708066,0x3f5d924d
.long 0x3f800000,0x3f7aed37,0x3f6be858,0x3f5389c7,0x3f800000,0x3f799b43,0x3f66becc,0x3f485bca,0x3f800000,0x3f7822d1,0x3f6106f2,0x3f3c17d9,0x3f800000,0x3f76841b,0x3f5ac450,0x3f2ecef7
.long 0x3f800000,0x3f74bf62,0x3f53fac3,0x3f209393,0x3f800000,0x3f72d4eb,0x3f4cae79,0x3f11796b,0x3f800000,0x3f70c501,0x3f44e3f5,0x3f019573,0x3f800000,0x3f6e8ff8,0x3f3ca003,0x3ee1fb6a
.long 0x3f7ffb11,0x3f7ff84a,0x3f7ff4e6,0x3f7ff0e3,0x3f7e70b0,0x3f7d906e,0x3f7c7eb0,0x3f7b3bab,0x3f7a7302,0x3f77583a,0x3f73913f,0x3f6f20b0,0x3f740bdd,0x3f6d67a1,0x3f655e0b,0x3f5bfb34
.long 0x3f6b4b0c,0x3f5fe4e9,0x3f5233c6,0x3f425b89,0x3f604621,0x3f4f0417,0x3f3a7ca4,0x3f2302d3,0x3f531849,0x3f3b0629,0x3f1ebc12,0x3efdbabb,0x3f43e200,0x3f24381a,0x3eff17b2,0x3eadf73c
.long 0x3f32c8c9,0x3f0af1b7,0x3ebb31a0,0x3e3228d4,0x3f1ff6cb,0x3edf28a9,0x3e667c66,0x3b490fc6,0x3f0b9a6b,0x3ea5129f,0x3da3308c,0xbe2bf804,0x3eebcbbb,0x3e5101f1,0xbd8a200a,0xbeab0201
.long 0x3ebe1d4a,0x3da973ba,0xbe5a3997,0xbefafef7,0x3e8e9a22,0xbd2351cb,0xbeb554ec,0xbf21cbfb,0x3e3b6ecf,0xbe25c58c,0xbef9a02d,0xbf4154e1,0x3dafb680,0xbe901c2c,0xbf1c420c,0xbf5b2c79
.long 0x3f7fec43,0x3f7fe705,0x3f7fe129,0x3f7fdaaf,0x3f79c79d,0x3f7822d1,0x3f764d97,0x3f74484b,0x3f6a09a7,0x3f644fac,0x3f5df6be,0x3f570348,0x3f514d3d,0x3f456439,0x3f385216,0x3f2a2a80
.long 0x3f3085bb,0x3f1ce11f,0x3f07a136,0x3ee1fb6a,0x3f08f59b,0x3ed97cb9,0x3e9d9e78,0x3e3e853e,0x3eb8442a,0x3e5d4b1a,0x3d8a200a,0xbda973ba,0x3e2f10a2,0xbb490fc6,0xbe354098,0xbeb0eacb
.long 0xbcc90ab0,0xbe636c83,0xbed25a09,0xbf1553b7,0xbe605c13,0xbedc53c1,0xbf1ebc12,0xbf476085,0xbecf7bca,0xbf1e1e22,0xbf4ac77f,0xbf6afb8c,0xbf13682a,0xbf466354,0xbf6aab7b,0xbf7d906e
.long 0xbf396842,0xbf650479,0xbf7c7eb0,0xbf7dc68c,0xbf584853,0xbf788486,0xbf7f2f9d,0xbf6b99fb,0xbf6ed89e,0xbf7ff0e3,0xbf7294f8,0xbf485bca,0xbf7c3b28,0xbf7aed37,0xbf577026,0xbf16999f
.long 0x3f7fd397,0x3f7fcbe2,0x3f7fc38f,0x3f7fba9e,0x3f721352,0x3f6faf1b,0x3f6d1c1d,0x3f6a5ad9,0x3f4f7a1f,0x3f476085,0x3f3ebc1b,0x3f3592e7,0x3f1b02c6,0x3f0af1b7,0x3ef41f07,0x3ed0eb2a
.long 0x3eb263ef,0x3e80f8c0,0x3e1c76de,0x3d55880e,0x3d7b2b74,0xbd83db0a,0xbe419b37,0xbe9f1cdf,0xbe6c9a7f,0xbebf926f,0xbf0242b1,0xbf21cbfb,0xbf00e7e4,0xbf256bcb,0xbf44e3f5,0xbf5e5aa6
.long 0xbf3b8f3b,0xbf5a5ba0,0xbf708066,0xbf7d1cdd,0xbf660f88,0xbf7940c0,0xbf7ffec4,0xbf79f35e,0xbf7cbfc9,0xbf7efcc9,0xbf718f57,0xbf554aa4,0xbf7dabcc,0xbf6afb8c,0xbf46e22a,0xbf140c5f
.long 0xbf68bf3c,0xbf3f41fc,0xbf04f484,0xbe7bdba4,0xbf3fc767,0xbf003a06,0xbe4dee60,0x3df475c0,0xbf064b82,0xbe5101f1,0x3e1008b7,0x3eeff7fb,0xbe827dc0,0x3de7fa9a,0x3eee9479,0x3f4154e1
.long 0x0,0x3b490fc6,0x3bc90f88,0x3c16cb58,0x0,0x3ce22a7a,0x3d621469,0x3da973ba,0x0,0x3d55880e,0x3dd53db9,0x3e1f917b,0x0,0x3d9cecf9,0x3e1c76de,0x3e698bba
.long 0x0,0x3dcefdb7,0x3e4dee60,0x3e9920fe,0x0,0x3e007745,0x3e7ee6e1,0x3ebca7af,0x0,0x3e195be0,0x3e97a117,0x3edf28a9,0x0,0x3e3228d4,0x3eaf713a,0x3f003a06
.long 0x0,0x3e4ada4f,0x3ec6d529,0x3f102dd5,0x0,0x3e636c83,0x3eddbe79,0x3f1f599f,0x0,0x3e7bdba4,0x3ef41f07,0x3f2da859,0x0,0x3e8a11f7,0x3f04f484,0x3f3b0629
.long 0x0,0x3e9620d2,0x3f0f8784,0x3f476085,0x0,0x3ea21887,0x3f19c200,0x3f52a649,0x0,0x3eadf73c,0x3f239da9,0x3f5cc7d1,0x0,0x3eb9bb1e,0x3f2d1469,0x3f65b710
.long 0x3c490e90,0x3c7b514b,0x3c96c9b6,0x3cafea69,0x3de1bc2e,0x3e0cec4a,0x3e28defc,0x3e44b0b9,0x3e541501,0x3e840270,0x3e9d9e78,0x3eb6ccc3,0x3e9aa086,0x3ebf926f,0x3ee363fa,0x3f02ef9f
.long 0x3ec9b953,0x3ef840c8,0x3f121eb0,0x3f269de3,0x3ef6e0cb,0x3f16999f,0x3f2f61a5,0x3f456439,0x3f10d3cd,0x3f2ecef7,0x3f48d8b3,0x3f5e5aa6,0x3f24d225,0x3f446337,0x3f5df6be,0x3f70c501
.long 0x3f373a23,0x3f570348,0x3f6e46be,0x3f7c187a,0x3f47de65,0x3f666771,0x3f796e4e,0x3f7fffb1,0x3f5695e5,0x3f725470,0x3f7f2f9d,0x3f7c5d3a,0x3f633c5a,0x3f7a9c59,0x3f7f6ac7,0x3f714c7a
.long 0x3f6db293,0x3f7f1f49,0x3f7a1e84,0x3f5f20db,0x3f75dec6,0x3f7fcbe2,0x3f6f6830,0x3f466354,0x3f7baccd,0x3f7c9f8a,0x3f5f8327,0x3f27ce61,0x3f7f0e58,0x3f75a67b,0x3f4ac77f,0x3f044889
.long 0x3cc90ab0,0x3ce22a7a,0x3cfb49ba,0x3d0a342f,0x3e605c13,0x3e7bdba4,0x3e8b9507,0x3e9920fe,0x3ecf7bca,0x3ee79a5d,0x3eff17b2,0x3f0af1b7,0x3f13682a,0x3f2302d3,0x3f31a81d,0x3f3f41fc
.long 0x3f396842,0x3f4a4c87,0x3f591e6a,0x3f65b710,0x3f584853,0x3f67c187,0x3f73913f,0x3f7b87b2,0x3f6ed89e,0x3f79f35e,0x3f7f6ac7,0x3f7f1f49,0x3f7c3b28,0x3f7fffb1,0x3f7bf531,0x3f703b37
.long 0x3f7fec43,0x3f799b43,0x3f696591,0x3f4fefa8,0x3f79c79d,0x3f671599,0x3f48d8b3,0x3f209393,0x3f6a09a7,0x3f495521,0x3f1c420c,0x3ecb2aae,0x3f514d3d,0x3f21cbfb,0x3ecc9b8b,0x3e0cec4a
.long 0x3f3085bb,0x3ee4cbfe,0x3e28defc,0xbe06b26e,0x3f08f59b,0x3e75c35a,0xbda3308c,0xbec8477c,0x3eb8442a,0x3cafea69,0xbea395c5,0xbf1f599f,0x3e2f10a2,0xbe4ada4f,0xbf0a48ad,0xbf4f0417
.long 0x3d16c32c,0x3d2351cb,0x3d2fe007,0x3d3c6dd5,0x3ea68f12,0x3eb3dca5,0x3ec1071e,0x3ece0bea,0x3f15f6d9,0x3f209393,0x3f2ac082,0x3f34768f,0x3f4bbbf8,0x3f570348,0x3f6106f2,0x3f69b7e4
.long 0x3f6ff573,0x3f77beb7,0x3f7cfe73,0x3f7fa6e3,0x3f7f84ab,0x3f7f7808,0x3f7b61fc,0x3f73530e,0x3f791298,0x3f6d67a1,0x3f5c61c7,0x3f466354,0x3f5d2d53,0x3f436051,0x3f239da9,0x3efdbabb
.long 0x3f2e3bde,0x3f05a02c,0x3eaf713a,0x3e195be0,0x3ee0924f,0x3e698bba,0x3bc90f88,0xbe5d4b1a,0x3e22abb6,0xbdb5f8da,0xbea986c4,0xbf0d9281,0xbe09cf86,0xbecb2aae,0xbf212ff9,0xbf50d937
.long 0xbed53641,0xbf2a2a80,0xbf5ac450,0xbf7822d1,0xbf299415,0xbf5d924d,0xbf7ac516,0xbf7e2b72,0xbf59f26a,0xbf7a9c59,0xbf7d7474,0xbf62241a,0xbf778bc5,0xbf7e5a38,0xbf628210,0xbf27ce61
.long 0x3f800000,0x3f800000,0x3f800000,0x3f800000,0x3f7fffb1,0x3f7fe705,0x3f7fa6e3,0x3f7f3f54,0x3f7ffec4,0x3f7f9c18,0x3f7e9bc9,0x3f7cfe73,0x3f7ffd39,0x3f7f1f49,0x3f7cdf6c,0x3f7940c0
.long 0x3f7ffb11,0x3f7e70b0,0x3f7a7302,0x3f740bdd,0x3f7ff84a,0x3f7d906e,0x3f77583a,0x3f6d67a1,0x3f7ff4e6,0x3f7c7eb0,0x3f73913f,0x3f655e0b,0x3f7ff0e3,0x3f7b3bab,0x3f6f20b0,0x3f5bfb34
.long 0x3f7fec43,0x3f79c79d,0x3f6a09a7,0x3f514d3d,0x3f7fe705,0x3f7822d1,0x3f644fac,0x3f456439,0x3f7fe129,0x3f764d97,0x3f5df6be,0x3f385216,0x3f7fdaaf,0x3f74484b,0x3f570348,0x3f2a2a80
.long 0x3f7fd397,0x3f721352,0x3f4f7a1f,0x3f1b02c6,0x3f7fcbe2,0x3f6faf1b,0x3f476085,0x3f0af1b7,0x3f7fc38f,0x3f6d1c1d,0x3f3ebc1b,0x3ef41f07,0x3f7fba9e,0x3f6a5ad9,0x3f3592e7,0x3ed0eb2a
.long 0x3f800000,0x3f800000,0x3f800000,0x3f800000,0x3f7eb069,0x3f7dfa38,0x3f7d1cdd,0x3f7c187a,0x3f7ac516,0x3f77f110,0x3f748422,0x3f708066,0x3f74484b,0x3f6dfcf2,0x3f666771,0x3f5d924d
.long 0x3f6b4b0c,0x3f604621,0x3f531849,0x3f43e200,0x3f5fe4e9,0x3f4f0417,0x3f3b0629,0x3f24381a,0x3f5233c6,0x3f3a7ca4,0x3f1ebc12,0x3eff17b2,0x3f425b89,0x3f2302d3,0x3efdbabb,0x3eadf73c
.long 0x3f3085bb,0x3f08f59b,0x3eb8442a,0x3e2f10a2,0x3f1ce11f,0x3ed97cb9,0x3e5d4b1a,0xbb490fc6,0x3f07a136,0x3e9d9e78,0x3d8a200a,0xbe354098,0x3ee1fb6a,0x3e3e853e,0xbda973ba,0xbeb0eacb
.long 0x3eb263ef,0x3d7b2b74,0xbe6c9a7f,0xbf00e7e4,0x3e80f8c0,0xbd83db0a,0xbebf926f,0xbf256bcb,0x3e1c76de,0xbe419b37,0xbf0242b1,0xbf44e3f5,0x3d55880e,0xbe9f1cdf,0xbf21cbfb,0xbf5e5aa6
.long 0x3f800000,0x3f800000,0x3f800000,0x3f800000,0x3f7aed37,0x3f799b43,0x3f7822d1,0x3f76841b,0x3f6be858,0x3f66becc,0x3f6106f2,0x3f5ac450,0x3f5389c7,0x3f485bca,0x3f3c17d9,0x3f2ecef7
.long 0x3f32c8c9,0x3f1ff6cb,0x3f0b9a6b,0x3eebcbbb,0x3f0af1b7,0x3edf28a9,0x3ea5129f,0x3e5101f1,0x3ebb31a0,0x3e667c66,0x3da3308c,0xbd8a200a,0x3e3228d4,0x3b490fc6,0xbe2bf804,0xbeab0201
.long 0xbcc90ab0,0xbe605c13,0xbecf7bca,0xbf13682a,0xbe636c83,0xbedc53c1,0xbf1e1e22,0xbf466354,0xbed25a09,0xbf1ebc12,0xbf4ac77f,0xbf6aab7b,0xbf1553b7,0xbf476085,0xbf6afb8c,0xbf7d906e
.long 0xbf3b8f3b,0xbf660f88,0xbf7cbfc9,0xbf7dabcc,0xbf5a5ba0,0xbf7940c0,0xbf7efcc9,0xbf6afb8c,0xbf708066,0xbf7ffec4,0xbf718f57,0xbf46e22a,0xbf7d1cdd,0xbf79f35e,0xbf554aa4,0xbf140c5f
.long 0x3f800000,0x3f800000,0x3f800000,0x3f800000,0x3f74bf62,0x3f72d4eb,0x3f70c501,0x3f6e8ff8,0x3f53fac3,0x3f4cae79,0x3f44e3f5,0x3f3ca003,0x3f209393,0x3f11796b,0x3f019573,0x3ee1fb6a
.long 0x3ebe1d4a,0x3e8e9a22,0x3e3b6ecf,0x3dafb680,0x3da973ba,0xbd2351cb,0xbe25c58c,0xbe901c2c,0xbe5a3997,0xbeb554ec,0xbef9a02d,0xbf1c420c,0xbefafef7,0xbf21cbfb,0xbf4154e1,0xbf5b2c79
.long 0xbf396842,0xbf584853,0xbf6ed89e,0xbf7c3b28,0xbf650479,0xbf788486,0xbf7ff0e3,0xbf7aed37,0xbf7c7eb0,0xbf7f2f9d,0xbf7294f8,0xbf577026,0xbf7dc68c,0xbf6b99fb,0xbf485bca,0xbf16999f
.long 0xbf68bf3c,0xbf3fc767,0xbf064b82,0xbe827dc0,0xbf3f41fc,0xbf003a06,0xbe5101f1,0x3de7fa9a,0xbf04f484,0xbe4dee60,0x3e1008b7,0x3eee9479,0xbe7bdba4,0x3df475c0,0x3eeff7fb,0x3f4154e1
.long 0x0,0x0,0x0,0x0,0x3b490fc6,0x3ce22a7a,0x3d55880e,0x3d9cecf9,0x3bc90f88,0x3d621469,0x3dd53db9,0x3e1c76de,0x3c16cb58,0x3da973ba,0x3e1f917b,0x3e698bba
.long 0x3c490e90,0x3de1bc2e,0x3e541501,0x3e9aa086,0x3c7b514b,0x3e0cec4a,0x3e840270,0x3ebf926f,0x3c96c9b6,0x3e28defc,0x3e9d9e78,0x3ee363fa,0x3cafea69,0x3e44b0b9,0x3eb6ccc3,0x3f02ef9f
.long 0x3cc90ab0,0x3e605c13,0x3ecf7bca,0x3f13682a,0x3ce22a7a,0x3e7bdba4,0x3ee79a5d,0x3f2302d3,0x3cfb49ba,0x3e8b9507,0x3eff17b2,0x3f31a81d,0x3d0a342f,0x3e9920fe,0x3f0af1b7,0x3f3f41fc
.long 0x3d16c32c,0x3ea68f12,0x3f15f6d9,0x3f4bbbf8,0x3d2351cb,0x3eb3dca5,0x3f209393,0x3f570348,0x3d2fe007,0x3ec1071e,0x3f2ac082,0x3f6106f2,0x3d3c6dd5,0x3ece0bea,0x3f34768f,0x3f69b7e4
.long 0x0,0x0,0x0,0x0,0x3dcefdb7,0x3e007745,0x3e195be0,0x3e3228d4,0x3e4dee60,0x3e7ee6e1,0x3e97a117,0x3eaf713a,0x3e9920fe,0x3ebca7af,0x3edf28a9,0x3f003a06
.long 0x3ec9b953,0x3ef6e0cb,0x3f10d3cd,0x3f24d225,0x3ef840c8,0x3f16999f,0x3f2ecef7,0x3f446337,0x3f121eb0,0x3f2f61a5,0x3f48d8b3,0x3f5df6be,0x3f269de3,0x3f456439,0x3f5e5aa6,0x3f70c501
.long 0x3f396842,0x3f584853,0x3f6ed89e,0x3f7c3b28,0x3f4a4c87,0x3f67c187,0x3f79f35e,0x3f7fffb1,0x3f591e6a,0x3f73913f,0x3f7f6ac7,0x3f7bf531,0x3f65b710,0x3f7b87b2,0x3f7f1f49,0x3f703b37
.long 0x3f6ff573,0x3f7f84ab,0x3f791298,0x3f5d2d53,0x3f77beb7,0x3f7f7808,0x3f6d67a1,0x3f436051,0x3f7cfe73,0x3f7b61fc,0x3f5c61c7,0x3f239da9,0x3f7fa6e3,0x3f73530e,0x3f466354,0x3efdbabb
.long 0x0,0x0,0x0,0x0,0x3e4ada4f,0x3e636c83,0x3e7bdba4,0x3e8a11f7,0x3ec6d529,0x3eddbe79,0x3ef41f07,0x3f04f484,0x3f102dd5,0x3f1f599f,0x3f2da859,0x3f3b0629
.long 0x3f373a23,0x3f47de65,0x3f5695e5,0x3f633c5a,0x3f570348,0x3f666771,0x3f725470,0x3f7a9c59,0x3f6e46be,0x3f796e4e,0x3f7f2f9d,0x3f7f6ac7,0x3f7c187a,0x3f7fffb1,0x3f7c5d3a,0x3f714c7a
.long 0x3f7fec43,0x3f79c79d,0x3f6a09a7,0x3f514d3d,0x3f799b43,0x3f671599,0x3f495521,0x3f21cbfb,0x3f696591,0x3f48d8b3,0x3f1c420c,0x3ecc9b8b,0x3f4fefa8,0x3f209393,0x3ecb2aae,0x3e0cec4a
.long 0x3f2e3bde,0x3ee0924f,0x3e22abb6,0xbe09cf86,0x3f05a02c,0x3e698bba,0xbdb5f8da,0xbecb2aae,0x3eaf713a,0x3bc90f88,0xbea986c4,0xbf212ff9,0x3e195be0,0xbe5d4b1a,0xbf0d9281,0xbf50d937
.long 0x0,0x0,0x0,0x0,0x3e9620d2,0x3ea21887,0x3eadf73c,0x3eb9bb1e,0x3f0f8784,0x3f19c200,0x3f239da9,0x3f2d1469,0x3f476085,0x3f52a649,0x3f5cc7d1,0x3f65b710
.long 0x3f6db293,0x3f75dec6,0x3f7baccd,0x3f7f0e58,0x3f7f1f49,0x3f7fcbe2,0x3f7c9f8a,0x3f75a67b,0x3f7a1e84,0x3f6f6830,0x3f5f8327,0x3f4ac77f,0x3f5f20db,0x3f466354,0x3f27ce61,0x3f044889
.long 0x3f3085bb,0x3f08f59b,0x3eb8442a,0x3e2f10a2,0x3ee4cbfe,0x3e75c35a,0x3cafea69,0xbe4ada4f,0x3e28defc,0xbda3308c,0xbea395c5,0xbf0a48ad,0xbe06b26e,0xbec8477c,0xbf1f599f,0xbf4f0417
.long 0xbed53641,0xbf299415,0xbf59f26a,0xbf778bc5,0xbf2a2a80,0xbf5d924d,0xbf7a9c59,0xbf7e5a38,0xbf5ac450,0xbf7ac516,0xbf7d7474,0xbf628210,0xbf7822d1,0xbf7e2b72,0xbf62241a,0xbf27ce61
.long 0x3f80,0x3dc93f7f,0x3e483f7b,0x3e953f75,0x3f80,0x3ef13f62,0x3f553f0e,0x3f7f3dc9,0x3f80,0x3f463f22,0x3f7bbe48,0x3ef1bf62,0x3f80,0x3f753e95,0x3f0ebf55,0xbf22bf46
.long 0x3f80,0x3f7fbdc9,0xbe48bf7b,0xbf753e95,0x3f80,0x3f62bef1,0xbf55bf0e,0xbdc93f7f,0x3f80,0x3f22bf46,0xbf7b3e48,0x3f623ef1,0x3f80,0x3e95bf75,0xbf0e3f55,0x3f46bf22
.long 0x3f80,0xbdc9bf7f,0x3e483f7b,0xbe95bf75,0x3f80,0xbef1bf62,0x3f553f0e,0xbf7fbdc9,0x3f80,0xbf46bf22,0x3f7bbe48,0xbef13f62,0x3f80,0xbf75be95,0x3f0ebf55,0x3f223f46
.long 0x3f80,0xbf7f3dc9,0xbe48bf7b,0x3f75be95,0x3f80,0xbf623ef1,0xbf55bf0e,0x3dc9bf7f,0x3f80,0xbf223f46,0xbf7b3e48,0xbf62bef1,0x3f80,0xbe953f75,0xbf0e3f55,0xbf463f22
.long 0x3ec43f6d,0x3ef13f62,0x3f0e3f55,0x3f223f46,0x3f6dbec4,0x3f22bf46,0x3e48bf7b,0xbe95bf75,0xbec4bf6d,0xbf75be95,0xbf553f0e,0xbdc93f7f,0xbf6d3ec4,0x3dc93f7f,0x3f7b3e48,0x3ef1bf62
.long 0x3ec43f6d,0x3f62bef1,0xbf0ebf55,0xbf463f22,0x3f6dbec4,0xbf46bf22,0xbe483f7b,0x3f75be95,0xbec4bf6d,0xbe953f75,0x3f55bf0e,0xbf7fbdc9,0xbf6d3ec4,0x3f7fbdc9,0xbf7bbe48,0x3f623ef1
.long 0x3ec43f6d,0xbef1bf62,0x3f0e3f55,0xbf22bf46,0x3f6dbec4,0xbf223f46,0x3e48bf7b,0x3e953f75,0xbec4bf6d,0x3f753e95,0xbf553f0e,0x3dc9bf7f,0xbf6d3ec4,0xbdc9bf7f,0x3f7b3e48,0xbef13f62
.long 0x3ec43f6d,0xbf623ef1,0xbf0ebf55,0x3f46bf22,0x3f6dbec4,0x3f463f22,0xbe483f7b,0xbf753e95,0xbec4bf6d,0x3e95bf75,0x3f55bf0e,0x3f7f3dc9,0xbf6d3ec4,0xbf7f3dc9,0xbf7bbe48,0xbf62bef1
.long 0x3f353f35,0x3f463f22,0x3f553f0e,0x3f623ef1,0xbf35bf35,0xbf75be95,0xbf7b3e48,0xbf463f22,0x3f353f35,0x3f7fbdc9,0x3f0ebf55,0xbe95bf75,0xbf35bf35,0xbf623ef1,0x3e483f7b,0x3f7f3dc9
.long 0x3f353f35,0x3f22bf46,0xbf55bf0e,0xbef13f62,0xbf35bf35,0xbe953f75,0x3f7bbe48,0xbf22bf46,0x3f353f35,0xbdc9bf7f,0xbf0e3f55,0x3f75be95,0xbf35bf35,0x3ef13f62,0xbe48bf7b,0xbdc93f7f
.long 0x3f353f35,0xbf46bf22,0x3f553f0e,0xbf62bef1,0xbf35bf35,0x3f753e95,0xbf7b3e48,0x3f46bf22,0x3f353f35,0xbf7f3dc9,0x3f0ebf55,0x3e953f75,0xbf35bf35,0x3f62bef1,0x3e483f7b,0xbf7fbdc9
.long 0x3f353f35,0xbf223f46,0xbf55bf0e,0x3ef1bf62,0xbf35bf35,0x3e95bf75,0x3f7bbe48,0x3f223f46,0x3f353f35,0x3dc93f7f,0xbf0e3f55,0xbf753e95,0xbf35bf35,0xbef1bf62,0xbe48bf7b,0x3dc9bf7f
.long 0x3f6d3ec4,0x3f753e95,0x3f7b3e48,0x3f7f3dc9,0xbec43f6d,0x3dc93f7f,0x3f0e3f55,0x3f623ef1,0xbf6dbec4,0xbf623ef1,0xbe483f7b,0x3f223f46,0x3ec4bf6d,0xbf46bf22,0xbf553f0e,0x3e953f75
.long 0x3f6d3ec4,0x3e95bf75,0xbf7bbe48,0xbdc93f7f,0xbec43f6d,0x3f7fbdc9,0xbf0ebf55,0xbef13f62,0xbf6dbec4,0x3ef13f62,0x3e48bf7b,0xbf463f22,0x3ec4bf6d,0xbf223f46,0x3f55bf0e,0xbf753e95
.long 0x3f6d3ec4,0xbf75be95,0x3f7b3e48,0xbf7fbdc9,0xbec43f6d,0xbdc9bf7f,0x3f0e3f55,0xbf62bef1,0xbf6dbec4,0x3f62bef1,0xbe483f7b,0xbf22bf46,0x3ec4bf6d,0x3f463f22,0xbf553f0e,0xbe95bf75
.long 0x3f6d3ec4,0xbe953f75,0xbf7bbe48,0x3dc9bf7f,0xbec43f6d,0xbf7f3dc9,0xbf0ebf55,0x3ef1bf62,0xbf6dbec4,0xbef1bf62,0x3e48bf7b,0x3f46bf22,0x3ec4bf6d,0x3f22bf46,0x3f55bf0e,0x3f75be95
.long 0x3f808000,0x3f7fbdc9,0x3f7bbe48,0x3f75be95,0x3f808000,0x3f62bef1,0x3f0ebf55,0x3dc9bf7f,0x3f808000,0x3f22bf46,0xbe48bf7b,0xbf62bef1,0x3f808000,0x3e95bf75,0xbf55bf0e,0xbf463f22
.long 0x3f808000,0xbdc9bf7f,0xbf7b3e48,0x3e953f75,0x3f808000,0xbef1bf62,0xbf0e3f55,0x3f7f3dc9,0x3f808000,0xbf46bf22,0x3e483f7b,0x3ef1bf62,0x3f808000,0xbf75be95,0x3f553f0e,0xbf22bf46
.long 0x3f808000,0xbf7f3dc9,0x3f7bbe48,0xbf753e95,0x3f808000,0xbf623ef1,0x3f0ebf55,0xbdc93f7f,0x3f808000,0xbf223f46,0xbe48bf7b,0x3f623ef1,0x3f808000,0xbe953f75,0xbf55bf0e,0x3f46bf22
.long 0x3f808000,0x3dc93f7f,0xbf7b3e48,0xbe95bf75,0x3f808000,0x3ef13f62,0xbf0e3f55,0xbf7fbdc9,0x3f808000,0x3f463f22,0x3e483f7b,0xbef13f62,0x3f808000,0x3f753e95,0x3f553f0e,0x3f223f46
.long 0x3f6dbec4,0x3f62bef1,0x3f55bf0e,0x3f46bf22,0xbec4bf6d,0xbf46bf22,0xbf7bbe48,0xbf753e95,0xbf6d3ec4,0xbe953f75,0x3f0e3f55,0x3f7f3dc9,0x3ec43f6d,0x3f7fbdc9,0x3e48bf7b,0xbf62bef1
.long 0x3f6dbec4,0xbef1bf62,0xbf553f0e,0x3f223f46,0xbec4bf6d,0xbf223f46,0x3f7b3e48,0xbe95bf75,0xbf6d3ec4,0x3f753e95,0xbf0ebf55,0xbdc93f7f,0x3ec43f6d,0xbdc9bf7f,0xbe483f7b,0x3ef1bf62
.long 0x3f6dbec4,0xbf623ef1,0x3f55bf0e,0xbf463f22,0xbec4bf6d,0x3f463f22,0xbf7bbe48,0x3f75be95,0xbf6d3ec4,0x3e95bf75,0x3f0e3f55,0xbf7fbdc9,0x3ec43f6d,0xbf7f3dc9,0x3e48bf7b,0x3f623ef1
.long 0x3f6dbec4,0x3ef13f62,0xbf553f0e,0xbf22bf46,0xbec4bf6d,0x3f22bf46,0x3f7b3e48,0x3e953f75,0xbf6d3ec4,0xbf75be95,0xbf0ebf55,0x3dc9bf7f,0x3ec43f6d,0x3dc93f7f,0xbe483f7b,0xbef13f62
.long 0x3f35bf35,0x3f22bf46,0x3f0ebf55,0x3ef1bf62,0xbf353f35,0xbe953f75,0x3e483f7b,0x3f223f46,0x3f35bf35,0xbdc9bf7f,0xbf55bf0e,0xbf753e95,0xbf353f35,0x3ef13f62,0x3f7bbe48,0x3dc9bf7f
.long 0x3f35bf35,0xbf46bf22,0xbf0e3f55,0x3f623ef1,0xbf353f35,0x3f753e95,0xbe48bf7b,0xbf463f22,0x3f35bf35,0xbf7f3dc9,0x3f553f0e,0xbe95bf75,0xbf353f35,0x3f62bef1,0xbf7b3e48,0x3f7f3dc9
.long 0x3f35bf35,0xbf223f46,0x3f0ebf55,0xbef13f62,0xbf353f35,0x3e95bf75,0x3e483f7b,0xbf22bf46,0x3f35bf35,0x3dc93f7f,0xbf55bf0e,0x3f75be95,0xbf353f35,0xbef1bf62,0x3f7bbe48,0xbdc93f7f
.long 0x3f35bf35,0x3f463f22,0xbf0e3f55,0xbf62bef1,0xbf353f35,0xbf75be95,0xbe48bf7b,0x3f46bf22,0x3f35bf35,0x3f7fbdc9,0x3f553f0e,0x3e953f75,0xbf353f35,0xbf623ef1,0xbf7b3e48,0xbf7fbdc9
.long 0x3ec4bf6d,0x3e95bf75,0x3e48bf7b,0x3dc9bf7f,0x3f6d3ec4,0x3f7fbdc9,0x3f55bf0e,0x3ef1bf62,0xbec43f6d,0x3ef13f62,0x3f7b3e48,0x3f46bf22,0xbf6dbec4,0xbf223f46,0x3f0e3f55,0x3f75be95
.long 0x3ec4bf6d,0xbf75be95,0xbe483f7b,0x3f7f3dc9,0x3f6d3ec4,0xbdc9bf7f,0xbf553f0e,0x3f623ef1,0xbec43f6d,0x3f62bef1,0xbf7bbe48,0x3f223f46,0xbf6dbec4,0x3f463f22,0xbf0ebf55,0x3e953f75
.long 0x3ec4bf6d,0xbe953f75,0x3e48bf7b,0xbdc93f7f,0x3f6d3ec4,0xbf7f3dc9,0x3f55bf0e,0xbef13f62,0xbec43f6d,0xbef1bf62,0x3f7b3e48,0xbf463f22,0xbf6dbec4,0x3f22bf46,0x3f0e3f55,0xbf753e95
.long 0x3ec4bf6d,0x3f753e95,0xbe483f7b,0xbf7fbdc9,0x3f6d3ec4,0x3dc93f7f,0xbf553f0e,0xbf62bef1,0xbec43f6d,0xbf623ef1,0xbf7bbe48,0xbf22bf46,0xbf6dbec4,0xbf46bf22,0xbf0ebf55,0xbe95bf75
.long 0x80003f80,0x80003f80,0x80003f80,0x80003f80,0xbdc93f7f,0xbef13f62,0xbf463f22,0xbf753e95,0xbe483f7b,0xbf553f0e,0xbf7bbe48,0xbf0ebf55,0xbe953f75,0xbf7f3dc9,0xbef1bf62,0x3f22bf46
.long 0xbec43f6d,0xbf6dbec4,0x3ec4bf6d,0x3f6d3ec4,0xbef13f62,0xbf22bf46,0x3f75be95,0xbdc93f7f,0xbf0e3f55,0xbe48bf7b,0x3f553f0e,0xbf7b3e48,0xbf223f46,0x3e95bf75,0x3dc93f7f,0xbef1bf62
.long 0xbf353f35,0x3f35bf35,0xbf353f35,0x3f35bf35,0xbf463f22,0x3f75be95,0xbf7fbdc9,0x3f623ef1,0xbf553f0e,0x3f7b3e48,0xbf0ebf55,0xbe483f7b,0xbf623ef1,0x3f463f22,0x3e95bf75,0xbf7f3dc9
.long 0xbf6d3ec4,0x3ec43f6d,0x3f6dbec4,0xbec4bf6d,0xbf753e95,0xbdc93f7f,0x3f623ef1,0x3f46bf22,0xbf7b3e48,0xbf0e3f55,0x3e483f7b,0x3f553f0e,0xbf7f3dc9,0xbf623ef1,0xbf223f46,0xbe953f75
.long 0x80003f80,0x80003f80,0x80003f80,0x80003f80,0xbf7fbdc9,0xbf62bef1,0xbf22bf46,0xbe95bf75,0x3e48bf7b,0x3f55bf0e,0x3f7b3e48,0x3f0e3f55,0x3f753e95,0x3dc93f7f,0xbf623ef1,0xbf46bf22
.long 0xbec43f6d,0xbf6dbec4,0x3ec4bf6d,0x3f6d3ec4,0xbf62bef1,0x3f46bf22,0x3e953f75,0xbf7fbdc9,0x3f0ebf55,0x3e483f7b,0xbf55bf0e,0x3f7bbe48,0x3f463f22,0xbf75be95,0x3f7fbdc9,0xbf623ef1
.long 0xbf353f35,0x3f35bf35,0xbf353f35,0x3f35bf35,0xbf22bf46,0x3e953f75,0x3dc9bf7f,0xbef13f62,0x3f55bf0e,0xbf7bbe48,0x3f0e3f55,0x3e48bf7b,0x3ef13f62,0x3f22bf46,0xbf75be95,0x3dc93f7f
.long 0xbf6d3ec4,0x3ec43f6d,0x3f6dbec4,0xbec4bf6d,0xbe95bf75,0xbf7fbdc9,0xbef13f62,0x3f223f46,0x3f7bbe48,0x3f0ebf55,0xbe48bf7b,0xbf55bf0e,0x3dc93f7f,0x3ef13f62,0x3f463f22,0x3f753e95
.long 0x80003f80,0x80003f80,0x80003f80,0x80003f80,0x3dc9bf7f,0x3ef1bf62,0x3f46bf22,0x3f75be95,0xbe483f7b,0xbf553f0e,0xbf7bbe48,0xbf0ebf55,0x3e95bf75,0x3f7fbdc9,0x3ef13f62,0xbf223f46
.long 0xbec43f6d,0xbf6dbec4,0x3ec4bf6d,0x3f6d3ec4,0x3ef1bf62,0x3f223f46,0xbf753e95,0x3dc9bf7f,0xbf0e3f55,0xbe48bf7b,0x3f553f0e,0xbf7b3e48,0x3f22bf46,0xbe953f75,0xbdc9bf7f,0x3ef13f62
.long 0xbf353f35,0x3f35bf35,0xbf353f35,0x3f35bf35,0x3f46bf22,0xbf753e95,0x3f7f3dc9,0xbf62bef1,0xbf553f0e,0x3f7b3e48,0xbf0ebf55,0xbe483f7b,0x3f62bef1,0xbf46bf22,0xbe953f75,0x3f7fbdc9
.long 0xbf6d3ec4,0x3ec43f6d,0x3f6dbec4,0xbec4bf6d,0x3f75be95,0x3dc9bf7f,0xbf62bef1,0xbf463f22,0xbf7b3e48,0xbf0e3f55,0x3e483f7b,0x3f553f0e,0x3f7fbdc9,0x3f62bef1,0x3f22bf46,0x3e95bf75
.long 0x80003f80,0x80003f80,0x80003f80,0x80003f80,0x3f7f3dc9,0x3f623ef1,0x3f223f46,0x3e953f75,0x3e48bf7b,0x3f55bf0e,0x3f7b3e48,0x3f0e3f55,0xbf75be95,0xbdc9bf7f,0x3f62bef1,0x3f463f22
.long 0xbec43f6d,0xbf6dbec4,0x3ec4bf6d,0x3f6d3ec4,0x3f623ef1,0xbf463f22,0xbe95bf75,0x3f7f3dc9,0x3f0ebf55,0x3e483f7b,0xbf55bf0e,0x3f7bbe48,0xbf46bf22,0x3f753e95,0xbf7f3dc9,0x3f62bef1
.long 0xbf353f35,0x3f35bf35,0xbf353f35,0x3f35bf35,0x3f223f46,0xbe95bf75,0xbdc93f7f,0x3ef1bf62,0x3f55bf0e,0xbf7bbe48,0x3f0e3f55,0x3e48bf7b,0xbef1bf62,0xbf223f46,0x3f753e95,0xbdc9bf7f
.long 0xbf6d3ec4,0x3ec43f6d,0x3f6dbec4,0xbec4bf6d,0x3e953f75,0x3f7f3dc9,0x3ef1bf62,0xbf22bf46,0x3f7bbe48,0x3f0ebf55,0xbe48bf7b,0xbf55bf0e,0xbdc9bf7f,0xbef1bf62,0xbf46bf22,0xbf75be95
.long 0x3f800000,0x3f800000,0x3f800000,0x3f800000,0x3f7f3dc9,0x3f623ef1,0x3f223f46,0x3e953f75,0x3f7b3e48,0x3f0e3f55,0xbe483f7b,0xbf553f0e,0x3f753e95,0x3dc93f7f,0xbf623ef1,0xbf46bf22
.long 0x3f6d3ec4,0xbec43f6d,0xbf6dbec4,0x3ec4bf6d,0x3f623ef1,0xbf463f22,0xbe95bf75,0x3f7f3dc9,0x3f553f0e,0xbf7b3e48,0x3f0ebf55,0x3e483f7b,0x3f463f22,0xbf75be95,0x3f7fbdc9,0xbf623ef1
.long 0x3f353f35,0xbf35bf35,0x3f353f35,0xbf35bf35,0x3f223f46,0xbe95bf75,0xbdc93f7f,0x3ef1bf62,0x3f0e3f55,0x3e48bf7b,0xbf553f0e,0x3f7b3e48,0x3ef13f62,0x3f22bf46,0xbf75be95,0x3dc93f7f
.long 0x3ec43f6d,0x3f6dbec4,0xbec4bf6d,0xbf6d3ec4,0x3e953f75,0x3f7f3dc9,0x3ef1bf62,0xbf22bf46,0x3e483f7b,0x3f553f0e,0x3f7bbe48,0x3f0ebf55,0x3dc93f7f,0x3ef13f62,0x3f463f22,0x3f753e95
.long 0x3f800000,0x3f800000,0x3f800000,0x3f800000,0xbdc93f7f,0xbef13f62,0xbf463f22,0xbf753e95,0xbf7bbe48,0xbf0ebf55,0x3e48bf7b,0x3f55bf0e,0x3e95bf75,0x3f7fbdc9,0x3ef13f62,0xbf223f46
.long 0x3f6d3ec4,0xbec43f6d,0xbf6dbec4,0x3ec4bf6d,0xbef13f62,0xbf22bf46,0x3f75be95,0xbdc93f7f,0xbf55bf0e,0x3f7bbe48,0xbf0e3f55,0xbe48bf7b,0x3f22bf46,0xbe953f75,0xbdc9bf7f,0x3ef13f62
.long 0x3f353f35,0xbf35bf35,0x3f353f35,0xbf35bf35,0xbf463f22,0x3f75be95,0xbf7fbdc9,0x3f623ef1,0xbf0ebf55,0xbe483f7b,0x3f55bf0e,0xbf7bbe48,0x3f62bef1,0xbf46bf22,0xbe953f75,0x3f7fbdc9
.long 0x3ec43f6d,0x3f6dbec4,0xbec4bf6d,0xbf6d3ec4,0xbf753e95,0xbdc93f7f,0x3f623ef1,0x3f46bf22,0xbe48bf7b,0xbf55bf0e,0xbf7b3e48,0xbf0e3f55,0x3f7fbdc9,0x3f62bef1,0x3f22bf46,0x3e95bf75
.long 0x3f800000,0x3f800000,0x3f800000,0x3f800000,0xbf7fbdc9,0xbf62bef1,0xbf22bf46,0xbe95bf75,0x3f7b3e48,0x3f0e3f55,0xbe483f7b,0xbf553f0e,0xbf75be95,0xbdc9bf7f,0x3f62bef1,0x3f463f22
.long 0x3f6d3ec4,0xbec43f6d,0xbf6dbec4,0x3ec4bf6d,0xbf62bef1,0x3f46bf22,0x3e953f75,0xbf7fbdc9,0x3f553f0e,0xbf7b3e48,0x3f0ebf55,0x3e483f7b,0xbf46bf22,0x3f753e95,0xbf7f3dc9,0x3f62bef1
.long 0x3f353f35,0xbf35bf35,0x3f353f35,0xbf35bf35,0xbf22bf46,0x3e953f75,0x3dc9bf7f,0xbef13f62,0x3f0e3f55,0x3e48bf7b,0xbf553f0e,0x3f7b3e48,0xbef1bf62,0xbf223f46,0x3f753e95,0xbdc9bf7f
.long 0x3ec43f6d,0x3f6dbec4,0xbec4bf6d,0xbf6d3ec4,0xbe95bf75,0xbf7fbdc9,0xbef13f62,0x3f223f46,0x3e483f7b,0x3f553f0e,0x3f7bbe48,0x3f0ebf55,0xbdc9bf7f,0xbef1bf62,0xbf46bf22,0xbf75be95
.long 0x3f800000,0x3f800000,0x3f800000,0x3f800000,0x3dc9bf7f,0x3ef1bf62,0x3f46bf22,0x3f75be95,0xbf7bbe48,0xbf0ebf55,0x3e48bf7b,0x3f55bf0e,0xbe953f75,0xbf7f3dc9,0xbef1bf62,0x3f22bf46
.long 0x3f6d3ec4,0xbec43f6d,0xbf6dbec4,0x3ec4bf6d,0x3ef1bf62,0x3f223f46,0xbf753e95,0x3dc9bf7f,0xbf55bf0e,0x3f7bbe48,0xbf0e3f55,0xbe48bf7b,0xbf223f46,0x3e95bf75,0x3dc93f7f,0xbef1bf62
.long 0x3f353f35,0xbf35bf35,0x3f353f35,0xbf35bf35,0x3f46bf22,0xbf753e95,0x3f7f3dc9,0xbf62bef1,0xbf0ebf55,0xbe483f7b,0x3f55bf0e,0xbf7bbe48,0xbf623ef1,0x3f463f22,0x3e95bf75,0xbf7f3dc9
.long 0x3ec43f6d,0x3f6dbec4,0xbec4bf6d,0xbf6d3ec4,0x3f75be95,0x3dc9bf7f,0xbf62bef1,0xbf463f22,0xbe48bf7b,0xbf55bf0e,0xbf7b3e48,0xbf0e3f55,0xbf7f3dc9,0xbf623ef1,0xbf223f46,0xbe953f75
.long 0x3f800000,0x3f7ffec4,0x3f7ffb11,0x3f7ff4e6,0x3f800000,0x3f7fe129,0x3f7f84ab,0x3f7eea9d,0x3f800000,0x3f7f9c18,0x3f7e70b0,0x3f7c7eb0,0x3f800000,0x3f7f2f9d,0x3f7cbfc9,0x3f78b47b
.long 0x3f800000,0x3f7e9bc9,0x3f7a7302,0x3f73913f,0x3f800000,0x3f7de0b1,0x3f778bc5,0x3f6d1c1d,0x3f800000,0x3f7cfe73,0x3f740bdd,0x3f655e0b,0x3f800000,0x3f7bf531,0x3f6ff573,0x3f5c61c7
.long 0x3f800000,0x3f7ac516,0x3f6b4b0c,0x3f5233c6,0x3f800000,0x3f796e4e,0x3f660f88,0x3f46e22a,0x3f800000,0x3f77f110,0x3f604621,0x3f3a7ca4,0x3f800000,0x3f764d97,0x3f59f26a,0x3f2d1469
.long 0x3f800000,0x3f748422,0x3f531849,0x3f1ebc12,0x3f800000,0x3f7294f8,0x3f4bbbf8,0x3f0f8784,0x3f800000,0x3f708066,0x3f43e200,0x3eff17b2,0x3f800000,0x3f6e46be,0x3f3b8f3b,0x3eddbe79
.long 0x3f7fec43,0x3f7fe129,0x3f7fd397,0x3f7fc38f,0x3f7e1324,0x3f7cfe73,0x3f7baccd,0x3f7a1e84,0x3f79c79d,0x3f764d97,0x3f721352,0x3f6d1c1d,0x3f731447,0x3f6be858,0x3f633c5a,0x3f591e6a
.long 0x3f6a09a7,0x3f5df6be,0x3f4f7a1f,0x3f3ebc1b,0x3f5ebe05,0x3f4cae79,0x3f373a23,0x3f1ebc12,0x3f514d3d,0x3f385216,0x3f1b02c6,0x3ef41f07,0x3f41d870,0x3f212ff9,0x3ef6e0cb,0x3ea395c5
.long 0x3f3085bb,0x3f07a136,0x3eb263ef,0x3e1c76de,0x3f1d7fd1,0x3ed8106b,0x3e541501,0xbc96c9b6,0x3f08f59b,0x3e9d9e78,0x3d7b2b74,0xbe419b37,0x3ee63375,0x3e419b37,0xbdafb680,0xbeb554ec
.long 0x3eb8442a,0x3d8a200a,0xbe6c9a7f,0xbf0242b1,0x3e888e93,0xbd621469,0xbebe1d4a,0xbf26050a,0x3e2f10a2,0xbe354098,0xbf00e7e4,0xbf44e3f5,0x3d96a905,0xbe97a117,0xbf1ff6cb,0xbf5df6be
.long 0x3f7fb10f,0x3f7f9c18,0x3f7f84ab,0x3f7f6ac7,0x3f7853f8,0x3f764d97,0x3f740bdd,0x3f718f57,0x3f676bd8,0x3f6106f2,0x3f59f26a,0x3f5233c6,0x3f4d9f02,0x3f40d0da,0x3f32c8c9,0x3f239da9
.long 0x3f2beb4a,0x3f173c07,0x3f00e7e4,0x3ed25a09,0x3f039c3d,0x3ecc9b8b,0x3e8e9a22,0x3e1c76de,0x3eac7cd4,0x3e419b37,0x3d16c32c,0xbdee3876,0x3e164083,0xbcfb49ba,0xbe541501,0xbec1071e
.long 0xbd48fb30,0xbe7ee6e1,0xbee0924f,0xbf1c420c,0xbe78cfcc,0xbee900b7,0xbf24d225,0xbf4cae79,0xbedae880,0xbf239da9,0xbf4f7a1f,0xbf6e46be,0xbf187fc0,0xbf4ac77f,0xbf6db293,0xbf7e9bc9
.long 0xbf3daef9,0xbf6816a8,0xbf7dabcc,0xbf7c7eb0,0xbf5b941a,0xbf7a1e84,0xbf7e70b0,0xbf6816a8,0xbf710908,0xbf7ffec4,0xbf6ff573,0xbf42de29,0xbf7d3aac,0xbf796e4e,0xbf531849,0xbf0f8784
.long 0x3f7f4e6d,0x3f7f2f9d,0x3f7f0e58,0x3f7eea9d,0x3f6ed89e,0x3f6be858,0x3f68bf3c,0x3f655e0b,0x3f49d112,0x3f40d0da,0x3f373a23,0x3f2d1469,0x3f13682a,0x3f0242b1,0x3ee0924f,0x3ebb31a0
.long 0x3ea09ae5,0x3e5a3997,0x3de1bc2e,0x3bc90f88,0x3cc90ab0,0xbdd53db9,0xbe6c9a7f,0xbeb554ec,0xbe888e93,0xbed25a09,0xbf0b9a6b,0xbf2ac082,0xbf08f59b,0xbf2d1469,0xbf4bbbf8,0xbf63f473
.long 0xbf41d870,0xbf5f8327,0xbf740bdd,0xbf7e9bc9,0xbf6a09a7,0xbf7b61fc,0xbf7fd397,0xbf772417,0xbf7e1324,0xbf7de0b1,0xbf6db293,0xbf4e8d90,0xbf7c3b28,0xbf66becc,0xbf3fc767,0xbf0a48ad
.long 0xbf64aa59,0xbf385216,0xbef6e0cb,0xbe4dee60,0xbf396842,0xbeee9479,0xbe22abb6,0x3e28defc,0xbefc5d27,0xbe28defc,0x3e3b6ecf,0x3f0242b1,0xbe605c13,0x3e1c76de,0x3f00e7e4,0x3f48d8b3
.long 0x0,0x3bc90f88,0x3c490e90,0x3c96c9b6,0x0,0x3cfb49ba,0x3d7b2b74,0x3dbc3ac3,0x0,0x3d621469,0x3de1bc2e,0x3e28defc,0x0,0x3da3308c,0x3e22abb6,0x3e72b651
.long 0x0,0x3dd53db9,0x3e541501,0x3e9d9e78,0x0,0x3e039502,0x3e827dc0,0x3ec1071e,0x0,0x3e1c76de,0x3e9aa086,0x3ee363fa,0x0,0x3e354098,0x3eb263ef,0x3f0242b1
.long 0x0,0x3e4dee60,0x3ec9b953,0x3f121eb0,0x0,0x3e667c66,0x3ee0924f,0x3f212ff9,0x0,0x3e7ee6e1,0x3ef6e0cb,0x3f2f61a5,0x0,0x3e8b9507,0x3f064b82,0x3f3ca003
.long 0x0,0x3e97a117,0x3f10d3cd,0x3f48d8b3,0x0,0x3ea395c5,0x3f1b02c6,0x3f53fac3,0x0,0x3eaf713a,0x3f24d225,0x3f5df6be,0x0,0x3ebb31a0,0x3f2e3bde,0x3f66becc
.long 0x3cc90ab0,0x3cfb49ba,0x3d16c32c,0x3d2fe007,0x3dfab273,0x3e1c76de,0x3e3b6ecf,0x3e5a3997,0x3e605c13,0x3e8b9507,0x3ea68f12,0x3ec1071e,0x3ea09ae5,0x3ec6d529,0x3eebcbbb,0x3f07a136
.long 0x3ecf7bca,0x3eff17b2,0x3f15f6d9,0x3f2ac082,0x3efc5d27,0x3f19c200,0x3f32c8c9,0x3f48d8b3,0x3f13682a,0x3f31a81d,0x3f4bbbf8,0x3f6106f2,0x3f273656,0x3f46e22a,0x3f604621,0x3f7294f8
.long 0x3f396842,0x3f591e6a,0x3f6ff573,0x3f7cfe73,0x3f49d112,0x3f6816a8,0x3f7a7302,0x3f7ff4e6,0x3f584853,0x3f73913f,0x3f7f84ab,0x3f7b61fc,0x3f64aa59,0x3f7b61fc,0x3f7f0e58,0x3f6f6830
.long 0x3f6ed89e,0x3f7f6ac7,0x3f791298,0x3f5c61c7,0x3f76ba07,0x3f7f9c18,0x3f6db293,0x3f42de29,0x3f7c3b28,0x3f7bf531,0x3f5d2d53,0x3f239da9,0x3f7f4e6d,0x3f748422,0x3f47de65,0x3eff17b2
.long 0x3d48fb30,0x3d621469,0x3d7b2b74,0x3d8a200a,0x3e78cfcc,0x3e8b9507,0x3e9aa086,0x3ea986c4,0x3edae880,0x3ef41f07,0x3f064b82,0x3f121eb0,0x3f187fc0,0x3f286605,0x3f373a23,0x3f44e3f5
.long 0x3f3daef9,0x3f4e8d90,0x3f5d2d53,0x3f696591,0x3f5b941a,0x3f6aab7b,0x3f75dec6,0x3f7cfe73,0x3f710908,0x3f7b61fc,0x3f7fd397,0x3f7e4323,0x3f7d3aac,0x3f7fe129,0x3f7a7302,0x3f6d1c1d
.long 0x3f7fb10f,0x3f77f110,0x3f660f88,0x3f4ac77f,0x3f7853f8,0x3f63f473,0x3f43e200,0x3f19c200,0x3f676bd8,0x3f44e3f5,0x3f15f6d9,0x3ebb31a0,0x3f4d9f02,0x3f1c420c,0x3ebe1d4a,0x3dd53db9
.long 0x3f2beb4a,0x3ed8106b,0x3e09cf86,0xbe28defc,0x3f039c3d,0x3e5a3997,0xbde1bc2e,0xbed8106b,0x3eac7cd4,0xbbc90f88,0xbeb263ef,0xbf26050a,0x3e164083,0xbe667c66,0xbf10d3cd,0xbf53fac3
.long 0x3d96a905,0x3da3308c,0x3dafb680,0x3dbc3ac3,0x3eb8442a,0x3ec6d529,0x3ed53641,0x3ee363fa,0x3f1d7fd1,0x3f286605,0x3f32c8c9,0x3f3ca003,0x3f514d3d,0x3f5c61c7,0x3f660f88,0x3f6e46be
.long 0x3f731447,0x3f7a1e84,0x3f7e70b0,0x3f7ffec4,0x3f7fec43,0x3f7e9bc9,0x3f791298,0x3f6f6830,0x3f76ba07,0x3f696591,0x3f5695e5,0x3f3ebc1b,0x3f584853,0x3f3ca003,0x3f1b02c6,0x3ee900b7
.long 0x3f273656,0x3ef9a02d,0x3e9aa086,0x3dd53db9,0x3ecf7bca,0x3e419b37,0xbd16c32c,0xbe8586ce,0x3dfab273,0xbe039502,0xbebe1d4a,0xbf173c07,0xbe2f10a2,0xbeddbe79,0xbf299415,0xbf577026
.long 0xbee63375,0xbf31a81d,0xbf604621,0xbf7ac516,0xbf3085bb,0xbf628210,0xbf7cbfc9,0xbf7c7eb0,0xbf5ebe05,0xbf7c7eb0,0xbf7baccd,0xbf5c61c7,0xbf79c79d,0xbf7cfe73,0xbf5d2d53,0xbf1ebc12
.long 0x3f800000,0x3f800000,0x3f800000,0x3f800000,0x3f7ffec4,0x3f7fe129,0x3f7f9c18,0x3f7f2f9d,0x3f7ffb11,0x3f7f84ab,0x3f7e70b0,0x3f7cbfc9,0x3f7ff4e6,0x3f7eea9d,0x3f7c7eb0,0x3f78b47b
.long 0x3f7fec43,0x3f7e1324,0x3f79c79d,0x3f731447,0x3f7fe129,0x3f7cfe73,0x3f764d97,0x3f6be858,0x3f7fd397,0x3f7baccd,0x3f721352,0x3f633c5a,0x3f7fc38f,0x3f7a1e84,0x3f6d1c1d,0x3f591e6a
.long 0x3f7fb10f,0x3f7853f8,0x3f676bd8,0x3f4d9f02,0x3f7f9c18,0x3f764d97,0x3f6106f2,0x3f40d0da,0x3f7f84ab,0x3f740bdd,0x3f59f26a,0x3f32c8c9,0x3f7f6ac7,0x3f718f57,0x3f5233c6,0x3f239da9
.long 0x3f7f4e6d,0x3f6ed89e,0x3f49d112,0x3f13682a,0x3f7f2f9d,0x3f6be858,0x3f40d0da,0x3f0242b1,0x3f7f0e58,0x3f68bf3c,0x3f373a23,0x3ee0924f,0x3f7eea9d,0x3f655e0b,0x3f2d1469,0x3ebb31a0
.long 0x3f800000,0x3f800000,0x3f800000,0x3f800000,0x3f7e9bc9,0x3f7de0b1,0x3f7cfe73,0x3f7bf531,0x3f7a7302,0x3f778bc5,0x3f740bdd,0x3f6ff573,0x3f73913f,0x3f6d1c1d,0x3f655e0b,0x3f5c61c7
.long 0x3f6a09a7,0x3f5ebe05,0x3f514d3d,0x3f41d870,0x3f5df6be,0x3f4cae79,0x3f385216,0x3f212ff9,0x3f4f7a1f,0x3f373a23,0x3f1b02c6,0x3ef6e0cb,0x3f3ebc1b,0x3f1ebc12,0x3ef41f07,0x3ea395c5
.long 0x3f2beb4a,0x3f039c3d,0x3eac7cd4,0x3e164083,0x3f173c07,0x3ecc9b8b,0x3e419b37,0xbcfb49ba,0x3f00e7e4,0x3e8e9a22,0x3d16c32c,0xbe541501,0x3ed25a09,0x3e1c76de,0xbdee3876,0xbec1071e
.long 0x3ea09ae5,0x3cc90ab0,0xbe888e93,0xbf08f59b,0x3e5a3997,0xbdd53db9,0xbed25a09,0xbf2d1469,0x3de1bc2e,0xbe6c9a7f,0xbf0b9a6b,0xbf4bbbf8,0x3bc90f88,0xbeb554ec,0xbf2ac082,0xbf63f473
.long 0x3f800000,0x3f800000,0x3f800000,0x3f800000,0x3f7ac516,0x3f796e4e,0x3f77f110,0x3f764d97,0x3f6b4b0c,0x3f660f88,0x3f604621,0x3f59f26a,0x3f5233c6,0x3f46e22a,0x3f3a7ca4,0x3f2d1469
.long 0x3f3085bb,0x3f1d7fd1,0x3f08f59b,0x3ee63375,0x3f07a136,0x3ed8106b,0x3e9d9e78,0x3e419b37,0x3eb263ef,0x3e541501,0x3d7b2b74,0xbdafb680,0x3e1c76de,0xbc96c9b6,0xbe419b37,0xbeb554ec
.long 0xbd48fb30,0xbe78cfcc,0xbedae880,0xbf187fc0,0xbe7ee6e1,0xbee900b7,0xbf239da9,0xbf4ac77f,0xbee0924f,0xbf24d225,0xbf4f7a1f,0xbf6db293,0xbf1c420c,0xbf4cae79,0xbf6e46be,0xbf7e9bc9
.long 0xbf41d870,0xbf6a09a7,0xbf7e1324,0xbf7c3b28,0xbf5f8327,0xbf7b61fc,0xbf7de0b1,0xbf66becc,0xbf740bdd,0xbf7fd397,0xbf6db293,0xbf3fc767,0xbf7e9bc9,0xbf772417,0xbf4e8d90,0xbf0a48ad
.long 0x3f800000,0x3f800000,0x3f800000,0x3f800000,0x3f748422,0x3f7294f8,0x3f708066,0x3f6e46be,0x3f531849,0x3f4bbbf8,0x3f43e200,0x3f3b8f3b,0x3f1ebc12,0x3f0f8784,0x3eff17b2,0x3eddbe79
.long 0x3eb8442a,0x3e888e93,0x3e2f10a2,0x3d96a905,0x3d8a200a,0xbd621469,0xbe354098,0xbe97a117,0xbe6c9a7f,0xbebe1d4a,0xbf00e7e4,0xbf1ff6cb,0xbf0242b1,0xbf26050a,0xbf44e3f5,0xbf5df6be
.long 0xbf3daef9,0xbf5b941a,0xbf710908,0xbf7d3aac,0xbf6816a8,0xbf7a1e84,0xbf7ffec4,0xbf796e4e,0xbf7dabcc,0xbf7e70b0,0xbf6ff573,0xbf531849,0xbf7c7eb0,0xbf6816a8,0xbf42de29,0xbf0f8784
.long 0xbf64aa59,0xbf396842,0xbefc5d27,0xbe605c13,0xbf385216,0xbeee9479,0xbe28defc,0x3e1c76de,0xbef6e0cb,0xbe22abb6,0x3e3b6ecf,0x3f00e7e4,0xbe4dee60,0x3e28defc,0x3f0242b1,0x3f48d8b3
.long 0x0,0x0,0x0,0x0,0x3bc90f88,0x3cfb49ba,0x3d621469,0x3da3308c,0x3c490e90,0x3d7b2b74,0x3de1bc2e,0x3e22abb6,0x3c96c9b6,0x3dbc3ac3,0x3e28defc,0x3e72b651
.long 0x3cc90ab0,0x3dfab273,0x3e605c13,0x3ea09ae5,0x3cfb49ba,0x3e1c76de,0x3e8b9507,0x3ec6d529,0x3d16c32c,0x3e3b6ecf,0x3ea68f12,0x3eebcbbb,0x3d2fe007,0x3e5a3997,0x3ec1071e,0x3f07a136
.long 0x3d48fb30,0x3e78cfcc,0x3edae880,0x3f187fc0,0x3d621469,0x3e8b9507,0x3ef41f07,0x3f286605,0x3d7b2b74,0x3e9aa086,0x3f064b82,0x3f373a23,0x3d8a200a,0x3ea986c4,0x3f121eb0,0x3f44e3f5
.long 0x3d96a905,0x3eb8442a,0x3f1d7fd1,0x3f514d3d,0x3da3308c,0x3ec6d529,0x3f286605,0x3f5c61c7,0x3dafb680,0x3ed53641,0x3f32c8c9,0x3f660f88,0x3dbc3ac3,0x3ee363fa,0x3f3ca003,0x3f6e46be
.long 0x0,0x0,0x0,0x0,0x3dd53db9,0x3e039502,0x3e1c76de,0x3e354098,0x3e541501,0x3e827dc0,0x3e9aa086,0x3eb263ef,0x3e9d9e78,0x3ec1071e,0x3ee363fa,0x3f0242b1
.long 0x3ecf7bca,0x3efc5d27,0x3f13682a,0x3f273656,0x3eff17b2,0x3f19c200,0x3f31a81d,0x3f46e22a,0x3f15f6d9,0x3f32c8c9,0x3f4bbbf8,0x3f604621,0x3f2ac082,0x3f48d8b3,0x3f6106f2,0x3f7294f8
.long 0x3f3daef9,0x3f5b941a,0x3f710908,0x3f7d3aac,0x3f4e8d90,0x3f6aab7b,0x3f7b61fc,0x3f7fe129,0x3f5d2d53,0x3f75dec6,0x3f7fd397,0x3f7a7302,0x3f696591,0x3f7cfe73,0x3f7e4323,0x3f6d1c1d
.long 0x3f731447,0x3f7fec43,0x3f76ba07,0x3f584853,0x3f7a1e84,0x3f7e9bc9,0x3f696591,0x3f3ca003,0x3f7e70b0,0x3f791298,0x3f5695e5,0x3f1b02c6,0x3f7ffec4,0x3f6f6830,0x3f3ebc1b,0x3ee900b7
.long 0x0,0x0,0x0,0x0,0x3e4dee60,0x3e667c66,0x3e7ee6e1,0x3e8b9507,0x3ec9b953,0x3ee0924f,0x3ef6e0cb,0x3f064b82,0x3f121eb0,0x3f212ff9,0x3f2f61a5,0x3f3ca003
.long 0x3f396842,0x3f49d112,0x3f584853,0x3f64aa59,0x3f591e6a,0x3f6816a8,0x3f73913f,0x3f7b61fc,0x3f6ff573,0x3f7a7302,0x3f7f84ab,0x3f7f0e58,0x3f7cfe73,0x3f7ff4e6,0x3f7b61fc,0x3f6f6830
.long 0x3f7fb10f,0x3f7853f8,0x3f676bd8,0x3f4d9f02,0x3f77f110,0x3f63f473,0x3f44e3f5,0x3f1c420c,0x3f660f88,0x3f43e200,0x3f15f6d9,0x3ebe1d4a,0x3f4ac77f,0x3f19c200,0x3ebb31a0,0x3dd53db9
.long 0x3f273656,0x3ecf7bca,0x3dfab273,0xbe2f10a2,0x3ef9a02d,0x3e419b37,0xbe039502,0xbeddbe79,0x3e9aa086,0xbd16c32c,0xbebe1d4a,0xbf299415,0x3dd53db9,0xbe8586ce,0xbf173c07,0xbf577026
.long 0x0,0x0,0x0,0x0,0x3e97a117,0x3ea395c5,0x3eaf713a,0x3ebb31a0,0x3f10d3cd,0x3f1b02c6,0x3f24d225,0x3f2e3bde,0x3f48d8b3,0x3f53fac3,0x3f5df6be,0x3f66becc
.long 0x3f6ed89e,0x3f76ba07,0x3f7c3b28,0x3f7f4e6d,0x3f7f6ac7,0x3f7f9c18,0x3f7bf531,0x3f748422,0x3f791298,0x3f6db293,0x3f5d2d53,0x3f47de65,0x3f5c61c7,0x3f42de29,0x3f239da9,0x3eff17b2
.long 0x3f2beb4a,0x3f039c3d,0x3eac7cd4,0x3e164083,0x3ed8106b,0x3e5a3997,0xbbc90f88,0xbe667c66,0x3e09cf86,0xbde1bc2e,0xbeb263ef,0xbf10d3cd,0xbe28defc,0xbed8106b,0xbf26050a,0xbf53fac3
.long 0xbee63375,0xbf3085bb,0xbf5ebe05,0xbf79c79d,0xbf31a81d,0xbf628210,0xbf7c7eb0,0xbf7cfe73,0xbf604621,0xbf7cbfc9,0xbf7baccd,0xbf5d2d53,0xbf7ac516,0xbf7c7eb0,0xbf5c61c7,0xbf1ebc12
.long 0x3f80,0x3e163f7d,0x3e953f75,0x3edb3f67,0x3f80,0x3f043f5c,0x3f623ef1,0x3f80bd49,0x3f80,0x3f4e3f18,0x3f75be95,0x3eacbf71,0x3f80,0x3f783e79,0x3ef1bf62,0xbf3ebf2c
.long 0x3f80,0x3f7dbe16,0xbe95bf75,0xbf673edb,0x3f80,0x3f5cbf04,0xbf62bef1,0x3d493f80,0x3f80,0x3f18bf4e,0xbf753e95,0x3f713eac,0x3f80,0x3e79bf78,0xbef13f62,0x3f2cbf3e
.long 0x3f80,0xbe16bf7d,0x3e953f75,0xbedbbf67,0x3f80,0xbf04bf5c,0x3f623ef1,0xbf803d49,0x3f80,0xbf4ebf18,0x3f75be95,0xbeac3f71,0x3f80,0xbf78be79,0x3ef1bf62,0x3f3e3f2c
.long 0x3f80,0xbf7d3e16,0xbe95bf75,0x3f67bedb,0x3f80,0xbf5c3f04,0xbf62bef1,0xbd49bf80,0x3f80,0xbf183f4e,0xbf753e95,0xbf71beac,0x3f80,0xbe793f78,0xbef13f62,0xbf2c3f3e
.long 0x3f0e3f55,0x3f2c3f3e,0x3f463f22,0x3f5c3f04,0x3f55bf0e,0x3edbbf67,0xbdc9bf7f,0xbf18bf4e,0xbf0ebf55,0xbf80bd49,0xbf223f46,0x3e793f78,0xbf553f0e,0x3eac3f71,0x3f7fbdc9,0x3e16bf7d
.long 0x3f0e3f55,0x3f3ebf2c,0xbf46bf22,0xbf043f5c,0x3f55bf0e,0xbf67bedb,0x3dc93f7f,0x3f4ebf18,0xbf0ebf55,0xbd493f80,0x3f22bf46,0xbf783e79,0xbf553f0e,0x3f71beac,0xbf7f3dc9,0x3f7d3e16
.long 0x3f0e3f55,0xbf2cbf3e,0x3f463f22,0xbf5cbf04,0x3f55bf0e,0xbedb3f67,0xbdc9bf7f,0x3f183f4e,0xbf0ebf55,0x3f803d49,0xbf223f46,0xbe79bf78,0xbf553f0e,0xbeacbf71,0x3f7fbdc9,0xbe163f7d
.long 0x3f0e3f55,0xbf3e3f2c,0xbf46bf22,0x3f04bf5c,0x3f55bf0e,0x3f673edb,0x3dc93f7f,0xbf4e3f18,0xbf0ebf55,0x3d49bf80,0x3f22bf46,0x3f78be79,0xbf553f0e,0xbf713eac,0xbf7f3dc9,0xbf7dbe16
.long 0x3f6d3ec4,0x3f783e79,0x3f7f3dc9,0x3f80bd49,0xbf6dbec4,0xbf7d3e16,0xbf463f22,0xbeac3f71,0x3f6d3ec4,0x3f5cbf04,0x3dc9bf7f,0xbf3ebf2c,0xbf6dbec4,0xbf183f4e,0x3f223f46,0x3f67bedb
.long 0x3f6d3ec4,0x3e79bf78,0xbf7fbdc9,0x3d493f80,0xbf6dbec4,0x3e163f7d,0x3f46bf22,0xbf71beac,0x3f6d3ec4,0xbf04bf5c,0xbdc93f7f,0x3f2cbf3e,0xbf6dbec4,0x3f4e3f18,0xbf22bf46,0x3edb3f67
.long 0x3f6d3ec4,0xbf78be79,0x3f7f3dc9,0xbf803d49,0xbf6dbec4,0x3f7dbe16,0xbf463f22,0x3eacbf71,0x3f6d3ec4,0xbf5c3f04,0x3dc9bf7f,0x3f3e3f2c,0xbf6dbec4,0x3f18bf4e,0x3f223f46,0xbf673edb
.long 0x3f6d3ec4,0xbe793f78,0xbf7fbdc9,0xbd49bf80,0xbf6dbec4,0xbe16bf7d,0x3f46bf22,0x3f713eac,0x3f6d3ec4,0x3f043f5c,0xbdc93f7f,0xbf2c3f3e,0xbf6dbec4,0xbf4ebf18,0xbf22bf46,0xbedbbf67
.long 0x3f7bbe48,0x3f71beac,0x3f62bef1,0x3f4ebf18,0x3e483f7b,0x3f2c3f3e,0x3f753e95,0x3f78be79,0xbf7b3e48,0xbedb3f67,0x3ef13f62,0x3f7d3e16,0xbe48bf7b,0xbf80bd49,0xbe953f75,0x3f5c3f04
.long 0x3f7bbe48,0xbeacbf71,0xbf623ef1,0x3f183f4e,0x3e483f7b,0x3f3ebf2c,0xbf75be95,0x3e793f78,0xbf7b3e48,0x3f673edb,0xbef1bf62,0xbe163f7d,0xbe48bf7b,0xbd493f80,0x3e95bf75,0xbf043f5c
.long 0x3f7bbe48,0xbf713eac,0x3f62bef1,0xbf4e3f18,0x3e483f7b,0xbf2cbf3e,0x3f753e95,0xbf783e79,0xbf7b3e48,0x3edbbf67,0x3ef13f62,0xbf7dbe16,0xbe48bf7b,0x3f803d49,0xbe953f75,0xbf5cbf04
.long 0x3f7bbe48,0x3eac3f71,0xbf623ef1,0xbf18bf4e,0x3e483f7b,0xbf3e3f2c,0xbf75be95,0xbe79bf78,0xbf7b3e48,0xbf67bedb,0xbef1bf62,0x3e16bf7d,0xbe48bf7b,0x3d49bf80,0x3e95bf75,0x3f04bf5c
.long 0x3f808000,0x3f7dbe16,0x3f75be95,0x3f67bedb,0x3f808000,0x3f5cbf04,0x3ef1bf62,0xbd49bf80,0x3f808000,0x3f18bf4e,0xbe95bf75,0xbf71beac,0x3f808000,0x3e79bf78,0xbf62bef1,0xbf2c3f3e
.long 0x3f808000,0xbe16bf7d,0xbf753e95,0x3edb3f67,0x3f808000,0xbf04bf5c,0xbef13f62,0x3f80bd49,0x3f808000,0xbf4ebf18,0x3e953f75,0x3eacbf71,0x3f808000,0xbf78be79,0x3f623ef1,0xbf3ebf2c
.long 0x3f808000,0xbf7d3e16,0x3f75be95,0xbf673edb,0x3f808000,0xbf5c3f04,0x3ef1bf62,0x3d493f80,0x3f808000,0xbf183f4e,0xbe95bf75,0x3f713eac,0x3f808000,0xbe793f78,0xbf62bef1,0x3f2cbf3e
.long 0x3f808000,0x3e163f7d,0xbf753e95,0xbedbbf67,0x3f808000,0x3f043f5c,0xbef13f62,0xbf803d49,0x3f808000,0x3f4e3f18,0x3e953f75,0xbeac3f71,0x3f808000,0x3f783e79,0x3f623ef1,0x3f3e3f2c
.long 0x3f55bf0e,0x3f3ebf2c,0x3f22bf46,0x3f04bf5c,0xbf0ebf55,0xbf67bedb,0xbf7f3dc9,0xbf4e3f18,0xbf553f0e,0xbd493f80,0x3f463f22,0x3f78be79,0x3f0e3f55,0x3f71beac,0xbdc9bf7f,0xbf7dbe16
.long 0x3f55bf0e,0xbf2cbf3e,0xbf223f46,0x3f5c3f04,0xbf0ebf55,0xbedb3f67,0x3f7fbdc9,0xbf18bf4e,0xbf553f0e,0x3f803d49,0xbf46bf22,0x3e793f78,0x3f0e3f55,0xbeacbf71,0x3dc93f7f,0x3e16bf7d
.long 0x3f55bf0e,0xbf3e3f2c,0x3f22bf46,0xbf043f5c,0xbf0ebf55,0x3f673edb,0xbf7f3dc9,0x3f4ebf18,0xbf553f0e,0x3d49bf80,0x3f463f22,0xbf783e79,0x3f0e3f55,0xbf713eac,0xbdc9bf7f,0x3f7d3e16
.long 0x3f55bf0e,0x3f2c3f3e,0xbf223f46,0xbf5cbf04,0xbf0ebf55,0x3edbbf67,0x3f7fbdc9,0x3f183f4e,0xbf553f0e,0xbf80bd49,0xbf46bf22,0xbe79bf78,0x3f0e3f55,0x3eac3f71,0x3dc93f7f,0xbe163f7d
.long 0x3ec4bf6d,0x3e79bf78,0x3dc9bf7f,0xbd49bf80,0xbec43f6d,0x3e163f7d,0x3f223f46,0x3f713eac,0x3ec4bf6d,0xbf04bf5c,0xbf7fbdc9,0xbf2c3f3e,0xbec43f6d,0x3f4e3f18,0x3f46bf22,0xbedbbf67
.long 0x3ec4bf6d,0xbf78be79,0xbdc93f7f,0x3f80bd49,0xbec43f6d,0x3f7dbe16,0xbf22bf46,0xbeac3f71,0x3ec4bf6d,0xbf5c3f04,0x3f7f3dc9,0xbf3ebf2c,0xbec43f6d,0x3f18bf4e,0xbf463f22,0x3f67bedb
.long 0x3ec4bf6d,0xbe793f78,0x3dc9bf7f,0x3d493f80,0xbec43f6d,0xbe16bf7d,0x3f223f46,0xbf71beac,0x3ec4bf6d,0x3f043f5c,0xbf7fbdc9,0x3f2cbf3e,0xbec43f6d,0xbf4ebf18,0x3f46bf22,0x3edb3f67
.long 0x3ec4bf6d,0x3f783e79,0xbdc93f7f,0xbf803d49,0xbec43f6d,0xbf7d3e16,0xbf22bf46,0x3eacbf71,0x3ec4bf6d,0x3f5cbf04,0x3f7f3dc9,0x3f3e3f2c,0xbec43f6d,0xbf183f4e,0xbf463f22,0xbf673edb
.long 0xbe48bf7b,0xbeacbf71,0xbef1bf62,0xbf18bf4e,0x3f7bbe48,0x3f3ebf2c,0x3e95bf75,0xbe79bf78,0x3e483f7b,0x3f673edb,0x3f62bef1,0x3e16bf7d,0xbf7b3e48,0xbd493f80,0x3f753e95,0x3f04bf5c
.long 0xbe48bf7b,0xbf713eac,0x3ef13f62,0x3f4ebf18,0x3f7bbe48,0xbf2cbf3e,0xbe953f75,0x3f78be79,0x3e483f7b,0x3edbbf67,0xbf623ef1,0x3f7d3e16,0xbf7b3e48,0x3f803d49,0xbf75be95,0x3f5c3f04
.long 0xbe48bf7b,0x3eac3f71,0xbef1bf62,0x3f183f4e,0x3f7bbe48,0xbf3e3f2c,0x3e95bf75,0x3e793f78,0x3e483f7b,0xbf67bedb,0x3f62bef1,0xbe163f7d,0xbf7b3e48,0x3d49bf80,0x3f753e95,0xbf043f5c
.long 0xbe48bf7b,0x3f71beac,0x3ef13f62,0xbf4e3f18,0x3f7bbe48,0x3f2c3f3e,0xbe953f75,0xbf783e79,0x3e483f7b,0xbedb3f67,0xbf623ef1,0xbf7dbe16,0xbf7b3e48,0xbf80bd49,0xbf75be95,0xbf5cbf04
.long 0x80003f80,0x80003f80,0x80003f80,0x80003f80,0xbe163f7d,0xbf043f5c,0xbf4e3f18,0xbf783e79,0xbe953f75,0xbf623ef1,0xbf75be95,0xbef1bf62,0xbedb3f67,0xbf80bd49,0xbeacbf71,0x3f3ebf2c
.long 0xbf0e3f55,0xbf55bf0e,0x3f0ebf55,0x3f553f0e,0xbf2c3f3e,0xbedbbf67,0x3f80bd49,0xbeac3f71,0xbf463f22,0x3dc9bf7f,0x3f223f46,0xbf7fbdc9,0xbf5c3f04,0x3f18bf4e,0xbe793f78,0xbe16bf7d
.long 0xbf6d3ec4,0x3f6dbec4,0xbf6d3ec4,0x3f6dbec4,0xbf783e79,0x3f7d3e16,0xbf5cbf04,0x3f183f4e,0xbf7f3dc9,0x3f463f22,0xbdc9bf7f,0xbf223f46,0xbf80bd49,0x3eac3f71,0x3f3ebf2c,0xbf67bedb
.long 0xbf7bbe48,0xbe483f7b,0x3f7b3e48,0x3e48bf7b,0xbf71beac,0xbf2c3f3e,0x3edb3f67,0x3f80bd49,0xbf62bef1,0xbf753e95,0xbef13f62,0x3e953f75,0xbf4ebf18,0xbf78be79,0xbf7d3e16,0xbf5c3f04
.long 0x80003f80,0x80003f80,0x80003f80,0x80003f80,0xbf7dbe16,0xbf5cbf04,0xbf18bf4e,0xbe79bf78,0x3e95bf75,0x3f62bef1,0x3f753e95,0x3ef13f62,0x3f673edb,0xbd493f80,0xbf713eac,0xbf2cbf3e
.long 0xbf0e3f55,0xbf55bf0e,0x3f0ebf55,0x3f553f0e,0xbf3ebf2c,0x3f67bedb,0x3d493f80,0xbf71beac,0x3f46bf22,0xbdc93f7f,0xbf22bf46,0x3f7f3dc9,0x3f043f5c,0xbf4ebf18,0x3f783e79,0xbf7d3e16
.long 0xbf6d3ec4,0x3f6dbec4,0xbf6d3ec4,0x3f6dbec4,0xbe79bf78,0xbe163f7d,0x3f04bf5c,0xbf4e3f18,0x3f7fbdc9,0xbf46bf22,0x3dc93f7f,0x3f22bf46,0xbd493f80,0x3f71beac,0xbf2cbf3e,0xbedb3f67
.long 0xbf7bbe48,0xbe483f7b,0x3f7b3e48,0x3e48bf7b,0x3eacbf71,0xbf3ebf2c,0xbf673edb,0x3d493f80,0x3f623ef1,0x3f75be95,0x3ef1bf62,0xbe95bf75,0xbf183f4e,0xbe793f78,0x3e163f7d,0x3f043f5c
.long 0x80003f80,0x80003f80,0x80003f80,0x80003f80,0x3e16bf7d,0x3f04bf5c,0x3f4ebf18,0x3f78be79,0xbe953f75,0xbf623ef1,0xbf75be95,0xbef1bf62,0x3edbbf67,0x3f803d49,0x3eac3f71,0xbf3e3f2c
.long 0xbf0e3f55,0xbf55bf0e,0x3f0ebf55,0x3f553f0e,0x3f2cbf3e,0x3edb3f67,0xbf803d49,0x3eacbf71,0xbf463f22,0x3dc9bf7f,0x3f223f46,0xbf7fbdc9,0x3f5cbf04,0xbf183f4e,0x3e79bf78,0x3e163f7d
.long 0xbf6d3ec4,0x3f6dbec4,0xbf6d3ec4,0x3f6dbec4,0x3f78be79,0xbf7dbe16,0x3f5c3f04,0xbf18bf4e,0xbf7f3dc9,0x3f463f22,0xbdc9bf7f,0xbf223f46,0x3f803d49,0xbeacbf71,0xbf3e3f2c,0x3f673edb
.long 0xbf7bbe48,0xbe483f7b,0x3f7b3e48,0x3e48bf7b,0x3f713eac,0x3f2cbf3e,0xbedbbf67,0xbf803d49,0xbf62bef1,0xbf753e95,0xbef13f62,0x3e953f75,0x3f4e3f18,0x3f783e79,0x3f7dbe16,0x3f5cbf04
.long 0x80003f80,0x80003f80,0x80003f80,0x80003f80,0x3f7d3e16,0x3f5c3f04,0x3f183f4e,0x3e793f78,0x3e95bf75,0x3f62bef1,0x3f753e95,0x3ef13f62,0xbf67bedb,0x3d49bf80,0x3f71beac,0x3f2c3f3e
.long 0xbf0e3f55,0xbf55bf0e,0x3f0ebf55,0x3f553f0e,0x3f3e3f2c,0xbf673edb,0xbd49bf80,0x3f713eac,0x3f46bf22,0xbdc93f7f,0xbf22bf46,0x3f7f3dc9,0xbf04bf5c,0x3f4e3f18,0xbf78be79,0x3f7dbe16
.long 0xbf6d3ec4,0x3f6dbec4,0xbf6d3ec4,0x3f6dbec4,0x3e793f78,0x3e16bf7d,0xbf043f5c,0x3f4ebf18,0x3f7fbdc9,0xbf46bf22,0x3dc93f7f,0x3f22bf46,0x3d49bf80,0xbf713eac,0x3f2c3f3e,0x3edbbf67
.long 0xbf7bbe48,0xbe483f7b,0x3f7b3e48,0x3e48bf7b,0xbeac3f71,0x3f3e3f2c,0x3f67bedb,0xbd49bf80,0x3f623ef1,0x3f75be95,0x3ef1bf62,0xbe95bf75,0x3f18bf4e,0x3e79bf78,0xbe16bf7d,0xbf04bf5c
.long 0x3f800000,0x3f800000,0x3f800000,0x3f800000,0x3f7d3e16,0x3f5c3f04,0x3f183f4e,0x3e793f78,0x3f753e95,0x3ef13f62,0xbe953f75,0xbf623ef1,0x3f673edb,0xbd493f80,0xbf713eac,0xbf2cbf3e
.long 0x3f553f0e,0xbf0e3f55,0xbf55bf0e,0x3f0ebf55,0x3f3e3f2c,0xbf673edb,0xbd49bf80,0x3f713eac,0x3f223f46,0xbf7fbdc9,0x3f46bf22,0xbdc93f7f,0x3f043f5c,0xbf4ebf18,0x3f783e79,0xbf7d3e16
.long 0x3ec43f6d,0xbec4bf6d,0x3ec43f6d,0xbec4bf6d,0x3e793f78,0x3e16bf7d,0xbf043f5c,0x3f4ebf18,0x3dc93f7f,0x3f22bf46,0xbf7f3dc9,0x3f463f22,0xbd493f80,0x3f71beac,0xbf2cbf3e,0xbedb3f67
.long 0xbe483f7b,0x3f7b3e48,0x3e48bf7b,0xbf7bbe48,0xbeac3f71,0x3f3e3f2c,0x3f67bedb,0xbd49bf80,0xbef13f62,0x3e953f75,0x3f623ef1,0x3f75be95,0xbf183f4e,0xbe793f78,0x3e163f7d,0x3f043f5c
.long 0x3f800000,0x3f800000,0x3f800000,0x3f800000,0xbe163f7d,0xbf043f5c,0xbf4e3f18,0xbf783e79,0xbf75be95,0xbef1bf62,0x3e95bf75,0x3f62bef1,0x3edbbf67,0x3f803d49,0x3eac3f71,0xbf3e3f2c
.long 0x3f553f0e,0xbf0e3f55,0xbf55bf0e,0x3f0ebf55,0xbf2c3f3e,0xbedbbf67,0x3f80bd49,0xbeac3f71,0xbf22bf46,0x3f7f3dc9,0xbf463f22,0x3dc9bf7f,0x3f5cbf04,0xbf183f4e,0x3e79bf78,0x3e163f7d
.long 0x3ec43f6d,0xbec4bf6d,0x3ec43f6d,0xbec4bf6d,0xbf783e79,0x3f7d3e16,0xbf5cbf04,0x3f183f4e,0xbdc9bf7f,0xbf223f46,0x3f7fbdc9,0xbf46bf22,0x3f803d49,0xbeacbf71,0xbf3e3f2c,0x3f673edb
.long 0xbe483f7b,0x3f7b3e48,0x3e48bf7b,0xbf7bbe48,0xbf71beac,0xbf2c3f3e,0x3edb3f67,0x3f80bd49,0x3ef1bf62,0xbe95bf75,0xbf62bef1,0xbf753e95,0x3f4e3f18,0x3f783e79,0x3f7dbe16,0x3f5cbf04
.long 0x3f800000,0x3f800000,0x3f800000,0x3f800000,0xbf7dbe16,0xbf5cbf04,0xbf18bf4e,0xbe79bf78,0x3f753e95,0x3ef13f62,0xbe953f75,0xbf623ef1,0xbf67bedb,0x3d49bf80,0x3f71beac,0x3f2c3f3e
.long 0x3f553f0e,0xbf0e3f55,0xbf55bf0e,0x3f0ebf55,0xbf3ebf2c,0x3f67bedb,0x3d493f80,0xbf71beac,0x3f223f46,0xbf7fbdc9,0x3f46bf22,0xbdc93f7f,0xbf04bf5c,0x3f4e3f18,0xbf78be79,0x3f7dbe16
.long 0x3ec43f6d,0xbec4bf6d,0x3ec43f6d,0xbec4bf6d,0xbe79bf78,0xbe163f7d,0x3f04bf5c,0xbf4e3f18,0x3dc93f7f,0x3f22bf46,0xbf7f3dc9,0x3f463f22,0x3d49bf80,0xbf713eac,0x3f2c3f3e,0x3edbbf67
.long 0xbe483f7b,0x3f7b3e48,0x3e48bf7b,0xbf7bbe48,0x3eacbf71,0xbf3ebf2c,0xbf673edb,0x3d493f80,0xbef13f62,0x3e953f75,0x3f623ef1,0x3f75be95,0x3f18bf4e,0x3e79bf78,0xbe16bf7d,0xbf04bf5c
.long 0x3f800000,0x3f800000,0x3f800000,0x3f800000,0x3e16bf7d,0x3f04bf5c,0x3f4ebf18,0x3f78be79,0xbf75be95,0xbef1bf62,0x3e95bf75,0x3f62bef1,0xbedb3f67,0xbf80bd49,0xbeacbf71,0x3f3ebf2c
.long 0x3f553f0e,0xbf0e3f55,0xbf55bf0e,0x3f0ebf55,0x3f2cbf3e,0x3edb3f67,0xbf803d49,0x3eacbf71,0xbf22bf46,0x3f7f3dc9,0xbf463f22,0x3dc9bf7f,0xbf5c3f04,0x3f18bf4e,0xbe793f78,0xbe16bf7d
.long 0x3ec43f6d,0xbec4bf6d,0x3ec43f6d,0xbec4bf6d,0x3f78be79,0xbf7dbe16,0x3f5c3f04,0xbf18bf4e,0xbdc9bf7f,0xbf223f46,0x3f7fbdc9,0xbf46bf22,0xbf80bd49,0x3eac3f71,0x3f3ebf2c,0xbf67bedb
.long 0xbe483f7b,0x3f7b3e48,0x3e48bf7b,0xbf7bbe48,0x3f713eac,0x3f2cbf3e,0xbedbbf67,0xbf803d49,0x3ef1bf62,0xbe95bf75,0xbf62bef1,0xbf753e95,0xbf4ebf18,0xbf78be79,0xbf7d3e16,0xbf5c3f04
.long 0x3f800000,0x3f7ffd39,0x3f7ff4e6,0x3f7fe705,0x3f800000,0x3f7fdaaf,0x3f7f6ac7,0x3f7eb069,0x3f800000,0x3f7f90b1,0x3f7e4323,0x3f7c187a,0x3f800000,0x3f7f1f49,0x3f7c7eb0,0x3f7822d1
.long 0x3f800000,0x3f7e868b,0x3f7a1e84,0x3f72d4eb,0x3f800000,0x3f7dc68c,0x3f772417,0x3f6c3624,0x3f800000,0x3f7cdf6c,0x3f73913f,0x3f644fac,0x3f800000,0x3f7bd14d,0x3f6f6830,0x3f5b2c79
.long 0x3f800000,0x3f7a9c59,0x3f6aab7b,0x3f50d937,0x3f800000,0x3f7940c0,0x3f655e0b,0x3f456439,0x3f800000,0x3f77beb7,0x3f5f8327,0x3f38dd65,0x3f800000,0x3f76167a,0x3f591e6a,0x3f2b561b
.long 0x3f800000,0x3f74484b,0x3f5233c6,0x3f1ce11f,0x3f800000,0x3f725470,0x3f4ac77f,0x3f0d9281,0x3f800000,0x3f703b37,0x3f42de29,0x3efafef7,0x3f800000,0x3f6dfcf2,0x3f3a7ca4,0x3ed97cb9
.long 0x3f7fd397,0x3f7fba9e,0x3f7f9c18,0x3f7f7808,0x3f7dabcc,0x3f7c5d3a,0x3f7ac516,0x3f78e3d6,0x3f791298,0x3f75341d,0x3f708066,0x3f6afb8c,0x3f721352,0x3f6a5ad9,0x3f6106f2,0x3f5627fe
.long 0x3f68bf3c,0x3f5bfb34,0x3f4cae79,0x3f3b0629,0x3f5d2d53,0x3f4a4c87,0x3f33e7bc,0x3f1a6293,0x3f4f7a1f,0x3f3592e7,0x3f173c07,0x3eea6681,0x3f3fc767,0x3f1e1e22,0x3eee9479,0x3e9920fe
.long 0x3f2e3bde,0x3f044889,0x3ea986c4,0x3e06b26e,0x3f1b02c6,0x3ed0eb2a,0x3e419b37,0xbd2351cb,0x3f064b82,0x3e9620d2,0x3d2fe007,0xbe57278f,0x3ee0924f,0x3e3228d4,0xbdd53db9,0xbebf926f
.long 0x3eb263ef,0x3d55880e,0xbe7ee6e1,0xbf06f686,0x3e827dc0,0xbd9064b4,0xbec6d529,0xbf2a2a80,0x3e22abb6,0xbe44b0b9,0xbf04f484,0xbf485bca,0x3d7b2b74,0xbe9f1cdf,0xbf239da9,0xbf60a6cf
.long 0x3f7f4e6d,0x3f7f1f49,0x3f7eea9d,0x3f7eb069,0x3f76ba07,0x3f74484b,0x3f718f57,0x3f6e8ff8,0x3f64aa59,0x3f5d924d,0x3f55b993,0x3f4d26fd,0x3f49d112,0x3f3c17d9,0x3f2d1469,0x3f1ce11f
.long 0x3f273656,0x3f11796b,0x3ef41f07,0x3ec27b55,0x3efc5d27,0x3ebf926f,0x3e7ee6e1,0x3df475c0,0x3ea09ae5,0x3e25c58c,0x3bc90f88,0xbe195be0,0x3dfab273,0xbd6ea038,0xbe72b651,0xbed0eb2a
.long 0xbd96a905,0xbe8d17c0,0xbeee9479,0xbf2302d3,0xbe888e93,0xbef58035,0xbf2ac082,0xbf51c0c2,0xbee63375,0xbf28fd41,0xbf53fac3,0xbf714c7a,0xbf1d7fd1,0xbf4f0417,0xbf708066,0xbf7f5ce9
.long 0xbf41d870,0xbf6afb8c,0xbf7e9bc9,0xbf7aed37,0xbf5ebe05,0xbf7b87b2,0xbf7d7474,0xbf644fac,0xbf731447,0xbf7fdaaf,0xbf6d1c1d,0xbf3d27b8,0xbf7e1324,0xbf77beb7,0xbf4e8d90,0xbf084b92
.long 0x3f7e70b0,0x3f7e2b72,0x3f7de0b1,0x3f7d906e,0x3f6b4b0c,0x3f67c187,0x3f63f473,0x3f5fe4e9,0x3f43e200,0x3f39f2ac,0x3f2f61a5,0x3f24381a,0x3f0b9a6b,0x3ef2bd43,0x3ecc9b8b,0x3ea5129f
.long 0x3e8e9a22,0x3e3228d4,0x3d8a200a,0xbd2351cb,0xbc490e90,0xbe1324ca,0xbe8b9507,0xbecb2aae,0xbe9aa086,0xbee4cbfe,0xbf14b039,0xbf33587a,0xbf10d3cd,0xbf34768f,0xbf5233c6,0xbf6912ae
.long 0xbf47de65,0xbf644fac,0xbf772417,0xbf7f90b1,0xbf6db293,0xbf7d1cdd,0xbf7f2f9d,0xbf73ced9,0xbf7f0e58,0xbf7c5d3a,0xbf696591,0xbf476085,0xbf7a7302,0xbf62241a,0xbf385216,0xbf003a06
.long 0xbf604621,0xbf311722,0xbee363fa,0xbe1f917b,0xbf32c8c9,0xbedc53c1,0xbdee3876,0x3e57278f,0xbeebcbbb,0xbe007745,0x3e667c66,0x3f0c42c9,0xbe3b6ecf,0x3e44b0b9,0x3f0a48ad,0x3f4fefa8
.long 0x0,0x3c16cb58,0x3c96c9b6,0x3ce22a7a,0x0,0x3d0a342f,0x3d8a200a,0x3dcefdb7,0x0,0x3d6ea038,0x3dee3876,0x3e3228d4,0x0,0x3da973ba,0x3e28defc,0x3e7bdba4
.long 0x0,0x3ddb7d37,0x3e5a3997,0x3ea21887,0x0,0x3e06b26e,0x3e8586ce,0x3ec5625c,0x0,0x3e1f917b,0x3e9d9e78,0x3ee79a5d,0x0,0x3e3857ec,0x3eb554ec,0x3f044889
.long 0x0,0x3e5101f1,0x3ecc9b8b,0x3f140c5f,0x0,0x3e698bba,0x3ee363fa,0x3f2302d3,0x0,0x3e80f8c0,0x3ef9a02d,0x3f311722,0x0,0x3e8d17c0,0x3f07a136,0x3f3e35c5
.long 0x0,0x3e9920fe,0x3f121eb0,0x3f4a4c87,0x0,0x3ea5129f,0x3f1c420c,0x3f554aa4,0x0,0x3eb0eacb,0x3f26050a,0x3f5f20db,0x0,0x3ebca7af,0x3f2f61a5,0x3f67c187
.long 0x3d16c32c,0x3d3c6dd5,0x3d621469,0x3d83db0a,0x3e09cf86,0x3e2bf804,0x3e4dee60,0x3e6fa8b2,0x3e6c9a7f,0x3e931f35,0x3eaf713a,0x3ecb2aae,0x3ea68f12,0x3ece0bea,0x3ef41f07,0x3f0c42c9
.long 0x3ed53641,0x3f02ef9f,0x3f19c200,0x3f2ecef7,0x3f00e7e4,0x3f1ce11f,0x3f36206c,0x3f4c3578,0x3f15f6d9,0x3f34768f,0x3f4e8d90,0x3f6398ac,0x3f299415,0x3f495521,0x3f628210,0x3f74484b
.long 0x3f3b8f3b,0x3f5b2c79,0x3f718f57,0x3f7dc68c,0x3f4bbbf8,0x3f69b7e4,0x3f7b61fc,0x3f7fcbe2,0x3f59f26a,0x3f74bf62,0x3f7fc38f,0x3f7a4910,0x3f660f88,0x3f7c187a,0x3f7e9bc9,0x3f6d67a1
.long 0x3f6ff573,0x3f7fa6e3,0x3f77f110,0x3f5988ad,0x3f778bc5,0x3f7f5ce9,0x3f6be858,0x3f3f41fc,0x3f7cbfc9,0x3f7b3bab,0x3f5ac450,0x3f1f599f,0x3f7f84ab,0x3f73530e,0x3f44e3f5,0x3ef58035
.long 0x3d96a905,0x3da973ba,0x3dbc3ac3,0x3dcefdb7,0x3e888e93,0x3e9920fe,0x3ea986c4,0x3eb9bb1e,0x3ee63375,0x3f003a06,0x3f0cead0,0x3f19210f,0x3f1d7fd1,0x3f2da859,0x3f3ca003,0x3f4a4c87
.long 0x3f41d870,0x3f52a649,0x3f6106f2,0x3f6cd007,0x3f5ebe05,0x3f6d67a1,0x3f77f110,0x3f7e2b72,0x3f731447,0x3f7c9f8a,0x3f7ffec4,0x3f7d1cdd,0x3f7e1324,0x3f7f90b1,0x3f78b47b,0x3f69b7e4
.long 0x3f7f4e6d,0x3f76167a,0x3f628210,0x3f456439,0x3f76ba07,0x3f60a6cf,0x3f3ebc1b,0x3f12c39a,0x3f64aa59,0x3f404c5c,0x3f0f8784,0x3eab0201,0x3f49d112,0x3f16999f,0x3eaf713a,0x3d9064b4
.long 0x3f273656,0x3ecb2aae,0x3dd53db9,0xbe4ada4f,0x3efc5d27,0x3e3e853e,0xbe1008b7,0xbee79a5d,0x3ea09ae5,0xbd0a342f,0xbec1071e,0xbf2c800f,0x3dfab273,0xbe80f8c0,0xbf173c07,0xbf58b3a1
.long 0x3de1bc2e,0x3df475c0,0x3e039502,0x3e0cec4a,0x3ec9b953,0x3ed97cb9,0x3ee900b7,0x3ef840c8,0x3f24d225,0x3f2ff3e6,0x3f3a7ca4,0x3f446337,0x3f5695e5,0x3f61668a,0x3f6aab7b,0x3f725470
.long 0x3f75dec6,0x3f7c187a,0x3f7f6ac7,0x3f7fcbe2,0x3f7ffb11,0x3f7d57de,0x3f764d97,0x3f6afb8c,0x3f740bdd,0x3f650479,0x3f5064af,0x3f36ad7f,0x3f531849,0x3f3592e7,0x3f121eb0,0x3ed3c867
.long 0x3f1ff6cb,0x3ee79a5d,0x3e8586ce,0x3d6ea038,0x3ebe1d4a,0x3e195be0,0xbda3308c,0xbe9c1faf,0x3dafb680,0xbe2bf804,0xbed25a09,0xbf209393,0xbe541501,0xbeeff7fb,0xbf31a81d,0xbf5d924d
.long 0xbef6e0cb,0xbf38dd65,0xbf655e0b,0xbf7cdf6c,0xbf373a23,0xbf671599,0xbf7e4323,0xbf7a4910,0xbf633c5a,0xbf7dfa38,0xbf796e4e,0xbf5627fe,0xbf7baccd,0xbf7b3bab,0xbf577026,0xbf1553b7
.long 0x3f800000,0x3f800000,0x3f800000,0x3f800000,0x3f7ffd39,0x3f7fdaaf,0x3f7f90b1,0x3f7f1f49,0x3f7ff4e6,0x3f7f6ac7,0x3f7e4323,0x3f7c7eb0,0x3f7fe705,0x3f7eb069,0x3f7c187a,0x3f7822d1
.long 0x3f7fd397,0x3f7dabcc,0x3f791298,0x3f721352,0x3f7fba9e,0x3f7c5d3a,0x3f75341d,0x3f6a5ad9,0x3f7f9c18,0x3f7ac516,0x3f708066,0x3f6106f2,0x3f7f7808,0x3f78e3d6,0x3f6afb8c,0x3f5627fe
.long 0x3f7f4e6d,0x3f76ba07,0x3f64aa59,0x3f49d112,0x3f7f1f49,0x3f74484b,0x3f5d924d,0x3f3c17d9,0x3f7eea9d,0x3f718f57,0x3f55b993,0x3f2d1469,0x3f7eb069,0x3f6e8ff8,0x3f4d26fd,0x3f1ce11f
.long 0x3f7e70b0,0x3f6b4b0c,0x3f43e200,0x3f0b9a6b,0x3f7e2b72,0x3f67c187,0x3f39f2ac,0x3ef2bd43,0x3f7de0b1,0x3f63f473,0x3f2f61a5,0x3ecc9b8b,0x3f7d906e,0x3f5fe4e9,0x3f24381a,0x3ea5129f
.long 0x3f800000,0x3f800000,0x3f800000,0x3f800000,0x3f7e868b,0x3f7dc68c,0x3f7cdf6c,0x3f7bd14d,0x3f7a1e84,0x3f772417,0x3f73913f,0x3f6f6830,0x3f72d4eb,0x3f6c3624,0x3f644fac,0x3f5b2c79
.long 0x3f68bf3c,0x3f5d2d53,0x3f4f7a1f,0x3f3fc767,0x3f5bfb34,0x3f4a4c87,0x3f3592e7,0x3f1e1e22,0x3f4cae79,0x3f33e7bc,0x3f173c07,0x3eee9479,0x3f3b0629,0x3f1a6293,0x3eea6681,0x3e9920fe
.long 0x3f273656,0x3efc5d27,0x3ea09ae5,0x3dfab273,0x3f11796b,0x3ebf926f,0x3e25c58c,0xbd6ea038,0x3ef41f07,0x3e7ee6e1,0x3bc90f88,0xbe72b651,0x3ec27b55,0x3df475c0,0xbe195be0,0xbed0eb2a
.long 0x3e8e9a22,0xbc490e90,0xbe9aa086,0xbf10d3cd,0x3e3228d4,0xbe1324ca,0xbee4cbfe,0xbf34768f,0x3d8a200a,0xbe8b9507,0xbf14b039,0xbf5233c6,0xbd2351cb,0xbecb2aae,0xbf33587a,0xbf6912ae
.long 0x3f800000,0x3f800000,0x3f800000,0x3f800000,0x3f7a9c59,0x3f7940c0,0x3f77beb7,0x3f76167a,0x3f6aab7b,0x3f655e0b,0x3f5f8327,0x3f591e6a,0x3f50d937,0x3f456439,0x3f38dd65,0x3f2b561b
.long 0x3f2e3bde,0x3f1b02c6,0x3f064b82,0x3ee0924f,0x3f044889,0x3ed0eb2a,0x3e9620d2,0x3e3228d4,0x3ea986c4,0x3e419b37,0x3d2fe007,0xbdd53db9,0x3e06b26e,0xbd2351cb,0xbe57278f,0xbebf926f
.long 0xbd96a905,0xbe888e93,0xbee63375,0xbf1d7fd1,0xbe8d17c0,0xbef58035,0xbf28fd41,0xbf4f0417,0xbeee9479,0xbf2ac082,0xbf53fac3,0xbf708066,0xbf2302d3,0xbf51c0c2,0xbf714c7a,0xbf7f5ce9
.long 0xbf47de65,0xbf6db293,0xbf7f0e58,0xbf7a7302,0xbf644fac,0xbf7d1cdd,0xbf7c5d3a,0xbf62241a,0xbf772417,0xbf7f2f9d,0xbf696591,0xbf385216,0xbf7f90b1,0xbf73ced9,0xbf476085,0xbf003a06
.long 0x3f800000,0x3f800000,0x3f800000,0x3f800000,0x3f74484b,0x3f725470,0x3f703b37,0x3f6dfcf2,0x3f5233c6,0x3f4ac77f,0x3f42de29,0x3f3a7ca4,0x3f1ce11f,0x3f0d9281,0x3efafef7,0x3ed97cb9
.long 0x3eb263ef,0x3e827dc0,0x3e22abb6,0x3d7b2b74,0x3d55880e,0xbd9064b4,0xbe44b0b9,0xbe9f1cdf,0xbe7ee6e1,0xbec6d529,0xbf04f484,0xbf239da9,0xbf06f686,0xbf2a2a80,0xbf485bca,0xbf60a6cf
.long 0xbf41d870,0xbf5ebe05,0xbf731447,0xbf7e1324,0xbf6afb8c,0xbf7b87b2,0xbf7fdaaf,0xbf77beb7,0xbf7e9bc9,0xbf7d7474,0xbf6d1c1d,0xbf4e8d90,0xbf7aed37,0xbf644fac,0xbf3d27b8,0xbf084b92
.long 0xbf604621,0xbf32c8c9,0xbeebcbbb,0xbe3b6ecf,0xbf311722,0xbedc53c1,0xbe007745,0x3e44b0b9,0xbee363fa,0xbdee3876,0x3e667c66,0x3f0a48ad,0xbe1f917b,0x3e57278f,0x3f0c42c9,0x3f4fefa8
.long 0x0,0x0,0x0,0x0,0x3c16cb58,0x3d0a342f,0x3d6ea038,0x3da973ba,0x3c96c9b6,0x3d8a200a,0x3dee3876,0x3e28defc,0x3ce22a7a,0x3dcefdb7,0x3e3228d4,0x3e7bdba4
.long 0x3d16c32c,0x3e09cf86,0x3e6c9a7f,0x3ea68f12,0x3d3c6dd5,0x3e2bf804,0x3e931f35,0x3ece0bea,0x3d621469,0x3e4dee60,0x3eaf713a,0x3ef41f07,0x3d83db0a,0x3e6fa8b2,0x3ecb2aae,0x3f0c42c9
.long 0x3d96a905,0x3e888e93,0x3ee63375,0x3f1d7fd1,0x3da973ba,0x3e9920fe,0x3f003a06,0x3f2da859,0x3dbc3ac3,0x3ea986c4,0x3f0cead0,0x3f3ca003,0x3dcefdb7,0x3eb9bb1e,0x3f19210f,0x3f4a4c87
.long 0x3de1bc2e,0x3ec9b953,0x3f24d225,0x3f5695e5,0x3df475c0,0x3ed97cb9,0x3f2ff3e6,0x3f61668a,0x3e039502,0x3ee900b7,0x3f3a7ca4,0x3f6aab7b,0x3e0cec4a,0x3ef840c8,0x3f446337,0x3f725470
.long 0x0,0x0,0x0,0x0,0x3ddb7d37,0x3e06b26e,0x3e1f917b,0x3e3857ec,0x3e5a3997,0x3e8586ce,0x3e9d9e78,0x3eb554ec,0x3ea21887,0x3ec5625c,0x3ee79a5d,0x3f044889
.long 0x3ed53641,0x3f00e7e4,0x3f15f6d9,0x3f299415,0x3f02ef9f,0x3f1ce11f,0x3f34768f,0x3f495521,0x3f19c200,0x3f36206c,0x3f4e8d90,0x3f628210,0x3f2ecef7,0x3f4c3578,0x3f6398ac,0x3f74484b
.long 0x3f41d870,0x3f5ebe05,0x3f731447,0x3f7e1324,0x3f52a649,0x3f6d67a1,0x3f7c9f8a,0x3f7f90b1,0x3f6106f2,0x3f77f110,0x3f7ffec4,0x3f78b47b,0x3f6cd007,0x3f7e2b72,0x3f7d1cdd,0x3f69b7e4
.long 0x3f75dec6,0x3f7ffb11,0x3f740bdd,0x3f531849,0x3f7c187a,0x3f7d57de,0x3f650479,0x3f3592e7,0x3f7f6ac7,0x3f764d97,0x3f5064af,0x3f121eb0,0x3f7fcbe2,0x3f6afb8c,0x3f36ad7f,0x3ed3c867
.long 0x0,0x0,0x0,0x0,0x3e5101f1,0x3e698bba,0x3e80f8c0,0x3e8d17c0,0x3ecc9b8b,0x3ee363fa,0x3ef9a02d,0x3f07a136,0x3f140c5f,0x3f2302d3,0x3f311722,0x3f3e35c5
.long 0x3f3b8f3b,0x3f4bbbf8,0x3f59f26a,0x3f660f88,0x3f5b2c79,0x3f69b7e4,0x3f74bf62,0x3f7c187a,0x3f718f57,0x3f7b61fc,0x3f7fc38f,0x3f7e9bc9,0x3f7dc68c,0x3f7fcbe2,0x3f7a4910,0x3f6d67a1
.long 0x3f7f4e6d,0x3f76ba07,0x3f64aa59,0x3f49d112,0x3f76167a,0x3f60a6cf,0x3f404c5c,0x3f16999f,0x3f628210,0x3f3ebc1b,0x3f0f8784,0x3eaf713a,0x3f456439,0x3f12c39a,0x3eab0201,0x3d9064b4
.long 0x3f1ff6cb,0x3ebe1d4a,0x3dafb680,0xbe541501,0x3ee79a5d,0x3e195be0,0xbe2bf804,0xbeeff7fb,0x3e8586ce,0xbda3308c,0xbed25a09,0xbf31a81d,0x3d6ea038,0xbe9c1faf,0xbf209393,0xbf5d924d
.long 0x0,0x0,0x0,0x0,0x3e9920fe,0x3ea5129f,0x3eb0eacb,0x3ebca7af,0x3f121eb0,0x3f1c420c,0x3f26050a,0x3f2f61a5,0x3f4a4c87,0x3f554aa4,0x3f5f20db,0x3f67c187
.long 0x3f6ff573,0x3f778bc5,0x3f7cbfc9,0x3f7f84ab,0x3f7fa6e3,0x3f7f5ce9,0x3f7b3bab,0x3f73530e,0x3f77f110,0x3f6be858,0x3f5ac450,0x3f44e3f5,0x3f5988ad,0x3f3f41fc,0x3f1f599f,0x3ef58035
.long 0x3f273656,0x3efc5d27,0x3ea09ae5,0x3dfab273,0x3ecb2aae,0x3e3e853e,0xbd0a342f,0xbe80f8c0,0x3dd53db9,0xbe1008b7,0xbec1071e,0xbf173c07,0xbe4ada4f,0xbee79a5d,0xbf2c800f,0xbf58b3a1
.long 0xbef6e0cb,0xbf373a23,0xbf633c5a,0xbf7baccd,0xbf38dd65,0xbf671599,0xbf7dfa38,0xbf7b3bab,0xbf655e0b,0xbf7e4323,0xbf796e4e,0xbf577026,0xbf7cdf6c,0xbf7a4910,0xbf5627fe,0xbf1553b7
.long 0x3f80,0x3e483f7b,0x3ec43f6d,0x3f0e3f55,0x3f80,0x3f0e3f55,0x3f6d3ec4,0x3f7bbe48,0x3f80,0x3f553f0e,0x3f6dbec4,0x3e48bf7b,0x3f80,0x3f7b3e48,0x3ec4bf6d,0xbf55bf0e
.long 0x3f80,0x3f7bbe48,0xbec4bf6d,0xbf553f0e,0x3f80,0x3f55bf0e,0xbf6dbec4,0x3e483f7b,0x3f80,0x3f0ebf55,0xbf6d3ec4,0x3f7b3e48,0x3f80,0x3e48bf7b,0xbec43f6d,0x3f0ebf55
.long 0x3f80,0xbe48bf7b,0x3ec43f6d,0xbf0ebf55,0x3f80,0xbf0ebf55,0x3f6d3ec4,0xbf7b3e48,0x3f80,0xbf55bf0e,0x3f6dbec4,0xbe483f7b,0x3f80,0xbf7bbe48,0x3ec4bf6d,0x3f553f0e
.long 0x3f80,0xbf7b3e48,0xbec4bf6d,0x3f55bf0e,0x3f80,0xbf553f0e,0xbf6dbec4,0xbe48bf7b,0x3f80,0xbf0e3f55,0xbf6d3ec4,0xbf7bbe48,0x3f80,0xbe483f7b,0xbec43f6d,0xbf0e3f55
.long 0x3f353f35,0x3f553f0e,0x3f6d3ec4,0x3f7b3e48,0x3f35bf35,0x3e48bf7b,0xbec4bf6d,0xbf55bf0e,0xbf35bf35,0xbf7b3e48,0xbec43f6d,0x3f0e3f55,0xbf353f35,0x3f0e3f55,0x3f6dbec4,0xbe48bf7b
.long 0x3f353f35,0x3f0ebf55,0xbf6dbec4,0xbe483f7b,0x3f35bf35,0xbf7bbe48,0x3ec43f6d,0x3f0ebf55,0xbf35bf35,0x3e483f7b,0x3ec4bf6d,0xbf553f0e,0xbf353f35,0x3f55bf0e,0xbf6d3ec4,0x3f7bbe48
.long 0x3f353f35,0xbf55bf0e,0x3f6d3ec4,0xbf7bbe48,0x3f35bf35,0xbe483f7b,0xbec4bf6d,0x3f553f0e,0xbf35bf35,0x3f7bbe48,0xbec43f6d,0xbf0ebf55,0xbf353f35,0xbf0ebf55,0x3f6dbec4,0x3e483f7b
.long 0x3f353f35,0xbf0e3f55,0xbf6dbec4,0x3e48bf7b,0x3f35bf35,0x3f7b3e48,0x3ec43f6d,0xbf0e3f55,0xbf35bf35,0xbe48bf7b,0x3ec4bf6d,0x3f55bf0e,0xbf353f35,0xbf553f0e,0xbf6d3ec4,0xbf7b3e48
.long 0x3f800000,0x3f7bbe48,0x3f6dbec4,0x3f55bf0e,0xbf800000,0xbf553f0e,0xbec43f6d,0x3e483f7b,0x3f800000,0x3f0ebf55,0xbec4bf6d,0xbf7bbe48,0xbf800000,0xbe483f7b,0x3f6d3ec4,0x3f0ebf55
.long 0x3f800000,0xbe48bf7b,0xbf6d3ec4,0x3f0e3f55,0xbf800000,0x3f0e3f55,0x3ec4bf6d,0xbf7b3e48,0x3f800000,0xbf55bf0e,0x3ec43f6d,0x3e48bf7b,0xbf800000,0x3f7b3e48,0xbf6dbec4,0x3f553f0e
.long 0x3f800000,0xbf7b3e48,0x3f6dbec4,0xbf553f0e,0xbf800000,0x3f55bf0e,0xbec43f6d,0xbe48bf7b,0x3f800000,0xbf0e3f55,0xbec4bf6d,0x3f7b3e48,0xbf800000,0x3e48bf7b,0x3f6d3ec4,0xbf0e3f55
.long 0x3f800000,0x3e483f7b,0xbf6d3ec4,0xbf0ebf55,0xbf800000,0xbf0ebf55,0x3ec4bf6d,0x3f7bbe48,0x3f800000,0x3f553f0e,0x3ec43f6d,0xbe483f7b,0xbf800000,0xbf7bbe48,0xbf6dbec4,0xbf55bf0e
.long 0x3f35bf35,0x3f0ebf55,0x3ec4bf6d,0x3e48bf7b,0x3f353f35,0x3f7b3e48,0x3f6dbec4,0x3f0ebf55,0xbf353f35,0x3e483f7b,0x3f6d3ec4,0x3f55bf0e,0xbf35bf35,0xbf553f0e,0x3ec43f6d,0x3f7bbe48
.long 0x3f35bf35,0xbf55bf0e,0xbec43f6d,0x3f7b3e48,0x3f353f35,0x3e48bf7b,0xbf6d3ec4,0x3f553f0e,0xbf353f35,0x3f7bbe48,0xbf6dbec4,0x3f0e3f55,0xbf35bf35,0x3f0e3f55,0xbec4bf6d,0x3e483f7b
.long 0x3f35bf35,0xbf0e3f55,0x3ec4bf6d,0xbe483f7b,0x3f353f35,0xbf7bbe48,0x3f6dbec4,0xbf0e3f55,0xbf353f35,0xbe48bf7b,0x3f6d3ec4,0xbf553f0e,0xbf35bf35,0x3f55bf0e,0x3ec43f6d,0xbf7b3e48
.long 0x3f35bf35,0x3f553f0e,0xbec43f6d,0xbf7bbe48,0x3f353f35,0xbe483f7b,0xbf6d3ec4,0xbf55bf0e,0xbf353f35,0xbf7b3e48,0xbf6dbec4,0xbf0ebf55,0xbf35bf35,0xbf0ebf55,0xbec4bf6d,0xbe48bf7b
.long 0x3f808000,0x3f7bbe48,0x3f6dbec4,0x3f55bf0e,0x3f808000,0x3f55bf0e,0x3ec4bf6d,0xbe48bf7b,0x3f808000,0x3f0ebf55,0xbec4bf6d,0xbf7bbe48,0x3f808000,0x3e48bf7b,0xbf6dbec4,0xbf0e3f55
.long 0x3f808000,0xbe48bf7b,0xbf6d3ec4,0x3f0e3f55,0x3f808000,0xbf0ebf55,0xbec43f6d,0x3f7bbe48,0x3f808000,0xbf55bf0e,0x3ec43f6d,0x3e48bf7b,0x3f808000,0xbf7bbe48,0x3f6d3ec4,0xbf55bf0e
.long 0x3f808000,0xbf7b3e48,0x3f6dbec4,0xbf553f0e,0x3f808000,0xbf553f0e,0x3ec4bf6d,0x3e483f7b,0x3f808000,0xbf0e3f55,0xbec4bf6d,0x3f7b3e48,0x3f808000,0xbe483f7b,0xbf6dbec4,0x3f0ebf55
.long 0x3f808000,0x3e483f7b,0xbf6d3ec4,0xbf0ebf55,0x3f808000,0x3f0e3f55,0xbec43f6d,0xbf7b3e48,0x3f808000,0x3f553f0e,0x3ec43f6d,0xbe483f7b,0x3f808000,0x3f7b3e48,0x3f6d3ec4,0x3f553f0e
.long 0x3f35bf35,0x3f0ebf55,0x3ec4bf6d,0x3e48bf7b,0xbf35bf35,0xbf7bbe48,0xbf6d3ec4,0xbf0e3f55,0xbf353f35,0x3e483f7b,0x3f6d3ec4,0x3f55bf0e,0x3f353f35,0x3f55bf0e,0xbec4bf6d,0xbf7b3e48
.long 0x3f35bf35,0xbf55bf0e,0xbec43f6d,0x3f7b3e48,0xbf35bf35,0xbe483f7b,0x3f6dbec4,0xbf55bf0e,0xbf353f35,0x3f7bbe48,0xbf6dbec4,0x3f0e3f55,0x3f353f35,0xbf0ebf55,0x3ec43f6d,0xbe48bf7b
.long 0x3f35bf35,0xbf0e3f55,0x3ec4bf6d,0xbe483f7b,0xbf35bf35,0x3f7b3e48,0xbf6d3ec4,0x3f0ebf55,0xbf353f35,0xbe48bf7b,0x3f6d3ec4,0xbf553f0e,0x3f353f35,0xbf553f0e,0xbec4bf6d,0x3f7bbe48
.long 0x3f35bf35,0x3f553f0e,0xbec43f6d,0xbf7bbe48,0xbf35bf35,0x3e48bf7b,0x3f6dbec4,0x3f553f0e,0xbf353f35,0xbf7b3e48,0xbf6dbec4,0xbf0ebf55,0x3f353f35,0x3f0e3f55,0x3ec43f6d,0x3e483f7b
.long 0xbf80,0xbe48bf7b,0xbec4bf6d,0xbf0ebf55,0x3f80,0x3f0e3f55,0x3f6d3ec4,0x3f7bbe48,0xbf80,0xbf55bf0e,0xbf6d3ec4,0xbe483f7b,0x3f80,0x3f7b3e48,0x3ec4bf6d,0xbf55bf0e
.long 0xbf80,0xbf7b3e48,0x3ec43f6d,0x3f55bf0e,0x3f80,0x3f55bf0e,0xbf6dbec4,0x3e483f7b,0xbf80,0xbf0e3f55,0x3f6dbec4,0xbf7bbe48,0x3f80,0x3e48bf7b,0xbec43f6d,0x3f0ebf55
.long 0xbf80,0x3e483f7b,0xbec4bf6d,0x3f0e3f55,0x3f80,0xbf0ebf55,0x3f6d3ec4,0xbf7b3e48,0xbf80,0x3f553f0e,0xbf6d3ec4,0x3e48bf7b,0x3f80,0xbf7bbe48,0x3ec4bf6d,0x3f553f0e
.long 0xbf80,0x3f7bbe48,0x3ec43f6d,0xbf553f0e,0x3f80,0xbf553f0e,0xbf6dbec4,0xbe48bf7b,0xbf80,0x3f0ebf55,0x3f6dbec4,0x3f7b3e48,0x3f80,0xbe483f7b,0xbec43f6d,0xbf0e3f55
.long 0xbf35bf35,0xbf55bf0e,0xbf6dbec4,0xbf7bbe48,0x3f35bf35,0x3e48bf7b,0xbec4bf6d,0xbf55bf0e,0x3f353f35,0x3f7bbe48,0x3ec4bf6d,0xbf0ebf55,0xbf353f35,0x3f0e3f55,0x3f6dbec4,0xbe48bf7b
.long 0xbf35bf35,0xbf0e3f55,0x3f6d3ec4,0x3e48bf7b,0x3f35bf35,0xbf7bbe48,0x3ec43f6d,0x3f0ebf55,0x3f353f35,0xbe48bf7b,0xbec43f6d,0x3f55bf0e,0xbf353f35,0x3f55bf0e,0xbf6d3ec4,0x3f7bbe48
.long 0xbf35bf35,0x3f553f0e,0xbf6dbec4,0x3f7b3e48,0x3f35bf35,0xbe483f7b,0xbec4bf6d,0x3f553f0e,0x3f353f35,0xbf7b3e48,0x3ec4bf6d,0x3f0e3f55,0xbf353f35,0xbf0ebf55,0x3f6dbec4,0x3e483f7b
.long 0xbf35bf35,0x3f0ebf55,0x3f6d3ec4,0xbe483f7b,0x3f35bf35,0x3f7b3e48,0x3ec43f6d,0xbf0e3f55,0x3f353f35,0x3e483f7b,0xbec43f6d,0xbf553f0e,0xbf353f35,0xbf553f0e,0xbf6d3ec4,0xbf7b3e48
.long 0x80003f80,0x80003f80,0x80003f80,0x80003f80,0xbe483f7b,0xbf0e3f55,0xbf553f0e,0xbf7b3e48,0xbec43f6d,0xbf6d3ec4,0xbf6dbec4,0xbec4bf6d,0xbf0e3f55,0xbf7bbe48,0xbe48bf7b,0x3f55bf0e
.long 0xbf353f35,0xbf35bf35,0x3f35bf35,0x3f353f35,0xbf553f0e,0xbe48bf7b,0x3f7b3e48,0xbf0e3f55,0xbf6d3ec4,0x3ec4bf6d,0x3ec43f6d,0xbf6dbec4,0xbf7b3e48,0x3f55bf0e,0xbf0e3f55,0x3e48bf7b
.long 0xbf800000,0x3f800000,0xbf800000,0x3f800000,0xbf7bbe48,0x3f553f0e,0xbf0ebf55,0x3e483f7b,0xbf6dbec4,0x3ec43f6d,0x3ec4bf6d,0xbf6d3ec4,0xbf55bf0e,0xbe483f7b,0x3f7bbe48,0xbf0ebf55
.long 0xbf35bf35,0xbf353f35,0x3f353f35,0x3f35bf35,0xbf0ebf55,0xbf7b3e48,0xbe483f7b,0x3f553f0e,0xbec4bf6d,0xbf6dbec4,0xbf6d3ec4,0xbec43f6d,0xbe48bf7b,0xbf0ebf55,0xbf55bf0e,0xbf7bbe48
.long 0x80003f80,0x80003f80,0x80003f80,0x80003f80,0xbf7bbe48,0xbf55bf0e,0xbf0ebf55,0xbe48bf7b,0x3ec4bf6d,0x3f6dbec4,0x3f6d3ec4,0x3ec43f6d,0x3f553f0e,0xbe483f7b,0xbf7b3e48,0xbf0ebf55
.long 0xbf353f35,0xbf35bf35,0x3f35bf35,0x3f353f35,0xbf0ebf55,0x3f7bbe48,0xbe483f7b,0xbf55bf0e,0x3f6dbec4,0xbec43f6d,0xbec4bf6d,0x3f6d3ec4,0x3e483f7b,0xbf0ebf55,0x3f553f0e,0xbf7bbe48
.long 0xbf800000,0x3f800000,0xbf800000,0x3f800000,0x3e48bf7b,0xbf0e3f55,0x3f55bf0e,0xbf7b3e48,0x3f6d3ec4,0xbec4bf6d,0xbec43f6d,0x3f6dbec4,0xbf0e3f55,0x3f7b3e48,0xbe48bf7b,0xbf553f0e
.long 0xbf35bf35,0xbf353f35,0x3f353f35,0x3f35bf35,0x3f55bf0e,0xbe48bf7b,0xbf7bbe48,0xbf0e3f55,0x3ec43f6d,0x3f6d3ec4,0x3f6dbec4,0x3ec4bf6d,0xbf7b3e48,0xbf553f0e,0xbf0e3f55,0xbe483f7b
.long 0x80003f80,0x80003f80,0x80003f80,0x80003f80,0x3e48bf7b,0x3f0ebf55,0x3f55bf0e,0x3f7bbe48,0xbec43f6d,0xbf6d3ec4,0xbf6dbec4,0xbec4bf6d,0x3f0ebf55,0x3f7b3e48,0x3e483f7b,0xbf553f0e
.long 0xbf353f35,0xbf35bf35,0x3f35bf35,0x3f353f35,0x3f55bf0e,0x3e483f7b,0xbf7bbe48,0x3f0ebf55,0xbf6d3ec4,0x3ec4bf6d,0x3ec43f6d,0xbf6dbec4,0x3f7bbe48,0xbf553f0e,0x3f0ebf55,0xbe483f7b
.long 0xbf800000,0x3f800000,0xbf800000,0x3f800000,0x3f7b3e48,0xbf55bf0e,0x3f0e3f55,0xbe48bf7b,0xbf6dbec4,0x3ec43f6d,0x3ec4bf6d,0xbf6d3ec4,0x3f553f0e,0x3e48bf7b,0xbf7b3e48,0x3f0e3f55
.long 0xbf35bf35,0xbf353f35,0x3f353f35,0x3f35bf35,0x3f0e3f55,0x3f7bbe48,0x3e48bf7b,0xbf55bf0e,0xbec4bf6d,0xbf6dbec4,0xbf6d3ec4,0xbec43f6d,0x3e483f7b,0x3f0e3f55,0x3f553f0e,0x3f7b3e48
.long 0x80003f80,0x80003f80,0x80003f80,0x80003f80,0x3f7b3e48,0x3f553f0e,0x3f0e3f55,0x3e483f7b,0x3ec4bf6d,0x3f6dbec4,0x3f6d3ec4,0x3ec43f6d,0xbf55bf0e,0x3e48bf7b,0x3f7bbe48,0x3f0e3f55
.long 0xbf353f35,0xbf35bf35,0x3f35bf35,0x3f353f35,0x3f0e3f55,0xbf7b3e48,0x3e48bf7b,0x3f553f0e,0x3f6dbec4,0xbec43f6d,0xbec4bf6d,0x3f6d3ec4,0xbe48bf7b,0x3f0e3f55,0xbf55bf0e,0x3f7b3e48
.long 0xbf800000,0x3f800000,0xbf800000,0x3f800000,0xbe483f7b,0x3f0ebf55,0xbf553f0e,0x3f7bbe48,0x3f6d3ec4,0xbec4bf6d,0xbec43f6d,0x3f6dbec4,0x3f0ebf55,0xbf7bbe48,0x3e483f7b,0x3f55bf0e
.long 0xbf35bf35,0xbf353f35,0x3f353f35,0x3f35bf35,0xbf553f0e,0x3e483f7b,0x3f7b3e48,0x3f0ebf55,0x3ec43f6d,0x3f6d3ec4,0x3f6dbec4,0x3ec4bf6d,0x3f7bbe48,0x3f55bf0e,0x3f0ebf55,0x3e48bf7b
.long 0x3f800000,0x3f800000,0x3f800000,0x3f800000,0x3f7b3e48,0x3f553f0e,0x3f0e3f55,0x3e483f7b,0x3f6d3ec4,0x3ec43f6d,0xbec43f6d,0xbf6d3ec4,0x3f553f0e,0xbe483f7b,0xbf7b3e48,0xbf0ebf55
.long 0x3f353f35,0xbf353f35,0xbf35bf35,0x3f35bf35,0x3f0e3f55,0xbf7b3e48,0x3e48bf7b,0x3f553f0e,0x3ec43f6d,0xbf6dbec4,0x3f6dbec4,0xbec43f6d,0x3e483f7b,0xbf0ebf55,0x3f553f0e,0xbf7bbe48
.long 0x3f80,0xbf80,0x3f80,0xbf80,0xbe483f7b,0x3f0ebf55,0xbf553f0e,0x3f7bbe48,0xbec43f6d,0x3f6dbec4,0xbf6dbec4,0x3ec43f6d,0xbf0e3f55,0x3f7b3e48,0xbe48bf7b,0xbf553f0e
.long 0xbf353f35,0x3f353f35,0x3f35bf35,0xbf35bf35,0xbf553f0e,0x3e483f7b,0x3f7b3e48,0x3f0ebf55,0xbf6d3ec4,0xbec43f6d,0x3ec43f6d,0x3f6d3ec4,0xbf7b3e48,0xbf553f0e,0xbf0e3f55,0xbe483f7b
.long 0x3f800000,0x3f800000,0x3f800000,0x3f800000,0xbe483f7b,0xbf0e3f55,0xbf553f0e,0xbf7b3e48,0xbf6dbec4,0xbec4bf6d,0x3ec4bf6d,0x3f6dbec4,0x3f0ebf55,0x3f7b3e48,0x3e483f7b,0xbf553f0e
.long 0x3f353f35,0xbf353f35,0xbf35bf35,0x3f35bf35,0xbf553f0e,0xbe48bf7b,0x3f7b3e48,0xbf0e3f55,0xbec4bf6d,0x3f6d3ec4,0xbf6d3ec4,0x3ec4bf6d,0x3f7bbe48,0xbf553f0e,0x3f0ebf55,0xbe483f7b
.long 0x3f80,0xbf80,0x3f80,0xbf80,0xbf7bbe48,0x3f553f0e,0xbf0ebf55,0x3e483f7b,0x3ec4bf6d,0xbf6d3ec4,0x3f6d3ec4,0xbec4bf6d,0x3f553f0e,0x3e48bf7b,0xbf7b3e48,0x3f0e3f55
.long 0xbf353f35,0x3f353f35,0x3f35bf35,0xbf35bf35,0xbf0ebf55,0xbf7b3e48,0xbe483f7b,0x3f553f0e,0x3f6dbec4,0x3ec4bf6d,0xbec4bf6d,0xbf6dbec4,0x3e483f7b,0x3f0e3f55,0x3f553f0e,0x3f7b3e48
.long 0x3f800000,0x3f800000,0x3f800000,0x3f800000,0xbf7bbe48,0xbf55bf0e,0xbf0ebf55,0xbe48bf7b,0x3f6d3ec4,0x3ec43f6d,0xbec43f6d,0xbf6d3ec4,0xbf55bf0e,0x3e48bf7b,0x3f7bbe48,0x3f0e3f55
.long 0x3f353f35,0xbf353f35,0xbf35bf35,0x3f35bf35,0xbf0ebf55,0x3f7bbe48,0xbe483f7b,0xbf55bf0e,0x3ec43f6d,0xbf6dbec4,0x3f6dbec4,0xbec43f6d,0xbe48bf7b,0x3f0e3f55,0xbf55bf0e,0x3f7b3e48
.long 0x3f80,0xbf80,0x3f80,0xbf80,0x3e48bf7b,0xbf0e3f55,0x3f55bf0e,0xbf7b3e48,0xbec43f6d,0x3f6dbec4,0xbf6dbec4,0x3ec43f6d,0x3f0ebf55,0xbf7bbe48,0x3e483f7b,0x3f55bf0e
.long 0xbf353f35,0x3f353f35,0x3f35bf35,0xbf35bf35,0x3f55bf0e,0xbe48bf7b,0xbf7bbe48,0xbf0e3f55,0xbf6d3ec4,0xbec43f6d,0x3ec43f6d,0x3f6d3ec4,0x3f7bbe48,0x3f55bf0e,0x3f0ebf55,0x3e48bf7b
.long 0x3f800000,0x3f800000,0x3f800000,0x3f800000,0x3e48bf7b,0x3f0ebf55,0x3f55bf0e,0x3f7bbe48,0xbf6dbec4,0xbec4bf6d,0x3ec4bf6d,0x3f6dbec4,0xbf0e3f55,0xbf7bbe48,0xbe48bf7b,0x3f55bf0e
.long 0x3f353f35,0xbf353f35,0xbf35bf35,0x3f35bf35,0x3f55bf0e,0x3e483f7b,0xbf7bbe48,0x3f0ebf55,0xbec4bf6d,0x3f6d3ec4,0xbf6d3ec4,0x3ec4bf6d,0xbf7b3e48,0x3f55bf0e,0xbf0e3f55,0x3e48bf7b
.long 0x3f80,0xbf80,0x3f80,0xbf80,0x3f7b3e48,0xbf55bf0e,0x3f0e3f55,0xbe48bf7b,0x3ec4bf6d,0xbf6d3ec4,0x3f6d3ec4,0xbec4bf6d,0xbf55bf0e,0xbe483f7b,0x3f7bbe48,0xbf0ebf55
.long 0xbf353f35,0x3f353f35,0x3f35bf35,0xbf35bf35,0x3f0e3f55,0x3f7bbe48,0x3e48bf7b,0xbf55bf0e,0x3f6dbec4,0x3ec4bf6d,0xbec4bf6d,0xbf6dbec4,0xbe48bf7b,0xbf0ebf55,0xbf55bf0e,0xbf7bbe48
.long 0x3f800000,0x3f7ffb11,0x3f7fec43,0x3f7fd397,0x3f800000,0x3f7fd397,0x3f7f4e6d,0x3f7e70b0,0x3f800000,0x3f7f84ab,0x3f7e1324,0x3f7baccd,0x3f800000,0x3f7f0e58,0x3f7c3b28,0x3f778bc5
.long 0x3f800000,0x3f7e70b0,0x3f79c79d,0x3f721352,0x3f800000,0x3f7dabcc,0x3f76ba07,0x3f6b4b0c,0x3f800000,0x3f7cbfc9,0x3f731447,0x3f633c5a,0x3f800000,0x3f7baccd,0x3f6ed89e,0x3f59f26a
.long 0x3f800000,0x3f7a7302,0x3f6a09a7,0x3f4f7a1f,0x3f800000,0x3f791298,0x3f64aa59,0x3f43e200,0x3f800000,0x3f778bc5,0x3f5ebe05,0x3f373a23,0x3f800000,0x3f75dec6,0x3f584853,0x3f299415
.long 0x3f800000,0x3f740bdd,0x3f514d3d,0x3f1b02c6,0x3f800000,0x3f721352,0x3f49d112,0x3f0b9a6b,0x3f800000,0x3f6ff573,0x3f41d870,0x3ef6e0cb,0x3f800000,0x3f6db293,0x3f396842,0x3ed53641
.long 0x3f7fb10f,0x3f7f84ab,0x3f7f4e6d,0x3f7f0e58,0x3f7d3aac,0x3f7baccd,0x3f79c79d,0x3f778bc5,0x3f7853f8,0x3f740bdd,0x3f6ed89e,0x3f68bf3c,0x3f710908,0x3f68bf3c,0x3f5ebe05,0x3f531849
.long 0x3f676bd8,0x3f59f26a,0x3f49d112,0x3f373a23,0x3f5b941a,0x3f47de65,0x3f3085bb,0x3f15f6d9,0x3f4d9f02,0x3f32c8c9,0x3f13682a,0x3ee0924f,0x3f3daef9,0x3f1b02c6,0x3ee63375,0x3e8e9a22
.long 0x3f2beb4a,0x3f00e7e4,0x3ea09ae5,0x3de1bc2e,0x3f187fc0,0x3ec9b953,0x3e2f10a2,0xbd7b2b74,0x3f039c3d,0x3e8e9a22,0x3cc90ab0,0xbe6c9a7f,0x3edae880,0x3e22abb6,0xbdfab273,0xbec9b953
.long 0x3eac7cd4,0x3d16c32c,0xbe888e93,0xbf0b9a6b,0x3e78cfcc,0xbdafb680,0xbecf7bca,0xbf2e3bde,0x3e164083,0xbe541501,0xbf08f59b,0xbf4bbbf8,0x3d48fb30,0xbea68f12,0xbf273656,0xbf633c5a
.long 0x3f7ec46d,0x3f7e70b0,0x3f7e1324,0x3f7dabcc,0x3f74fa0b,0x3f721352,0x3f6ed89e,0x3f6b4b0c,0x3f61c598,0x3f59f26a,0x3f514d3d,0x3f47de65,0x3f45e403,0x3f373a23,0x3f273656,0x3f15f6d9
.long 0x3f226799,0x3f0b9a6b,0x3ee63375,0x3eb263ef,0x3ef15aea,0x3eb263ef,0x3e605c13,0x3dafb680,0x3e94a031,0x3e09cf86,0xbcc90ab0,0xbe3b6ecf,0x3dc8bd36,0xbdafb680,0xbe888e93,0xbee0924f
.long 0xbdc8bd36,0xbe9aa086,0xbefc5d27,0xbf299415,0xbe94a031,0xbf00e7e4,0xbf3085bb,0xbf5695e5,0xbef15aea,0xbf2e3bde,0xbf584853,0xbf740bdd,0xbf226799,0xbf531849,0xbf731447,0xbf7fd397
.long 0xbf45e403,0xbf6db293,0xbf7f4e6d,0xbf791298,0xbf61c598,0xbf7cbfc9,0xbf7c3b28,0xbf604621,0xbf74fa0b,0xbf7f84ab,0xbf6a09a7,0xbf373a23,0xbf7ec46d,0xbf75dec6,0xbf49d112,0xbf00e7e4
.long 0x3f7d3aac,0x3f7cbfc9,0x3f7c3b28,0x3f7baccd,0x3f676bd8,0x3f633c5a,0x3f5ebe05,0x3f59f26a,0x3f3daef9,0x3f32c8c9,0x3f273656,0x3f1b02c6,0x3f039c3d,0x3ee0924f,0x3eb8442a,0x3e8e9a22
.long 0x3e78cfcc,0x3e09cf86,0x3cc90ab0,0xbdafb680,0xbd48fb30,0xbe3b6ecf,0xbea09ae5,0xbee0924f,0xbeac7cd4,0xbef6e0cb,0xbf1d7fd1,0xbf3b8f3b,0xbf187fc0,0xbf3b8f3b,0xbf584853,0xbf6db293
.long 0xbf4d9f02,0xbf68bf3c,0xbf79c79d,0xbf7ffb11,0xbf710908,0xbf7e70b0,0xbf7e1324,0xbf6ff573,0xbf7fb10f,0xbf7a7302,0xbf64aa59,0xbf3fc767,0xbf7853f8,0xbf5d2d53,0xbf3085bb,0xbeebcbbb
.long 0xbf5b941a,0xbf299415,0xbecf7bca,0xbde1bc2e,0xbf2beb4a,0xbec9b953,0xbd96a905,0x3e827dc0,0xbedae880,0xbdafb680,0x3e888e93,0x3f15f6d9,0xbe164083,0x3e6c9a7f,0x3f13682a,0x3f5695e5
.long 0x0,0x3c490e90,0x3cc90ab0,0x3d16c32c,0x0,0x3d16c32c,0x3d96a905,0x3de1bc2e,0x0,0x3d7b2b74,0x3dfab273,0x3e3b6ecf,0x0,0x3dafb680,0x3e2f10a2,0x3e827dc0
.long 0x0,0x3de1bc2e,0x3e605c13,0x3ea68f12,0x0,0x3e09cf86,0x3e888e93,0x3ec9b953,0x0,0x3e22abb6,0x3ea09ae5,0x3eebcbbb,0x0,0x3e3b6ecf,0x3eb8442a,0x3f064b82
.long 0x0,0x3e541501,0x3ecf7bca,0x3f15f6d9,0x0,0x3e6c9a7f,0x3ee63375,0x3f24d225,0x0,0x3e827dc0,0x3efc5d27,0x3f32c8c9,0x0,0x3e8e9a22,0x3f08f59b,0x3f3fc767
.long 0x0,0x3e9aa086,0x3f13682a,0x3f4bbbf8,0x0,0x3ea68f12,0x3f1d7fd1,0x3f5695e5,0x0,0x3eb263ef,0x3f273656,0x3f604621,0x0,0x3ebe1d4a,0x3f3085bb,0x3f68bf3c
.long 0x3d48fb30,0x3d7b2b74,0x3d96a905,0x3dafb680,0x3e164083,0x3e3b6ecf,0x3e605c13,0x3e827dc0,0x3e78cfcc,0x3e9aa086,0x3eb8442a,0x3ed53641,0x3eac7cd4,0x3ed53641,0x3efc5d27,0x3f10d3cd
.long 0x3edae880,0x3f064b82,0x3f1d7fd1,0x3f32c8c9,0x3f039c3d,0x3f1ff6cb,0x3f396842,0x3f4f7a1f,0x3f187fc0,0x3f373a23,0x3f514d3d,0x3f660f88,0x3f2beb4a,0x3f4bbbf8,0x3f64aa59,0x3f75dec6
.long 0x3f3daef9,0x3f5d2d53,0x3f731447,0x3f7e70b0,0x3f4d9f02,0x3f6b4b0c,0x3f7c3b28,0x3f7f84ab,0x3f5b941a,0x3f75dec6,0x3f7fec43,0x3f791298,0x3f676bd8,0x3f7cbfc9,0x3f7e1324,0x3f6b4b0c
.long 0x3f710908,0x3f7fd397,0x3f76ba07,0x3f5695e5,0x3f7853f8,0x3f7f0e58,0x3f6a09a7,0x3f3b8f3b,0x3f7d3aac,0x3f7a7302,0x3f584853,0x3f1b02c6,0x3f7fb10f,0x3f721352,0x3f41d870,0x3eebcbbb
.long 0x3dc8bd36,0x3de1bc2e,0x3dfab273,0x3e09cf86,0x3e94a031,0x3ea68f12,0x3eb8442a,0x3ec9b953,0x3ef15aea,0x3f064b82,0x3f13682a,0x3f1ff6cb,0x3f226799,0x3f32c8c9,0x3f41d870,0x3f4f7a1f
.long 0x3f45e403,0x3f5695e5,0x3f64aa59,0x3f6ff573,0x3f61c598,0x3f6ff573,0x3f79c79d,0x3f7f0e58,0x3f74fa0b,0x3f7dabcc,0x3f7fec43,0x3f7baccd,0x3f7ec46d,0x3f7f0e58,0x3f76ba07,0x3f660f88
.long 0x3f7ec46d,0x3f740bdd,0x3f5ebe05,0x3f3fc767,0x3f74fa0b,0x3f5d2d53,0x3f396842,0x3f0b9a6b,0x3f61c598,0x3f3b8f3b,0x3f08f59b,0x3e9aa086,0x3f45e403,0x3f10d3cd,0x3ea09ae5,0x3d16c32c
.long 0x3f226799,0x3ebe1d4a,0x3d96a905,0xbe6c9a7f,0x3ef15aea,0x3e22abb6,0xbe2f10a2,0xbef6e0cb,0x3e94a031,0xbd7b2b74,0xbecf7bca,0xbf32c8c9,0x3dc8bd36,0xbe8e9a22,0xbf1d7fd1,0xbf5d2d53
.long 0x3e164083,0x3e22abb6,0x3e2f10a2,0x3e3b6ecf,0x3edae880,0x3eebcbbb,0x3efc5d27,0x3f064b82,0x3f2beb4a,0x3f373a23,0x3f41d870,0x3f4bbbf8,0x3f5b941a,0x3f660f88,0x3f6ed89e,0x3f75dec6
.long 0x3f7853f8,0x3f7dabcc,0x3f7fec43,0x3f7f0e58,0x3f7fb10f,0x3f7baccd,0x3f731447,0x3f660f88,0x3f710908,0x3f604621,0x3f49d112,0x3f2e3bde,0x3f4d9f02,0x3f2e3bde,0x3f08f59b,0x3ebe1d4a
.long 0x3f187fc0,0x3ed53641,0x3e605c13,0x3c490e90,0x3eac7cd4,0x3de1bc2e,0xbdfab273,0xbeb263ef,0x3d48fb30,0xbe541501,0xbee63375,0xbf299415,0xbe78cfcc,0xbf00e7e4,0xbf396842,0xbf633c5a
.long 0xbf039c3d,0xbf3fc767,0xbf6a09a7,0xbf7e70b0,0xbf3daef9,0xbf6b4b0c,0xbf7f4e6d,0xbf778bc5,0xbf676bd8,0xbf7f0e58,0xbf76ba07,0xbf4f7a1f,0xbf7d3aac,0xbf791298,0xbf514d3d,0xbf0b9a6b
.long 0x3f800000,0x3f800000,0x3f800000,0x3f800000,0x3f7ffb11,0x3f7fd397,0x3f7f84ab,0x3f7f0e58,0x3f7fec43,0x3f7f4e6d,0x3f7e1324,0x3f7c3b28,0x3f7fd397,0x3f7e70b0,0x3f7baccd,0x3f778bc5
.long 0x3f7fb10f,0x3f7d3aac,0x3f7853f8,0x3f710908,0x3f7f84ab,0x3f7baccd,0x3f740bdd,0x3f68bf3c,0x3f7f4e6d,0x3f79c79d,0x3f6ed89e,0x3f5ebe05,0x3f7f0e58,0x3f778bc5,0x3f68bf3c,0x3f531849
.long 0x3f7ec46d,0x3f74fa0b,0x3f61c598,0x3f45e403,0x3f7e70b0,0x3f721352,0x3f59f26a,0x3f373a23,0x3f7e1324,0x3f6ed89e,0x3f514d3d,0x3f273656,0x3f7dabcc,0x3f6b4b0c,0x3f47de65,0x3f15f6d9
.long 0x3f7d3aac,0x3f676bd8,0x3f3daef9,0x3f039c3d,0x3f7cbfc9,0x3f633c5a,0x3f32c8c9,0x3ee0924f,0x3f7c3b28,0x3f5ebe05,0x3f273656,0x3eb8442a,0x3f7baccd,0x3f59f26a,0x3f1b02c6,0x3e8e9a22
.long 0x3f800000,0x3f800000,0x3f800000,0x3f800000,0x3f7e70b0,0x3f7dabcc,0x3f7cbfc9,0x3f7baccd,0x3f79c79d,0x3f76ba07,0x3f731447,0x3f6ed89e,0x3f721352,0x3f6b4b0c,0x3f633c5a,0x3f59f26a
.long 0x3f676bd8,0x3f5b941a,0x3f4d9f02,0x3f3daef9,0x3f59f26a,0x3f47de65,0x3f32c8c9,0x3f1b02c6,0x3f49d112,0x3f3085bb,0x3f13682a,0x3ee63375,0x3f373a23,0x3f15f6d9,0x3ee0924f,0x3e8e9a22
.long 0x3f226799,0x3ef15aea,0x3e94a031,0x3dc8bd36,0x3f0b9a6b,0x3eb263ef,0x3e09cf86,0xbdafb680,0x3ee63375,0x3e605c13,0xbcc90ab0,0xbe888e93,0x3eb263ef,0x3dafb680,0xbe3b6ecf,0xbee0924f
.long 0x3e78cfcc,0xbd48fb30,0xbeac7cd4,0xbf187fc0,0x3e09cf86,0xbe3b6ecf,0xbef6e0cb,0xbf3b8f3b,0x3cc90ab0,0xbea09ae5,0xbf1d7fd1,0xbf584853,0xbdafb680,0xbee0924f,0xbf3b8f3b,0xbf6db293
.long 0x3f800000,0x3f800000,0x3f800000,0x3f800000,0x3f7a7302,0x3f791298,0x3f778bc5,0x3f75dec6,0x3f6a09a7,0x3f64aa59,0x3f5ebe05,0x3f584853,0x3f4f7a1f,0x3f43e200,0x3f373a23,0x3f299415
.long 0x3f2beb4a,0x3f187fc0,0x3f039c3d,0x3edae880,0x3f00e7e4,0x3ec9b953,0x3e8e9a22,0x3e22abb6,0x3ea09ae5,0x3e2f10a2,0x3cc90ab0,0xbdfab273,0x3de1bc2e,0xbd7b2b74,0xbe6c9a7f,0xbec9b953
.long 0xbdc8bd36,0xbe94a031,0xbef15aea,0xbf226799,0xbe9aa086,0xbf00e7e4,0xbf2e3bde,0xbf531849,0xbefc5d27,0xbf3085bb,0xbf584853,0xbf731447,0xbf299415,0xbf5695e5,0xbf740bdd,0xbf7fd397
.long 0xbf4d9f02,0xbf710908,0xbf7fb10f,0xbf7853f8,0xbf68bf3c,0xbf7e70b0,0xbf7a7302,0xbf5d2d53,0xbf79c79d,0xbf7e1324,0xbf64aa59,0xbf3085bb,0xbf7ffb11,0xbf6ff573,0xbf3fc767,0xbeebcbbb
.long 0x3f800000,0x3f800000,0x3f800000,0x3f800000,0x3f740bdd,0x3f721352,0x3f6ff573,0x3f6db293,0x3f514d3d,0x3f49d112,0x3f41d870,0x3f396842,0x3f1b02c6,0x3f0b9a6b,0x3ef6e0cb,0x3ed53641
.long 0x3eac7cd4,0x3e78cfcc,0x3e164083,0x3d48fb30,0x3d16c32c,0xbdafb680,0xbe541501,0xbea68f12,0xbe888e93,0xbecf7bca,0xbf08f59b,0xbf273656,0xbf0b9a6b,0xbf2e3bde,0xbf4bbbf8,0xbf633c5a
.long 0xbf45e403,0xbf61c598,0xbf74fa0b,0xbf7ec46d,0xbf6db293,0xbf7cbfc9,0xbf7f84ab,0xbf75dec6,0xbf7f4e6d,0xbf7c3b28,0xbf6a09a7,0xbf49d112,0xbf791298,0xbf604621,0xbf373a23,0xbf00e7e4
.long 0xbf5b941a,0xbf2beb4a,0xbedae880,0xbe164083,0xbf299415,0xbec9b953,0xbdafb680,0x3e6c9a7f,0xbecf7bca,0xbd96a905,0x3e888e93,0x3f13682a,0xbde1bc2e,0x3e827dc0,0x3f15f6d9,0x3f5695e5
.long 0x0,0x0,0x0,0x0,0x3c490e90,0x3d16c32c,0x3d7b2b74,0x3dafb680,0x3cc90ab0,0x3d96a905,0x3dfab273,0x3e2f10a2,0x3d16c32c,0x3de1bc2e,0x3e3b6ecf,0x3e827dc0
.long 0x3d48fb30,0x3e164083,0x3e78cfcc,0x3eac7cd4,0x3d7b2b74,0x3e3b6ecf,0x3e9aa086,0x3ed53641,0x3d96a905,0x3e605c13,0x3eb8442a,0x3efc5d27,0x3dafb680,0x3e827dc0,0x3ed53641,0x3f10d3cd
.long 0x3dc8bd36,0x3e94a031,0x3ef15aea,0x3f226799,0x3de1bc2e,0x3ea68f12,0x3f064b82,0x3f32c8c9,0x3dfab273,0x3eb8442a,0x3f13682a,0x3f41d870,0x3e09cf86,0x3ec9b953,0x3f1ff6cb,0x3f4f7a1f
.long 0x3e164083,0x3edae880,0x3f2beb4a,0x3f5b941a,0x3e22abb6,0x3eebcbbb,0x3f373a23,0x3f660f88,0x3e2f10a2,0x3efc5d27,0x3f41d870,0x3f6ed89e,0x3e3b6ecf,0x3f064b82,0x3f4bbbf8,0x3f75dec6
.long 0x0,0x0,0x0,0x0,0x3de1bc2e,0x3e09cf86,0x3e22abb6,0x3e3b6ecf,0x3e605c13,0x3e888e93,0x3ea09ae5,0x3eb8442a,0x3ea68f12,0x3ec9b953,0x3eebcbbb,0x3f064b82
.long 0x3edae880,0x3f039c3d,0x3f187fc0,0x3f2beb4a,0x3f064b82,0x3f1ff6cb,0x3f373a23,0x3f4bbbf8,0x3f1d7fd1,0x3f396842,0x3f514d3d,0x3f64aa59,0x3f32c8c9,0x3f4f7a1f,0x3f660f88,0x3f75dec6
.long 0x3f45e403,0x3f61c598,0x3f74fa0b,0x3f7ec46d,0x3f5695e5,0x3f6ff573,0x3f7dabcc,0x3f7f0e58,0x3f64aa59,0x3f79c79d,0x3f7fec43,0x3f76ba07,0x3f6ff573,0x3f7f0e58,0x3f7baccd,0x3f660f88
.long 0x3f7853f8,0x3f7fb10f,0x3f710908,0x3f4d9f02,0x3f7dabcc,0x3f7baccd,0x3f604621,0x3f2e3bde,0x3f7fec43,0x3f731447,0x3f49d112,0x3f08f59b,0x3f7f0e58,0x3f660f88,0x3f2e3bde,0x3ebe1d4a
.long 0x0,0x0,0x0,0x0,0x3e541501,0x3e6c9a7f,0x3e827dc0,0x3e8e9a22,0x3ecf7bca,0x3ee63375,0x3efc5d27,0x3f08f59b,0x3f15f6d9,0x3f24d225,0x3f32c8c9,0x3f3fc767
.long 0x3f3daef9,0x3f4d9f02,0x3f5b941a,0x3f676bd8,0x3f5d2d53,0x3f6b4b0c,0x3f75dec6,0x3f7cbfc9,0x3f731447,0x3f7c3b28,0x3f7fec43,0x3f7e1324,0x3f7e70b0,0x3f7f84ab,0x3f791298,0x3f6b4b0c
.long 0x3f7ec46d,0x3f74fa0b,0x3f61c598,0x3f45e403,0x3f740bdd,0x3f5d2d53,0x3f3b8f3b,0x3f10d3cd,0x3f5ebe05,0x3f396842,0x3f08f59b,0x3ea09ae5,0x3f3fc767,0x3f0b9a6b,0x3e9aa086,0x3d16c32c
.long 0x3f187fc0,0x3eac7cd4,0x3d48fb30,0xbe78cfcc,0x3ed53641,0x3de1bc2e,0xbe541501,0xbf00e7e4,0x3e605c13,0xbdfab273,0xbee63375,0xbf396842,0x3c490e90,0xbeb263ef,0xbf299415,0xbf633c5a
.long 0x0,0x0,0x0,0x0,0x3e9aa086,0x3ea68f12,0x3eb263ef,0x3ebe1d4a,0x3f13682a,0x3f1d7fd1,0x3f273656,0x3f3085bb,0x3f4bbbf8,0x3f5695e5,0x3f604621,0x3f68bf3c
.long 0x3f710908,0x3f7853f8,0x3f7d3aac,0x3f7fb10f,0x3f7fd397,0x3f7f0e58,0x3f7a7302,0x3f721352,0x3f76ba07,0x3f6a09a7,0x3f584853,0x3f41d870,0x3f5695e5,0x3f3b8f3b,0x3f1b02c6,0x3eebcbbb
.long 0x3f226799,0x3ef15aea,0x3e94a031,0x3dc8bd36,0x3ebe1d4a,0x3e22abb6,0xbd7b2b74,0xbe8e9a22,0x3d96a905,0xbe2f10a2,0xbecf7bca,0xbf1d7fd1,0xbe6c9a7f,0xbef6e0cb,0xbf32c8c9,0xbf5d2d53
.long 0xbf039c3d,0xbf3daef9,0xbf676bd8,0xbf7d3aac,0xbf3fc767,0xbf6b4b0c,0xbf7f0e58,0xbf791298,0xbf6a09a7,0xbf7f4e6d,0xbf76ba07,0xbf514d3d,0xbf7e70b0,0xbf778bc5,0xbf4f7a1f,0xbf0b9a6b
.long 0x3f80,0xbe163f7d,0xbe953f75,0xbedb3f67,0x3f80,0x3e793f78,0x3ef13f62,0x3f2c3f3e,0x3f80,0x3f183f4e,0x3f753e95,0x3f71beac,0x3f80,0x3f5c3f04,0x3f62bef1,0x3d49bf80
.long 0x3f80,0x3f7d3e16,0x3e95bf75,0xbf67bedb,0x3f80,0x3f78be79,0xbef1bf62,0xbf3e3f2c,0x3f80,0x3f4ebf18,0xbf75be95,0x3eac3f71,0x3f80,0x3f04bf5c,0xbf623ef1,0x3f803d49
.long 0x3f80,0x3e16bf7d,0xbe953f75,0x3edbbf67,0x3f80,0xbe79bf78,0x3ef13f62,0xbf2cbf3e,0x3f80,0xbf18bf4e,0x3f753e95,0xbf713eac,0x3f80,0xbf5cbf04,0x3f62bef1,0xbd493f80
.long 0x3f80,0xbf7dbe16,0x3e95bf75,0x3f673edb,0x3f80,0xbf783e79,0xbef1bf62,0x3f3ebf2c,0x3f80,0xbf4e3f18,0xbf75be95,0xbeacbf71,0x3f80,0xbf043f5c,0xbf623ef1,0xbf80bd49
.long 0xbf0e3f55,0xbf2c3f3e,0xbf463f22,0xbf5c3f04,0x3f553f0e,0x3f713eac,0x3f7f3dc9,0x3f7dbe16,0x3f0ebf55,0xbd49bf80,0xbf22bf46,0xbf78be79,0xbf55bf0e,0xbf673edb,0xbdc93f7f,0x3f4e3f18
.long 0xbf0e3f55,0x3f3e3f2c,0x3f46bf22,0xbf04bf5c,0x3f553f0e,0x3eacbf71,0xbf7fbdc9,0x3e163f7d,0x3f0ebf55,0xbf803d49,0x3f223f46,0x3e79bf78,0xbf55bf0e,0x3edb3f67,0x3dc9bf7f,0xbf183f4e
.long 0xbf0e3f55,0x3f2cbf3e,0xbf463f22,0x3f5cbf04,0x3f553f0e,0xbf71beac,0x3f7f3dc9,0xbf7d3e16,0x3f0ebf55,0x3d493f80,0xbf22bf46,0x3f783e79,0xbf55bf0e,0x3f67bedb,0xbdc93f7f,0xbf4ebf18
.long 0xbf0e3f55,0xbf3ebf2c,0x3f46bf22,0x3f043f5c,0x3f553f0e,0xbeac3f71,0xbf7fbdc9,0xbe16bf7d,0x3f0ebf55,0x3f80bd49,0x3f223f46,0xbe793f78,0xbf55bf0e,0xbedbbf67,0x3dc9bf7f,0x3f18bf4e
.long 0xbf6d3ec4,0xbf783e79,0xbf7f3dc9,0xbf80bd49,0x3f6dbec4,0x3f4ebf18,0x3f22bf46,0x3edbbf67,0xbf6d3ec4,0xbf043f5c,0x3dc93f7f,0x3f2c3f3e,0x3f6dbec4,0x3e16bf7d,0xbf46bf22,0xbf713eac
.long 0xbf6d3ec4,0x3e793f78,0x3f7fbdc9,0x3d49bf80,0x3f6dbec4,0xbf18bf4e,0xbf223f46,0x3f673edb,0xbf6d3ec4,0x3f5c3f04,0xbdc9bf7f,0xbf3e3f2c,0x3f6dbec4,0xbf7dbe16,0x3f463f22,0xbeacbf71
.long 0xbf6d3ec4,0x3f78be79,0xbf7f3dc9,0x3f803d49,0x3f6dbec4,0xbf4e3f18,0x3f22bf46,0xbedb3f67,0xbf6d3ec4,0x3f04bf5c,0x3dc93f7f,0xbf2cbf3e,0x3f6dbec4,0xbe163f7d,0xbf46bf22,0x3f71beac
.long 0xbf6d3ec4,0xbe79bf78,0x3f7fbdc9,0xbd493f80,0x3f6dbec4,0x3f183f4e,0xbf223f46,0xbf67bedb,0xbf6d3ec4,0xbf5cbf04,0xbdc9bf7f,0x3f3ebf2c,0x3f6dbec4,0x3f7d3e16,0x3f463f22,0x3eac3f71
.long 0xbf7bbe48,0xbf71beac,0xbf62bef1,0xbf4ebf18,0x3e48bf7b,0xbd49bf80,0xbe95bf75,0xbf04bf5c,0x3f7b3e48,0x3f67bedb,0x3ef1bf62,0xbe16bf7d,0xbe483f7b,0x3f3e3f2c,0x3f75be95,0x3e79bf78
.long 0xbf7bbe48,0xbeac3f71,0x3f623ef1,0x3f18bf4e,0x3e48bf7b,0xbf803d49,0x3e953f75,0x3f5cbf04,0x3f7b3e48,0xbedbbf67,0xbef13f62,0x3f7dbe16,0xbe483f7b,0x3f2cbf3e,0xbf753e95,0x3f783e79
.long 0xbf7bbe48,0x3f713eac,0xbf62bef1,0x3f4e3f18,0x3e48bf7b,0x3d493f80,0xbe95bf75,0x3f043f5c,0x3f7b3e48,0xbf673edb,0x3ef1bf62,0x3e163f7d,0xbe483f7b,0xbf3ebf2c,0x3f75be95,0xbe793f78
.long 0xbf7bbe48,0x3eacbf71,0x3f623ef1,0xbf183f4e,0x3e48bf7b,0x3f80bd49,0x3e953f75,0xbf5c3f04,0x3f7b3e48,0x3edb3f67,0xbef13f62,0xbf7d3e16,0xbe483f7b,0xbf2c3f3e,0xbf753e95,0xbf78be79
.long 0x3f808000,0x3f7d3e16,0x3f753e95,0x3f673edb,0x3f808000,0x3f78be79,0x3f62bef1,0x3f3ebf2c,0x3f808000,0x3f4ebf18,0x3e95bf75,0xbeacbf71,0x3f808000,0x3f04bf5c,0xbef1bf62,0xbf80bd49
.long 0x3f808000,0x3e16bf7d,0xbf75be95,0xbedb3f67,0x3f808000,0xbe79bf78,0xbf623ef1,0x3f2c3f3e,0x3f808000,0xbf18bf4e,0xbe953f75,0x3f71beac,0x3f808000,0xbf5cbf04,0x3ef13f62,0x3d49bf80
.long 0x3f808000,0xbf7dbe16,0x3f753e95,0xbf67bedb,0x3f808000,0xbf783e79,0x3f62bef1,0xbf3e3f2c,0x3f808000,0xbf4e3f18,0x3e95bf75,0x3eac3f71,0x3f808000,0xbf043f5c,0xbef1bf62,0x3f803d49
.long 0x3f808000,0xbe163f7d,0xbf75be95,0x3edbbf67,0x3f808000,0x3e793f78,0xbf623ef1,0xbf2cbf3e,0x3f808000,0x3f183f4e,0xbe953f75,0xbf713eac,0x3f808000,0x3f5c3f04,0x3ef13f62,0xbd493f80
.long 0x3f553f0e,0x3f3e3f2c,0x3f223f46,0x3f043f5c,0x3f0ebf55,0x3eacbf71,0x3dc9bf7f,0xbe16bf7d,0xbf55bf0e,0xbf803d49,0xbf463f22,0xbe793f78,0xbf0e3f55,0x3edb3f67,0x3f7f3dc9,0x3f18bf4e
.long 0x3f553f0e,0x3f2cbf3e,0xbf22bf46,0xbf5c3f04,0x3f0ebf55,0xbf71beac,0xbdc93f7f,0x3f7dbe16,0xbf55bf0e,0x3d493f80,0x3f46bf22,0xbf78be79,0xbf0e3f55,0x3f67bedb,0xbf7fbdc9,0x3f4e3f18
.long 0x3f553f0e,0xbf3ebf2c,0x3f223f46,0xbf04bf5c,0x3f0ebf55,0xbeac3f71,0x3dc9bf7f,0x3e163f7d,0xbf55bf0e,0x3f80bd49,0xbf463f22,0x3e79bf78,0xbf0e3f55,0xbedbbf67,0x3f7f3dc9,0xbf183f4e
.long 0x3f553f0e,0xbf2c3f3e,0xbf22bf46,0x3f5cbf04,0x3f0ebf55,0x3f713eac,0xbdc93f7f,0xbf7d3e16,0xbf55bf0e,0xbd49bf80,0x3f46bf22,0x3f783e79,0xbf0e3f55,0xbf673edb,0xbf7fbdc9,0xbf4ebf18
.long 0x3ec43f6d,0x3e793f78,0x3dc93f7f,0xbd493f80,0xbec4bf6d,0xbf18bf4e,0xbf46bf22,0xbf67bedb,0x3ec43f6d,0x3f5c3f04,0x3f7fbdc9,0x3f3ebf2c,0xbec4bf6d,0xbf7dbe16,0xbf223f46,0x3eac3f71
.long 0x3ec43f6d,0x3f78be79,0xbdc9bf7f,0xbf80bd49,0xbec4bf6d,0xbf4e3f18,0x3f463f22,0x3edbbf67,0x3ec43f6d,0x3f04bf5c,0xbf7f3dc9,0x3f2c3f3e,0xbec4bf6d,0xbe163f7d,0x3f22bf46,0xbf713eac
.long 0x3ec43f6d,0xbe79bf78,0x3dc93f7f,0x3d49bf80,0xbec4bf6d,0x3f183f4e,0xbf46bf22,0x3f673edb,0x3ec43f6d,0xbf5cbf04,0x3f7fbdc9,0xbf3e3f2c,0xbec4bf6d,0x3f7d3e16,0xbf223f46,0xbeacbf71
.long 0x3ec43f6d,0xbf783e79,0xbdc9bf7f,0x3f803d49,0xbec4bf6d,0x3f4ebf18,0x3f463f22,0xbedb3f67,0x3ec43f6d,0xbf043f5c,0xbf7f3dc9,0xbf2cbf3e,0xbec4bf6d,0x3e16bf7d,0x3f22bf46,0x3f71beac
.long 0xbe483f7b,0xbeac3f71,0xbef13f62,0xbf183f4e,0xbf7bbe48,0xbf803d49,0xbf753e95,0xbf5c3f04,0x3e48bf7b,0xbedbbf67,0xbf62bef1,0xbf7d3e16,0x3f7b3e48,0x3f2cbf3e,0xbe95bf75,0xbf78be79
.long 0xbe483f7b,0x3f713eac,0x3ef1bf62,0xbf4ebf18,0xbf7bbe48,0x3d493f80,0x3f75be95,0xbf04bf5c,0x3e48bf7b,0xbf673edb,0x3f623ef1,0xbe16bf7d,0x3f7b3e48,0xbf3ebf2c,0x3e953f75,0x3e79bf78
.long 0xbe483f7b,0x3eacbf71,0xbef13f62,0x3f18bf4e,0xbf7bbe48,0x3f80bd49,0xbf753e95,0x3f5cbf04,0x3e48bf7b,0x3edb3f67,0xbf62bef1,0x3f7dbe16,0x3f7b3e48,0xbf2c3f3e,0xbe95bf75,0x3f783e79
.long 0xbe483f7b,0xbf71beac,0x3ef1bf62,0x3f4e3f18,0xbf7bbe48,0xbd49bf80,0x3f75be95,0x3f043f5c,0x3e48bf7b,0x3f67bedb,0x3f623ef1,0x3e163f7d,0x3f7b3e48,0x3f3e3f2c,0x3e953f75,0xbe793f78
.long 0x80003f80,0x80003f80,0x80003f80,0x80003f80,0x3e163f7d,0xbe793f78,0xbf183f4e,0xbf5c3f04,0x3e953f75,0xbef13f62,0xbf753e95,0xbf62bef1,0x3edb3f67,0xbf2c3f3e,0xbf71beac,0xbd49bf80
.long 0x3f0e3f55,0xbf553f0e,0xbf0ebf55,0x3f55bf0e,0x3f2c3f3e,0xbf713eac,0x3d49bf80,0x3f673edb,0x3f463f22,0xbf7f3dc9,0x3f22bf46,0x3dc93f7f,0x3f5c3f04,0xbf7dbe16,0x3f78be79,0xbf4e3f18
.long 0x3f6d3ec4,0xbf6dbec4,0x3f6d3ec4,0xbf6dbec4,0x3f783e79,0xbf4ebf18,0x3f043f5c,0xbe16bf7d,0x3f7f3dc9,0xbf22bf46,0xbdc93f7f,0x3f46bf22,0x3f80bd49,0xbedbbf67,0xbf2c3f3e,0x3f713eac
.long 0x3f7bbe48,0xbe48bf7b,0xbf7b3e48,0x3e483f7b,0x3f71beac,0x3d49bf80,0xbf67bedb,0xbf3e3f2c,0x3f62bef1,0x3e95bf75,0xbef1bf62,0xbf75be95,0x3f4ebf18,0x3f04bf5c,0x3e16bf7d,0xbe79bf78
.long 0x80003f80,0x80003f80,0x80003f80,0x80003f80,0xbf7d3e16,0xbf78be79,0xbf4ebf18,0xbf04bf5c,0xbe95bf75,0x3ef1bf62,0x3f75be95,0x3f623ef1,0x3f67bedb,0x3f3e3f2c,0xbeac3f71,0xbf803d49
.long 0x3f0e3f55,0xbf553f0e,0xbf0ebf55,0x3f55bf0e,0xbf3e3f2c,0xbeacbf71,0x3f803d49,0xbedb3f67,0xbf46bf22,0x3f7fbdc9,0xbf223f46,0xbdc9bf7f,0x3f04bf5c,0xbe163f7d,0xbe79bf78,0x3f183f4e
.long 0x3f6d3ec4,0xbf6dbec4,0x3f6d3ec4,0xbf6dbec4,0xbe793f78,0x3f18bf4e,0xbf5c3f04,0x3f7dbe16,0xbf7fbdc9,0x3f223f46,0x3dc9bf7f,0xbf463f22,0xbd49bf80,0xbf673edb,0x3f3e3f2c,0x3eacbf71
.long 0x3f7bbe48,0xbe48bf7b,0xbf7b3e48,0x3e483f7b,0x3eac3f71,0x3f803d49,0x3edbbf67,0xbf2cbf3e,0xbf623ef1,0xbe953f75,0x3ef13f62,0x3f753e95,0xbf18bf4e,0xbf5cbf04,0xbf7dbe16,0xbf783e79
.long 0x80003f80,0x80003f80,0x80003f80,0x80003f80,0xbe16bf7d,0x3e79bf78,0x3f18bf4e,0x3f5cbf04,0x3e953f75,0xbef13f62,0xbf753e95,0xbf62bef1,0xbedbbf67,0x3f2cbf3e,0x3f713eac,0x3d493f80
.long 0x3f0e3f55,0xbf553f0e,0xbf0ebf55,0x3f55bf0e,0xbf2cbf3e,0x3f71beac,0xbd493f80,0xbf67bedb,0x3f463f22,0xbf7f3dc9,0x3f22bf46,0x3dc93f7f,0xbf5cbf04,0x3f7d3e16,0xbf783e79,0x3f4ebf18
.long 0x3f6d3ec4,0xbf6dbec4,0x3f6d3ec4,0xbf6dbec4,0xbf78be79,0x3f4e3f18,0xbf04bf5c,0x3e163f7d,0x3f7f3dc9,0xbf22bf46,0xbdc93f7f,0x3f46bf22,0xbf803d49,0x3edb3f67,0x3f2cbf3e,0xbf71beac
.long 0x3f7bbe48,0xbe48bf7b,0xbf7b3e48,0x3e483f7b,0xbf713eac,0xbd493f80,0x3f673edb,0x3f3ebf2c,0x3f62bef1,0x3e95bf75,0xbef1bf62,0xbf75be95,0xbf4e3f18,0xbf043f5c,0xbe163f7d,0x3e793f78
.long 0x80003f80,0x80003f80,0x80003f80,0x80003f80,0x3f7dbe16,0x3f783e79,0x3f4e3f18,0x3f043f5c,0xbe95bf75,0x3ef1bf62,0x3f75be95,0x3f623ef1,0xbf673edb,0xbf3ebf2c,0x3eacbf71,0x3f80bd49
.long 0x3f0e3f55,0xbf553f0e,0xbf0ebf55,0x3f55bf0e,0x3f3ebf2c,0x3eac3f71,0xbf80bd49,0x3edbbf67,0xbf46bf22,0x3f7fbdc9,0xbf223f46,0xbdc9bf7f,0xbf043f5c,0x3e16bf7d,0x3e793f78,0xbf18bf4e
.long 0x3f6d3ec4,0xbf6dbec4,0x3f6d3ec4,0xbf6dbec4,0x3e79bf78,0xbf183f4e,0x3f5cbf04,0xbf7d3e16,0xbf7fbdc9,0x3f223f46,0x3dc9bf7f,0xbf463f22,0x3d493f80,0x3f67bedb,0xbf3ebf2c,0xbeac3f71
.long 0x3f7bbe48,0xbe48bf7b,0xbf7b3e48,0x3e483f7b,0xbeacbf71,0xbf80bd49,0xbedb3f67,0x3f2c3f3e,0xbf623ef1,0xbe953f75,0x3ef13f62,0x3f753e95,0x3f183f4e,0x3f5c3f04,0x3f7d3e16,0x3f78be79
.long 0x3f800000,0x3f800000,0x3f800000,0x3f800000,0x3f7dbe16,0x3f783e79,0x3f4e3f18,0x3f043f5c,0x3f75be95,0x3f623ef1,0x3e953f75,0xbef13f62,0x3f67bedb,0x3f3e3f2c,0xbeac3f71,0xbf803d49
.long 0x3f55bf0e,0x3f0e3f55,0xbf553f0e,0xbf0ebf55,0x3f3ebf2c,0x3eac3f71,0xbf80bd49,0x3edbbf67,0x3f22bf46,0x3dc93f7f,0xbf46bf22,0x3f7fbdc9,0x3f04bf5c,0xbe163f7d,0xbe79bf78,0x3f183f4e
.long 0x3ec4bf6d,0xbec43f6d,0x3ec4bf6d,0xbec43f6d,0x3e79bf78,0xbf183f4e,0x3f5cbf04,0xbf7d3e16,0x3dc9bf7f,0xbf463f22,0x3f7f3dc9,0xbf22bf46,0xbd49bf80,0xbf673edb,0x3f3e3f2c,0x3eacbf71
.long 0xbe48bf7b,0xbf7b3e48,0x3e483f7b,0x3f7bbe48,0xbeacbf71,0xbf80bd49,0xbedb3f67,0x3f2c3f3e,0xbef1bf62,0xbf75be95,0xbf623ef1,0xbe953f75,0xbf18bf4e,0xbf5cbf04,0xbf7dbe16,0xbf783e79
.long 0x3f800000,0x3f800000,0x3f800000,0x3f800000,0x3e163f7d,0xbe793f78,0xbf183f4e,0xbf5c3f04,0xbf753e95,0xbf62bef1,0xbe95bf75,0x3ef1bf62,0xbedbbf67,0x3f2cbf3e,0x3f713eac,0x3d493f80
.long 0x3f55bf0e,0x3f0e3f55,0xbf553f0e,0xbf0ebf55,0x3f2c3f3e,0xbf713eac,0x3d49bf80,0x3f673edb,0xbf223f46,0xbdc9bf7f,0x3f463f22,0xbf7f3dc9,0xbf5cbf04,0x3f7d3e16,0xbf783e79,0x3f4ebf18
.long 0x3ec4bf6d,0xbec43f6d,0x3ec4bf6d,0xbec43f6d,0x3f783e79,0xbf4ebf18,0x3f043f5c,0xbe16bf7d,0xbdc93f7f,0x3f46bf22,0xbf7fbdc9,0x3f223f46,0xbf803d49,0x3edb3f67,0x3f2cbf3e,0xbf71beac
.long 0xbe48bf7b,0xbf7b3e48,0x3e483f7b,0x3f7bbe48,0x3f71beac,0x3d49bf80,0xbf67bedb,0xbf3e3f2c,0x3ef13f62,0x3f753e95,0x3f62bef1,0x3e95bf75,0xbf4e3f18,0xbf043f5c,0xbe163f7d,0x3e793f78
.long 0x3f800000,0x3f800000,0x3f800000,0x3f800000,0xbf7d3e16,0xbf78be79,0xbf4ebf18,0xbf04bf5c,0x3f75be95,0x3f623ef1,0x3e953f75,0xbef13f62,0xbf673edb,0xbf3ebf2c,0x3eacbf71,0x3f80bd49
.long 0x3f55bf0e,0x3f0e3f55,0xbf553f0e,0xbf0ebf55,0xbf3e3f2c,0xbeacbf71,0x3f803d49,0xbedb3f67,0x3f22bf46,0x3dc93f7f,0xbf46bf22,0x3f7fbdc9,0xbf043f5c,0x3e16bf7d,0x3e793f78,0xbf18bf4e
.long 0x3ec4bf6d,0xbec43f6d,0x3ec4bf6d,0xbec43f6d,0xbe793f78,0x3f18bf4e,0xbf5c3f04,0x3f7dbe16,0x3dc9bf7f,0xbf463f22,0x3f7f3dc9,0xbf22bf46,0x3d493f80,0x3f67bedb,0xbf3ebf2c,0xbeac3f71
.long 0xbe48bf7b,0xbf7b3e48,0x3e483f7b,0x3f7bbe48,0x3eac3f71,0x3f803d49,0x3edbbf67,0xbf2cbf3e,0xbef1bf62,0xbf75be95,0xbf623ef1,0xbe953f75,0x3f183f4e,0x3f5c3f04,0x3f7d3e16,0x3f78be79
.long 0x3f800000,0x3f800000,0x3f800000,0x3f800000,0xbe16bf7d,0x3e79bf78,0x3f18bf4e,0x3f5cbf04,0xbf753e95,0xbf62bef1,0xbe95bf75,0x3ef1bf62,0x3edb3f67,0xbf2c3f3e,0xbf71beac,0xbd49bf80
.long 0x3f55bf0e,0x3f0e3f55,0xbf553f0e,0xbf0ebf55,0xbf2cbf3e,0x3f71beac,0xbd493f80,0xbf67bedb,0xbf223f46,0xbdc9bf7f,0x3f463f22,0xbf7f3dc9,0x3f5c3f04,0xbf7dbe16,0x3f78be79,0xbf4e3f18
.long 0x3ec4bf6d,0xbec43f6d,0x3ec4bf6d,0xbec43f6d,0xbf78be79,0x3f4e3f18,0xbf04bf5c,0x3e163f7d,0xbdc93f7f,0x3f46bf22,0xbf7fbdc9,0x3f223f46,0x3f80bd49,0xbedbbf67,0xbf2c3f3e,0x3f713eac
.long 0xbe48bf7b,0xbf7b3e48,0x3e483f7b,0x3f7bbe48,0xbf713eac,0xbd493f80,0x3f673edb,0x3f3ebf2c,0x3ef13f62,0x3f753e95,0x3f62bef1,0x3e95bf75,0x3f4ebf18,0x3f04bf5c,0x3e16bf7d,0xbe79bf78
.long 0x3f800000,0x3f7ffd39,0x3f7ff4e6,0x3f7fe705,0x3f800000,0x3f7ff84a,0x3f7fe129,0x3f7fba9e,0x3f800000,0x3f7fcbe2,0x3f7f2f9d,0x3f7e2b72,0x3f800000,0x3f7f7808,0x3f7de0b1,0x3f7b3bab
.long 0x3f800000,0x3f7efcc9,0x3f7bf531,0x3f76ef5b,0x3f800000,0x3f7e5a38,0x3f796e4e,0x3f714c7a,0x3f800000,0x3f7d906e,0x3f764d97,0x3f6a5ad9,0x3f800000,0x3f7c9f8a,0x3f7294f8,0x3f62241a
.long 0x3f800000,0x3f7b87b2,0x3f6e46be,0x3f58b3a1,0x3f800000,0x3f7a4910,0x3f696591,0x3f4e1689,0x3f800000,0x3f78e3d6,0x3f63f473,0x3f425b89,0x3f800000,0x3f77583a,0x3f5df6be,0x3f3592e7
.long 0x3f800000,0x3f75a67b,0x3f577026,0x3f27ce61,0x3f800000,0x3f73ced9,0x3f5064af,0x3f19210f,0x3f800000,0x3f71d19f,0x3f48d8b3,0x3f099f4e,0x3f800000,0x3f6faf1b,0x3f40d0da,0x3ef2bd43
.long 0x3f7fd397,0x3f7fba9e,0x3f7f9c18,0x3f7f7808,0x3f7f84ab,0x3f7f3f54,0x3f7eea9d,0x3f7e868b,0x3f7cbfc9,0x3f7aed37,0x3f78b47b,0x3f76167a,0x3f778bc5,0x3f72d4eb,0x3f6d1c1d,0x3f666771
.long 0x3f6ff573,0x3f671599,0x3f5c61c7,0x3f4fefa8,0x3f660f88,0x3f57dc7f,0x3f46e22a,0x3f33587a,0x3f59f26a,0x3f456439,0x3f2d1469,0x3f11796b,0x3f4bbbf8,0x3f2ff3e6,0x3f0f8784,0x3ed6a399
.long 0x3f3b8f3b,0x3f17de12,0x3eddbe79,0x3e840270,0x3f299415,0x3efafef7,0x3e97a117,0x3db5f8da,0x3f15f6d9,0x3ec27b55,0x3e1c76de,0xbda973ba,0x3f00e7e4,0x3e870ada,0x3bc90f88,0xbe80f8c0
.long 0x3ed53641,0x3e1324ca,0xbe1008b7,0xbed3c867,0x3ea68f12,0x3cafea69,0xbe919ddd,0xbf102dd5,0x3e6c9a7f,0xbdcefdb7,0xbed8106b,0xbf3238aa,0x3e09cf86,0xbe636c83,0xbf0cead0,0xbf4f0417
.long 0x3f7f4e6d,0x3f7f1f49,0x3f7eea9d,0x3f7eb069,0x3f7e1324,0x3f7d906e,0x3f7cfe73,0x3f7c5d3a,0x3f731447,0x3f6faf1b,0x3f6be858,0x3f67c187,0x3f5ebe05,0x3f5627fe,0x3f4cae79,0x3f425b89
.long 0x3f41d870,0x3f3238aa,0x3f212ff9,0x3f0ee0db,0x3f1d7fd1,0x3f05a02c,0x3ed8106b,0x3ea21887,0x3ee63375,0x3ea5129f,0x3e419b37,0x3d55880e,0x3e888e93,0x3ddb7d37,0xbd621469,0xbe5d4b1a
.long 0x3d96a905,0xbde7fa9a,0xbe97a117,0xbeeff7fb,0xbdfab273,0xbea80b1f,0xbf04f484,0xbf2ff3e6,0xbea09ae5,0xbf06f686,0xbf36206c,0xbf5b2c79,0xbefc5d27,0xbf33587a,0xbf5c61c7,0xbf76841b
.long 0xbf273656,0xbf570348,0xbf756d97,0xbf7fffb1,0xbf49d112,0xbf703b37,0xbf7fc38f,0xbf76ef5b,0xbf64aa59,0xbf7dc68c,0xbf7ac516,0xbf5bfb34,0xbf76ba07,0xbf7efcc9,0xbf66becc,0xbf311722
.long 0x3f7e70b0,0x3f7e2b72,0x3f7de0b1,0x3f7d906e,0x3f7baccd,0x3f7aed37,0x3f7a1e84,0x3f7940c0,0x3f633c5a,0x3f5e5aa6,0x3f591e6a,0x3f5389c7,0x3f373a23,0x3f2b561b,0x3f1ebc12,0x3f11796b
.long 0x3ef6e0cb,0x3ece0bea,0x3ea395c5,0x3e6fa8b2,0x3e541501,0x3dc27c39,0xbc96c9b6,0xbe06b26e,0xbdafb680,0xbe636c83,0xbeb554ec,0xbef58035,0xbebe1d4a,0xbf044889,0xbf26050a,0xbf436051
.long 0xbf1ff6cb,0xbf425b89,0xbf5df6be,0xbf71d19f,0xbf531849,0xbf6cd007,0xbf7bf531,0xbf7fdaaf,0xbf740bdd,0xbf7f5ce9,0xbf7c7eb0,0xbf6b99fb,0xbf7ffb11,0xbf7822d1,0xbf5f8327,0xbf37c655
.long 0xbf75dec6,0xbf57dc7f,0xbf286605,0xbed6a399,0xbf5695e5,0xbf21cbfb,0xbebb31a0,0xbd83db0a,0xbf24d225,0xbeb6ccc3,0xbcfb49ba,0x3e9920fe,0xbec9b953,0xbd3c6dd5,0x3e9d9e78,0x3f1f599f
.long 0x0,0xbc16cb58,0xbc96c9b6,0xbce22a7a,0x0,0x3c7b514b,0x3cfb49ba,0x3d3c6dd5,0x0,0x3d2351cb,0x3da3308c,0x3df475c0,0x0,0x3d83db0a,0x3e039502,0x3e44b0b9
.long 0x0,0x3db5f8da,0x3e354098,0x3e870ada,0x0,0x3de7fa9a,0x3e667c66,0x3eab0201,0x0,0x3e0cec4a,0x3e8b9507,0x3ece0bea,0x0,0x3e25c58c,0x3ea395c5,0x3eeff7fb
.long 0x0,0x3e3e853e,0x3ebb31a0,0x3f084b92,0x0,0x3e57278f,0x3ed25a09,0x3f17de12,0x0,0x3e6fa8b2,0x3ee900b7,0x3f269de3,0x0,0x3e840270,0x3eff17b2,0x3f34768f
.long 0x0,0x3e901c2c,0x3f0a48ad,0x3f4154e1,0x0,0x3e9c1faf,0x3f14b039,0x3f4d26fd,0x0,0x3ea80b1f,0x3f1ebc12,0x3f57dc7f,0x0,0x3eb3dca5,0x3f286605,0x3f61668a
.long 0xbd16c32c,0xbd3c6dd5,0xbd621469,0xbd83db0a,0x3d7b2b74,0x3d9cecf9,0x3dbc3ac3,0x3ddb7d37,0x3e22abb6,0x3e4ada4f,0x3e72b651,0x3e8d17c0,0x3e827dc0,0x3ea21887,0x3ec1071e,0x3edf28a9
.long 0x3eb263ef,0x3edc53c1,0x3f0242b1,0x3f1553b7,0x3ee0924f,0x3f099f4e,0x3f212ff9,0x3f36ad7f,0x3f064b82,0x3f2302d3,0x3f3ca003,0x3f52a649,0x3f1b02c6,0x3f39f2ac,0x3f53fac3,0x3f686b39
.long 0x3f2e3bde,0x3f4e1689,0x3f66becc,0x3f77583a,0x3f3fc767,0x3f5f20db,0x3f748422,0x3f7efcc9,0x3f4f7a1f,0x3f6cd007,0x3f7cfe73,0x3f7f1f49,0x3f5d2d53,0x3f76ef5b,0x3f7ffec4,0x3f77beb7
.long 0x3f68bf3c,0x3f7d57de,0x3f7d7474,0x3f6912ae,0x3f721352,0x3f7ff0e3,0x3f756d97,0x3f5389c7,0x3f791298,0x3f7eb069,0x3f6816a8,0x3f37c655,0x3f7dabcc,0x3f799b43,0x3f55b993,0x3f16999f
.long 0xbd96a905,0xbda973ba,0xbdbc3ac3,0xbdcefdb7,0x3dfab273,0x3e0cec4a,0x3e1c76de,0x3e2bf804,0x3ea09ae5,0x3eb3dca5,0x3ec6d529,0x3ed97cb9,0x3efc5d27,0x3f0c42c9,0x3f19c200,0x3f269de3
.long 0x3f273656,0x3f37c655,0x3f46e22a,0x3f546b3b,0x3f49d112,0x3f5a5ba0,0x3f6816a8,0x3f72d4eb,0x3f64aa59,0x3f725470,0x3f7b61fc,0x3f7fa6e3,0x3f76ba07,0x3f7e868b,0x3f7f9c18,0x3f79f35e
.long 0x3f7f4e6d,0x3f7e5a38,0x3f748422,0x3f62241a,0x3f7e1324,0x3f71d19f,0x3f5ac450,0x3f39f2ac,0x3f731447,0x3f5988ad,0x3f33e7bc,0x3f044889,0x3f5ebe05,0x3f36ad7f,0x3f0242b1,0x3e8a11f7
.long 0x3f41d870,0x3f0af1b7,0x3e919ddd,0x3b490fc6,0x3f1d7fd1,0x3eb0eacb,0x3d2fe007,0xbe870ada,0x3ee63375,0x3e06b26e,0xbe4dee60,0xbf02ef9f,0x3e888e93,0xbdb5f8da,0xbeddbe79,0xbf38dd65
.long 0xbde1bc2e,0xbdf475c0,0xbe039502,0xbe0cec4a,0x3e3b6ecf,0x3e4ada4f,0x3e5a3997,0x3e698bba,0x3eebcbbb,0x3efdbabb,0x3f07a136,0x3f102dd5,0x3f32c8c9,0x3f3e35c5,0x3f48d8b3,0x3f52a649
.long 0x3f604621,0x3f6a5ad9,0x3f7294f8,0x3f78e3d6,0x3f7a7302,0x3f7ed7d4,0x3f7ff4e6,0x3f7dc68c,0x3f7f0e58,0x3f799b43,0x3f6f6830,0x3f60a6cf,0x3f6db293,0x3f5b2c79,0x3f42de29,0x3f256bcb
.long 0x3f47de65,0x3f269de3,0x3eff17b2,0x3ea80b1f,0x3f10d3cd,0x3ec27b55,0x3e354098,0xbd0a342f,0x3e9aa086,0x3d9064b4,0xbe28defc,0xbec8477c,0x3c490e90,0xbe7bdba4,0xbef9a02d,0xbf3238aa
.long 0xbe8e9a22,0xbf099f4e,0xbf40d0da,0xbf686b39,0xbf0b9a6b,0xbf466354,0xbf6e46be,0xbf7f7808,0xbf43e200,0xbf6f20b0,0xbf7fe129,0xbf74484b,0xbf6b4b0c,0xbf7fba9e,0xbf73913f,0xbf485bca
.long 0x3f800000,0x3f800000,0x3f800000,0x3f800000,0x3f7ffd39,0x3f7ff84a,0x3f7fcbe2,0x3f7f7808,0x3f7ff4e6,0x3f7fe129,0x3f7f2f9d,0x3f7de0b1,0x3f7fe705,0x3f7fba9e,0x3f7e2b72,0x3f7b3bab
.long 0x3f7fd397,0x3f7f84ab,0x3f7cbfc9,0x3f778bc5,0x3f7fba9e,0x3f7f3f54,0x3f7aed37,0x3f72d4eb,0x3f7f9c18,0x3f7eea9d,0x3f78b47b,0x3f6d1c1d,0x3f7f7808,0x3f7e868b,0x3f76167a,0x3f666771
.long 0x3f7f4e6d,0x3f7e1324,0x3f731447,0x3f5ebe05,0x3f7f1f49,0x3f7d906e,0x3f6faf1b,0x3f5627fe,0x3f7eea9d,0x3f7cfe73,0x3f6be858,0x3f4cae79,0x3f7eb069,0x3f7c5d3a,0x3f67c187,0x3f425b89
.long 0x3f7e70b0,0x3f7baccd,0x3f633c5a,0x3f373a23,0x3f7e2b72,0x3f7aed37,0x3f5e5aa6,0x3f2b561b,0x3f7de0b1,0x3f7a1e84,0x3f591e6a,0x3f1ebc12,0x3f7d906e,0x3f7940c0,0x3f5389c7,0x3f11796b
.long 0x3f800000,0x3f800000,0x3f800000,0x3f800000,0x3f7efcc9,0x3f7e5a38,0x3f7d906e,0x3f7c9f8a,0x3f7bf531,0x3f796e4e,0x3f764d97,0x3f7294f8,0x3f76ef5b,0x3f714c7a,0x3f6a5ad9,0x3f62241a
.long 0x3f6ff573,0x3f660f88,0x3f59f26a,0x3f4bbbf8,0x3f671599,0x3f57dc7f,0x3f456439,0x3f2ff3e6,0x3f5c61c7,0x3f46e22a,0x3f2d1469,0x3f0f8784,0x3f4fefa8,0x3f33587a,0x3f11796b,0x3ed6a399
.long 0x3f41d870,0x3f1d7fd1,0x3ee63375,0x3e888e93,0x3f3238aa,0x3f05a02c,0x3ea5129f,0x3ddb7d37,0x3f212ff9,0x3ed8106b,0x3e419b37,0xbd621469,0x3f0ee0db,0x3ea21887,0x3d55880e,0xbe5d4b1a
.long 0x3ef6e0cb,0x3e541501,0xbdafb680,0xbebe1d4a,0x3ece0bea,0x3dc27c39,0xbe636c83,0xbf044889,0x3ea395c5,0xbc96c9b6,0xbeb554ec,0xbf26050a,0x3e6fa8b2,0xbe06b26e,0xbef58035,0xbf436051
.long 0x3f800000,0x3f800000,0x3f800000,0x3f800000,0x3f7b87b2,0x3f7a4910,0x3f78e3d6,0x3f77583a,0x3f6e46be,0x3f696591,0x3f63f473,0x3f5df6be,0x3f58b3a1,0x3f4e1689,0x3f425b89,0x3f3592e7
.long 0x3f3b8f3b,0x3f299415,0x3f15f6d9,0x3f00e7e4,0x3f17de12,0x3efafef7,0x3ec27b55,0x3e870ada,0x3eddbe79,0x3e97a117,0x3e1c76de,0x3bc90f88,0x3e840270,0x3db5f8da,0xbda973ba,0xbe80f8c0
.long 0x3d96a905,0xbdfab273,0xbea09ae5,0xbefc5d27,0xbde7fa9a,0xbea80b1f,0xbf06f686,0xbf33587a,0xbe97a117,0xbf04f484,0xbf36206c,0xbf5c61c7,0xbeeff7fb,0xbf2ff3e6,0xbf5b2c79,0xbf76841b
.long 0xbf1ff6cb,0xbf531849,0xbf740bdd,0xbf7ffb11,0xbf425b89,0xbf6cd007,0xbf7f5ce9,0xbf7822d1,0xbf5df6be,0xbf7bf531,0xbf7c7eb0,0xbf5f8327,0xbf71d19f,0xbf7fdaaf,0xbf6b99fb,0xbf37c655
.long 0x3f800000,0x3f800000,0x3f800000,0x3f800000,0x3f75a67b,0x3f73ced9,0x3f71d19f,0x3f6faf1b,0x3f577026,0x3f5064af,0x3f48d8b3,0x3f40d0da,0x3f27ce61,0x3f19210f,0x3f099f4e,0x3ef2bd43
.long 0x3ed53641,0x3ea68f12,0x3e6c9a7f,0x3e09cf86,0x3e1324ca,0x3cafea69,0xbdcefdb7,0xbe636c83,0xbe1008b7,0xbe919ddd,0xbed8106b,0xbf0cead0,0xbed3c867,0xbf102dd5,0xbf3238aa,0xbf4f0417
.long 0xbf273656,0xbf49d112,0xbf64aa59,0xbf76ba07,0xbf570348,0xbf703b37,0xbf7dc68c,0xbf7efcc9,0xbf756d97,0xbf7fc38f,0xbf7ac516,0xbf66becc,0xbf7fffb1,0xbf76ef5b,0xbf5bfb34,0xbf311722
.long 0xbf75dec6,0xbf5695e5,0xbf24d225,0xbec9b953,0xbf57dc7f,0xbf21cbfb,0xbeb6ccc3,0xbd3c6dd5,0xbf286605,0xbebb31a0,0xbcfb49ba,0x3e9d9e78,0xbed6a399,0xbd83db0a,0x3e9920fe,0x3f1f599f
.long 0x0,0x0,0x0,0x0,0xbc16cb58,0x3c7b514b,0x3d2351cb,0x3d83db0a,0xbc96c9b6,0x3cfb49ba,0x3da3308c,0x3e039502,0xbce22a7a,0x3d3c6dd5,0x3df475c0,0x3e44b0b9
.long 0xbd16c32c,0x3d7b2b74,0x3e22abb6,0x3e827dc0,0xbd3c6dd5,0x3d9cecf9,0x3e4ada4f,0x3ea21887,0xbd621469,0x3dbc3ac3,0x3e72b651,0x3ec1071e,0xbd83db0a,0x3ddb7d37,0x3e8d17c0,0x3edf28a9
.long 0xbd96a905,0x3dfab273,0x3ea09ae5,0x3efc5d27,0xbda973ba,0x3e0cec4a,0x3eb3dca5,0x3f0c42c9,0xbdbc3ac3,0x3e1c76de,0x3ec6d529,0x3f19c200,0xbdcefdb7,0x3e2bf804,0x3ed97cb9,0x3f269de3
.long 0xbde1bc2e,0x3e3b6ecf,0x3eebcbbb,0x3f32c8c9,0xbdf475c0,0x3e4ada4f,0x3efdbabb,0x3f3e35c5,0xbe039502,0x3e5a3997,0x3f07a136,0x3f48d8b3,0xbe0cec4a,0x3e698bba,0x3f102dd5,0x3f52a649
.long 0x0,0x0,0x0,0x0,0x3db5f8da,0x3de7fa9a,0x3e0cec4a,0x3e25c58c,0x3e354098,0x3e667c66,0x3e8b9507,0x3ea395c5,0x3e870ada,0x3eab0201,0x3ece0bea,0x3eeff7fb
.long 0x3eb263ef,0x3ee0924f,0x3f064b82,0x3f1b02c6,0x3edc53c1,0x3f099f4e,0x3f2302d3,0x3f39f2ac,0x3f0242b1,0x3f212ff9,0x3f3ca003,0x3f53fac3,0x3f1553b7,0x3f36ad7f,0x3f52a649,0x3f686b39
.long 0x3f273656,0x3f49d112,0x3f64aa59,0x3f76ba07,0x3f37c655,0x3f5a5ba0,0x3f725470,0x3f7e868b,0x3f46e22a,0x3f6816a8,0x3f7b61fc,0x3f7f9c18,0x3f546b3b,0x3f72d4eb,0x3f7fa6e3,0x3f79f35e
.long 0x3f604621,0x3f7a7302,0x3f7f0e58,0x3f6db293,0x3f6a5ad9,0x3f7ed7d4,0x3f799b43,0x3f5b2c79,0x3f7294f8,0x3f7ff4e6,0x3f6f6830,0x3f42de29,0x3f78e3d6,0x3f7dc68c,0x3f60a6cf,0x3f256bcb
.long 0x0,0x0,0x0,0x0,0x3e3e853e,0x3e57278f,0x3e6fa8b2,0x3e840270,0x3ebb31a0,0x3ed25a09,0x3ee900b7,0x3eff17b2,0x3f084b92,0x3f17de12,0x3f269de3,0x3f34768f
.long 0x3f2e3bde,0x3f3fc767,0x3f4f7a1f,0x3f5d2d53,0x3f4e1689,0x3f5f20db,0x3f6cd007,0x3f76ef5b,0x3f66becc,0x3f748422,0x3f7cfe73,0x3f7ffec4,0x3f77583a,0x3f7efcc9,0x3f7f1f49,0x3f77beb7
.long 0x3f7f4e6d,0x3f7e1324,0x3f731447,0x3f5ebe05,0x3f7e5a38,0x3f71d19f,0x3f5988ad,0x3f36ad7f,0x3f748422,0x3f5ac450,0x3f33e7bc,0x3f0242b1,0x3f62241a,0x3f39f2ac,0x3f044889,0x3e8a11f7
.long 0x3f47de65,0x3f10d3cd,0x3e9aa086,0x3c490e90,0x3f269de3,0x3ec27b55,0x3d9064b4,0xbe7bdba4,0x3eff17b2,0x3e354098,0xbe28defc,0xbef9a02d,0x3ea80b1f,0xbd0a342f,0xbec8477c,0xbf3238aa
.long 0x0,0x0,0x0,0x0,0x3e901c2c,0x3e9c1faf,0x3ea80b1f,0x3eb3dca5,0x3f0a48ad,0x3f14b039,0x3f1ebc12,0x3f286605,0x3f4154e1,0x3f4d26fd,0x3f57dc7f,0x3f61668a
.long 0x3f68bf3c,0x3f721352,0x3f791298,0x3f7dabcc,0x3f7d57de,0x3f7ff0e3,0x3f7eb069,0x3f799b43,0x3f7d7474,0x3f756d97,0x3f6816a8,0x3f55b993,0x3f6912ae,0x3f5389c7,0x3f37c655,0x3f16999f
.long 0x3f41d870,0x3f1d7fd1,0x3ee63375,0x3e888e93,0x3f0af1b7,0x3eb0eacb,0x3e06b26e,0xbdb5f8da,0x3e919ddd,0x3d2fe007,0xbe4dee60,0xbeddbe79,0x3b490fc6,0xbe870ada,0xbf02ef9f,0xbf38dd65
.long 0xbe8e9a22,0xbf0b9a6b,0xbf43e200,0xbf6b4b0c,0xbf099f4e,0xbf466354,0xbf6f20b0,0xbf7fba9e,0xbf40d0da,0xbf6e46be,0xbf7fe129,0xbf73913f,0xbf686b39,0xbf7f7808,0xbf74484b,0xbf485bca
.long 0x3f80,0xbdc93f7f,0xbe483f7b,0xbe953f75,0x3f80,0x3e953f75,0x3f0e3f55,0x3f463f22,0x3f80,0x3f223f46,0x3f7b3e48,0x3f62bef1,0x3f80,0x3f623ef1,0x3f55bf0e,0xbdc9bf7f
.long 0x3f80,0x3f7f3dc9,0x3e48bf7b,0xbf75be95,0x3f80,0x3f75be95,0xbf0ebf55,0xbf223f46,0x3f80,0x3f46bf22,0xbf7bbe48,0x3ef13f62,0x3f80,0x3ef1bf62,0xbf553f0e,0x3f7fbdc9
.long 0x3f80,0x3dc9bf7f,0xbe483f7b,0x3e95bf75,0x3f80,0xbe95bf75,0x3f0e3f55,0xbf46bf22,0x3f80,0xbf22bf46,0x3f7b3e48,0xbf623ef1,0x3f80,0xbf62bef1,0x3f55bf0e,0x3dc93f7f
.long 0x3f80,0xbf7fbdc9,0x3e48bf7b,0x3f753e95,0x3f80,0xbf753e95,0xbf0ebf55,0x3f22bf46,0x3f80,0xbf463f22,0xbf7bbe48,0xbef1bf62,0x3f80,0xbef13f62,0xbf553f0e,0xbf7f3dc9
.long 0xbec43f6d,0xbef13f62,0xbf0e3f55,0xbf223f46,0x3f6d3ec4,0x3f7f3dc9,0x3f7bbe48,0x3f62bef1,0x3ec4bf6d,0xbe95bf75,0xbf55bf0e,0xbf7f3dc9,0xbf6dbec4,0xbf463f22,0x3e483f7b,0x3f753e95
.long 0xbec43f6d,0x3f623ef1,0x3f0ebf55,0xbf46bf22,0x3f6d3ec4,0x3dc9bf7f,0xbf7b3e48,0x3ef13f62,0x3ec4bf6d,0xbf753e95,0x3f553f0e,0xbdc9bf7f,0xbf6dbec4,0x3f223f46,0xbe48bf7b,0xbe953f75
.long 0xbec43f6d,0x3ef1bf62,0xbf0e3f55,0x3f22bf46,0x3f6d3ec4,0xbf7fbdc9,0x3f7bbe48,0xbf623ef1,0x3ec4bf6d,0x3e953f75,0xbf55bf0e,0x3f7fbdc9,0xbf6dbec4,0x3f46bf22,0x3e483f7b,0xbf75be95
.long 0xbec43f6d,0xbf62bef1,0x3f0ebf55,0x3f463f22,0x3f6d3ec4,0xbdc93f7f,0xbf7b3e48,0xbef1bf62,0x3ec4bf6d,0x3f75be95,0x3f553f0e,0x3dc93f7f,0xbf6dbec4,0xbf22bf46,0xbe48bf7b,0x3e95bf75
.long 0xbf353f35,0xbf463f22,0xbf553f0e,0xbf623ef1,0x3f35bf35,0x3ef1bf62,0x3e48bf7b,0xbdc9bf7f,0xbf353f35,0xbdc93f7f,0x3f0e3f55,0x3f753e95,0x3f35bf35,0xbe95bf75,0xbf7bbe48,0xbf223f46
.long 0xbf353f35,0x3f223f46,0x3f55bf0e,0xbef1bf62,0x3f35bf35,0xbf62bef1,0xbe483f7b,0x3f7fbdc9,0xbf353f35,0x3f7f3dc9,0xbf0ebf55,0xbe953f75,0x3f35bf35,0xbf753e95,0x3f7b3e48,0xbf46bf22
.long 0xbf353f35,0x3f46bf22,0xbf553f0e,0x3f62bef1,0x3f35bf35,0xbef13f62,0x3e48bf7b,0x3dc93f7f,0xbf353f35,0x3dc9bf7f,0x3f0e3f55,0xbf75be95,0x3f35bf35,0x3e953f75,0xbf7bbe48,0x3f22bf46
.long 0xbf353f35,0xbf22bf46,0x3f55bf0e,0x3ef13f62,0x3f35bf35,0x3f623ef1,0xbe483f7b,0xbf7f3dc9,0xbf353f35,0xbf7fbdc9,0xbf0ebf55,0x3e95bf75,0x3f35bf35,0x3f75be95,0x3f7b3e48,0x3f463f22
.long 0xbf6d3ec4,0xbf753e95,0xbf7b3e48,0xbf7f3dc9,0xbec4bf6d,0xbf22bf46,0xbf55bf0e,0xbf75be95,0x3f6dbec4,0x3ef1bf62,0xbe48bf7b,0xbf46bf22,0x3ec43f6d,0x3f7f3dc9,0x3f0ebf55,0xbef1bf62
.long 0xbf6d3ec4,0x3e953f75,0x3f7bbe48,0xbdc9bf7f,0xbec4bf6d,0xbf463f22,0x3f553f0e,0x3e95bf75,0x3f6dbec4,0xbf62bef1,0x3e483f7b,0x3f22bf46,0x3ec43f6d,0x3dc9bf7f,0xbf0e3f55,0x3f62bef1
.long 0xbf6d3ec4,0x3f75be95,0xbf7b3e48,0x3f7fbdc9,0xbec4bf6d,0x3f223f46,0xbf55bf0e,0x3f753e95,0x3f6dbec4,0xbef13f62,0xbe48bf7b,0x3f463f22,0x3ec43f6d,0xbf7fbdc9,0x3f0ebf55,0x3ef13f62
.long 0xbf6d3ec4,0xbe95bf75,0x3f7bbe48,0x3dc93f7f,0xbec4bf6d,0x3f46bf22,0x3f553f0e,0xbe953f75,0x3f6dbec4,0x3f623ef1,0x3e483f7b,0xbf223f46,0x3ec43f6d,0xbdc93f7f,0xbf0e3f55,0xbf623ef1
.long 0x3f808000,0x3f7f3dc9,0x3f7b3e48,0x3f753e95,0x3f808000,0x3f75be95,0x3f55bf0e,0x3f22bf46,0x3f808000,0x3f46bf22,0x3e48bf7b,0xbef1bf62,0x3f808000,0x3ef1bf62,0xbf0ebf55,0xbf7f3dc9
.long 0x3f808000,0x3dc9bf7f,0xbf7bbe48,0xbe953f75,0x3f808000,0xbe95bf75,0xbf553f0e,0x3f463f22,0x3f808000,0xbf22bf46,0xbe483f7b,0x3f62bef1,0x3f808000,0xbf62bef1,0x3f0e3f55,0xbdc9bf7f
.long 0x3f808000,0xbf7fbdc9,0x3f7b3e48,0xbf75be95,0x3f808000,0xbf753e95,0x3f55bf0e,0xbf223f46,0x3f808000,0xbf463f22,0x3e48bf7b,0x3ef13f62,0x3f808000,0xbef13f62,0xbf0ebf55,0x3f7fbdc9
.long 0x3f808000,0xbdc93f7f,0xbf7bbe48,0x3e95bf75,0x3f808000,0x3e953f75,0xbf553f0e,0xbf46bf22,0x3f808000,0x3f223f46,0xbe483f7b,0xbf623ef1,0x3f808000,0x3f623ef1,0x3f0e3f55,0x3dc93f7f
.long 0x3f6d3ec4,0x3f623ef1,0x3f553f0e,0x3f463f22,0x3ec4bf6d,0x3dc9bf7f,0xbe48bf7b,0xbef1bf62,0xbf6dbec4,0xbf753e95,0xbf0e3f55,0x3dc93f7f,0xbec43f6d,0x3f223f46,0x3f7bbe48,0x3e95bf75
.long 0x3f6d3ec4,0x3ef1bf62,0xbf55bf0e,0xbf223f46,0x3ec4bf6d,0xbf7fbdc9,0x3e483f7b,0x3f62bef1,0xbf6dbec4,0x3e953f75,0x3f0ebf55,0xbf7f3dc9,0xbec43f6d,0x3f46bf22,0xbf7b3e48,0x3f753e95
.long 0x3f6d3ec4,0xbf62bef1,0x3f553f0e,0xbf46bf22,0x3ec4bf6d,0xbdc93f7f,0xbe48bf7b,0x3ef13f62,0xbf6dbec4,0x3f75be95,0xbf0e3f55,0xbdc9bf7f,0xbec43f6d,0xbf22bf46,0x3f7bbe48,0xbe953f75
.long 0x3f6d3ec4,0xbef13f62,0xbf55bf0e,0x3f22bf46,0x3ec4bf6d,0x3f7f3dc9,0x3e483f7b,0xbf623ef1,0xbf6dbec4,0xbe95bf75,0x3f0ebf55,0x3f7fbdc9,0xbec43f6d,0xbf463f22,0xbf7b3e48,0xbf75be95
.long 0x3f353f35,0x3f223f46,0x3f0e3f55,0x3ef13f62,0xbf35bf35,0xbf62bef1,0xbf7bbe48,0xbf7f3dc9,0x3f353f35,0x3f7f3dc9,0x3f55bf0e,0x3e95bf75,0xbf35bf35,0xbf753e95,0xbe483f7b,0x3f463f22
.long 0x3f353f35,0x3f46bf22,0xbf0ebf55,0xbf623ef1,0xbf35bf35,0xbef13f62,0x3f7b3e48,0xbdc9bf7f,0x3f353f35,0x3dc9bf7f,0xbf553f0e,0x3f753e95,0xbf35bf35,0x3e953f75,0x3e48bf7b,0xbf223f46
.long 0x3f353f35,0xbf22bf46,0x3f0e3f55,0xbef1bf62,0xbf35bf35,0x3f623ef1,0xbf7bbe48,0x3f7fbdc9,0x3f353f35,0xbf7fbdc9,0x3f55bf0e,0xbe953f75,0xbf35bf35,0x3f75be95,0xbe483f7b,0xbf46bf22
.long 0x3f353f35,0xbf463f22,0xbf0ebf55,0x3f62bef1,0xbf35bf35,0x3ef1bf62,0x3f7b3e48,0x3dc93f7f,0x3f353f35,0xbdc93f7f,0xbf553f0e,0xbf75be95,0xbf35bf35,0xbe95bf75,0x3e48bf7b,0x3f22bf46
.long 0x3ec43f6d,0x3e953f75,0x3e483f7b,0x3dc93f7f,0xbf6d3ec4,0xbf463f22,0xbf0e3f55,0xbe953f75,0xbec4bf6d,0xbf62bef1,0xbf7b3e48,0xbf223f46,0x3f6dbec4,0x3dc9bf7f,0xbf55bf0e,0xbf623ef1
.long 0x3ec43f6d,0x3f75be95,0xbe48bf7b,0xbf7f3dc9,0xbf6d3ec4,0x3f223f46,0x3f0ebf55,0xbf75be95,0xbec4bf6d,0xbef13f62,0x3f7bbe48,0xbf46bf22,0x3f6dbec4,0xbf7fbdc9,0x3f553f0e,0xbef1bf62
.long 0x3ec43f6d,0xbe95bf75,0x3e483f7b,0xbdc9bf7f,0xbf6d3ec4,0x3f46bf22,0xbf0e3f55,0x3e95bf75,0xbec4bf6d,0x3f623ef1,0xbf7b3e48,0x3f22bf46,0x3f6dbec4,0xbdc93f7f,0xbf55bf0e,0x3f62bef1
.long 0x3ec43f6d,0xbf753e95,0xbe48bf7b,0x3f7fbdc9,0xbf6d3ec4,0xbf22bf46,0x3f0ebf55,0x3f753e95,0xbec4bf6d,0x3ef1bf62,0x3f7bbe48,0x3f463f22,0x3f6dbec4,0x3f7f3dc9,0x3f553f0e,0x3ef13f62
.long 0x80003f80,0x80003f80,0x80003f80,0x80003f80,0x3dc93f7f,0xbe953f75,0xbf223f46,0xbf623ef1,0x3e483f7b,0xbf0e3f55,0xbf7b3e48,0xbf55bf0e,0x3e953f75,0xbf463f22,0xbf62bef1,0x3dc9bf7f
.long 0x3ec43f6d,0xbf6d3ec4,0xbec4bf6d,0x3f6dbec4,0x3ef13f62,0xbf7f3dc9,0x3e95bf75,0x3f463f22,0x3f0e3f55,0xbf7bbe48,0x3f55bf0e,0xbe483f7b,0x3f223f46,0xbf62bef1,0x3f7f3dc9,0xbf753e95
.long 0x3f353f35,0xbf35bf35,0x3f353f35,0xbf35bf35,0x3f463f22,0xbef1bf62,0x3dc93f7f,0x3e95bf75,0x3f553f0e,0xbe48bf7b,0xbf0e3f55,0x3f7bbe48,0x3f623ef1,0x3dc9bf7f,0xbf753e95,0x3f223f46
.long 0x3f6d3ec4,0x3ec4bf6d,0xbf6dbec4,0xbec43f6d,0x3f753e95,0x3f22bf46,0xbef1bf62,0xbf7f3dc9,0x3f7b3e48,0x3f55bf0e,0x3e48bf7b,0xbf0ebf55,0x3f7f3dc9,0x3f75be95,0x3f46bf22,0x3ef1bf62
.long 0x80003f80,0x80003f80,0x80003f80,0x80003f80,0xbf7f3dc9,0xbf75be95,0xbf46bf22,0xbef1bf62,0xbe48bf7b,0x3f0ebf55,0x3f7bbe48,0x3f553f0e,0x3f75be95,0x3f223f46,0xbef13f62,0xbf7fbdc9
.long 0x3ec43f6d,0xbf6d3ec4,0xbec4bf6d,0x3f6dbec4,0xbf623ef1,0xbdc9bf7f,0x3f753e95,0xbf223f46,0xbf0ebf55,0x3f7b3e48,0xbf553f0e,0x3e48bf7b,0x3f46bf22,0xbef13f62,0x3dc9bf7f,0x3e953f75
.long 0x3f353f35,0xbf35bf35,0x3f353f35,0xbf35bf35,0xbf223f46,0x3f62bef1,0xbf7f3dc9,0x3f753e95,0xbf55bf0e,0x3e483f7b,0x3f0ebf55,0xbf7b3e48,0x3ef1bf62,0xbf7fbdc9,0x3e953f75,0x3f46bf22
.long 0x3f6d3ec4,0x3ec4bf6d,0xbf6dbec4,0xbec43f6d,0xbe953f75,0x3f463f22,0x3f62bef1,0xbdc9bf7f,0xbf7bbe48,0xbf553f0e,0xbe483f7b,0x3f0e3f55,0x3dc9bf7f,0xbe95bf75,0xbf22bf46,0xbf62bef1
.long 0x80003f80,0x80003f80,0x80003f80,0x80003f80,0xbdc9bf7f,0x3e95bf75,0x3f22bf46,0x3f62bef1,0x3e483f7b,0xbf0e3f55,0xbf7b3e48,0xbf55bf0e,0xbe95bf75,0x3f46bf22,0x3f623ef1,0xbdc93f7f
.long 0x3ec43f6d,0xbf6d3ec4,0xbec4bf6d,0x3f6dbec4,0xbef1bf62,0x3f7fbdc9,0xbe953f75,0xbf46bf22,0x3f0e3f55,0xbf7bbe48,0x3f55bf0e,0xbe483f7b,0xbf22bf46,0x3f623ef1,0xbf7fbdc9,0x3f75be95
.long 0x3f353f35,0xbf35bf35,0x3f353f35,0xbf35bf35,0xbf46bf22,0x3ef13f62,0xbdc9bf7f,0xbe953f75,0x3f553f0e,0xbe48bf7b,0xbf0e3f55,0x3f7bbe48,0xbf62bef1,0xbdc93f7f,0x3f75be95,0xbf22bf46
.long 0x3f6d3ec4,0x3ec4bf6d,0xbf6dbec4,0xbec43f6d,0xbf75be95,0xbf223f46,0x3ef13f62,0x3f7fbdc9,0x3f7b3e48,0x3f55bf0e,0x3e48bf7b,0xbf0ebf55,0xbf7fbdc9,0xbf753e95,0xbf463f22,0xbef13f62
.long 0x80003f80,0x80003f80,0x80003f80,0x80003f80,0x3f7fbdc9,0x3f753e95,0x3f463f22,0x3ef13f62,0xbe48bf7b,0x3f0ebf55,0x3f7bbe48,0x3f553f0e,0xbf753e95,0xbf22bf46,0x3ef1bf62,0x3f7f3dc9
.long 0x3ec43f6d,0xbf6d3ec4,0xbec4bf6d,0x3f6dbec4,0x3f62bef1,0x3dc93f7f,0xbf75be95,0x3f22bf46,0xbf0ebf55,0x3f7b3e48,0xbf553f0e,0x3e48bf7b,0xbf463f22,0x3ef1bf62,0xbdc93f7f,0xbe95bf75
.long 0x3f353f35,0xbf35bf35,0x3f353f35,0xbf35bf35,0x3f22bf46,0xbf623ef1,0x3f7fbdc9,0xbf75be95,0xbf55bf0e,0x3e483f7b,0x3f0ebf55,0xbf7b3e48,0xbef13f62,0x3f7f3dc9,0xbe95bf75,0xbf463f22
.long 0x3f6d3ec4,0x3ec4bf6d,0xbf6dbec4,0xbec43f6d,0x3e95bf75,0xbf46bf22,0xbf623ef1,0x3dc93f7f,0xbf7bbe48,0xbf553f0e,0xbe483f7b,0x3f0e3f55,0xbdc93f7f,0x3e953f75,0x3f223f46,0x3f623ef1
.long 0x3f800000,0x3f800000,0x3f800000,0x3f800000,0x3f7fbdc9,0x3f753e95,0x3f463f22,0x3ef13f62,0x3f7bbe48,0x3f553f0e,0x3e483f7b,0xbf0e3f55,0x3f75be95,0x3f223f46,0xbef13f62,0xbf7fbdc9
.long 0x3f6dbec4,0x3ec43f6d,0xbf6d3ec4,0xbec4bf6d,0x3f62bef1,0x3dc93f7f,0xbf75be95,0x3f22bf46,0x3f55bf0e,0xbe483f7b,0xbf0ebf55,0x3f7b3e48,0x3f46bf22,0xbef13f62,0x3dc9bf7f,0x3e953f75
.long 0x3f35bf35,0xbf353f35,0x3f35bf35,0xbf353f35,0x3f22bf46,0xbf623ef1,0x3f7fbdc9,0xbf75be95,0x3f0ebf55,0xbf7b3e48,0x3f553f0e,0xbe48bf7b,0x3ef1bf62,0xbf7fbdc9,0x3e953f75,0x3f46bf22
.long 0x3ec4bf6d,0xbf6dbec4,0xbec43f6d,0x3f6d3ec4,0x3e95bf75,0xbf46bf22,0xbf623ef1,0x3dc93f7f,0x3e48bf7b,0xbf0ebf55,0xbf7bbe48,0xbf553f0e,0x3dc9bf7f,0xbe95bf75,0xbf22bf46,0xbf62bef1
.long 0x3f800000,0x3f800000,0x3f800000,0x3f800000,0x3dc93f7f,0xbe953f75,0xbf223f46,0xbf623ef1,0xbf7b3e48,0xbf55bf0e,0xbe48bf7b,0x3f0ebf55,0xbe95bf75,0x3f46bf22,0x3f623ef1,0xbdc93f7f
.long 0x3f6dbec4,0x3ec43f6d,0xbf6d3ec4,0xbec4bf6d,0x3ef13f62,0xbf7f3dc9,0x3e95bf75,0x3f463f22,0xbf553f0e,0x3e48bf7b,0x3f0e3f55,0xbf7bbe48,0xbf22bf46,0x3f623ef1,0xbf7fbdc9,0x3f75be95
.long 0x3f35bf35,0xbf353f35,0x3f35bf35,0xbf353f35,0x3f463f22,0xbef1bf62,0x3dc93f7f,0x3e95bf75,0xbf0e3f55,0x3f7bbe48,0xbf55bf0e,0x3e483f7b,0xbf62bef1,0xbdc93f7f,0x3f75be95,0xbf22bf46
.long 0x3ec4bf6d,0xbf6dbec4,0xbec43f6d,0x3f6d3ec4,0x3f753e95,0x3f22bf46,0xbef1bf62,0xbf7f3dc9,0xbe483f7b,0x3f0e3f55,0x3f7b3e48,0x3f55bf0e,0xbf7fbdc9,0xbf753e95,0xbf463f22,0xbef13f62
.long 0x3f800000,0x3f800000,0x3f800000,0x3f800000,0xbf7f3dc9,0xbf75be95,0xbf46bf22,0xbef1bf62,0x3f7bbe48,0x3f553f0e,0x3e483f7b,0xbf0e3f55,0xbf753e95,0xbf22bf46,0x3ef1bf62,0x3f7f3dc9
.long 0x3f6dbec4,0x3ec43f6d,0xbf6d3ec4,0xbec4bf6d,0xbf623ef1,0xbdc9bf7f,0x3f753e95,0xbf223f46,0x3f55bf0e,0xbe483f7b,0xbf0ebf55,0x3f7b3e48,0xbf463f22,0x3ef1bf62,0xbdc93f7f,0xbe95bf75
.long 0x3f35bf35,0xbf353f35,0x3f35bf35,0xbf353f35,0xbf223f46,0x3f62bef1,0xbf7f3dc9,0x3f753e95,0x3f0ebf55,0xbf7b3e48,0x3f553f0e,0xbe48bf7b,0xbef13f62,0x3f7f3dc9,0xbe95bf75,0xbf463f22
.long 0x3ec4bf6d,0xbf6dbec4,0xbec43f6d,0x3f6d3ec4,0xbe953f75,0x3f463f22,0x3f62bef1,0xbdc9bf7f,0x3e48bf7b,0xbf0ebf55,0xbf7bbe48,0xbf553f0e,0xbdc93f7f,0x3e953f75,0x3f223f46,0x3f623ef1
.long 0x3f800000,0x3f800000,0x3f800000,0x3f800000,0xbdc9bf7f,0x3e95bf75,0x3f22bf46,0x3f62bef1,0xbf7b3e48,0xbf55bf0e,0xbe48bf7b,0x3f0ebf55,0x3e953f75,0xbf463f22,0xbf62bef1,0x3dc9bf7f
.long 0x3f6dbec4,0x3ec43f6d,0xbf6d3ec4,0xbec4bf6d,0xbef1bf62,0x3f7fbdc9,0xbe953f75,0xbf46bf22,0xbf553f0e,0x3e48bf7b,0x3f0e3f55,0xbf7bbe48,0x3f223f46,0xbf62bef1,0x3f7f3dc9,0xbf753e95
.long 0x3f35bf35,0xbf353f35,0x3f35bf35,0xbf353f35,0xbf46bf22,0x3ef13f62,0xbdc9bf7f,0xbe953f75,0xbf0e3f55,0x3f7bbe48,0xbf55bf0e,0x3e483f7b,0x3f623ef1,0x3dc9bf7f,0xbf753e95,0x3f223f46
.long 0x3ec4bf6d,0xbf6dbec4,0xbec43f6d,0x3f6d3ec4,0xbf75be95,0xbf223f46,0x3ef13f62,0x3f7fbdc9,0xbe483f7b,0x3f0e3f55,0x3f7b3e48,0x3f55bf0e,0x3f7f3dc9,0x3f75be95,0x3f46bf22,0x3ef1bf62
.long 0x3f800000,0x3f7ffec4,0x3f7ffb11,0x3f7ff4e6,0x3f800000,0x3f7ff4e6,0x3f7fd397,0x3f7f9c18,0x3f800000,0x3f7fc38f,0x3f7f0e58,0x3f7de0b1,0x3f800000,0x3f7f6ac7,0x3f7dabcc,0x3f7ac516
.long 0x3f800000,0x3f7eea9d,0x3f7baccd,0x3f764d97,0x3f800000,0x3f7e4323,0x3f791298,0x3f708066,0x3f800000,0x3f7d7474,0x3f75dec6,0x3f696591,0x3f800000,0x3f7c7eb0,0x3f721352,0x3f6106f2
.long 0x3f800000,0x3f7b61fc,0x3f6db293,0x3f577026,0x3f800000,0x3f7a1e84,0x3f68bf3c,0x3f4cae79,0x3f800000,0x3f78b47b,0x3f633c5a,0x3f40d0da,0x3f800000,0x3f772417,0x3f5d2d53,0x3f33e7bc
.long 0x3f800000,0x3f756d97,0x3f5695e5,0x3f26050a,0x3f800000,0x3f73913f,0x3f4f7a1f,0x3f173c07,0x3f800000,0x3f718f57,0x3f47de65,0x3f07a136,0x3f800000,0x3f6f6830,0x3f3fc767,0x3eee9479
.long 0x3f7fec43,0x3f7fe129,0x3f7fd397,0x3f7fc38f,0x3f7f4e6d,0x3f7eea9d,0x3f7e70b0,0x3f7de0b1,0x3f7c3b28,0x3f7a1e84,0x3f778bc5,0x3f748422,0x3f76ba07,0x3f718f57,0x3f6b4b0c,0x3f63f473
.long 0x3f6ed89e,0x3f655e0b,0x3f59f26a,0x3f4cae79,0x3f64aa59,0x3f55b993,0x3f43e200,0x3f2f61a5,0x3f584853,0x3f42de29,0x3f299415,0x3f0cead0,0x3f49d112,0x3f2d1469,0x3f0b9a6b,0x3ecc9b8b
.long 0x3f396842,0x3f14b039,0x3ed53641,0x3e72b651,0x3f273656,0x3ef41f07,0x3e8e9a22,0x3d8a200a,0x3f13682a,0x3ebb31a0,0x3e09cf86,0xbdd53db9,0x3efc5d27,0x3e7ee6e1,0xbc490e90,0xbe8b9507
.long 0x3ecf7bca,0x3e039502,0xbe22abb6,0xbeddbe79,0x3ea09ae5,0x3bc90f88,0xbe9aa086,0xbf14b039,0x3e605c13,0xbdee3876,0xbee0924f,0xbf36206c,0x3dfab273,0xbe72b651,0xbf10d3cd,0xbf5233c6
.long 0x3f7fb10f,0x3f7f9c18,0x3f7f84ab,0x3f7f6ac7,0x3f7d3aac,0x3f7c7eb0,0x3f7baccd,0x3f7ac516,0x3f710908,0x3f6d1c1d,0x3f68bf3c,0x3f63f473,0x3f5b941a,0x3f5233c6,0x3f47de65,0x3f3ca003
.long 0x3f3daef9,0x3f2d1469,0x3f1b02c6,0x3f07a136,0x3f187fc0,0x3eff17b2,0x3ec9b953,0x3e919ddd,0x3edae880,0x3e97a117,0x3e22abb6,0x3c96c9b6,0x3e78cfcc,0x3da3308c,0xbdafb680,0xbe7ee6e1
.long 0x3d48fb30,0xbe1008b7,0xbea68f12,0xbeff17b2,0xbe164083,0xbeb554ec,0xbf0b9a6b,0xbf36206c,0xbeac7cd4,0xbf0cead0,0xbf3b8f3b,0xbf5f8327,0xbf039c3d,0xbf385216,0xbf604621,0xbf78b47b
.long 0xbf2beb4a,0xbf5ac450,0xbf778bc5,0xbf7fe129,0xbf4d9f02,0xbf7294f8,0xbf7ffb11,0xbf748422,0xbf676bd8,0xbf7e9bc9,0xbf791298,0xbf577026,0xbf7853f8,0xbf7e4323,0xbf633c5a,0xbf2ac082
.long 0x3f7f4e6d,0x3f7f2f9d,0x3f7f0e58,0x3f7eea9d,0x3f79c79d,0x3f78b47b,0x3f778bc5,0x3f764d97,0x3f5ebe05,0x3f591e6a,0x3f531849,0x3f4cae79,0x3f3085bb,0x3f239da9,0x3f15f6d9,0x3f07a136
.long 0x3ee63375,0x3ebb31a0,0x3e8e9a22,0x3e419b37,0x3e2f10a2,0x3d621469,0xbd7b2b74,0xbe354098,0xbdfab273,0xbe8586ce,0xbec9b953,0xbf04f484,0xbecf7bca,0xbf0cead0,0xbf2e3bde,0xbf4ac77f
.long 0xbf273656,0xbf48d8b3,0xbf633c5a,0xbf756d97,0xbf584853,0xbf708066,0xbf7dabcc,0xbf7f2f9d,0xbf76ba07,0xbf7fe129,0xbf7a7302,0xbf66becc,0xbf7fec43,0xbf756d97,0xbf59f26a,0xbf2f61a5
.long 0xbf731447,0xbf5233c6,0xbf1ff6cb,0xbec1071e,0xbf514d3d,0xbf19c200,0xbea68f12,0xbc96c9b6,0xbf1d7fd1,0xbea395c5,0x3c490e90,0x3eaf713a,0xbeb8442a,0xbbc90f88,0x3eb263ef,0x3f286605
.long 0x0,0xbbc90f88,0xbc490e90,0xbc96c9b6,0x0,0x3c96c9b6,0x3d16c32c,0x3d621469,0x0,0x3d2fe007,0x3dafb680,0x3e039502,0x0,0x3d8a200a,0x3e09cf86,0x3e4dee60
.long 0x0,0x3dbc3ac3,0x3e3b6ecf,0x3e8b9507,0x0,0x3dee3876,0x3e6c9a7f,0x3eaf713a,0x0,0x3e1008b7,0x3e8e9a22,0x3ed25a09,0x0,0x3e28defc,0x3ea68f12,0x3ef41f07
.long 0x0,0x3e419b37,0x3ebe1d4a,0x3f0a48ad,0x0,0x3e5a3997,0x3ed53641,0x3f19c200,0x0,0x3e72b651,0x3eebcbbb,0x3f286605,0x0,0x3e8586ce,0x3f00e7e4,0x3f36206c
.long 0x0,0x3e919ddd,0x3f0b9a6b,0x3f42de29,0x0,0x3e9d9e78,0x3f15f6d9,0x3f4e8d90,0x0,0x3ea986c4,0x3f1ff6cb,0x3f591e6a,0x0,0x3eb554ec,0x3f299415,0x3f628210
.long 0xbcc90ab0,0xbcfb49ba,0xbd16c32c,0xbd2fe007,0x3d96a905,0x3dbc3ac3,0x3de1bc2e,0x3e039502,0x3e2f10a2,0x3e5a3997,0x3e827dc0,0x3e97a117,0x3e888e93,0x3ea986c4,0x3ec9b953,0x3ee900b7
.long 0x3eb8442a,0x3ee363fa,0x3f064b82,0x3f19c200,0x3ee63375,0x3f0cead0,0x3f24d225,0x3f3a7ca4,0x3f08f59b,0x3f26050a,0x3f3fc767,0x3f55b993,0x3f1d7fd1,0x3f3ca003,0x3f5695e5,0x3f6aab7b
.long 0x3f3085bb,0x3f5064af,0x3f68bf3c,0x3f78b47b,0x3f41d870,0x3f6106f2,0x3f75dec6,0x3f7f6ac7,0x3f514d3d,0x3f6e46be,0x3f7dabcc,0x3f7e9bc9,0x3f5ebe05,0x3f77f110,0x3f7ffb11,0x3f764d97
.long 0x3f6a09a7,0x3f7de0b1,0x3f7cbfc9,0x3f66becc,0x3f731447,0x3f7ffec4,0x3f740bdd,0x3f5064af,0x3f79c79d,0x3f7e4323,0x3f660f88,0x3f33e7bc,0x3f7e1324,0x3f78b47b,0x3f531849,0x3f121eb0
.long 0xbd48fb30,0xbd621469,0xbd7b2b74,0xbd8a200a,0x3e164083,0x3e28defc,0x3e3b6ecf,0x3e4dee60,0x3eac7cd4,0x3ec1071e,0x3ed53641,0x3ee900b7,0x3f039c3d,0x3f121eb0,0x3f1ff6cb,0x3f2d1469
.long 0x3f2beb4a,0x3f3ca003,0x3f4bbbf8,0x3f591e6a,0x3f4d9f02,0x3f5df6be,0x3f6b4b0c,0x3f756d97,0x3f676bd8,0x3f748422,0x3f7cbfc9,0x3f7ff4e6,0x3f7853f8,0x3f7f2f9d,0x3f7f0e58,0x3f77f110
.long 0x3f7fb10f,0x3f7d7474,0x3f721352,0x3f5df6be,0x3f7d3aac,0x3f6f6830,0x3f5695e5,0x3f33e7bc,0x3f710908,0x3f55b993,0x3f2e3bde,0x3ef9a02d,0x3f5b941a,0x3f31a81d,0x3ef6e0cb,0x3e72b651
.long 0x3f3daef9,0x3f04f484,0x3e827dc0,0xbcfb49ba,0x3f187fc0,0x3ea395c5,0x3c490e90,0xbe97a117,0x3edae880,0x3dd53db9,0xbe6c9a7f,0xbf0a48ad,0x3e78cfcc,0xbdee3876,0xbeebcbbb,0xbf3ebc1b
.long 0xbd96a905,0xbda3308c,0xbdafb680,0xbdbc3ac3,0x3e605c13,0x3e72b651,0x3e827dc0,0x3e8b9507,0x3efc5d27,0x3f07a136,0x3f10d3cd,0x3f19c200,0x3f396842,0x3f44e3f5,0x3f4f7a1f,0x3f591e6a
.long 0x3f64aa59,0x3f6e46be,0x3f75dec6,0x3f7b61fc,0x3f7c3b28,0x3f7f9c18,0x3f7f84ab,0x3f7bf531,0x3f7e1324,0x3f772417,0x3f6b4b0c,0x3f5ac450,0x3f6a09a7,0x3f55b993,0x3f3b8f3b,0x3f1c420c
.long 0x3f41d870,0x3f1ebc12,0x3eebcbbb,0x3e919ddd,0x3f08f59b,0x3eaf713a,0x3e09cf86,0xbda3308c,0x3e888e93,0x3cfb49ba,0xbe541501,0xbeddbe79,0xbcc90ab0,0xbe919ddd,0xbf064b82,0xbf3a7ca4
.long 0xbea09ae5,0xbf121eb0,0xbf47de65,0xbf6d1c1d,0xbf13682a,0xbf4cae79,0xbf721352,0xbf7ff4e6,0xbf49d112,0xbf7294f8,0xbf7ffb11,0xbf708066,0xbf6ed89e,0xbf7ffec4,0xbf6ff573,0xbf40d0da
.long 0x3f800000,0x3f800000,0x3f800000,0x3f800000,0x3f7ffec4,0x3f7ff4e6,0x3f7fc38f,0x3f7f6ac7,0x3f7ffb11,0x3f7fd397,0x3f7f0e58,0x3f7dabcc,0x3f7ff4e6,0x3f7f9c18,0x3f7de0b1,0x3f7ac516
.long 0x3f7fec43,0x3f7f4e6d,0x3f7c3b28,0x3f76ba07,0x3f7fe129,0x3f7eea9d,0x3f7a1e84,0x3f718f57,0x3f7fd397,0x3f7e70b0,0x3f778bc5,0x3f6b4b0c,0x3f7fc38f,0x3f7de0b1,0x3f748422,0x3f63f473
.long 0x3f7fb10f,0x3f7d3aac,0x3f710908,0x3f5b941a,0x3f7f9c18,0x3f7c7eb0,0x3f6d1c1d,0x3f5233c6,0x3f7f84ab,0x3f7baccd,0x3f68bf3c,0x3f47de65,0x3f7f6ac7,0x3f7ac516,0x3f63f473,0x3f3ca003
.long 0x3f7f4e6d,0x3f79c79d,0x3f5ebe05,0x3f3085bb,0x3f7f2f9d,0x3f78b47b,0x3f591e6a,0x3f239da9,0x3f7f0e58,0x3f778bc5,0x3f531849,0x3f15f6d9,0x3f7eea9d,0x3f764d97,0x3f4cae79,0x3f07a136
.long 0x3f800000,0x3f800000,0x3f800000,0x3f800000,0x3f7eea9d,0x3f7e4323,0x3f7d7474,0x3f7c7eb0,0x3f7baccd,0x3f791298,0x3f75dec6,0x3f721352,0x3f764d97,0x3f708066,0x3f696591,0x3f6106f2
.long 0x3f6ed89e,0x3f64aa59,0x3f584853,0x3f49d112,0x3f655e0b,0x3f55b993,0x3f42de29,0x3f2d1469,0x3f59f26a,0x3f43e200,0x3f299415,0x3f0b9a6b,0x3f4cae79,0x3f2f61a5,0x3f0cead0,0x3ecc9b8b
.long 0x3f3daef9,0x3f187fc0,0x3edae880,0x3e78cfcc,0x3f2d1469,0x3eff17b2,0x3e97a117,0x3da3308c,0x3f1b02c6,0x3ec9b953,0x3e22abb6,0xbdafb680,0x3f07a136,0x3e919ddd,0x3c96c9b6,0xbe7ee6e1
.long 0x3ee63375,0x3e2f10a2,0xbdfab273,0xbecf7bca,0x3ebb31a0,0x3d621469,0xbe8586ce,0xbf0cead0,0x3e8e9a22,0xbd7b2b74,0xbec9b953,0xbf2e3bde,0x3e419b37,0xbe354098,0xbf04f484,0xbf4ac77f
.long 0x3f800000,0x3f800000,0x3f800000,0x3f800000,0x3f7b61fc,0x3f7a1e84,0x3f78b47b,0x3f772417,0x3f6db293,0x3f68bf3c,0x3f633c5a,0x3f5d2d53,0x3f577026,0x3f4cae79,0x3f40d0da,0x3f33e7bc
.long 0x3f396842,0x3f273656,0x3f13682a,0x3efc5d27,0x3f14b039,0x3ef41f07,0x3ebb31a0,0x3e7ee6e1,0x3ed53641,0x3e8e9a22,0x3e09cf86,0xbc490e90,0x3e72b651,0x3d8a200a,0xbdd53db9,0xbe8b9507
.long 0x3d48fb30,0xbe164083,0xbeac7cd4,0xbf039c3d,0xbe1008b7,0xbeb554ec,0xbf0cead0,0xbf385216,0xbea68f12,0xbf0b9a6b,0xbf3b8f3b,0xbf604621,0xbeff17b2,0xbf36206c,0xbf5f8327,0xbf78b47b
.long 0xbf273656,0xbf584853,0xbf76ba07,0xbf7fec43,0xbf48d8b3,0xbf708066,0xbf7fe129,0xbf756d97,0xbf633c5a,0xbf7dabcc,0xbf7a7302,0xbf59f26a,0xbf756d97,0xbf7f2f9d,0xbf66becc,0xbf2f61a5
.long 0x3f800000,0x3f800000,0x3f800000,0x3f800000,0x3f756d97,0x3f73913f,0x3f718f57,0x3f6f6830,0x3f5695e5,0x3f4f7a1f,0x3f47de65,0x3f3fc767,0x3f26050a,0x3f173c07,0x3f07a136,0x3eee9479
.long 0x3ecf7bca,0x3ea09ae5,0x3e605c13,0x3dfab273,0x3e039502,0x3bc90f88,0xbdee3876,0xbe72b651,0xbe22abb6,0xbe9aa086,0xbee0924f,0xbf10d3cd,0xbeddbe79,0xbf14b039,0xbf36206c,0xbf5233c6
.long 0xbf2beb4a,0xbf4d9f02,0xbf676bd8,0xbf7853f8,0xbf5ac450,0xbf7294f8,0xbf7e9bc9,0xbf7e4323,0xbf778bc5,0xbf7ffb11,0xbf791298,0xbf633c5a,0xbf7fe129,0xbf748422,0xbf577026,0xbf2ac082
.long 0xbf731447,0xbf514d3d,0xbf1d7fd1,0xbeb8442a,0xbf5233c6,0xbf19c200,0xbea395c5,0xbbc90f88,0xbf1ff6cb,0xbea68f12,0x3c490e90,0x3eb263ef,0xbec1071e,0xbc96c9b6,0x3eaf713a,0x3f286605
.long 0x0,0x0,0x0,0x0,0xbbc90f88,0x3c96c9b6,0x3d2fe007,0x3d8a200a,0xbc490e90,0x3d16c32c,0x3dafb680,0x3e09cf86,0xbc96c9b6,0x3d621469,0x3e039502,0x3e4dee60
.long 0xbcc90ab0,0x3d96a905,0x3e2f10a2,0x3e888e93,0xbcfb49ba,0x3dbc3ac3,0x3e5a3997,0x3ea986c4,0xbd16c32c,0x3de1bc2e,0x3e827dc0,0x3ec9b953,0xbd2fe007,0x3e039502,0x3e97a117,0x3ee900b7
.long 0xbd48fb30,0x3e164083,0x3eac7cd4,0x3f039c3d,0xbd621469,0x3e28defc,0x3ec1071e,0x3f121eb0,0xbd7b2b74,0x3e3b6ecf,0x3ed53641,0x3f1ff6cb,0xbd8a200a,0x3e4dee60,0x3ee900b7,0x3f2d1469
.long 0xbd96a905,0x3e605c13,0x3efc5d27,0x3f396842,0xbda3308c,0x3e72b651,0x3f07a136,0x3f44e3f5,0xbdafb680,0x3e827dc0,0x3f10d3cd,0x3f4f7a1f,0xbdbc3ac3,0x3e8b9507,0x3f19c200,0x3f591e6a
.long 0x0,0x0,0x0,0x0,0x3dbc3ac3,0x3dee3876,0x3e1008b7,0x3e28defc,0x3e3b6ecf,0x3e6c9a7f,0x3e8e9a22,0x3ea68f12,0x3e8b9507,0x3eaf713a,0x3ed25a09,0x3ef41f07
.long 0x3eb8442a,0x3ee63375,0x3f08f59b,0x3f1d7fd1,0x3ee363fa,0x3f0cead0,0x3f26050a,0x3f3ca003,0x3f064b82,0x3f24d225,0x3f3fc767,0x3f5695e5,0x3f19c200,0x3f3a7ca4,0x3f55b993,0x3f6aab7b
.long 0x3f2beb4a,0x3f4d9f02,0x3f676bd8,0x3f7853f8,0x3f3ca003,0x3f5df6be,0x3f748422,0x3f7f2f9d,0x3f4bbbf8,0x3f6b4b0c,0x3f7cbfc9,0x3f7f0e58,0x3f591e6a,0x3f756d97,0x3f7ff4e6,0x3f77f110
.long 0x3f64aa59,0x3f7c3b28,0x3f7e1324,0x3f6a09a7,0x3f6e46be,0x3f7f9c18,0x3f772417,0x3f55b993,0x3f75dec6,0x3f7f84ab,0x3f6b4b0c,0x3f3b8f3b,0x3f7b61fc,0x3f7bf531,0x3f5ac450,0x3f1c420c
.long 0x0,0x0,0x0,0x0,0x3e419b37,0x3e5a3997,0x3e72b651,0x3e8586ce,0x3ebe1d4a,0x3ed53641,0x3eebcbbb,0x3f00e7e4,0x3f0a48ad,0x3f19c200,0x3f286605,0x3f36206c
.long 0x3f3085bb,0x3f41d870,0x3f514d3d,0x3f5ebe05,0x3f5064af,0x3f6106f2,0x3f6e46be,0x3f77f110,0x3f68bf3c,0x3f75dec6,0x3f7dabcc,0x3f7ffb11,0x3f78b47b,0x3f7f6ac7,0x3f7e9bc9,0x3f764d97
.long 0x3f7fb10f,0x3f7d3aac,0x3f710908,0x3f5b941a,0x3f7d7474,0x3f6f6830,0x3f55b993,0x3f31a81d,0x3f721352,0x3f5695e5,0x3f2e3bde,0x3ef6e0cb,0x3f5df6be,0x3f33e7bc,0x3ef9a02d,0x3e72b651
.long 0x3f41d870,0x3f08f59b,0x3e888e93,0xbcc90ab0,0x3f1ebc12,0x3eaf713a,0x3cfb49ba,0xbe919ddd,0x3eebcbbb,0x3e09cf86,0xbe541501,0xbf064b82,0x3e919ddd,0xbda3308c,0xbeddbe79,0xbf3a7ca4
.long 0x0,0x0,0x0,0x0,0x3e919ddd,0x3e9d9e78,0x3ea986c4,0x3eb554ec,0x3f0b9a6b,0x3f15f6d9,0x3f1ff6cb,0x3f299415,0x3f42de29,0x3f4e8d90,0x3f591e6a,0x3f628210
.long 0x3f6a09a7,0x3f731447,0x3f79c79d,0x3f7e1324,0x3f7de0b1,0x3f7ffec4,0x3f7e4323,0x3f78b47b,0x3f7cbfc9,0x3f740bdd,0x3f660f88,0x3f531849,0x3f66becc,0x3f5064af,0x3f33e7bc,0x3f121eb0
.long 0x3f3daef9,0x3f187fc0,0x3edae880,0x3e78cfcc,0x3f04f484,0x3ea395c5,0x3dd53db9,0xbdee3876,0x3e827dc0,0x3c490e90,0xbe6c9a7f,0xbeebcbbb,0xbcfb49ba,0xbe97a117,0xbf0a48ad,0xbf3ebc1b
.long 0xbea09ae5,0xbf13682a,0xbf49d112,0xbf6ed89e,0xbf121eb0,0xbf4cae79,0xbf7294f8,0xbf7ffec4,0xbf47de65,0xbf721352,0xbf7ffb11,0xbf6ff573,0xbf6d1c1d,0xbf7ff4e6,0xbf708066,0xbf40d0da
.long 0x3f80,0xbd493f80,0xbdc93f7f,0xbe163f7d,0x3f80,0x3eac3f71,0x3f223f46,0x3f5c3f04,0x3f80,0x3f2c3f3e,0x3f7f3dc9,0x3f4ebf18,0x3f80,0x3f673edb,0x3f46bf22,0xbe79bf78
.long 0x3f80,0x3f803d49,0x3dc9bf7f,0xbf7dbe16,0x3f80,0x3f71beac,0xbf22bf46,0xbf043f5c,0x3f80,0x3f3ebf2c,0xbf7fbdc9,0x3f183f4e,0x3f80,0x3edbbf67,0xbf463f22,0x3f78be79
.long 0x3f80,0x3d49bf80,0xbdc93f7f,0x3e16bf7d,0x3f80,0xbeacbf71,0x3f223f46,0xbf5cbf04,0x3f80,0xbf2cbf3e,0x3f7f3dc9,0xbf4e3f18,0x3f80,0xbf67bedb,0x3f46bf22,0x3e793f78
.long 0x3f80,0xbf80bd49,0x3dc9bf7f,0x3f7d3e16,0x3f80,0xbf713eac,0xbf22bf46,0x3f04bf5c,0x3f80,0xbf3e3f2c,0xbf7fbdc9,0xbf18bf4e,0x3f80,0xbedb3f67,0xbf463f22,0xbf783e79
.long 0xbe483f7b,0xbe793f78,0xbe953f75,0xbeac3f71,0x3f7b3e48,0x3f7dbe16,0x3f62bef1,0x3f2cbf3e,0x3e48bf7b,0xbf04bf5c,0xbf75be95,0xbf673edb,0xbf7bbe48,0xbf183f4e,0x3ef13f62,0x3f80bd49
.long 0xbe483f7b,0x3f783e79,0x3e95bf75,0xbf71beac,0x3f7b3e48,0xbe16bf7d,0xbf623ef1,0x3f3e3f2c,0x3e48bf7b,0xbf5c3f04,0x3f753e95,0xbedbbf67,0xbf7bbe48,0x3f4e3f18,0xbef1bf62,0x3d493f80
.long 0xbe483f7b,0x3e79bf78,0xbe953f75,0x3eacbf71,0x3f7b3e48,0xbf7d3e16,0x3f62bef1,0xbf2c3f3e,0x3e48bf7b,0x3f043f5c,0xbf75be95,0x3f67bedb,0xbf7bbe48,0x3f18bf4e,0x3ef13f62,0xbf803d49
.long 0xbe483f7b,0xbf78be79,0x3e95bf75,0x3f713eac,0x3f7b3e48,0x3e163f7d,0xbf623ef1,0xbf3ebf2c,0x3e48bf7b,0x3f5cbf04,0x3f753e95,0x3edb3f67,0xbf7bbe48,0xbf4ebf18,0xbef1bf62,0xbd49bf80
.long 0xbec43f6d,0xbedb3f67,0xbef13f62,0xbf043f5c,0x3ec4bf6d,0x3d49bf80,0xbe95bf75,0xbf18bf4e,0xbec43f6d,0x3eac3f71,0x3f623ef1,0x3f78be79,0x3ec4bf6d,0xbf2cbf3e,0xbf753e95,0xbe163f7d
.long 0xbec43f6d,0x3f673edb,0x3ef1bf62,0xbf5cbf04,0x3ec4bf6d,0xbf80bd49,0x3e953f75,0x3f4ebf18,0xbec43f6d,0x3f71beac,0xbf62bef1,0x3e793f78,0x3ec4bf6d,0xbf3e3f2c,0x3f75be95,0xbf7dbe16
.long 0xbec43f6d,0x3edbbf67,0xbef13f62,0x3f04bf5c,0x3ec4bf6d,0xbd493f80,0xbe95bf75,0x3f183f4e,0xbec43f6d,0xbeacbf71,0x3f623ef1,0xbf783e79,0x3ec4bf6d,0x3f2c3f3e,0xbf753e95,0x3e16bf7d
.long 0xbec43f6d,0xbf67bedb,0x3ef1bf62,0x3f5c3f04,0x3ec4bf6d,0x3f803d49,0x3e953f75,0xbf4e3f18,0xbec43f6d,0xbf713eac,0xbf62bef1,0xbe79bf78,0x3ec4bf6d,0x3f3ebf2c,0x3f75be95,0x3f7d3e16
.long 0xbf0e3f55,0xbf183f4e,0xbf223f46,0xbf2c3f3e,0xbf55bf0e,0xbf78be79,0xbf7f3dc9,0xbf673edb,0x3f0ebf55,0xbe16bf7d,0xbf46bf22,0xbf803d49,0x3f553f0e,0x3f5cbf04,0xbdc9bf7f,0xbf71beac
.long 0xbf0e3f55,0x3f4e3f18,0x3f22bf46,0xbf3ebf2c,0xbf55bf0e,0xbe793f78,0x3f7fbdc9,0xbedbbf67,0x3f0ebf55,0xbf7d3e16,0x3f463f22,0xbd49bf80,0x3f553f0e,0xbf04bf5c,0x3dc93f7f,0x3eacbf71
.long 0xbf0e3f55,0x3f18bf4e,0xbf223f46,0x3f2cbf3e,0xbf55bf0e,0x3f783e79,0xbf7f3dc9,0x3f67bedb,0x3f0ebf55,0x3e163f7d,0xbf46bf22,0x3f80bd49,0x3f553f0e,0xbf5c3f04,0xbdc9bf7f,0x3f713eac
.long 0xbf0e3f55,0xbf4ebf18,0x3f22bf46,0x3f3e3f2c,0xbf55bf0e,0x3e79bf78,0x3f7fbdc9,0x3edb3f67,0x3f0ebf55,0x3f7dbe16,0x3f463f22,0x3d493f80,0x3f553f0e,0x3f043f5c,0x3dc93f7f,0xbeac3f71
.long 0x3f808000,0x3f803d49,0x3f7f3dc9,0x3f7d3e16,0x3f808000,0x3f71beac,0x3f46bf22,0x3f04bf5c,0x3f808000,0x3f3ebf2c,0x3dc9bf7f,0xbf18bf4e,0x3f808000,0x3edbbf67,0xbf22bf46,0xbf783e79
.long 0x3f808000,0x3d49bf80,0xbf7fbdc9,0xbe163f7d,0x3f808000,0xbeacbf71,0xbf463f22,0x3f5c3f04,0x3f808000,0xbf2cbf3e,0xbdc93f7f,0x3f4ebf18,0x3f808000,0xbf67bedb,0x3f223f46,0xbe79bf78
.long 0x3f808000,0xbf80bd49,0x3f7f3dc9,0xbf7dbe16,0x3f808000,0xbf713eac,0x3f46bf22,0xbf043f5c,0x3f808000,0xbf3e3f2c,0x3dc9bf7f,0x3f183f4e,0x3f808000,0xbedb3f67,0xbf22bf46,0x3f78be79
.long 0x3f808000,0xbd493f80,0xbf7fbdc9,0x3e16bf7d,0x3f808000,0x3eac3f71,0xbf463f22,0xbf5cbf04,0x3f808000,0x3f2c3f3e,0xbdc93f7f,0xbf4e3f18,0x3f808000,0x3f673edb,0x3f223f46,0x3e793f78
.long 0x3f7b3e48,0x3f783e79,0x3f753e95,0x3f713eac,0x3e48bf7b,0xbe16bf7d,0xbef1bf62,0xbf3ebf2c,0xbf7bbe48,0xbf5c3f04,0xbe953f75,0x3edb3f67,0xbe483f7b,0x3f4e3f18,0x3f62bef1,0xbd49bf80
.long 0x3f7b3e48,0x3e79bf78,0xbf75be95,0xbeac3f71,0x3e48bf7b,0xbf7d3e16,0x3ef13f62,0x3f2cbf3e,0xbf7bbe48,0x3f043f5c,0x3e95bf75,0xbf673edb,0xbe483f7b,0x3f18bf4e,0xbf623ef1,0x3f80bd49
.long 0x3f7b3e48,0xbf78be79,0x3f753e95,0xbf71beac,0x3e48bf7b,0x3e163f7d,0xbef1bf62,0x3f3e3f2c,0xbf7bbe48,0x3f5cbf04,0xbe953f75,0xbedbbf67,0xbe483f7b,0xbf4ebf18,0x3f62bef1,0x3d493f80
.long 0x3f7b3e48,0xbe793f78,0xbf75be95,0x3eacbf71,0x3e48bf7b,0x3f7dbe16,0x3ef13f62,0xbf2c3f3e,0xbf7bbe48,0xbf04bf5c,0x3e95bf75,0x3f67bedb,0xbe483f7b,0xbf183f4e,0xbf623ef1,0xbf803d49
.long 0x3f6d3ec4,0x3f673edb,0x3f623ef1,0x3f5c3f04,0xbf6dbec4,0xbf80bd49,0xbf753e95,0xbf4e3f18,0x3f6d3ec4,0x3f71beac,0x3ef1bf62,0xbe79bf78,0xbf6dbec4,0xbf3e3f2c,0x3e953f75,0x3f7d3e16
.long 0x3f6d3ec4,0x3edbbf67,0xbf62bef1,0xbf043f5c,0xbf6dbec4,0xbd493f80,0x3f75be95,0xbf18bf4e,0x3f6d3ec4,0xbeacbf71,0xbef13f62,0x3f78be79,0xbf6dbec4,0x3f2c3f3e,0xbe95bf75,0xbe163f7d
.long 0x3f6d3ec4,0xbf67bedb,0x3f623ef1,0xbf5cbf04,0xbf6dbec4,0x3f803d49,0xbf753e95,0x3f4ebf18,0x3f6d3ec4,0xbf713eac,0x3ef1bf62,0x3e793f78,0xbf6dbec4,0x3f3ebf2c,0x3e953f75,0xbf7dbe16
.long 0x3f6d3ec4,0xbedb3f67,0xbf62bef1,0x3f04bf5c,0xbf6dbec4,0x3d49bf80,0x3f75be95,0x3f183f4e,0x3f6d3ec4,0x3eac3f71,0xbef13f62,0xbf783e79,0xbf6dbec4,0xbf2cbf3e,0xbe95bf75,0x3e16bf7d
.long 0x3f553f0e,0x3f4e3f18,0x3f463f22,0x3f3e3f2c,0xbf0e3f55,0xbe793f78,0x3dc93f7f,0x3edb3f67,0xbf55bf0e,0xbf7d3e16,0xbf223f46,0x3d493f80,0x3f0ebf55,0xbf04bf5c,0xbf7f3dc9,0xbeac3f71
.long 0x3f553f0e,0x3f18bf4e,0xbf46bf22,0xbf2c3f3e,0xbf0e3f55,0x3f783e79,0xbdc9bf7f,0xbf673edb,0xbf55bf0e,0x3e163f7d,0x3f22bf46,0xbf803d49,0x3f0ebf55,0xbf5c3f04,0x3f7fbdc9,0xbf71beac
.long 0x3f553f0e,0xbf4ebf18,0x3f463f22,0xbf3ebf2c,0xbf0e3f55,0x3e79bf78,0x3dc93f7f,0xbedbbf67,0xbf55bf0e,0x3f7dbe16,0xbf223f46,0xbd49bf80,0x3f0ebf55,0x3f043f5c,0xbf7f3dc9,0x3eacbf71
.long 0x3f553f0e,0xbf183f4e,0xbf46bf22,0x3f2cbf3e,0xbf0e3f55,0xbf78be79,0xbdc9bf7f,0x3f67bedb,0xbf55bf0e,0xbe16bf7d,0x3f22bf46,0x3f80bd49,0x3f0ebf55,0x3f5cbf04,0x3f7fbdc9,0x3f713eac
.long 0x80003f80,0x80003f80,0x80003f80,0x80003f80,0x3d493f80,0xbeac3f71,0xbf2c3f3e,0xbf673edb,0x3dc93f7f,0xbf223f46,0xbf7f3dc9,0xbf46bf22,0x3e163f7d,0xbf5c3f04,0xbf4ebf18,0x3e79bf78
.long 0x3e483f7b,0xbf7b3e48,0xbe48bf7b,0x3f7bbe48,0x3e793f78,0xbf7dbe16,0x3f04bf5c,0x3f183f4e,0x3e953f75,0xbf62bef1,0x3f75be95,0xbef13f62,0x3eac3f71,0xbf2cbf3e,0x3f673edb,0xbf80bd49
.long 0x3ec43f6d,0xbec4bf6d,0x3ec43f6d,0xbec4bf6d,0x3edb3f67,0xbd49bf80,0xbeac3f71,0x3f2cbf3e,0x3ef13f62,0x3e95bf75,0xbf623ef1,0x3f753e95,0x3f043f5c,0x3f18bf4e,0xbf78be79,0x3e163f7d
.long 0x3f0e3f55,0x3f55bf0e,0xbf0ebf55,0xbf553f0e,0x3f183f4e,0x3f78be79,0x3e16bf7d,0xbf5cbf04,0x3f223f46,0x3f7f3dc9,0x3f46bf22,0x3dc9bf7f,0x3f2c3f3e,0x3f673edb,0x3f803d49,0x3f71beac
.long 0x80003f80,0x80003f80,0x80003f80,0x80003f80,0xbf803d49,0xbf71beac,0xbf3ebf2c,0xbedbbf67,0xbdc9bf7f,0x3f22bf46,0x3f7fbdc9,0x3f463f22,0x3f7dbe16,0x3f043f5c,0xbf183f4e,0xbf78be79
.long 0x3e483f7b,0xbf7b3e48,0xbe48bf7b,0x3f7bbe48,0xbf783e79,0x3e16bf7d,0x3f5c3f04,0xbf4e3f18,0xbe95bf75,0x3f623ef1,0xbf753e95,0x3ef1bf62,0x3f71beac,0xbf3e3f2c,0x3edbbf67,0xbd493f80
.long 0x3ec43f6d,0xbec4bf6d,0x3ec43f6d,0xbec4bf6d,0xbf673edb,0x3f80bd49,0xbf71beac,0x3f3e3f2c,0xbef1bf62,0xbe953f75,0x3f62bef1,0xbf75be95,0x3f5cbf04,0xbf4ebf18,0xbe793f78,0x3f7dbe16
.long 0x3f0e3f55,0x3f55bf0e,0xbf0ebf55,0xbf553f0e,0xbf4e3f18,0x3e793f78,0x3f7d3e16,0x3f04bf5c,0xbf22bf46,0xbf7fbdc9,0xbf463f22,0xbdc93f7f,0x3f3ebf2c,0x3edbbf67,0x3d49bf80,0xbeacbf71
.long 0x80003f80,0x80003f80,0x80003f80,0x80003f80,0xbd49bf80,0x3eacbf71,0x3f2cbf3e,0x3f67bedb,0x3dc93f7f,0xbf223f46,0xbf7f3dc9,0xbf46bf22,0xbe16bf7d,0x3f5cbf04,0x3f4e3f18,0xbe793f78
.long 0x3e483f7b,0xbf7b3e48,0xbe48bf7b,0x3f7bbe48,0xbe79bf78,0x3f7d3e16,0xbf043f5c,0xbf18bf4e,0x3e953f75,0xbf62bef1,0x3f75be95,0xbef13f62,0xbeacbf71,0x3f2c3f3e,0xbf67bedb,0x3f803d49
.long 0x3ec43f6d,0xbec4bf6d,0x3ec43f6d,0xbec4bf6d,0xbedbbf67,0x3d493f80,0x3eacbf71,0xbf2c3f3e,0x3ef13f62,0x3e95bf75,0xbf623ef1,0x3f753e95,0xbf04bf5c,0xbf183f4e,0x3f783e79,0xbe16bf7d
.long 0x3f0e3f55,0x3f55bf0e,0xbf0ebf55,0xbf553f0e,0xbf18bf4e,0xbf783e79,0xbe163f7d,0x3f5c3f04,0x3f223f46,0x3f7f3dc9,0x3f46bf22,0x3dc9bf7f,0xbf2cbf3e,0xbf67bedb,0xbf80bd49,0xbf713eac
.long 0x80003f80,0x80003f80,0x80003f80,0x80003f80,0x3f80bd49,0x3f713eac,0x3f3e3f2c,0x3edb3f67,0xbdc9bf7f,0x3f22bf46,0x3f7fbdc9,0x3f463f22,0xbf7d3e16,0xbf04bf5c,0x3f18bf4e,0x3f783e79
.long 0x3e483f7b,0xbf7b3e48,0xbe48bf7b,0x3f7bbe48,0x3f78be79,0xbe163f7d,0xbf5cbf04,0x3f4ebf18,0xbe95bf75,0x3f623ef1,0xbf753e95,0x3ef1bf62,0xbf713eac,0x3f3ebf2c,0xbedb3f67,0x3d49bf80
.long 0x3ec43f6d,0xbec4bf6d,0x3ec43f6d,0xbec4bf6d,0x3f67bedb,0xbf803d49,0x3f713eac,0xbf3ebf2c,0xbef1bf62,0xbe953f75,0x3f62bef1,0xbf75be95,0xbf5c3f04,0x3f4e3f18,0x3e79bf78,0xbf7d3e16
.long 0x3f0e3f55,0x3f55bf0e,0xbf0ebf55,0xbf553f0e,0x3f4ebf18,0xbe79bf78,0xbf7dbe16,0xbf043f5c,0xbf22bf46,0xbf7fbdc9,0xbf463f22,0xbdc93f7f,0xbf3e3f2c,0xbedb3f67,0xbd493f80,0x3eac3f71
.long 0x3f800000,0x3f800000,0x3f800000,0x3f800000,0x3f80bd49,0x3f713eac,0x3f3e3f2c,0x3edb3f67,0x3f7fbdc9,0x3f463f22,0x3dc93f7f,0xbf223f46,0x3f7dbe16,0x3f043f5c,0xbf183f4e,0xbf78be79
.long 0x3f7bbe48,0x3e483f7b,0xbf7b3e48,0xbe48bf7b,0x3f78be79,0xbe163f7d,0xbf5cbf04,0x3f4ebf18,0x3f75be95,0xbef13f62,0xbe95bf75,0x3f623ef1,0x3f71beac,0xbf3e3f2c,0x3edbbf67,0xbd493f80
.long 0x3f6dbec4,0xbf6d3ec4,0x3f6dbec4,0xbf6d3ec4,0x3f67bedb,0xbf803d49,0x3f713eac,0xbf3ebf2c,0x3f62bef1,0xbf75be95,0x3ef13f62,0x3e95bf75,0x3f5cbf04,0xbf4ebf18,0xbe793f78,0x3f7dbe16
.long 0x3f55bf0e,0xbf0ebf55,0xbf553f0e,0x3f0e3f55,0x3f4ebf18,0xbe79bf78,0xbf7dbe16,0xbf043f5c,0x3f46bf22,0x3dc9bf7f,0xbf22bf46,0xbf7fbdc9,0x3f3ebf2c,0x3edbbf67,0x3d49bf80,0xbeacbf71
.long 0x3f800000,0x3f800000,0x3f800000,0x3f800000,0x3d493f80,0xbeac3f71,0xbf2c3f3e,0xbf673edb,0xbf7f3dc9,0xbf46bf22,0xbdc9bf7f,0x3f22bf46,0xbe16bf7d,0x3f5cbf04,0x3f4e3f18,0xbe793f78
.long 0x3f7bbe48,0x3e483f7b,0xbf7b3e48,0xbe48bf7b,0x3e793f78,0xbf7dbe16,0x3f04bf5c,0x3f183f4e,0xbf753e95,0x3ef1bf62,0x3e953f75,0xbf62bef1,0xbeacbf71,0x3f2c3f3e,0xbf67bedb,0x3f803d49
.long 0x3f6dbec4,0xbf6d3ec4,0x3f6dbec4,0xbf6d3ec4,0x3edb3f67,0xbd49bf80,0xbeac3f71,0x3f2cbf3e,0xbf623ef1,0x3f753e95,0xbef1bf62,0xbe953f75,0xbf04bf5c,0xbf183f4e,0x3f783e79,0xbe16bf7d
.long 0x3f55bf0e,0xbf0ebf55,0xbf553f0e,0x3f0e3f55,0x3f183f4e,0x3f78be79,0x3e16bf7d,0xbf5cbf04,0xbf463f22,0xbdc93f7f,0x3f223f46,0x3f7f3dc9,0xbf2cbf3e,0xbf67bedb,0xbf80bd49,0xbf713eac
.long 0x3f800000,0x3f800000,0x3f800000,0x3f800000,0xbf803d49,0xbf71beac,0xbf3ebf2c,0xbedbbf67,0x3f7fbdc9,0x3f463f22,0x3dc93f7f,0xbf223f46,0xbf7d3e16,0xbf04bf5c,0x3f18bf4e,0x3f783e79
.long 0x3f7bbe48,0x3e483f7b,0xbf7b3e48,0xbe48bf7b,0xbf783e79,0x3e16bf7d,0x3f5c3f04,0xbf4e3f18,0x3f75be95,0xbef13f62,0xbe95bf75,0x3f623ef1,0xbf713eac,0x3f3ebf2c,0xbedb3f67,0x3d49bf80
.long 0x3f6dbec4,0xbf6d3ec4,0x3f6dbec4,0xbf6d3ec4,0xbf673edb,0x3f80bd49,0xbf71beac,0x3f3e3f2c,0x3f62bef1,0xbf75be95,0x3ef13f62,0x3e95bf75,0xbf5c3f04,0x3f4e3f18,0x3e79bf78,0xbf7d3e16
.long 0x3f55bf0e,0xbf0ebf55,0xbf553f0e,0x3f0e3f55,0xbf4e3f18,0x3e793f78,0x3f7d3e16,0x3f04bf5c,0x3f46bf22,0x3dc9bf7f,0xbf22bf46,0xbf7fbdc9,0xbf3e3f2c,0xbedb3f67,0xbd493f80,0x3eac3f71
.long 0x3f800000,0x3f800000,0x3f800000,0x3f800000,0xbd49bf80,0x3eacbf71,0x3f2cbf3e,0x3f67bedb,0xbf7f3dc9,0xbf46bf22,0xbdc9bf7f,0x3f22bf46,0x3e163f7d,0xbf5c3f04,0xbf4ebf18,0x3e79bf78
.long 0x3f7bbe48,0x3e483f7b,0xbf7b3e48,0xbe48bf7b,0xbe79bf78,0x3f7d3e16,0xbf043f5c,0xbf18bf4e,0xbf753e95,0x3ef1bf62,0x3e953f75,0xbf62bef1,0x3eac3f71,0xbf2cbf3e,0x3f673edb,0xbf80bd49
.long 0x3f6dbec4,0xbf6d3ec4,0x3f6dbec4,0xbf6d3ec4,0xbedbbf67,0x3d493f80,0x3eacbf71,0xbf2c3f3e,0xbf623ef1,0x3f753e95,0xbef1bf62,0xbe953f75,0x3f043f5c,0x3f18bf4e,0xbf78be79,0x3e163f7d
.long 0x3f55bf0e,0xbf0ebf55,0xbf553f0e,0x3f0e3f55,0xbf18bf4e,0xbf783e79,0xbe163f7d,0x3f5c3f04,0xbf463f22,0xbdc93f7f,0x3f223f46,0x3f7f3dc9,0x3f2c3f3e,0x3f673edb,0x3f803d49,0x3f71beac
.long 0x3f800000,0x3f7fffb1,0x3f7ffec4,0x3f7ffd39,0x3f800000,0x3f7ff0e3,0x3f7fc38f,0x3f7f7808,0x3f800000,0x3f7fba9e,0x3f7eea9d,0x3f7d906e,0x3f800000,0x3f7f5ce9,0x3f7d7474,0x3f7a4910
.long 0x3f800000,0x3f7ed7d4,0x3f7b61fc,0x3f75a67b,0x3f800000,0x3f7e2b72,0x3f78b47b,0x3f6faf1b,0x3f800000,0x3f7d57de,0x3f756d97,0x3f686b39,0x3f800000,0x3f7c5d3a,0x3f718f57,0x3f5fe4e9
.long 0x3f800000,0x3f7b3bab,0x3f6d1c1d,0x3f5627fe,0x3f800000,0x3f79f35e,0x3f6816a8,0x3f4b41fa,0x3f800000,0x3f788486,0x3f628210,0x3f3f41fc,0x3f800000,0x3f76ef5b,0x3f5c61c7,0x3f3238aa
.long 0x3f800000,0x3f75341d,0x3f55b993,0x3f24381a,0x3f800000,0x3f73530e,0x3f4e8d90,0x3f1553b7,0x3f800000,0x3f714c7a,0x3f46e22a,0x3f05a02c,0x3f800000,0x3f6f20b0,0x3f3ebc1b,0x3eea6681
.long 0x3f7ffb11,0x3f7ff84a,0x3f7ff4e6,0x3f7ff0e3,0x3f7f0e58,0x3f7e868b,0x3f7de0b1,0x3f7d1cdd,0x3f7baccd,0x3f7940c0,0x3f764d97,0x3f72d4eb,0x3f75dec6,0x3f703b37,0x3f696591,0x3f61668a
.long 0x3f6db293,0x3f6398ac,0x3f577026,0x3f495521,0x3f633c5a,0x3f5389c7,0x3f40d0da,0x3f2b561b,0x3f5695e5,0x3f404c5c,0x3f26050a,0x3f084b92,0x3f47de65,0x3f2a2a80,0x3f07a136,0x3ec27b55
.long 0x3f373a23,0x3f11796b,0x3ecc9b8b,0x3e5d4b1a,0x3f24d225,0x3eed3063,0x3e8586ce,0x3d3c6dd5,0x3f10d3cd,0x3eb3dca5,0x3dee3876,0xbe007745,0x3ef6e0cb,0x3e6fa8b2,0xbcfb49ba,0xbe9620d2
.long 0x3ec9b953,0x3de7fa9a,0xbe354098,0xbee79a5d,0x3e9aa086,0xbc16cb58,0xbea395c5,0xbf19210f,0x3e541501,0xbe06b26e,0xbee900b7,0xbf39f2ac,0x3de1bc2e,0xbe80f8c0,0xbf14b039,0xbf554aa4
.long 0x3f7fec43,0x3f7fe705,0x3f7fe129,0x3f7fdaaf,0x3f7c3b28,0x3f7b3bab,0x3f7a1e84,0x3f78e3d6,0x3f6ed89e,0x3f6a5ad9,0x3f655e0b,0x3f5fe4e9,0x3f584853,0x3f4e1689,0x3f42de29,0x3f36ad7f
.long 0x3f396842,0x3f27ce61,0x3f14b039,0x3f003a06,0x3f13682a,0x3ef2bd43,0x3ebb31a0,0x3e80f8c0,0x3ecf7bca,0x3e8a11f7,0x3e039502,0xbc7b514b,0x3e605c13,0x3d55880e,0xbdee3876,0xbe901c2c
.long 0x3cc90ab0,0xbe2bf804,0xbeb554ec,0xbf06f686,0xbe2f10a2,0xbec27b55,0xbf121eb0,0xbf3c17d9,0xbeb8442a,0xbf12c39a,0xbf40d0da,0xbf6398ac,0xbf08f59b,0xbf3d27b8,0xbf63f473,0xbf7a9c59
.long 0xbf3085bb,0xbf5e5aa6,0xbf796e4e,0xbf7f7808,0xbf514d3d,0xbf74bf62,0xbf7ff4e6,0xbf71d19f,0xbf6a09a7,0xbf7f3f54,0xbf772417,0xbf52a649,0xbf79c79d,0xbf7d57de,0xbf5f8327,0xbf24381a
.long 0x3f7fd397,0x3f7fcbe2,0x3f7fc38f,0x3f7fba9e,0x3f778bc5,0x3f76167a,0x3f748422,0x3f72d4eb,0x3f59f26a,0x3f5389c7,0x3f4cae79,0x3f456439,0x3f299415,0x3f1ba299,0x3f0cead0,0x3efafef7
.long 0x3ed53641,0x3ea80b1f,0x3e72b651,0x3e1324ca,0x3e09cf86,0x3c7b514b,0xbdd53db9,0xbe636c83,0xbe22abb6,0xbe9920fe,0xbeddbe79,0xbf0ee0db,0xbee0924f,0xbf1553b7,0xbf36206c,0xbf51c0c2
.long 0xbf2e3bde,0xbf4f0417,0xbf6816a8,0xbf788486,0xbf5d2d53,0xbf73ced9,0xbf7eea9d,0xbf7dfa38,0xbf791298,0xbf7ffd39,0xbf77f110,0xbf61668a,0xbf7f84ab,0xbf725470,0xbf53fac3,0xbf269de3
.long 0xbf6ff573,0xbf4c3578,0xbf173c07,0xbeab0201,0xbf4bbbf8,0xbf11796b,0xbe919ddd,0x3ce22a7a,0xbf15f6d9,0xbe901c2c,0x3d621469,0x3ec5625c,0xbea68f12,0x3d0a342f,0x3ec6d529,0x3f311722
.long 0x0,0xbb490fc6,0xbbc90f88,0xbc16cb58,0x0,0x3cafea69,0x3d2fe007,0x3d83db0a,0x0,0x3d3c6dd5,0x3dbc3ac3,0x3e0cec4a,0x0,0x3d9064b4,0x3e1008b7,0x3e57278f
.long 0x0,0x3dc27c39,0x3e419b37,0x3e901c2c,0x0,0x3df475c0,0x3e72b651,0x3eb3dca5,0x0,0x3e1324ca,0x3e919ddd,0x3ed6a399,0x0,0x3e2bf804,0x3ea986c4,0x3ef840c8
.long 0x0,0x3e44b0b9,0x3ec1071e,0x3f0c42c9,0x0,0x3e5d4b1a,0x3ed8106b,0x3f1ba299,0x0,0x3e75c35a,0x3eee9479,0x3f2a2a80,0x0,0x3e870ada,0x3f0242b1,0x3f37c655
.long 0x0,0x3e931f35,0x3f0cead0,0x3f446337,0x0,0x3e9f1cdf,0x3f173c07,0x3f4fefa8,0x0,0x3eab0201,0x3f212ff9,0x3f5a5ba0,0x0,0x3eb6ccc3,0x3f2ac082,0x3f6398ac
.long 0xbc490e90,0xbc7b514b,0xbc96c9b6,0xbcafea69,0x3dafb680,0x3ddb7d37,0x3e039502,0x3e195be0,0x3e3b6ecf,0x3e698bba,0x3e8b9507,0x3ea21887,0x3e8e9a22,0x3eb0eacb,0x3ed25a09,0x3ef2bd43
.long 0x3ebe1d4a,0x3eea6681,0x3f0a48ad,0x3f1e1e22,0x3eebcbbb,0x3f102dd5,0x3f286605,0x3f3e35c5,0x3f0b9a6b,0x3f28fd41,0x3f42de29,0x3f58b3a1,0x3f1ff6cb,0x3f3f41fc,0x3f591e6a,0x3f6cd007
.long 0x3f32c8c9,0x3f52a649,0x3f6aab7b,0x3f79f35e,0x3f43e200,0x3f62df7b,0x3f772417,0x3f7fba9e,0x3f531849,0x3f6faf1b,0x3f7e4323,0x3f7dfa38,0x3f604621,0x3f78e3d6,0x3f7fe129,0x3f74bf62
.long 0x3f6b4b0c,0x3f7e5a38,0x3f7bf531,0x3f644fac,0x3f740bdd,0x3f7ffd39,0x3f7294f8,0x3f4d26fd,0x3f7a7302,0x3f7dc68c,0x3f63f473,0x3f2ff3e6,0x3f7e70b0,0x3f77beb7,0x3f5064af,0x3f0d9281
.long 0xbcc90ab0,0xbce22a7a,0xbcfb49ba,0xbd0a342f,0x3e2f10a2,0x3e44b0b9,0x3e5a3997,0x3e6fa8b2,0x3eb8442a,0x3ece0bea,0x3ee363fa,0x3ef840c8,0x3f08f59b,0x3f17de12,0x3f26050a,0x3f33587a
.long 0x3f3085bb,0x3f4154e1,0x3f5064af,0x3f5d924d,0x3f514d3d,0x3f61668a,0x3f6e46be,0x3f77beb7,0x3f6a09a7,0x3f76841b,0x3f7de0b1,0x3f7ff84a,0x3f79c79d,0x3f7fa6e3,0x3f7e4323,0x3f75a67b
.long 0x3f7fec43,0x3f7c5d3a,0x3f6f6830,0x3f5988ad,0x3f7c3b28,0x3f6cd007,0x3f5233c6,0x3f2da859,0x3f6ed89e,0x3f51c0c2,0x3f286605,0x3eea6681,0x3f584853,0x3f2c800f,0x3ee900b7,0x3e5101f1
.long 0x3f396842,0x3efdbabb,0x3e667c66,0xbd83db0a,0x3f13682a,0x3e9620d2,0xbc96c9b6,0xbea80b1f,0x3ecf7bca,0x3d9cecf9,0xbe8586ce,0xbf11796b,0x3e605c13,0xbe1324ca,0xbef9a02d,0xbf446337
.long 0xbd16c32c,0xbd2351cb,0xbd2fe007,0xbd3c6dd5,0x3e827dc0,0x3e8d17c0,0x3e97a117,0x3ea21887,0x3f064b82,0x3f102dd5,0x3f19c200,0x3f2302d3,0x3f3fc767,0x3f4b41fa,0x3f55b993,0x3f5f20db
.long 0x3f68bf3c,0x3f71d19f,0x3f78b47b,0x3f7d57de,0x3f7dabcc,0x3f7ff84a,0x3f7e9bc9,0x3f799b43,0x3f7cbfc9,0x3f74484b,0x3f66becc,0x3f546b3b,0x3f660f88,0x3f4fefa8,0x3f33e7bc,0x3f12c39a
.long 0x3f3b8f3b,0x3f16999f,0x3ed8106b,0x3e75c35a,0x3f00e7e4,0x3e9c1faf,0x3dbc3ac3,0xbe007745,0x3e6c9a7f,0xbc16cb58,0xbe7ee6e1,0xbef2bd43,0xbd7b2b74,0xbea5129f,0xbf0f8784,0xbf425b89
.long 0xbeb263ef,0xbf1a6293,0xbf4e8d90,0xbf714c7a,0xbf1b02c6,0xbf52a649,0xbf756d97,0xbf7fe705,0xbf4f7a1f,0xbf75a67b,0xbf7f9c18,0xbf6c3624,0xbf721352,0xbf7fdaaf,0xbf6be858,0xbf38dd65
.long 0x3f800000,0x3f800000,0x3f800000,0x3f800000,0x3f7fffb1,0x3f7ff0e3,0x3f7fba9e,0x3f7f5ce9,0x3f7ffec4,0x3f7fc38f,0x3f7eea9d,0x3f7d7474,0x3f7ffd39,0x3f7f7808,0x3f7d906e,0x3f7a4910
.long 0x3f7ffb11,0x3f7f0e58,0x3f7baccd,0x3f75dec6,0x3f7ff84a,0x3f7e868b,0x3f7940c0,0x3f703b37,0x3f7ff4e6,0x3f7de0b1,0x3f764d97,0x3f696591,0x3f7ff0e3,0x3f7d1cdd,0x3f72d4eb,0x3f61668a
.long 0x3f7fec43,0x3f7c3b28,0x3f6ed89e,0x3f584853,0x3f7fe705,0x3f7b3bab,0x3f6a5ad9,0x3f4e1689,0x3f7fe129,0x3f7a1e84,0x3f655e0b,0x3f42de29,0x3f7fdaaf,0x3f78e3d6,0x3f5fe4e9,0x3f36ad7f
.long 0x3f7fd397,0x3f778bc5,0x3f59f26a,0x3f299415,0x3f7fcbe2,0x3f76167a,0x3f5389c7,0x3f1ba299,0x3f7fc38f,0x3f748422,0x3f4cae79,0x3f0cead0,0x3f7fba9e,0x3f72d4eb,0x3f456439,0x3efafef7
.long 0x3f800000,0x3f800000,0x3f800000,0x3f800000,0x3f7ed7d4,0x3f7e2b72,0x3f7d57de,0x3f7c5d3a,0x3f7b61fc,0x3f78b47b,0x3f756d97,0x3f718f57,0x3f75a67b,0x3f6faf1b,0x3f686b39,0x3f5fe4e9
.long 0x3f6db293,0x3f633c5a,0x3f5695e5,0x3f47de65,0x3f6398ac,0x3f5389c7,0x3f404c5c,0x3f2a2a80,0x3f577026,0x3f40d0da,0x3f26050a,0x3f07a136,0x3f495521,0x3f2b561b,0x3f084b92,0x3ec27b55
.long 0x3f396842,0x3f13682a,0x3ecf7bca,0x3e605c13,0x3f27ce61,0x3ef2bd43,0x3e8a11f7,0x3d55880e,0x3f14b039,0x3ebb31a0,0x3e039502,0xbdee3876,0x3f003a06,0x3e80f8c0,0xbc7b514b,0xbe901c2c
.long 0x3ed53641,0x3e09cf86,0xbe22abb6,0xbee0924f,0x3ea80b1f,0x3c7b514b,0xbe9920fe,0xbf1553b7,0x3e72b651,0xbdd53db9,0xbeddbe79,0xbf36206c,0x3e1324ca,0xbe636c83,0xbf0ee0db,0xbf51c0c2
.long 0x3f800000,0x3f800000,0x3f800000,0x3f800000,0x3f7b3bab,0x3f79f35e,0x3f788486,0x3f76ef5b,0x3f6d1c1d,0x3f6816a8,0x3f628210,0x3f5c61c7,0x3f5627fe,0x3f4b41fa,0x3f3f41fc,0x3f3238aa
.long 0x3f373a23,0x3f24d225,0x3f10d3cd,0x3ef6e0cb,0x3f11796b,0x3eed3063,0x3eb3dca5,0x3e6fa8b2,0x3ecc9b8b,0x3e8586ce,0x3dee3876,0xbcfb49ba,0x3e5d4b1a,0x3d3c6dd5,0xbe007745,0xbe9620d2
.long 0x3cc90ab0,0xbe2f10a2,0xbeb8442a,0xbf08f59b,0xbe2bf804,0xbec27b55,0xbf12c39a,0xbf3d27b8,0xbeb554ec,0xbf121eb0,0xbf40d0da,0xbf63f473,0xbf06f686,0xbf3c17d9,0xbf6398ac,0xbf7a9c59
.long 0xbf2e3bde,0xbf5d2d53,0xbf791298,0xbf7f84ab,0xbf4f0417,0xbf73ced9,0xbf7ffd39,0xbf725470,0xbf6816a8,0xbf7eea9d,0xbf77f110,0xbf53fac3,0xbf788486,0xbf7dfa38,0xbf61668a,0xbf269de3
.long 0x3f800000,0x3f800000,0x3f800000,0x3f800000,0x3f75341d,0x3f73530e,0x3f714c7a,0x3f6f20b0,0x3f55b993,0x3f4e8d90,0x3f46e22a,0x3f3ebc1b,0x3f24381a,0x3f1553b7,0x3f05a02c,0x3eea6681
.long 0x3ec9b953,0x3e9aa086,0x3e541501,0x3de1bc2e,0x3de7fa9a,0xbc16cb58,0xbe06b26e,0xbe80f8c0,0xbe354098,0xbea395c5,0xbee900b7,0xbf14b039,0xbee79a5d,0xbf19210f,0xbf39f2ac,0xbf554aa4
.long 0xbf3085bb,0xbf514d3d,0xbf6a09a7,0xbf79c79d,0xbf5e5aa6,0xbf74bf62,0xbf7f3f54,0xbf7d57de,0xbf796e4e,0xbf7ff4e6,0xbf772417,0xbf5f8327,0xbf7f7808,0xbf71d19f,0xbf52a649,0xbf24381a
.long 0xbf6ff573,0xbf4bbbf8,0xbf15f6d9,0xbea68f12,0xbf4c3578,0xbf11796b,0xbe901c2c,0x3d0a342f,0xbf173c07,0xbe919ddd,0x3d621469,0x3ec6d529,0xbeab0201,0x3ce22a7a,0x3ec5625c,0x3f311722
.long 0x0,0x0,0x0,0x0,0xbb490fc6,0x3cafea69,0x3d3c6dd5,0x3d9064b4,0xbbc90f88,0x3d2fe007,0x3dbc3ac3,0x3e1008b7,0xbc16cb58,0x3d83db0a,0x3e0cec4a,0x3e57278f
.long 0xbc490e90,0x3dafb680,0x3e3b6ecf,0x3e8e9a22,0xbc7b514b,0x3ddb7d37,0x3e698bba,0x3eb0eacb,0xbc96c9b6,0x3e039502,0x3e8b9507,0x3ed25a09,0xbcafea69,0x3e195be0,0x3ea21887,0x3ef2bd43
.long 0xbcc90ab0,0x3e2f10a2,0x3eb8442a,0x3f08f59b,0xbce22a7a,0x3e44b0b9,0x3ece0bea,0x3f17de12,0xbcfb49ba,0x3e5a3997,0x3ee363fa,0x3f26050a,0xbd0a342f,0x3e6fa8b2,0x3ef840c8,0x3f33587a
.long 0xbd16c32c,0x3e827dc0,0x3f064b82,0x3f3fc767,0xbd2351cb,0x3e8d17c0,0x3f102dd5,0x3f4b41fa,0xbd2fe007,0x3e97a117,0x3f19c200,0x3f55b993,0xbd3c6dd5,0x3ea21887,0x3f2302d3,0x3f5f20db
.long 0x0,0x0,0x0,0x0,0x3dc27c39,0x3df475c0,0x3e1324ca,0x3e2bf804,0x3e419b37,0x3e72b651,0x3e919ddd,0x3ea986c4,0x3e901c2c,0x3eb3dca5,0x3ed6a399,0x3ef840c8
.long 0x3ebe1d4a,0x3eebcbbb,0x3f0b9a6b,0x3f1ff6cb,0x3eea6681,0x3f102dd5,0x3f28fd41,0x3f3f41fc,0x3f0a48ad,0x3f286605,0x3f42de29,0x3f591e6a,0x3f1e1e22,0x3f3e35c5,0x3f58b3a1,0x3f6cd007
.long 0x3f3085bb,0x3f514d3d,0x3f6a09a7,0x3f79c79d,0x3f4154e1,0x3f61668a,0x3f76841b,0x3f7fa6e3,0x3f5064af,0x3f6e46be,0x3f7de0b1,0x3f7e4323,0x3f5d924d,0x3f77beb7,0x3f7ff84a,0x3f75a67b
.long 0x3f68bf3c,0x3f7dabcc,0x3f7cbfc9,0x3f660f88,0x3f71d19f,0x3f7ff84a,0x3f74484b,0x3f4fefa8,0x3f78b47b,0x3f7e9bc9,0x3f66becc,0x3f33e7bc,0x3f7d57de,0x3f799b43,0x3f546b3b,0x3f12c39a
.long 0x0,0x0,0x0,0x0,0x3e44b0b9,0x3e5d4b1a,0x3e75c35a,0x3e870ada,0x3ec1071e,0x3ed8106b,0x3eee9479,0x3f0242b1,0x3f0c42c9,0x3f1ba299,0x3f2a2a80,0x3f37c655
.long 0x3f32c8c9,0x3f43e200,0x3f531849,0x3f604621,0x3f52a649,0x3f62df7b,0x3f6faf1b,0x3f78e3d6,0x3f6aab7b,0x3f772417,0x3f7e4323,0x3f7fe129,0x3f79f35e,0x3f7fba9e,0x3f7dfa38,0x3f74bf62
.long 0x3f7fec43,0x3f7c3b28,0x3f6ed89e,0x3f584853,0x3f7c5d3a,0x3f6cd007,0x3f51c0c2,0x3f2c800f,0x3f6f6830,0x3f5233c6,0x3f286605,0x3ee900b7,0x3f5988ad,0x3f2da859,0x3eea6681,0x3e5101f1
.long 0x3f3b8f3b,0x3f00e7e4,0x3e6c9a7f,0xbd7b2b74,0x3f16999f,0x3e9c1faf,0xbc16cb58,0xbea5129f,0x3ed8106b,0x3dbc3ac3,0xbe7ee6e1,0xbf0f8784,0x3e75c35a,0xbe007745,0xbef2bd43,0xbf425b89
.long 0x0,0x0,0x0,0x0,0x3e931f35,0x3e9f1cdf,0x3eab0201,0x3eb6ccc3,0x3f0cead0,0x3f173c07,0x3f212ff9,0x3f2ac082,0x3f446337,0x3f4fefa8,0x3f5a5ba0,0x3f6398ac
.long 0x3f6b4b0c,0x3f740bdd,0x3f7a7302,0x3f7e70b0,0x3f7e5a38,0x3f7ffd39,0x3f7dc68c,0x3f77beb7,0x3f7bf531,0x3f7294f8,0x3f63f473,0x3f5064af,0x3f644fac,0x3f4d26fd,0x3f2ff3e6,0x3f0d9281
.long 0x3f396842,0x3f13682a,0x3ecf7bca,0x3e605c13,0x3efdbabb,0x3e9620d2,0x3d9cecf9,0xbe1324ca,0x3e667c66,0xbc96c9b6,0xbe8586ce,0xbef9a02d,0xbd83db0a,0xbea80b1f,0xbf11796b,0xbf446337
.long 0xbeb263ef,0xbf1b02c6,0xbf4f7a1f,0xbf721352,0xbf1a6293,0xbf52a649,0xbf75a67b,0xbf7fdaaf,0xbf4e8d90,0xbf756d97,0xbf7f9c18,0xbf6be858,0xbf714c7a,0xbf7fe705,0xbf6c3624,0xbf38dd65
Lend_tab:
.size Ltab, 108544
.section .rodata,"a"
.p2align 6
.amdhsa_kernel gated_mix__ssm_conv_s4d__spectral_gfnet__prompt_kernel
  .amdhsa_next_free_vgpr 256
  .amdhsa_next_free_sgpr 102
  .amdhsa_accum_offset 256
  .amdhsa_group_segment_fixed_size 0
  .amdhsa_kernarg_size 112
  .amdhsa_user_sgpr_count 2
  .amdhsa_user_sgpr_kernarg_segment_ptr 1
  .amdhsa_system_sgpr_workgroup_id_x 1
.end_amdhsa_kernel
```
